```python
import torch

def _softmax(x, axis=-1):
    return torch.softmax(x, dim=axis)
def _gelu(x):
    return torch.nn.functional.gelu(x, approximate="tanh")
def _silu(x):
    return torch.nn.functional.silu(x)
def _sigmoid(x):
    return torch.sigmoid(x)
def _layernorm(x, axis=-1, eps=1e-5):
    m = x.mean(dim=axis, keepdim=True)
    v = x.var(dim=axis, keepdim=True, unbiased=False)
    return (x - m) / torch.sqrt(v + eps)
def _scatter_add(tgt, idx, src, axis=0):
    return tgt.clone().index_add_(axis, idx, src)
def _segment_sum(src, seg, n):
    out = torch.zeros((n,) + src.shape[1:], dtype=src.dtype)
    return out.index_add_(0, seg, src)
def _pad(x, pw):
    flat = tuple(v for pair in reversed(pw) for v in pair)
    return torch.nn.functional.pad(x, flat)

kernel_name = 'recurrent_scan__mha_block_cached__glu_gated_swiglu__prompt'

def setup_inputs():

    _w = (lambda a: (lambda t: t.to(torch.bfloat16) if t.is_floating_point() else t)(torch.as_tensor(a)))
    def _A_setup():
        B, Sq, D = 1, 2048, 512
        H, Sk, Dh = 32, 2048, 128
        return {
            "x": _w((lambda *s: torch.randn(*s, dtype=torch.bfloat16) * 0.05)(B, Sq, D)),
            "k_cache": _w((lambda *s: torch.randn(*s, dtype=torch.bfloat16) * 1.6)(B, H, Sk, Dh)),
            "v_cache": _w((lambda *s: torch.randn(*s, dtype=torch.bfloat16) * 1.6)(B, H, Sk, Dh)),
            "wq": _w((lambda *s: torch.randn(*s, dtype=torch.bfloat16) * 1.6)(D, H * Dh) * (D ** -0.5)),
            "wo": _w((lambda *s: torch.randn(*s, dtype=torch.bfloat16) * 1.6)(H * Dh, D) * ((H * Dh) ** -0.5)),
        }
    _A_in = _A_setup()

    def _B_setup():
        B, S, D, F = 1, 2048, 512, 1792
        return {
            "x": _w((lambda *s: torch.randn(*s, dtype=torch.bfloat16) * 0.05)(B, S, D)),
            "w1": _w((lambda *s: torch.randn(*s, dtype=torch.bfloat16) * 0.2)(D, F) * (2.0 / D) ** 0.5),
            "w3": _w((lambda *s: torch.randn(*s, dtype=torch.bfloat16) * 0.2)(D, F) * (2.0 / D) ** 0.5),
            "w2": _w((lambda *s: torch.randn(*s, dtype=torch.bfloat16) * 0.2)(F, D) * (2.0 / F) ** 0.5),
        }
    _B_in = _B_setup()

    return {
        "A_x": _A_in["x"],
        "A_k_cache": _A_in["k_cache"],
        "A_v_cache": _A_in["v_cache"],
        "A_wq": _A_in["wq"],
        "A_wo": _A_in["wo"],
        "B_x": _B_in["x"],
        "B_w1": _B_in["w1"],
        "B_w3": _B_in["w3"],
        "B_w2": _B_in["w2"],
    }

def reference(A_x, A_k_cache, A_v_cache, A_wq, A_wo, B_x, B_w1, B_w3, B_w2):
    def _A_ref(x, k_cache, v_cache, wq, wo):
        B, Sq, D = x.shape
        H, Dh = 32, 128
        q = (lambda x, *d: x.permute(*d))((x @ wq).reshape(B, Sq, H, Dh), 0, 2, 1, 3)
        scores = torch.einsum("bhqd,bhkd->bhqk", q, k_cache) * (Dh ** -0.5)
        p = _softmax(scores, axis=-1)
        o = torch.einsum("bhqk,bhkd->bhqd", p, v_cache)
        return (lambda x, *d: x.permute(*d))(o, 0, 2, 1, 3).reshape(B, Sq, H * Dh) @ wo

    def _B_ref(x, w1, w3, w2):
        gate = torch.einsum("bsd,df->bsf", x, w1)
        up = torch.einsum("bsd,df->bsf", x, w3)
        h = _silu(gate) * up
        out = torch.einsum("bsf,fd->bsd", h, w2)
        return out

    x = A_x
    xn = _layernorm(x, axis=-1)
    s = _A_ref(xn, A_k_cache, A_v_cache, A_wq, A_wo)
    g = _silu(_B_ref(xn, B_w1, B_w3, B_w2))
    return x + s * g
```

```asm
; @launch grid=(256,1,1) block=(256,1,1) lds=163840
.amdgcn_target "amdgcn-amd-amdhsa--gfx950"
.text
.globl recurrent_scan__mha_block_cached__glu_gated_swiglu__prompt_kernel
.p2align 8
.type recurrent_scan__mha_block_cached__glu_gated_swiglu__prompt_kernel,@function
recurrent_scan__mha_block_cached__glu_gated_swiglu__prompt_kernel:
s_cmp_ge_u32 s2, 256
s_cbranch_scc1 L_end
s_load_dwordx2 s[72:73], s[0:1], 0
s_load_dwordx8 s[52:59], s[0:1], 8
s_load_dwordx4 s[60:63], s[0:1], 48
s_load_dwordx8 s[64:71], s[0:1], 64
s_getpc_b64 s[4:5]
L_pc:
s_mov_b32 s6, L_end-L_pc
s_mov_b32 s7, 0x20000
s_bfe_u32 s80, s2, 0x30003
s_lshl_b32 s3, s80, 7
v_lshlrev_b32 v61, 10, v0
buffer_load_dword v60, v61, s[4:7], s3 offen
s_and_b32 s74, s2, 7
s_lshr_b32 s80, s2, 3
s_and_b32 s75, s80, 3
s_lshr_b32 s76, s80, 2
s_lshl_b32 s77, s74, 2
s_add_u32 s77, s77, s75
v_lshrrev_b32 v52, 5, v0
v_and_b32 v53, 31, v0
v_lshlrev_b32 v54, 10, v52
v_lshl_add_u32 v58, v53, 4, v54
s_lshl_b32 s80, s76, 18
s_lshl_b32 s81, s77, 13
s_add_u32 s81, s81, s80
s_mul_i32 s80, s76, 2113536
s_add_u32 s82, s80, 327680
v_and_b32 v54, 7, v0
v_xor_b32 v54, v54, v52
v_lshlrev_b32 v54, 4, v54
v_lshl_add_u32 v59, v53, 7, v54
v_add_u32 v59, 131072, v59
v_lshlrev_b32 v56, 24, v52
v_lshl_add_u32 v56, v53, 2, v56
v_lshrrev_b32 v1, 6, v0
v_and_b32 v0, 63, v0
v_readfirstlane_b32 s50, v1
v_and_b32 v2, 15, v0
v_lshrrev_b32 v3, 4, v0
s_waitcnt lgkmcnt(0)
s_add_u32 s8, s72, s81
s_addc_u32 s9, s73, 0
s_mov_b32 s10, 8192
s_mov_b32 s11, 0x20000
buffer_load_dwordx4 v[64:67], v58, s[8:11], 0 offen
buffer_load_dwordx4 v[68:71], v58, s[8:11], 0 offen offset:512
s_lshr_b32 s83, s74, 1
s_and_b32 s84, s74, 1
s_mul_i32 s78, s83, 896
s_mul_i32 s43, s75, 96
s_add_u32 s43, s43, 512
s_lshl_b32 s45, s75, 7
s_cmp_eq_u32 s84, 1
s_cselect_b32 s43, s43, s45
s_add_u32 s78, s78, s43
s_and_b32 s100, s74, 7
s_lshl_b32 s101, s100, 19
s_lshl_b32 s79, s100, 11
s_lshl_b32 s43, s76, 2
s_add_u32 s43, s43, s50
s_lshl_b32 s43, s43, 3
v_lshrrev_b32 v38, 1, v0
v_add_u32 v38, s43, v38
v_lshlrev_b32 v38, 13, v38
v_and_b32 v52, 1, v0
v_lshl_add_u32 v38, v52, 7, v38
v_lshrrev_b32 v52, 4, v0
v_lshl_add_u32 v38, v52, 26, v38
v_add_u32 v39, s43, v0
v_mul_u32_u24 v39, 3584, v39
v_lshrrev_b32 v52, 3, v0
v_lshl_add_u32 v39, v52, 26, v39
s_lshl_b32 s43, s77, 8
s_add_u32 s16, s56, s43
s_addc_u32 s17, s57, 0
s_mov_b32 s18, 4194304
s_mov_b32 s19, 0x20000
s_sub_u32 s18, s18, s43
s_add_u32 s20, s60, s78
s_addc_u32 s21, s61, 0
s_mov_b32 s22, 1835008
s_mov_b32 s23, 0x20000
s_add_u32 s24, s62, s78
s_addc_u32 s25, s63, 0
s_mov_b32 s26, 1835008
s_mov_b32 s27, 0x20000
s_sub_u32 s22, s22, s78
s_mov_b32 s26, s22
s_xor_b32 s45, s101, 0
s_and_b32 s45, s45, 2097152
buffer_load_dword v114, v38, s[16:19], s45 offen
s_lshr_b32 s45, s45, 13
s_mul_i32 s45, s45, 3584
buffer_load_dword v115, v39, s[20:23], s45 offen offset:64
buffer_load_dword v116, v39, s[24:27], s45 offen offset:64
s_add_u32 s88, s70, s82
s_addc_u32 s89, s71, 0
s_mov_b32 s90, 196608
s_mov_b32 s91, 0x20000
buffer_load_dword v57, off, s[88:91], 0 sc1
s_add_u32 s28, s70, s80
s_addc_u32 s29, s71, 0
s_mov_b32 s30, 278528
s_mov_b32 s31, 0x20000
s_lshl_b32 s81, s84, 22
v_lshlrev_b32 v52, 2, v3
v_xor_b32 v52, v52, v2
v_lshlrev_b32 v52, 4, v52
v_lshl_add_u32 v53, v1, 4, v3
v_lshl_add_u32 v32, v53, 13, v52
v_add_u32 v33, 31744, v32
v_add_u32 v34, 63488, v32
v_add_u32 v35, 95232, v32
v_lshrrev_b32 v52, 3, v0
v_and_b32 v53, 7, v0
v_lshl_add_u32 v55, v1, 4, v52
v_lshlrev_b32 v58, 8, v55
v_xor_b32 v54, v52, v53
v_lshl_add_u32 v58, v54, 4, v58
v_and_b32 v54, 2, v52
v_xor_b32 v53, v53, v54
v_mul_u32_u24 v52, 3584, v55
v_lshl_add_u32 v36, v53, 4, v52
v_add_u32 v54, 2, v53
v_lshrrev_b32 v54, 3, v54
v_mad_u32_u24 v36, v54, s81, v36
v_xor_b32 v53, 4, v53
v_lshl_add_u32 v37, v53, 4, v52
v_add_u32 v54, 2, v53
v_lshrrev_b32 v54, 3, v54
v_mad_u32_u24 v37, v54, s81, v37
v_add_u32 v37, 27648, v37
s_lshl_b32 s40, s50, 12
s_lshl_b32 s41, s50, 11
s_add_u32 s41, s41, 65536
s_add_u32 s42, s40, 65536
s_lshr_b32 s80, s77, 1
s_mul_i32 s80, s80, 17408
s_and_b32 s81, s77, 1
s_lshl_b32 s81, s81, 7
s_add_u32 s44, s80, s81
v_lshlrev_b32 v52, 4, v0
s_add_u32 s80, s41, 65536
v_add_u32 v55, s80, v52
s_mov_b32 s82, 0xffff0000
s_waitcnt vmcnt(5)
v_lshlrev_b32 v96, 16, v64
v_and_b32 v97, s82, v64
v_lshlrev_b32 v98, 16, v65
v_and_b32 v99, s82, v65
v_lshlrev_b32 v100, 16, v66
v_and_b32 v101, s82, v66
v_lshlrev_b32 v102, 16, v67
v_and_b32 v103, s82, v67
s_waitcnt vmcnt(4)
v_lshlrev_b32 v104, 16, v68
v_and_b32 v105, s82, v68
v_lshlrev_b32 v106, 16, v69
v_and_b32 v107, s82, v69
v_lshlrev_b32 v108, 16, v70
v_and_b32 v109, s82, v70
v_lshlrev_b32 v110, 16, v71
v_and_b32 v111, s82, v71
v_pk_add_f32 v[80:81], v[96:97], v[98:99]
v_pk_add_f32 v[82:83], v[100:101], v[102:103]
v_pk_add_f32 v[80:81], v[80:81], v[104:105]
v_pk_add_f32 v[82:83], v[82:83], v[106:107]
v_pk_add_f32 v[80:81], v[80:81], v[108:109]
v_pk_add_f32 v[82:83], v[82:83], v[110:111]
v_pk_add_f32 v[80:81], v[80:81], v[82:83]
v_add_f32 v80, v80, v81
s_nop 1
v_add_f32_dpp v80, v80, v80 row_ror:1 row_mask:0xf bank_mask:0xf
s_nop 1
v_add_f32_dpp v80, v80, v80 row_ror:2 row_mask:0xf bank_mask:0xf
s_nop 1
v_add_f32_dpp v80, v80, v80 row_ror:4 row_mask:0xf bank_mask:0xf
s_nop 1
v_add_f32_dpp v80, v80, v80 row_ror:8 row_mask:0xf bank_mask:0xf
v_mov_b32 v81, v80
s_nop 1
v_permlane16_swap_b32 v80, v81
v_add_f32 v80, v80, v81
v_mul_f32 v80, 0x3b000000, v80
v_pk_add_f32 v[88:89], v[96:97], v[80:81] op_sel_hi:[1,0] neg_lo:[0,1] neg_hi:[0,1]
v_pk_mul_f32 v[84:85], v[88:89], v[88:89]
v_pk_add_f32 v[90:91], v[98:99], v[80:81] op_sel_hi:[1,0] neg_lo:[0,1] neg_hi:[0,1]
v_pk_mul_f32 v[86:87], v[90:91], v[90:91]
v_pk_add_f32 v[88:89], v[100:101], v[80:81] op_sel_hi:[1,0] neg_lo:[0,1] neg_hi:[0,1]
v_pk_fma_f32 v[84:85], v[88:89], v[88:89], v[84:85]
v_pk_add_f32 v[90:91], v[102:103], v[80:81] op_sel_hi:[1,0] neg_lo:[0,1] neg_hi:[0,1]
v_pk_fma_f32 v[86:87], v[90:91], v[90:91], v[86:87]
v_pk_add_f32 v[88:89], v[104:105], v[80:81] op_sel_hi:[1,0] neg_lo:[0,1] neg_hi:[0,1]
v_pk_fma_f32 v[84:85], v[88:89], v[88:89], v[84:85]
v_pk_add_f32 v[90:91], v[106:107], v[80:81] op_sel_hi:[1,0] neg_lo:[0,1] neg_hi:[0,1]
v_pk_fma_f32 v[86:87], v[90:91], v[90:91], v[86:87]
v_pk_add_f32 v[88:89], v[108:109], v[80:81] op_sel_hi:[1,0] neg_lo:[0,1] neg_hi:[0,1]
v_pk_fma_f32 v[84:85], v[88:89], v[88:89], v[84:85]
v_pk_add_f32 v[90:91], v[110:111], v[80:81] op_sel_hi:[1,0] neg_lo:[0,1] neg_hi:[0,1]
v_pk_fma_f32 v[86:87], v[90:91], v[90:91], v[86:87]
v_pk_add_f32 v[84:85], v[84:85], v[86:87]
v_add_f32 v84, v84, v85
v_cvt_pk_bf16_f32 v80, v80, v80
v_and_b32 v80, s82, v80
v_add_f32_dpp v84, v84, v84 row_ror:1 row_mask:0xf bank_mask:0xf
v_pk_add_f32 v[96:97], v[96:97], v[80:81] op_sel_hi:[1,0] neg_lo:[0,1] neg_hi:[0,1]
v_cvt_pk_bf16_f32 v88, v96, v97
v_add_f32_dpp v84, v84, v84 row_ror:2 row_mask:0xf bank_mask:0xf
v_lshlrev_b32 v96, 16, v88
v_and_b32 v97, s82, v88
v_add_f32_dpp v84, v84, v84 row_ror:4 row_mask:0xf bank_mask:0xf
v_pk_add_f32 v[98:99], v[98:99], v[80:81] op_sel_hi:[1,0] neg_lo:[0,1] neg_hi:[0,1]
v_cvt_pk_bf16_f32 v88, v98, v99
v_add_f32_dpp v84, v84, v84 row_ror:8 row_mask:0xf bank_mask:0xf
v_mov_b32 v85, v84
v_lshlrev_b32 v98, 16, v88
v_and_b32 v99, s82, v88
v_permlane16_swap_b32 v84, v85
v_add_f32 v84, v84, v85
v_mul_f32 v84, 0x3b000000, v84
v_cvt_pk_bf16_f32 v84, v84, v84
v_and_b32 v84, s82, v84
v_add_f32 v84, 0x3727c5ac, v84
v_cvt_pk_bf16_f32 v84, v84, v84
v_and_b32 v84, s82, v84
v_sqrt_f32 v84, v84
v_pk_add_f32 v[100:101], v[100:101], v[80:81] op_sel_hi:[1,0] neg_lo:[0,1] neg_hi:[0,1]
v_cvt_pk_bf16_f32 v88, v100, v101
v_cvt_pk_bf16_f32 v84, v84, v84
v_and_b32 v84, s82, v84
v_rcp_f32 v84, v84
v_lshlrev_b32 v100, 16, v88
v_and_b32 v101, s82, v88
v_pk_add_f32 v[102:103], v[102:103], v[80:81] op_sel_hi:[1,0] neg_lo:[0,1] neg_hi:[0,1]
v_cvt_pk_bf16_f32 v88, v102, v103
v_lshlrev_b32 v102, 16, v88
v_and_b32 v103, s82, v88
v_pk_add_f32 v[104:105], v[104:105], v[80:81] op_sel_hi:[1,0] neg_lo:[0,1] neg_hi:[0,1]
v_cvt_pk_bf16_f32 v88, v104, v105
v_lshlrev_b32 v104, 16, v88
v_and_b32 v105, s82, v88
v_pk_add_f32 v[106:107], v[106:107], v[80:81] op_sel_hi:[1,0] neg_lo:[0,1] neg_hi:[0,1]
v_cvt_pk_bf16_f32 v88, v106, v107
v_lshlrev_b32 v106, 16, v88
v_and_b32 v107, s82, v88
v_pk_add_f32 v[108:109], v[108:109], v[80:81] op_sel_hi:[1,0] neg_lo:[0,1] neg_hi:[0,1]
v_cvt_pk_bf16_f32 v88, v108, v109
v_lshlrev_b32 v108, 16, v88
v_and_b32 v109, s82, v88
v_pk_add_f32 v[110:111], v[110:111], v[80:81] op_sel_hi:[1,0] neg_lo:[0,1] neg_hi:[0,1]
v_cvt_pk_bf16_f32 v88, v110, v111
v_lshlrev_b32 v110, 16, v88
v_and_b32 v111, s82, v88
v_pk_mul_f32 v[96:97], v[96:97], v[84:85] op_sel_hi:[1,0]
v_pk_mul_f32 v[98:99], v[98:99], v[84:85] op_sel_hi:[1,0]
v_pk_mul_f32 v[100:101], v[100:101], v[84:85] op_sel_hi:[1,0]
v_pk_mul_f32 v[102:103], v[102:103], v[84:85] op_sel_hi:[1,0]
v_cvt_pk_bf16_f32 v64, v96, v97
v_cvt_pk_bf16_f32 v65, v98, v99
v_cvt_pk_bf16_f32 v66, v100, v101
v_cvt_pk_bf16_f32 v67, v102, v103
ds_write_b128 v59, v[64:67]
v_pk_mul_f32 v[104:105], v[104:105], v[84:85] op_sel_hi:[1,0]
v_pk_mul_f32 v[106:107], v[106:107], v[84:85] op_sel_hi:[1,0]
v_pk_mul_f32 v[108:109], v[108:109], v[84:85] op_sel_hi:[1,0]
v_pk_mul_f32 v[110:111], v[110:111], v[84:85] op_sel_hi:[1,0]
v_cvt_pk_bf16_f32 v68, v104, v105
v_cvt_pk_bf16_f32 v69, v106, v107
v_cvt_pk_bf16_f32 v70, v108, v109
v_cvt_pk_bf16_f32 v71, v110, v111
ds_write_b128 v59, v[68:71] offset:4096
s_waitcnt lgkmcnt(0)
s_barrier
ds_read_b128 v[72:75], v55
ds_read_b128 v[76:79], v55 offset:1024
s_lshl_b32 s81, s77, 7
s_add_u32 s81, s81, 4096
s_waitcnt lgkmcnt(1)
buffer_store_dwordx4 v[72:75], v58, s[28:31], s44 offen sc1
s_waitcnt lgkmcnt(0)
buffer_store_dwordx4 v[76:79], v58, s[28:31], s44 offen offset:2048 sc1
v_mul_u32_u24 v52, 69632, v1
v_lshl_add_u32 v40, v0, 4, v52
v_add_u32 v41, 17408, v40
v_add_u32 v42, 34816, v40
v_add_u32 v43, 52224, v40
s_mov_b64 exec, 0
s_lshl_b32 s45, s84, 2
s_add_u32 s45, s45, s50
s_cmp_eq_u32 s45, 4
s_cbranch_scc1 L_pad1
s_cmp_eq_u32 s45, 0
s_cbranch_scc1 L_pad15
s_cmp_eq_u32 s45, 5
s_cbranch_scc1 L_pad3
s_cmp_eq_u32 s45, 1
s_cbranch_scc1 L_pad17
s_cmp_eq_u32 s50, 2
s_cbranch_scc1 L_pad0
s_cmp_eq_u32 s50, 3
s_cbranch_scc1 L_pad6
L_walked0:
s_mov_b64 exec, -1
s_waitcnt vmcnt(0)
v_readfirstlane_b32 s87, v57
s_barrier
s_mul_i32 s87, s87, 0x9e3779b5
s_add_u32 s87, s87, 0x7f4a7c15
v_mov_b32 v60, s87
buffer_store_dword v60, v56, s[88:91], s81 offen sc1
s_add_u32 m0, s40, 0
s_xor_b32 s43, s101, 0
buffer_load_dwordx4 v32, s[16:19], s43 offen lds
buffer_load_dwordx4 v33, s[16:19], s43 offen offset:1024 lds
buffer_load_dwordx4 v34, s[16:19], s43 offen offset:2048 lds
s_xor_b32 s86, s100, 0
buffer_load_dwordx4 v35, s[16:19], s43 offen offset:3072 lds
s_add_u32 m0, s41, 0
s_mul_i32 s43, s86, 229376
buffer_load_dwordx4 v36, s[20:23], s43 offen lds
buffer_load_dwordx4 v37, s[20:23], s43 offen offset:1024 lds
s_add_u32 m0, s41, 8192
s_nop 0
buffer_load_dwordx4 v36, s[24:27], s43 offen lds
buffer_load_dwordx4 v37, s[24:27], s43 offen offset:1024 lds
s_add_u32 m0, s40, 16384
s_xor_b32 s43, s101, 524288
buffer_load_dwordx4 v32, s[16:19], s43 offen lds
buffer_load_dwordx4 v33, s[16:19], s43 offen offset:1024 lds
buffer_load_dwordx4 v34, s[16:19], s43 offen offset:2048 lds
s_xor_b32 s86, s100, 1
buffer_load_dwordx4 v35, s[16:19], s43 offen offset:3072 lds
s_add_u32 m0, s41, 16384
s_mul_i32 s43, s86, 229376
buffer_load_dwordx4 v36, s[20:23], s43 offen lds
buffer_load_dwordx4 v37, s[20:23], s43 offen offset:1024 lds
s_add_u32 m0, s41, 24576
s_nop 0
buffer_load_dwordx4 v36, s[24:27], s43 offen lds
buffer_load_dwordx4 v37, s[24:27], s43 offen offset:1024 lds
v_lshrrev_b32 v52, 2, v2
v_and_b32 v53, 3, v2
v_lshl_add_u32 v54, v3, 3, v52
v_lshlrev_b32 v55, 8, v54
v_lshl_add_u32 v55, v53, 4, v55
v_xor_b32 v57, 0, v52
v_lshl_add_u32 v24, v57, 6, v55
v_xor_b32 v57, 1, v52
v_lshl_add_u32 v25, v57, 6, v55
v_xor_b32 v57, 2, v52
v_lshl_add_u32 v26, v57, 6, v55
v_xor_b32 v57, 3, v52
v_lshl_add_u32 v27, v57, 6, v55
v_lshrrev_b32 v58, 3, v2
v_and_b32 v57, 1, v3
v_lshl_add_u32 v58, v57, 1, v58
v_lshlrev_b32 v55, 7, v54
v_lshl_add_u32 v55, v53, 3, v55
v_add_u32 v55, 65536, v55
s_and_b32 s80, s84, s75
s_cselect_b32 s80, 1, 0
v_xor_b32 v57, s80, v58
v_lshl_add_u32 v28, v57, 5, v55
s_cselect_b32 s80, 2, 1
v_xor_b32 v57, s80, v58
v_lshl_add_u32 v29, v57, 5, v55
s_cselect_b32 s80, 0, 2
v_xor_b32 v57, s80, v58
v_lshl_add_u32 v30, v57, 5, v55
s_cselect_b32 s80, 1, 3
v_xor_b32 v57, s80, v58
v_lshl_add_u32 v31, v57, 5, v55
v_and_b32 v57, 7, v0
v_lshlrev_b32 v57, 7, v57
s_lshl_b32 s81, s50, 10
s_add_u32 s81, s81, 4096
s_mov_b64 exec, 0
s_cmp_eq_u32 s50, 0
s_cbranch_scc1 L_pad8
s_cmp_eq_u32 s50, 1
s_cbranch_scc1 L_pad10
s_cmp_eq_u32 s50, 2
s_cbranch_scc1 L_pad12
s_cmp_eq_u32 s50, 3
s_cbranch_scc1 L_pad14
s_branch L_walked
L_hwait:
s_mov_b32 s45, 0x40000
L_spin3:
buffer_load_dword v60, v53, s[88:91], s81 offen sc1
s_sub_u32 s45, s45, 1
s_waitcnt vmcnt(0)
s_cbranch_scc1 L_spin_done3
v_cmp_ne_u32 vcc, s87, v60
s_cbranch_vccnz L_spin3
L_spin_done3:
s_branch L_hok
L_owait:
s_mov_b32 s45, 0x40000
L_spin4:
buffer_load_dword v60, v224, s[88:91], s82 offen sc1
s_sub_u32 s45, s45, 1
s_waitcnt vmcnt(0)
s_cbranch_scc1 L_spin_done4
v_cmp_ne_u32 vcc, s87, v60
s_cbranch_vccnz L_spin4
L_spin_done4:
s_branch L_ook
L_owait2:
s_mov_b32 s45, 0x40000
L_spin5:
buffer_load_dword v60, v224, s[88:91], s82 offen offset:512 sc1
s_sub_u32 s45, s45, 1
s_waitcnt vmcnt(0)
s_cbranch_scc1 L_spin_done5
v_cmp_ne_u32 vcc, s87, v60
s_cbranch_vccnz L_spin5
L_spin_done5:
s_branch L_ook2
L_fwait:
s_mov_b32 s45, 0x40000
L_spin6:
buffer_load_dword v60, v224, s[88:91], s82 offen sc1
s_sub_u32 s45, s45, 1
s_waitcnt vmcnt(0)
s_cbranch_scc1 L_spin_done6
v_cmp_ne_u32 vcc, s87, v60
s_cbranch_vccnz L_spin6
L_spin_done6:
s_branch L_fok
.p2align 12
L_walked:
s_mov_b64 exec, -1
L_pad0:
s_cbranch_execz L_pad5
s_mov_b32 s45, 0x40000
L_spin1:
buffer_load_dword v60, v57, s[88:91], s81 offen sc1
s_sub_u32 s45, s45, 1
s_waitcnt vmcnt(0)
s_cbranch_scc1 L_spin_done1
v_cmp_ne_u32 vcc, s87, v60
s_cbranch_vccnz L_spin1
L_spin_done1:
s_barrier
s_xor_b32 s44, s79, 0
buffer_load_dwordx4 a[128:131], v40, s[28:31], s44 offen sc1
buffer_load_dwordx4 a[132:135], v40, s[28:31], s44 offen offset:1024 sc1
buffer_load_dwordx4 a[136:139], v41, s[28:31], s44 offen sc1
buffer_load_dwordx4 a[140:143], v41, s[28:31], s44 offen offset:1024 sc1
buffer_load_dwordx4 a[144:147], v42, s[28:31], s44 offen sc1
buffer_load_dwordx4 a[148:151], v42, s[28:31], s44 offen offset:1024 sc1
buffer_load_dwordx4 a[152:155], v43, s[28:31], s44 offen sc1
buffer_load_dwordx4 a[156:159], v43, s[28:31], s44 offen offset:1024 sc1
ds_read_b64_tr_b16 a[224:225], v24 offset:0
ds_read_b64_tr_b16 a[226:227], v24 offset:1024
ds_read_b64_tr_b16 a[228:229], v24 offset:8192
ds_read_b64_tr_b16 a[230:231], v24 offset:9216
ds_read_b64_tr_b16 a[232:233], v24 offset:8
ds_read_b64_tr_b16 a[234:235], v24 offset:1032
ds_read_b64_tr_b16 a[236:237], v24 offset:8200
ds_read_b64_tr_b16 a[238:239], v24 offset:9224
s_xor_b32 s85, s75, 1
s_mov_b32 s51, 0
s_lshl_b32 s80, s77, 19
s_add_u32 s8, s52, s80
s_addc_u32 s9, s53, 0
s_mov_b32 s10, 524288
s_mov_b32 s11, 0x20000
s_add_u32 s12, s54, s80
s_addc_u32 s13, s55, 0
s_mov_b32 s14, 524288
s_mov_b32 s15, 0x20000
s_mul_i32 s80, s76, 2113536
s_mul_i32 s81, s83, 14336
s_add_u32 s80, s80, s81
s_add_u32 s80, s80, 524288
s_add_u32 s32, s70, s80
s_addc_u32 s33, s71, 0
s_mov_b32 s34, 933888
s_mov_b32 s35, 0x20000
s_sub_u32 s34, s34, s81
s_mul_i32 s80, s76, 2097152
s_lshl_b32 s81, s77, 12
s_add_u32 s80, s80, s81
s_add_u32 s80, s80, 17825792
s_add_u32 s36, s70, s80
s_addc_u32 s37, s71, 0
s_mov_b32 s38, 2097152
s_mov_b32 s39, 0x20000
s_sub_u32 s38, s38, s81
v_xor_b32 v55, v2, v3
v_lshlrev_b32 v56, 8, v2
v_xor_b32 v57, 0, v55
v_lshl_add_u32 v4, v57, 4, v56
v_xor_b32 v57, 4, v55
v_lshl_add_u32 v5, v57, 4, v56
v_xor_b32 v57, 8, v55
v_lshl_add_u32 v6, v57, 4, v56
v_xor_b32 v57, 12, v55
v_lshl_add_u32 v7, v57, 4, v56
v_lshl_add_u32 v54, v3, 2, v52
v_and_b32 v55, 7, v54
v_lshlrev_b32 v56, 8, v54
v_lshl_add_u32 v56, v53, 3, v56
v_add_u32 v56, 65536, v56
v_xor_b32 v57, 0, v55
s_cmp_eq_u32 s84, 0
s_cbranch_scc1 L_even
s_waitcnt vmcnt(0) lgkmcnt(4)
v_mfma_f32_16x16x32_bf16 v[128:131], a[224:227], a[128:131], 0
ds_read_b64_tr_b16 a[240:241], v25 offset:0
ds_read_b64_tr_b16 a[242:243], v25 offset:1024
v_mfma_f32_16x16x32_bf16 v[128:131], a[228:231], a[132:135], v[128:131]
ds_read_b64_tr_b16 a[244:245], v25 offset:8192
ds_read_b64_tr_b16 a[246:247], v25 offset:9216
v_mfma_f32_16x16x32_bf16 v[144:147], a[228:231], a[140:143], 0
s_xor_b32 s44, s79, 2048
v_mfma_f32_16x16x32_bf16 v[144:147], a[224:227], a[136:139], v[144:147]
buffer_load_dwordx4 a[160:163], v40, s[28:31], s44 offen sc1
v_mfma_f32_16x16x32_bf16 v[160:163], a[224:227], a[144:147], 0
v_lshl_add_u32 v8, v57, 5, v56
v_xor_b32 v57, 1, v55
v_mfma_f32_16x16x32_bf16 v[160:163], a[228:231], a[148:151], v[160:163]
buffer_load_dwordx4 a[164:167], v40, s[28:31], s44 offen offset:1024 sc1
v_mfma_f32_16x16x32_bf16 v[176:179], a[228:231], a[156:159], 0
v_lshl_add_u32 v9, v57, 5, v56
v_xor_b32 v57, 2, v55
v_mfma_f32_16x16x32_bf16 v[176:179], a[224:227], a[152:155], v[176:179]
s_waitcnt lgkmcnt(4)
v_mfma_f32_16x16x32_bf16 v[240:243], a[232:235], a[152:155], 0
ds_read_b64_tr_b16 a[224:225], v25 offset:8
ds_read_b64_tr_b16 a[226:227], v25 offset:1032
v_mfma_f32_16x16x32_bf16 v[240:243], a[236:239], a[156:159], v[240:243]
ds_read_b64_tr_b16 a[228:229], v25 offset:8200
ds_read_b64_tr_b16 a[230:231], v25 offset:9224
v_mfma_f32_16x16x32_bf16 v[224:227], a[236:239], a[148:151], 0
v_mfma_f32_16x16x32_bf16 v[224:227], a[232:235], a[144:147], v[224:227]
buffer_load_dwordx4 a[168:171], v41, s[28:31], s44 offen sc1
v_mfma_f32_16x16x32_bf16 v[208:211], a[232:235], a[136:139], 0
v_lshl_add_u32 v10, v57, 5, v56
v_xor_b32 v57, 3, v55
v_mfma_f32_16x16x32_bf16 v[208:211], a[236:239], a[140:143], v[208:211]
buffer_load_dwordx4 a[172:175], v41, s[28:31], s44 offen offset:1024 sc1
v_mfma_f32_16x16x32_bf16 v[192:195], a[236:239], a[132:135], 0
v_lshl_add_u32 v11, v57, 5, v56
v_xor_b32 v57, 4, v55
v_mfma_f32_16x16x32_bf16 v[192:195], a[232:235], a[128:131], v[192:195]
s_waitcnt lgkmcnt(4)
v_mfma_f32_16x16x32_bf16 v[132:135], a[240:243], a[128:131], 0
ds_read_b64_tr_b16 a[232:233], v26 offset:0
ds_read_b64_tr_b16 a[234:235], v26 offset:1024
v_mfma_f32_16x16x32_bf16 v[132:135], a[244:247], a[132:135], v[132:135]
ds_read_b64_tr_b16 a[236:237], v26 offset:8192
ds_read_b64_tr_b16 a[238:239], v26 offset:9216
v_mfma_f32_16x16x32_bf16 v[148:151], a[244:247], a[140:143], 0
v_mfma_f32_16x16x32_bf16 v[148:151], a[240:243], a[136:139], v[148:151]
buffer_load_dwordx4 a[176:179], v42, s[28:31], s44 offen sc1
v_mfma_f32_16x16x32_bf16 v[164:167], a[240:243], a[144:147], 0
v_lshl_add_u32 v12, v57, 5, v56
v_xor_b32 v57, 5, v55
v_mfma_f32_16x16x32_bf16 v[164:167], a[244:247], a[148:151], v[164:167]
buffer_load_dwordx4 a[180:183], v42, s[28:31], s44 offen offset:1024 sc1
v_mfma_f32_16x16x32_bf16 v[180:183], a[244:247], a[156:159], 0
v_lshl_add_u32 v13, v57, 5, v56
v_xor_b32 v57, 6, v55
v_mfma_f32_16x16x32_bf16 v[180:183], a[240:243], a[152:155], v[180:183]
s_waitcnt lgkmcnt(4)
v_mfma_f32_16x16x32_bf16 v[244:247], a[224:227], a[152:155], 0
ds_read_b64_tr_b16 a[240:241], v26 offset:8
ds_read_b64_tr_b16 a[242:243], v26 offset:1032
v_mfma_f32_16x16x32_bf16 v[244:247], a[228:231], a[156:159], v[244:247]
ds_read_b64_tr_b16 a[244:245], v26 offset:8200
ds_read_b64_tr_b16 a[246:247], v26 offset:9224
v_mfma_f32_16x16x32_bf16 v[228:231], a[228:231], a[148:151], 0
v_mfma_f32_16x16x32_bf16 v[228:231], a[224:227], a[144:147], v[228:231]
buffer_load_dwordx4 a[184:187], v43, s[28:31], s44 offen sc1
v_mfma_f32_16x16x32_bf16 v[212:215], a[224:227], a[136:139], 0
v_lshl_add_u32 v14, v57, 5, v56
v_xor_b32 v57, 7, v55
v_mfma_f32_16x16x32_bf16 v[212:215], a[228:231], a[140:143], v[212:215]
buffer_load_dwordx4 a[188:191], v43, s[28:31], s44 offen offset:1024 sc1
v_mfma_f32_16x16x32_bf16 v[196:199], a[228:231], a[132:135], 0
v_lshl_add_u32 v15, v57, 5, v56
v_lshlrev_b32 v55, 12, v1
v_mfma_f32_16x16x32_bf16 v[196:199], a[224:227], a[128:131], v[196:199]
s_waitcnt lgkmcnt(4)
v_mfma_f32_16x16x32_bf16 v[136:139], a[232:235], a[128:131], 0
ds_read_b64_tr_b16 a[224:225], v27 offset:0
ds_read_b64_tr_b16 a[226:227], v27 offset:1024
v_mfma_f32_16x16x32_bf16 v[136:139], a[236:239], a[132:135], v[136:139]
ds_read_b64_tr_b16 a[228:229], v27 offset:8192
ds_read_b64_tr_b16 a[230:231], v27 offset:9216
v_mfma_f32_16x16x32_bf16 v[152:155], a[236:239], a[140:143], 0
s_add_u32 m0, s40, 32768
s_xor_b32 s43, s101, 1048576
v_mfma_f32_16x16x32_bf16 v[152:155], a[232:235], a[136:139], v[152:155]
buffer_load_dwordx4 v32, s[16:19], s43 offen lds
v_mfma_f32_16x16x32_bf16 v[168:171], a[232:235], a[144:147], 0
v_lshl_add_u32 v55, v3, 8, v55
v_xor_b32 v56, v2, v3
v_mfma_f32_16x16x32_bf16 v[168:171], a[236:239], a[148:151], v[168:171]
buffer_load_dwordx4 v33, s[16:19], s43 offen offset:1024 lds
v_mfma_f32_16x16x32_bf16 v[184:187], a[236:239], a[156:159], 0
v_xor_b32 v57, 0, v56
v_lshl_add_u32 v16, v57, 4, v55
v_mfma_f32_16x16x32_bf16 v[184:187], a[232:235], a[152:155], v[184:187]
s_waitcnt lgkmcnt(4)
v_mfma_f32_16x16x32_bf16 v[248:251], a[240:243], a[152:155], 0
ds_read_b64_tr_b16 a[232:233], v27 offset:8
ds_read_b64_tr_b16 a[234:235], v27 offset:1032
v_mfma_f32_16x16x32_bf16 v[248:251], a[244:247], a[156:159], v[248:251]
ds_read_b64_tr_b16 a[236:237], v27 offset:8200
ds_read_b64_tr_b16 a[238:239], v27 offset:9224
v_mfma_f32_16x16x32_bf16 v[232:235], a[244:247], a[148:151], 0
v_mfma_f32_16x16x32_bf16 v[232:235], a[240:243], a[144:147], v[232:235]
buffer_load_dwordx4 v34, s[16:19], s43 offen offset:2048 lds
v_mfma_f32_16x16x32_bf16 v[216:219], a[240:243], a[136:139], 0
s_xor_b32 s86, s100, 2
v_mfma_f32_16x16x32_bf16 v[216:219], a[244:247], a[140:143], v[216:219]
buffer_load_dwordx4 v35, s[16:19], s43 offen offset:3072 lds
v_mfma_f32_16x16x32_bf16 v[200:203], a[244:247], a[132:135], 0
v_xor_b32 v57, 4, v56
v_lshl_add_u32 v17, v57, 4, v55
v_mfma_f32_16x16x32_bf16 v[200:203], a[240:243], a[128:131], v[200:203]
s_waitcnt lgkmcnt(4)
v_mfma_f32_16x16x32_bf16 v[140:143], a[224:227], a[128:131], 0
ds_read_b64_tr_b16 a[240:241], v28 offset:0
ds_read_b64_tr_b16 a[242:243], v28 offset:512
v_mfma_f32_16x16x32_bf16 v[140:143], a[228:231], a[132:135], v[140:143]
ds_read_b64_tr_b16 a[244:245], v28 offset:4096
ds_read_b64_tr_b16 a[246:247], v28 offset:4608
v_mfma_f32_16x16x32_bf16 v[156:159], a[228:231], a[140:143], 0
s_add_u32 m0, s41, 32768
s_mul_i32 s43, s86, 229376
v_mfma_f32_16x16x32_bf16 v[156:159], a[224:227], a[136:139], v[156:159]
buffer_load_dwordx4 v36, s[20:23], s43 offen lds
v_mfma_f32_16x16x32_bf16 v[172:175], a[224:227], a[144:147], 0
v_xor_b32 v57, 8, v56
v_lshl_add_u32 v18, v57, 4, v55
v_mfma_f32_16x16x32_bf16 v[172:175], a[228:231], a[148:151], v[172:175]
buffer_load_dwordx4 v37, s[20:23], s43 offen offset:1024 lds
v_mfma_f32_16x16x32_bf16 v[188:191], a[228:231], a[156:159], 0
v_xor_b32 v57, 12, v56
v_lshl_add_u32 v19, v57, 4, v55
v_mfma_f32_16x16x32_bf16 v[188:191], a[224:227], a[152:155], v[188:191]
s_waitcnt lgkmcnt(4)
v_mfma_f32_16x16x32_bf16 v[252:255], a[232:235], a[152:155], 0
ds_read_b64_tr_b16 a[224:225], v29 offset:0
ds_read_b64_tr_b16 a[226:227], v29 offset:512
v_mfma_f32_16x16x32_bf16 v[252:255], a[236:239], a[156:159], v[252:255]
ds_read_b64_tr_b16 a[228:229], v29 offset:4096
ds_read_b64_tr_b16 a[230:231], v29 offset:4608
v_mfma_f32_16x16x32_bf16 v[236:239], a[236:239], a[148:151], 0
s_add_u32 m0, s41, 40960
v_mfma_f32_16x16x32_bf16 v[236:239], a[232:235], a[144:147], v[236:239]
buffer_load_dwordx4 v36, s[24:27], s43 offen lds
v_mfma_f32_16x16x32_bf16 v[220:223], a[232:235], a[136:139], 0
v_lshlrev_b32 v56, 1, v3
v_xor_b32 v56, v2, v56
v_mfma_f32_16x16x32_bf16 v[220:223], a[236:239], a[140:143], v[220:223]
buffer_load_dwordx4 v37, s[24:27], s43 offen offset:1024 lds
v_mfma_f32_16x16x32_bf16 v[204:207], a[236:239], a[132:135], 0
v_xor_b32 v57, 0, v56
v_lshl_add_u32 v20, v57, 4, v55
v_mfma_f32_16x16x32_bf16 v[204:207], a[232:235], a[128:131], v[204:207]
s_waitcnt lgkmcnt(4)
v_mfma_f32_16x16x32_bf16 v[64:67], a[240:243], a[128:131], 0
ds_read_b64_tr_b16 a[232:233], v30 offset:0
ds_read_b64_tr_b16 a[234:235], v30 offset:512
v_mfma_f32_16x16x32_bf16 v[64:67], a[244:247], a[132:135], v[64:67]
ds_read_b64_tr_b16 a[236:237], v30 offset:4096
ds_read_b64_tr_b16 a[238:239], v30 offset:4608
v_mfma_f32_16x16x32_bf16 v[80:83], a[244:247], a[140:143], 0
s_xor_b32 s44, s79, 4096
v_mfma_f32_16x16x32_bf16 v[80:83], a[240:243], a[136:139], v[80:83]
buffer_load_dwordx4 a[192:195], v40, s[28:31], s44 offen sc1
v_mfma_f32_16x16x32_bf16 v[96:99], a[240:243], a[144:147], 0
v_xor_b32 v57, 8, v56
v_lshl_add_u32 v21, v57, 4, v55
v_mfma_f32_16x16x32_bf16 v[96:99], a[244:247], a[148:151], v[96:99]
buffer_load_dwordx4 a[196:199], v40, s[28:31], s44 offen offset:1024 sc1
v_mfma_f32_16x16x32_bf16 v[112:115], a[244:247], a[156:159], 0
s_mul_i32 s80, s50, 233472
v_lshlrev_b32 v55, 4, v0
v_mfma_f32_16x16x32_bf16 v[112:115], a[240:243], a[152:155], v[112:115]
s_waitcnt lgkmcnt(4)
v_mfma_f32_16x16x32_bf16 v[116:119], a[224:227], a[152:155], 0
ds_read_b64_tr_b16 a[240:241], v28 offset:8192
ds_read_b64_tr_b16 a[242:243], v28 offset:8704
v_mfma_f32_16x16x32_bf16 v[116:119], a[228:231], a[156:159], v[116:119]
ds_read_b64_tr_b16 a[244:245], v28 offset:12288
ds_read_b64_tr_b16 a[246:247], v28 offset:12800
v_mfma_f32_16x16x32_bf16 v[100:103], a[228:231], a[148:151], 0
v_mfma_f32_16x16x32_bf16 v[100:103], a[224:227], a[144:147], v[100:103]
buffer_load_dwordx4 a[200:203], v41, s[28:31], s44 offen sc1
v_mfma_f32_16x16x32_bf16 v[84:87], a[224:227], a[136:139], 0
v_add_u32 v44, s80, v55
s_mul_i32 s80, s50, 524288
v_mfma_f32_16x16x32_bf16 v[84:87], a[228:231], a[140:143], v[84:87]
buffer_load_dwordx4 a[204:207], v41, s[28:31], s44 offen offset:1024 sc1
v_mfma_f32_16x16x32_bf16 v[68:71], a[228:231], a[132:135], 0
v_add_u32 v48, s80, v55
v_add_u32 v45, 58368, v44
v_mfma_f32_16x16x32_bf16 v[68:71], a[224:227], a[128:131], v[68:71]
s_waitcnt lgkmcnt(4)
v_mfma_f32_16x16x32_bf16 v[72:75], a[232:235], a[128:131], 0
ds_read_b64_tr_b16 a[224:225], v29 offset:8192
ds_read_b64_tr_b16 a[226:227], v29 offset:8704
v_mfma_f32_16x16x32_bf16 v[72:75], a[236:239], a[132:135], v[72:75]
ds_read_b64_tr_b16 a[228:229], v29 offset:12288
ds_read_b64_tr_b16 a[230:231], v29 offset:12800
v_mfma_f32_16x16x32_bf16 v[88:91], a[236:239], a[140:143], 0
v_mfma_f32_16x16x32_bf16 v[88:91], a[232:235], a[136:139], v[88:91]
buffer_load_dwordx4 a[208:211], v42, s[28:31], s44 offen sc1
v_mfma_f32_16x16x32_bf16 v[104:107], a[232:235], a[144:147], 0
v_add_u32 v49, 131072, v48
v_add_u32 v46, 116736, v44
v_mfma_f32_16x16x32_bf16 v[104:107], a[236:239], a[148:151], v[104:107]
buffer_load_dwordx4 a[212:215], v42, s[28:31], s44 offen offset:1024 sc1
v_mfma_f32_16x16x32_bf16 v[120:123], a[236:239], a[156:159], 0
v_add_u32 v50, 262144, v48
v_add_u32 v47, 175104, v44
v_mfma_f32_16x16x32_bf16 v[120:123], a[232:235], a[152:155], v[120:123]
s_waitcnt lgkmcnt(4)
v_mfma_f32_16x16x32_bf16 a[48:51], a[240:243], a[152:155], 0
ds_read_b64_tr_b16 a[232:233], v30 offset:8192
ds_read_b64_tr_b16 a[234:235], v30 offset:8704
v_mfma_f32_16x16x32_bf16 a[48:51], a[244:247], a[156:159], a[48:51]
ds_read_b64_tr_b16 a[236:237], v30 offset:12288
ds_read_b64_tr_b16 a[238:239], v30 offset:12800
v_mfma_f32_16x16x32_bf16 a[32:35], a[244:247], a[148:151], 0
v_mfma_f32_16x16x32_bf16 a[32:35], a[240:243], a[144:147], a[32:35]
buffer_load_dwordx4 a[216:219], v43, s[28:31], s44 offen sc1
v_mfma_f32_16x16x32_bf16 a[16:19], a[240:243], a[136:139], 0
v_add_u32 v51, 393216, v48
s_mul_i32 s80, s50, 116736
v_mfma_f32_16x16x32_bf16 a[16:19], a[244:247], a[140:143], a[16:19]
buffer_load_dwordx4 a[220:223], v43, s[28:31], s44 offen offset:1024 sc1
v_mfma_f32_16x16x32_bf16 a[0:3], a[244:247], a[132:135], 0
v_add_u32 v22, s80, v55
v_add_u32 v23, 58368, v22
v_mfma_f32_16x16x32_bf16 a[0:3], a[240:243], a[128:131], a[0:3]
s_waitcnt vmcnt(16) lgkmcnt(4)
s_barrier
v_mfma_f32_16x16x32_bf16 a[4:7], a[224:227], a[128:131], 0
ds_read_b64_tr_b16 a[240:241], v24 offset:16384
ds_read_b64_tr_b16 a[242:243], v24 offset:17408
v_mfma_f32_16x16x32_bf16 a[4:7], a[228:231], a[132:135], a[4:7]
ds_read_b64_tr_b16 a[244:245], v24 offset:24576
ds_read_b64_tr_b16 a[246:247], v24 offset:25600
v_mfma_f32_16x16x32_bf16 a[20:23], a[228:231], a[140:143], 0
s_xor_b32 s45, s101, 2097152
s_and_b32 s45, s45, 2097152
v_mfma_f32_16x16x32_bf16 a[20:23], a[224:227], a[136:139], a[20:23]
buffer_load_dword v58, v38, s[16:19], s45 offen
v_mfma_f32_16x16x32_bf16 a[36:39], a[224:227], a[144:147], 0
s_lshr_b32 s45, s45, 13
s_mul_i32 s45, s45, 3584
v_mfma_f32_16x16x32_bf16 a[36:39], a[228:231], a[148:151], a[36:39]
buffer_load_dword v59, v39, s[20:23], s45 offen offset:64
v_mfma_f32_16x16x32_bf16 a[52:55], a[228:231], a[156:159], 0
s_mov_b32 s46, 0x3e0293ee
s_mov_b32 s47, 0x3e0293ee
v_mfma_f32_16x16x32_bf16 a[52:55], a[224:227], a[152:155], a[52:55]
s_waitcnt lgkmcnt(4)
v_mfma_f32_16x16x32_bf16 a[56:59], a[232:235], a[152:155], 0
ds_read_b64_tr_b16 a[224:225], v24 offset:16392
ds_read_b64_tr_b16 a[226:227], v24 offset:17416
v_mfma_f32_16x16x32_bf16 a[56:59], a[236:239], a[156:159], a[56:59]
ds_read_b64_tr_b16 a[228:229], v24 offset:24584
ds_read_b64_tr_b16 a[230:231], v24 offset:25608
v_mfma_f32_16x16x32_bf16 a[40:43], a[236:239], a[148:151], 0
v_mfma_f32_16x16x32_bf16 a[40:43], a[232:235], a[144:147], a[40:43]
v_mfma_f32_16x16x32_bf16 a[24:27], a[232:235], a[136:139], 0
v_mfma_f32_16x16x32_bf16 a[24:27], a[236:239], a[140:143], a[24:27]
buffer_load_dword v60, v39, s[24:27], s45 offen offset:64
v_mfma_f32_16x16x32_bf16 a[8:11], a[236:239], a[132:135], 0
v_mfma_f32_16x16x32_bf16 a[8:11], a[232:235], a[128:131], a[8:11]
s_waitcnt lgkmcnt(4)
v_mfma_f32_16x16x32_bf16 v[128:131], a[240:243], a[160:163], v[128:131]
ds_read_b64_tr_b16 a[232:233], v25 offset:16384
ds_read_b64_tr_b16 a[234:235], v25 offset:17408
v_mfma_f32_16x16x32_bf16 v[128:131], a[244:247], a[164:167], v[128:131]
ds_read_b64_tr_b16 a[236:237], v25 offset:24576
ds_read_b64_tr_b16 a[238:239], v25 offset:25600
v_mfma_f32_16x16x32_bf16 v[144:147], a[244:247], a[172:175], v[144:147]
s_add_u32 m0, s40, 49152
s_xor_b32 s43, s101, 1572864
v_mfma_f32_16x16x32_bf16 v[144:147], a[240:243], a[168:171], v[144:147]
buffer_load_dwordx4 v32, s[16:19], s43 offen lds
v_mfma_f32_16x16x32_bf16 v[160:163], a[240:243], a[176:179], v[160:163]
v_mfma_f32_16x16x32_bf16 v[160:163], a[244:247], a[180:183], v[160:163]
buffer_load_dwordx4 v33, s[16:19], s43 offen offset:1024 lds
v_mfma_f32_16x16x32_bf16 v[176:179], a[244:247], a[188:191], v[176:179]
v_mfma_f32_16x16x32_bf16 v[176:179], a[240:243], a[184:187], v[176:179]
s_waitcnt lgkmcnt(4)
v_mfma_f32_16x16x32_bf16 v[240:243], a[224:227], a[184:187], v[240:243]
ds_read_b64_tr_b16 a[240:241], v25 offset:16392
ds_read_b64_tr_b16 a[242:243], v25 offset:17416
v_mfma_f32_16x16x32_bf16 v[240:243], a[228:231], a[188:191], v[240:243]
ds_read_b64_tr_b16 a[244:245], v25 offset:24584
ds_read_b64_tr_b16 a[246:247], v25 offset:25608
v_mfma_f32_16x16x32_bf16 v[224:227], a[228:231], a[180:183], v[224:227]
v_mfma_f32_16x16x32_bf16 v[224:227], a[224:227], a[176:179], v[224:227]
buffer_load_dwordx4 v34, s[16:19], s43 offen offset:2048 lds
v_mfma_f32_16x16x32_bf16 v[208:211], a[224:227], a[168:171], v[208:211]
s_xor_b32 s86, s100, 3
v_mfma_f32_16x16x32_bf16 v[208:211], a[228:231], a[172:175], v[208:211]
buffer_load_dwordx4 v35, s[16:19], s43 offen offset:3072 lds
v_mfma_f32_16x16x32_bf16 v[192:195], a[228:231], a[164:167], v[192:195]
v_mfma_f32_16x16x32_bf16 v[192:195], a[224:227], a[160:163], v[192:195]
s_waitcnt lgkmcnt(4)
v_mfma_f32_16x16x32_bf16 v[132:135], a[232:235], a[160:163], v[132:135]
ds_read_b64_tr_b16 a[224:225], v26 offset:16384
ds_read_b64_tr_b16 a[226:227], v26 offset:17408
v_mfma_f32_16x16x32_bf16 v[132:135], a[236:239], a[164:167], v[132:135]
ds_read_b64_tr_b16 a[228:229], v26 offset:24576
ds_read_b64_tr_b16 a[230:231], v26 offset:25600
v_mfma_f32_16x16x32_bf16 v[148:151], a[236:239], a[172:175], v[148:151]
v_mfma_f32_16x16x32_bf16 v[148:151], a[232:235], a[168:171], v[148:151]
v_mfma_f32_16x16x32_bf16 v[164:167], a[232:235], a[176:179], v[164:167]
s_add_u32 m0, s41, 49152
s_mul_i32 s43, s86, 229376
v_mfma_f32_16x16x32_bf16 v[164:167], a[236:239], a[180:183], v[164:167]
buffer_load_dwordx4 v36, s[20:23], s43 offen lds
v_mfma_f32_16x16x32_bf16 v[180:183], a[236:239], a[188:191], v[180:183]
v_mfma_f32_16x16x32_bf16 v[180:183], a[232:235], a[184:187], v[180:183]
s_waitcnt lgkmcnt(4)
v_mfma_f32_16x16x32_bf16 v[244:247], a[240:243], a[184:187], v[244:247]
ds_read_b64_tr_b16 a[232:233], v26 offset:16392
ds_read_b64_tr_b16 a[234:235], v26 offset:17416
v_mfma_f32_16x16x32_bf16 v[244:247], a[244:247], a[188:191], v[244:247]
ds_read_b64_tr_b16 a[236:237], v26 offset:24584
ds_read_b64_tr_b16 a[238:239], v26 offset:25608
v_mfma_f32_16x16x32_bf16 v[228:231], a[244:247], a[180:183], v[228:231]
v_mfma_f32_16x16x32_bf16 v[228:231], a[240:243], a[176:179], v[228:231]
v_mfma_f32_16x16x32_bf16 v[212:215], a[240:243], a[168:171], v[212:215]
v_mfma_f32_16x16x32_bf16 v[212:215], a[244:247], a[172:175], v[212:215]
buffer_load_dwordx4 v37, s[20:23], s43 offen offset:1024 lds
v_mfma_f32_16x16x32_bf16 v[196:199], a[244:247], a[164:167], v[196:199]
v_mfma_f32_16x16x32_bf16 v[196:199], a[240:243], a[160:163], v[196:199]
s_waitcnt lgkmcnt(4)
v_mfma_f32_16x16x32_bf16 v[136:139], a[224:227], a[160:163], v[136:139]
ds_read_b64_tr_b16 a[240:241], v27 offset:16384
ds_read_b64_tr_b16 a[242:243], v27 offset:17408
v_mfma_f32_16x16x32_bf16 v[136:139], a[228:231], a[164:167], v[136:139]
ds_read_b64_tr_b16 a[244:245], v27 offset:24576
ds_read_b64_tr_b16 a[246:247], v27 offset:25600
v_mfma_f32_16x16x32_bf16 v[152:155], a[228:231], a[172:175], v[152:155]
v_mfma_f32_16x16x32_bf16 v[152:155], a[224:227], a[168:171], v[152:155]
v_mfma_f32_16x16x32_bf16 v[168:171], a[224:227], a[176:179], v[168:171]
s_add_u32 m0, s41, 57344
v_mfma_f32_16x16x32_bf16 v[168:171], a[228:231], a[180:183], v[168:171]
buffer_load_dwordx4 v36, s[24:27], s43 offen lds
v_mfma_f32_16x16x32_bf16 v[184:187], a[228:231], a[188:191], v[184:187]
v_mfma_f32_16x16x32_bf16 v[184:187], a[224:227], a[184:187], v[184:187]
s_waitcnt lgkmcnt(4)
v_mfma_f32_16x16x32_bf16 v[248:251], a[232:235], a[184:187], v[248:251]
ds_read_b64_tr_b16 a[224:225], v27 offset:16392
ds_read_b64_tr_b16 a[226:227], v27 offset:17416
v_mfma_f32_16x16x32_bf16 v[248:251], a[236:239], a[188:191], v[248:251]
ds_read_b64_tr_b16 a[228:229], v27 offset:24584
ds_read_b64_tr_b16 a[230:231], v27 offset:25608
v_mfma_f32_16x16x32_bf16 v[232:235], a[236:239], a[180:183], v[232:235]
v_mfma_f32_16x16x32_bf16 v[232:235], a[232:235], a[176:179], v[232:235]
v_mfma_f32_16x16x32_bf16 v[216:219], a[232:235], a[168:171], v[216:219]
v_mfma_f32_16x16x32_bf16 v[216:219], a[236:239], a[172:175], v[216:219]
buffer_load_dwordx4 v37, s[24:27], s43 offen offset:1024 lds
v_mfma_f32_16x16x32_bf16 v[200:203], a[236:239], a[164:167], v[200:203]
v_mfma_f32_16x16x32_bf16 v[200:203], a[232:235], a[160:163], v[200:203]
s_waitcnt lgkmcnt(4)
v_mfma_f32_16x16x32_bf16 v[140:143], a[240:243], a[160:163], v[140:143]
ds_read_b64_tr_b16 a[232:233], v28 offset:16384
ds_read_b64_tr_b16 a[234:235], v28 offset:16896
v_mfma_f32_16x16x32_bf16 v[140:143], a[244:247], a[164:167], v[140:143]
ds_read_b64_tr_b16 a[236:237], v28 offset:20480
ds_read_b64_tr_b16 a[238:239], v28 offset:20992
v_mfma_f32_16x16x32_bf16 v[156:159], a[244:247], a[172:175], v[156:159]
v_mfma_f32_16x16x32_bf16 v[156:159], a[240:243], a[168:171], v[156:159]
v_mfma_f32_16x16x32_bf16 v[172:175], a[240:243], a[176:179], v[172:175]
s_xor_b32 s44, s79, 6144
v_mfma_f32_16x16x32_bf16 v[172:175], a[244:247], a[180:183], v[172:175]
buffer_load_dwordx4 a[128:131], v40, s[28:31], s44 offen sc1
v_mfma_f32_16x16x32_bf16 v[188:191], a[244:247], a[188:191], v[188:191]
v_mfma_f32_16x16x32_bf16 v[188:191], a[240:243], a[184:187], v[188:191]
s_waitcnt lgkmcnt(4)
v_mfma_f32_16x16x32_bf16 v[252:255], a[224:227], a[184:187], v[252:255]
ds_read_b64_tr_b16 a[240:241], v29 offset:16384
ds_read_b64_tr_b16 a[242:243], v29 offset:16896
v_mfma_f32_16x16x32_bf16 v[252:255], a[228:231], a[188:191], v[252:255]
ds_read_b64_tr_b16 a[244:245], v29 offset:20480
ds_read_b64_tr_b16 a[246:247], v29 offset:20992
v_mfma_f32_16x16x32_bf16 v[236:239], a[228:231], a[180:183], v[236:239]
v_mfma_f32_16x16x32_bf16 v[236:239], a[224:227], a[176:179], v[236:239]
v_mfma_f32_16x16x32_bf16 v[220:223], a[224:227], a[168:171], v[220:223]
v_mfma_f32_16x16x32_bf16 v[220:223], a[228:231], a[172:175], v[220:223]
buffer_load_dwordx4 a[132:135], v40, s[28:31], s44 offen offset:1024 sc1
v_mfma_f32_16x16x32_bf16 v[204:207], a[228:231], a[164:167], v[204:207]
v_mfma_f32_16x16x32_bf16 v[204:207], a[224:227], a[160:163], v[204:207]
s_waitcnt lgkmcnt(4)
v_mfma_f32_16x16x32_bf16 v[64:67], a[232:235], a[160:163], v[64:67]
ds_read_b64_tr_b16 a[224:225], v30 offset:16384
ds_read_b64_tr_b16 a[226:227], v30 offset:16896
v_mfma_f32_16x16x32_bf16 v[64:67], a[236:239], a[164:167], v[64:67]
ds_read_b64_tr_b16 a[228:229], v30 offset:20480
ds_read_b64_tr_b16 a[230:231], v30 offset:20992
v_mfma_f32_16x16x32_bf16 v[80:83], a[236:239], a[172:175], v[80:83]
v_mfma_f32_16x16x32_bf16 v[80:83], a[232:235], a[168:171], v[80:83]
v_mfma_f32_16x16x32_bf16 v[96:99], a[232:235], a[176:179], v[96:99]
v_mfma_f32_16x16x32_bf16 v[96:99], a[236:239], a[180:183], v[96:99]
buffer_load_dwordx4 a[136:139], v41, s[28:31], s44 offen sc1
v_mfma_f32_16x16x32_bf16 v[112:115], a[236:239], a[188:191], v[112:115]
v_mfma_f32_16x16x32_bf16 v[112:115], a[232:235], a[184:187], v[112:115]
s_waitcnt lgkmcnt(4)
v_mfma_f32_16x16x32_bf16 v[116:119], a[240:243], a[184:187], v[116:119]
ds_read_b64_tr_b16 a[232:233], v28 offset:24576
ds_read_b64_tr_b16 a[234:235], v28 offset:25088
v_mfma_f32_16x16x32_bf16 v[116:119], a[244:247], a[188:191], v[116:119]
ds_read_b64_tr_b16 a[236:237], v28 offset:28672
ds_read_b64_tr_b16 a[238:239], v28 offset:29184
v_mfma_f32_16x16x32_bf16 v[100:103], a[244:247], a[180:183], v[100:103]
v_mfma_f32_16x16x32_bf16 v[100:103], a[240:243], a[176:179], v[100:103]
v_mfma_f32_16x16x32_bf16 v[84:87], a[240:243], a[168:171], v[84:87]
v_mfma_f32_16x16x32_bf16 v[84:87], a[244:247], a[172:175], v[84:87]
buffer_load_dwordx4 a[140:143], v41, s[28:31], s44 offen offset:1024 sc1
v_mfma_f32_16x16x32_bf16 v[68:71], a[244:247], a[164:167], v[68:71]
v_mfma_f32_16x16x32_bf16 v[68:71], a[240:243], a[160:163], v[68:71]
s_waitcnt lgkmcnt(4)
v_mfma_f32_16x16x32_bf16 v[72:75], a[224:227], a[160:163], v[72:75]
ds_read_b64_tr_b16 a[240:241], v29 offset:24576
ds_read_b64_tr_b16 a[242:243], v29 offset:25088
v_mfma_f32_16x16x32_bf16 v[72:75], a[228:231], a[164:167], v[72:75]
ds_read_b64_tr_b16 a[244:245], v29 offset:28672
ds_read_b64_tr_b16 a[246:247], v29 offset:29184
v_mfma_f32_16x16x32_bf16 v[88:91], a[228:231], a[172:175], v[88:91]
v_mfma_f32_16x16x32_bf16 v[88:91], a[224:227], a[168:171], v[88:91]
v_mfma_f32_16x16x32_bf16 v[104:107], a[224:227], a[176:179], v[104:107]
v_mfma_f32_16x16x32_bf16 v[104:107], a[228:231], a[180:183], v[104:107]
buffer_load_dwordx4 a[144:147], v42, s[28:31], s44 offen sc1
v_mfma_f32_16x16x32_bf16 v[120:123], a[228:231], a[188:191], v[120:123]
v_mfma_f32_16x16x32_bf16 v[120:123], a[224:227], a[184:187], v[120:123]
s_waitcnt lgkmcnt(4)
v_mfma_f32_16x16x32_bf16 a[48:51], a[232:235], a[184:187], a[48:51]
ds_read_b64_tr_b16 a[224:225], v30 offset:24576
ds_read_b64_tr_b16 a[226:227], v30 offset:25088
v_mfma_f32_16x16x32_bf16 a[48:51], a[236:239], a[188:191], a[48:51]
ds_read_b64_tr_b16 a[228:229], v30 offset:28672
ds_read_b64_tr_b16 a[230:231], v30 offset:29184
v_mfma_f32_16x16x32_bf16 a[32:35], a[236:239], a[180:183], a[32:35]
v_mfma_f32_16x16x32_bf16 a[32:35], a[232:235], a[176:179], a[32:35]
v_mfma_f32_16x16x32_bf16 a[16:19], a[232:235], a[168:171], a[16:19]
v_mfma_f32_16x16x32_bf16 a[16:19], a[236:239], a[172:175], a[16:19]
buffer_load_dwordx4 a[148:151], v42, s[28:31], s44 offen offset:1024 sc1
v_mfma_f32_16x16x32_bf16 a[0:3], a[236:239], a[164:167], a[0:3]
v_mfma_f32_16x16x32_bf16 a[0:3], a[232:235], a[160:163], a[0:3]
s_waitcnt vmcnt(17) lgkmcnt(4)
s_barrier
v_mfma_f32_16x16x32_bf16 a[4:7], a[240:243], a[160:163], a[4:7]
ds_read_b64_tr_b16 a[232:233], v24 offset:32768
ds_read_b64_tr_b16 a[234:235], v24 offset:33792
v_mfma_f32_16x16x32_bf16 a[4:7], a[244:247], a[164:167], a[4:7]
ds_read_b64_tr_b16 a[236:237], v24 offset:40960
ds_read_b64_tr_b16 a[238:239], v24 offset:41984
v_mfma_f32_16x16x32_bf16 a[20:23], a[244:247], a[172:175], a[20:23]
v_mfma_f32_16x16x32_bf16 a[20:23], a[240:243], a[168:171], a[20:23]
v_mfma_f32_16x16x32_bf16 a[36:39], a[240:243], a[176:179], a[36:39]
v_mfma_f32_16x16x32_bf16 a[36:39], a[244:247], a[180:183], a[36:39]
buffer_load_dwordx4 a[152:155], v43, s[28:31], s44 offen sc1
v_mfma_f32_16x16x32_bf16 a[52:55], a[244:247], a[188:191], a[52:55]
v_mfma_f32_16x16x32_bf16 a[52:55], a[240:243], a[184:187], a[52:55]
s_waitcnt lgkmcnt(4)
v_mfma_f32_16x16x32_bf16 a[56:59], a[224:227], a[184:187], a[56:59]
ds_read_b64_tr_b16 a[240:241], v24 offset:32776
ds_read_b64_tr_b16 a[242:243], v24 offset:33800
v_mfma_f32_16x16x32_bf16 a[56:59], a[228:231], a[188:191], a[56:59]
ds_read_b64_tr_b16 a[244:245], v24 offset:40968
ds_read_b64_tr_b16 a[246:247], v24 offset:41992
v_mfma_f32_16x16x32_bf16 a[40:43], a[228:231], a[180:183], a[40:43]
v_mfma_f32_16x16x32_bf16 a[40:43], a[224:227], a[176:179], a[40:43]
v_mfma_f32_16x16x32_bf16 a[24:27], a[224:227], a[168:171], a[24:27]
v_mfma_f32_16x16x32_bf16 a[24:27], a[228:231], a[172:175], a[24:27]
buffer_load_dwordx4 a[156:159], v43, s[28:31], s44 offen offset:1024 sc1
v_mfma_f32_16x16x32_bf16 a[8:11], a[228:231], a[164:167], a[8:11]
v_mfma_f32_16x16x32_bf16 a[8:11], a[224:227], a[160:163], a[8:11]
s_waitcnt lgkmcnt(4)
v_mfma_f32_16x16x32_bf16 v[128:131], a[232:235], a[192:195], v[128:131]
ds_read_b64_tr_b16 a[224:225], v25 offset:32768
ds_read_b64_tr_b16 a[226:227], v25 offset:33792
v_mfma_f32_16x16x32_bf16 v[128:131], a[236:239], a[196:199], v[128:131]
ds_read_b64_tr_b16 a[228:229], v25 offset:40960
ds_read_b64_tr_b16 a[230:231], v25 offset:41984
v_mfma_f32_16x16x32_bf16 v[144:147], a[236:239], a[204:207], v[144:147]
L_pad1:
s_cbranch_execz L_pad2
s_add_u32 m0, s40, 0
s_xor_b32 s43, s101, 2097152
v_mfma_f32_16x16x32_bf16 v[144:147], a[232:235], a[200:203], v[144:147]
buffer_load_dwordx4 v32, s[16:19], s43 offen lds
v_mfma_f32_16x16x32_bf16 v[160:163], a[232:235], a[208:211], v[160:163]
v_mfma_f32_16x16x32_bf16 v[160:163], a[236:239], a[212:215], v[160:163]
buffer_load_dwordx4 v33, s[16:19], s43 offen offset:1024 lds
v_mfma_f32_16x16x32_bf16 v[176:179], a[236:239], a[220:223], v[176:179]
v_mfma_f32_16x16x32_bf16 v[176:179], a[232:235], a[216:219], v[176:179]
s_waitcnt lgkmcnt(4)
v_mfma_f32_16x16x32_bf16 v[240:243], a[240:243], a[216:219], v[240:243]
ds_read_b64_tr_b16 a[232:233], v25 offset:32776
ds_read_b64_tr_b16 a[234:235], v25 offset:33800
v_mfma_f32_16x16x32_bf16 v[240:243], a[244:247], a[220:223], v[240:243]
ds_read_b64_tr_b16 a[236:237], v25 offset:40968
ds_read_b64_tr_b16 a[238:239], v25 offset:41992
v_mfma_f32_16x16x32_bf16 v[224:227], a[244:247], a[212:215], v[224:227]
v_mfma_f32_16x16x32_bf16 v[224:227], a[240:243], a[208:211], v[224:227]
buffer_load_dwordx4 v34, s[16:19], s43 offen offset:2048 lds
v_mfma_f32_16x16x32_bf16 v[208:211], a[240:243], a[200:203], v[208:211]
s_xor_b32 s86, s100, 4
v_mfma_f32_16x16x32_bf16 v[208:211], a[244:247], a[204:207], v[208:211]
buffer_load_dwordx4 v35, s[16:19], s43 offen offset:3072 lds
v_mfma_f32_16x16x32_bf16 v[192:195], a[244:247], a[196:199], v[192:195]
v_mfma_f32_16x16x32_bf16 v[192:195], a[240:243], a[192:195], v[192:195]
s_waitcnt lgkmcnt(4)
v_mfma_f32_16x16x32_bf16 v[132:135], a[224:227], a[192:195], v[132:135]
ds_read_b64_tr_b16 a[240:241], v26 offset:32768
ds_read_b64_tr_b16 a[242:243], v26 offset:33792
v_mfma_f32_16x16x32_bf16 v[132:135], a[228:231], a[196:199], v[132:135]
ds_read_b64_tr_b16 a[244:245], v26 offset:40960
ds_read_b64_tr_b16 a[246:247], v26 offset:41984
v_mfma_f32_16x16x32_bf16 v[148:151], a[228:231], a[204:207], v[148:151]
v_mfma_f32_16x16x32_bf16 v[148:151], a[224:227], a[200:203], v[148:151]
v_mfma_f32_16x16x32_bf16 v[164:167], a[224:227], a[208:211], v[164:167]
s_add_u32 m0, s41, 0
s_mul_i32 s43, s86, 229376
v_mfma_f32_16x16x32_bf16 v[164:167], a[228:231], a[212:215], v[164:167]
buffer_load_dwordx4 v36, s[20:23], s43 offen lds
v_mfma_f32_16x16x32_bf16 v[180:183], a[228:231], a[220:223], v[180:183]
v_mfma_f32_16x16x32_bf16 v[180:183], a[224:227], a[216:219], v[180:183]
s_waitcnt lgkmcnt(4)
v_mfma_f32_16x16x32_bf16 v[244:247], a[232:235], a[216:219], v[244:247]
ds_read_b64_tr_b16 a[224:225], v26 offset:32776
ds_read_b64_tr_b16 a[226:227], v26 offset:33800
v_mfma_f32_16x16x32_bf16 v[244:247], a[236:239], a[220:223], v[244:247]
ds_read_b64_tr_b16 a[228:229], v26 offset:40968
ds_read_b64_tr_b16 a[230:231], v26 offset:41992
v_mfma_f32_16x16x32_bf16 v[228:231], a[236:239], a[212:215], v[228:231]
v_mfma_f32_16x16x32_bf16 v[228:231], a[232:235], a[208:211], v[228:231]
v_mfma_f32_16x16x32_bf16 v[212:215], a[232:235], a[200:203], v[212:215]
v_mfma_f32_16x16x32_bf16 v[212:215], a[236:239], a[204:207], v[212:215]
buffer_load_dwordx4 v37, s[20:23], s43 offen offset:1024 lds
v_mfma_f32_16x16x32_bf16 v[196:199], a[236:239], a[196:199], v[196:199]
v_mfma_f32_16x16x32_bf16 v[196:199], a[232:235], a[192:195], v[196:199]
s_waitcnt lgkmcnt(4)
v_mfma_f32_16x16x32_bf16 v[136:139], a[240:243], a[192:195], v[136:139]
ds_read_b64_tr_b16 a[232:233], v27 offset:32768
ds_read_b64_tr_b16 a[234:235], v27 offset:33792
v_mfma_f32_16x16x32_bf16 v[136:139], a[244:247], a[196:199], v[136:139]
ds_read_b64_tr_b16 a[236:237], v27 offset:40960
ds_read_b64_tr_b16 a[238:239], v27 offset:41984
v_mfma_f32_16x16x32_bf16 v[152:155], a[244:247], a[204:207], v[152:155]
v_mfma_f32_16x16x32_bf16 v[152:155], a[240:243], a[200:203], v[152:155]
v_mfma_f32_16x16x32_bf16 v[168:171], a[240:243], a[208:211], v[168:171]
s_add_u32 m0, s41, 8192
v_mfma_f32_16x16x32_bf16 v[168:171], a[244:247], a[212:215], v[168:171]
buffer_load_dwordx4 v36, s[24:27], s43 offen lds
v_mfma_f32_16x16x32_bf16 v[184:187], a[244:247], a[220:223], v[184:187]
v_mfma_f32_16x16x32_bf16 v[184:187], a[240:243], a[216:219], v[184:187]
s_waitcnt lgkmcnt(4)
v_mfma_f32_16x16x32_bf16 v[248:251], a[224:227], a[216:219], v[248:251]
ds_read_b64_tr_b16 a[240:241], v27 offset:32776
ds_read_b64_tr_b16 a[242:243], v27 offset:33800
v_mfma_f32_16x16x32_bf16 v[248:251], a[228:231], a[220:223], v[248:251]
ds_read_b64_tr_b16 a[244:245], v27 offset:40968
ds_read_b64_tr_b16 a[246:247], v27 offset:41992
v_mfma_f32_16x16x32_bf16 v[232:235], a[228:231], a[212:215], v[232:235]
v_mfma_f32_16x16x32_bf16 v[232:235], a[224:227], a[208:211], v[232:235]
v_mfma_f32_16x16x32_bf16 v[216:219], a[224:227], a[200:203], v[216:219]
v_mfma_f32_16x16x32_bf16 v[216:219], a[228:231], a[204:207], v[216:219]
buffer_load_dwordx4 v37, s[24:27], s43 offen offset:1024 lds
v_mfma_f32_16x16x32_bf16 v[200:203], a[228:231], a[196:199], v[200:203]
v_mfma_f32_16x16x32_bf16 v[200:203], a[224:227], a[192:195], v[200:203]
s_waitcnt lgkmcnt(4)
v_mfma_f32_16x16x32_bf16 v[140:143], a[232:235], a[192:195], v[140:143]
ds_read_b64_tr_b16 a[224:225], v28 offset:32768
ds_read_b64_tr_b16 a[226:227], v28 offset:33280
v_mfma_f32_16x16x32_bf16 v[140:143], a[236:239], a[196:199], v[140:143]
ds_read_b64_tr_b16 a[228:229], v28 offset:36864
ds_read_b64_tr_b16 a[230:231], v28 offset:37376
v_mfma_f32_16x16x32_bf16 v[156:159], a[236:239], a[204:207], v[156:159]
v_mfma_f32_16x16x32_bf16 v[156:159], a[232:235], a[200:203], v[156:159]
v_mfma_f32_16x16x32_bf16 v[172:175], a[232:235], a[208:211], v[172:175]
s_xor_b32 s44, s79, 8192
v_mfma_f32_16x16x32_bf16 v[172:175], a[236:239], a[212:215], v[172:175]
buffer_load_dwordx4 a[160:163], v40, s[28:31], s44 offen sc1
v_mfma_f32_16x16x32_bf16 v[188:191], a[236:239], a[220:223], v[188:191]
v_mfma_f32_16x16x32_bf16 v[188:191], a[232:235], a[216:219], v[188:191]
s_waitcnt lgkmcnt(4)
v_mfma_f32_16x16x32_bf16 v[252:255], a[240:243], a[216:219], v[252:255]
ds_read_b64_tr_b16 a[232:233], v29 offset:32768
ds_read_b64_tr_b16 a[234:235], v29 offset:33280
v_mfma_f32_16x16x32_bf16 v[252:255], a[244:247], a[220:223], v[252:255]
ds_read_b64_tr_b16 a[236:237], v29 offset:36864
ds_read_b64_tr_b16 a[238:239], v29 offset:37376
v_mfma_f32_16x16x32_bf16 v[236:239], a[244:247], a[212:215], v[236:239]
v_mfma_f32_16x16x32_bf16 v[236:239], a[240:243], a[208:211], v[236:239]
v_mfma_f32_16x16x32_bf16 v[220:223], a[240:243], a[200:203], v[220:223]
v_mfma_f32_16x16x32_bf16 v[220:223], a[244:247], a[204:207], v[220:223]
buffer_load_dwordx4 a[164:167], v40, s[28:31], s44 offen offset:1024 sc1
v_mfma_f32_16x16x32_bf16 v[204:207], a[244:247], a[196:199], v[204:207]
v_mfma_f32_16x16x32_bf16 v[204:207], a[240:243], a[192:195], v[204:207]
s_waitcnt lgkmcnt(4)
v_mfma_f32_16x16x32_bf16 v[64:67], a[224:227], a[192:195], v[64:67]
ds_read_b64_tr_b16 a[240:241], v30 offset:32768
ds_read_b64_tr_b16 a[242:243], v30 offset:33280
v_mfma_f32_16x16x32_bf16 v[64:67], a[228:231], a[196:199], v[64:67]
ds_read_b64_tr_b16 a[244:245], v30 offset:36864
ds_read_b64_tr_b16 a[246:247], v30 offset:37376
v_mfma_f32_16x16x32_bf16 v[80:83], a[228:231], a[204:207], v[80:83]
v_mfma_f32_16x16x32_bf16 v[80:83], a[224:227], a[200:203], v[80:83]
v_mfma_f32_16x16x32_bf16 v[96:99], a[224:227], a[208:211], v[96:99]
v_mfma_f32_16x16x32_bf16 v[96:99], a[228:231], a[212:215], v[96:99]
buffer_load_dwordx4 a[168:171], v41, s[28:31], s44 offen sc1
v_mfma_f32_16x16x32_bf16 v[112:115], a[228:231], a[220:223], v[112:115]
v_mfma_f32_16x16x32_bf16 v[112:115], a[224:227], a[216:219], v[112:115]
s_waitcnt lgkmcnt(4)
v_mfma_f32_16x16x32_bf16 v[116:119], a[232:235], a[216:219], v[116:119]
ds_read_b64_tr_b16 a[224:225], v28 offset:40960
ds_read_b64_tr_b16 a[226:227], v28 offset:41472
v_mfma_f32_16x16x32_bf16 v[116:119], a[236:239], a[220:223], v[116:119]
ds_read_b64_tr_b16 a[228:229], v28 offset:45056
ds_read_b64_tr_b16 a[230:231], v28 offset:45568
v_mfma_f32_16x16x32_bf16 v[100:103], a[236:239], a[212:215], v[100:103]
v_mfma_f32_16x16x32_bf16 v[100:103], a[232:235], a[208:211], v[100:103]
v_mfma_f32_16x16x32_bf16 v[84:87], a[232:235], a[200:203], v[84:87]
v_mfma_f32_16x16x32_bf16 v[84:87], a[236:239], a[204:207], v[84:87]
buffer_load_dwordx4 a[172:175], v41, s[28:31], s44 offen offset:1024 sc1
v_mfma_f32_16x16x32_bf16 v[68:71], a[236:239], a[196:199], v[68:71]
v_mfma_f32_16x16x32_bf16 v[68:71], a[232:235], a[192:195], v[68:71]
s_waitcnt lgkmcnt(4)
v_mfma_f32_16x16x32_bf16 v[72:75], a[240:243], a[192:195], v[72:75]
ds_read_b64_tr_b16 a[232:233], v29 offset:40960
ds_read_b64_tr_b16 a[234:235], v29 offset:41472
v_mfma_f32_16x16x32_bf16 v[72:75], a[244:247], a[196:199], v[72:75]
ds_read_b64_tr_b16 a[236:237], v29 offset:45056
ds_read_b64_tr_b16 a[238:239], v29 offset:45568
v_mfma_f32_16x16x32_bf16 v[88:91], a[244:247], a[204:207], v[88:91]
v_mfma_f32_16x16x32_bf16 v[88:91], a[240:243], a[200:203], v[88:91]
v_mfma_f32_16x16x32_bf16 v[104:107], a[240:243], a[208:211], v[104:107]
v_mfma_f32_16x16x32_bf16 v[104:107], a[244:247], a[212:215], v[104:107]
buffer_load_dwordx4 a[176:179], v42, s[28:31], s44 offen sc1
v_mfma_f32_16x16x32_bf16 v[120:123], a[244:247], a[220:223], v[120:123]
v_mfma_f32_16x16x32_bf16 v[120:123], a[240:243], a[216:219], v[120:123]
s_waitcnt lgkmcnt(4)
v_mfma_f32_16x16x32_bf16 a[48:51], a[224:227], a[216:219], a[48:51]
ds_read_b64_tr_b16 a[240:241], v30 offset:40960
ds_read_b64_tr_b16 a[242:243], v30 offset:41472
v_mfma_f32_16x16x32_bf16 a[48:51], a[228:231], a[220:223], a[48:51]
ds_read_b64_tr_b16 a[244:245], v30 offset:45056
ds_read_b64_tr_b16 a[246:247], v30 offset:45568
v_mfma_f32_16x16x32_bf16 a[32:35], a[228:231], a[212:215], a[32:35]
v_mfma_f32_16x16x32_bf16 a[32:35], a[224:227], a[208:211], a[32:35]
v_mfma_f32_16x16x32_bf16 a[16:19], a[224:227], a[200:203], a[16:19]
v_mfma_f32_16x16x32_bf16 a[16:19], a[228:231], a[204:207], a[16:19]
buffer_load_dwordx4 a[180:183], v42, s[28:31], s44 offen offset:1024 sc1
v_mfma_f32_16x16x32_bf16 a[0:3], a[228:231], a[196:199], a[0:3]
v_mfma_f32_16x16x32_bf16 a[0:3], a[224:227], a[192:195], a[0:3]
s_waitcnt vmcnt(14) lgkmcnt(4)
s_barrier
v_mfma_f32_16x16x32_bf16 a[4:7], a[232:235], a[192:195], a[4:7]
ds_read_b64_tr_b16 a[224:225], v24 offset:49152
ds_read_b64_tr_b16 a[226:227], v24 offset:50176
v_mfma_f32_16x16x32_bf16 a[4:7], a[236:239], a[196:199], a[4:7]
ds_read_b64_tr_b16 a[228:229], v24 offset:57344
ds_read_b64_tr_b16 a[230:231], v24 offset:58368
v_mfma_f32_16x16x32_bf16 a[20:23], a[236:239], a[204:207], a[20:23]
v_mfma_f32_16x16x32_bf16 a[20:23], a[232:235], a[200:203], a[20:23]
v_mfma_f32_16x16x32_bf16 a[36:39], a[232:235], a[208:211], a[36:39]
v_mfma_f32_16x16x32_bf16 a[36:39], a[236:239], a[212:215], a[36:39]
buffer_load_dwordx4 a[184:187], v43, s[28:31], s44 offen sc1
v_mfma_f32_16x16x32_bf16 a[52:55], a[236:239], a[220:223], a[52:55]
v_mfma_f32_16x16x32_bf16 a[52:55], a[232:235], a[216:219], a[52:55]
s_waitcnt lgkmcnt(4)
v_mfma_f32_16x16x32_bf16 a[56:59], a[240:243], a[216:219], a[56:59]
ds_read_b64_tr_b16 a[232:233], v24 offset:49160
ds_read_b64_tr_b16 a[234:235], v24 offset:50184
v_mfma_f32_16x16x32_bf16 a[56:59], a[244:247], a[220:223], a[56:59]
ds_read_b64_tr_b16 a[236:237], v24 offset:57352
ds_read_b64_tr_b16 a[238:239], v24 offset:58376
v_mfma_f32_16x16x32_bf16 a[40:43], a[244:247], a[212:215], a[40:43]
v_mfma_f32_16x16x32_bf16 a[40:43], a[240:243], a[208:211], a[40:43]
v_mfma_f32_16x16x32_bf16 a[24:27], a[240:243], a[200:203], a[24:27]
v_mfma_f32_16x16x32_bf16 a[24:27], a[244:247], a[204:207], a[24:27]
buffer_load_dwordx4 a[188:191], v43, s[28:31], s44 offen offset:1024 sc1
v_mfma_f32_16x16x32_bf16 a[8:11], a[244:247], a[196:199], a[8:11]
v_mfma_f32_16x16x32_bf16 a[8:11], a[240:243], a[192:195], a[8:11]
s_waitcnt lgkmcnt(4)
v_mfma_f32_16x16x32_bf16 v[128:131], a[224:227], a[128:131], v[128:131]
ds_read_b64_tr_b16 a[240:241], v25 offset:49152
ds_read_b64_tr_b16 a[242:243], v25 offset:50176
v_mfma_f32_16x16x32_bf16 v[128:131], a[228:231], a[132:135], v[128:131]
ds_read_b64_tr_b16 a[244:245], v25 offset:57344
ds_read_b64_tr_b16 a[246:247], v25 offset:58368
v_mfma_f32_16x16x32_bf16 v[144:147], a[228:231], a[140:143], v[144:147]
s_add_u32 m0, s40, 16384
s_xor_b32 s43, s101, 2621440
v_mfma_f32_16x16x32_bf16 v[144:147], a[224:227], a[136:139], v[144:147]
buffer_load_dwordx4 v32, s[16:19], s43 offen lds
v_mfma_f32_16x16x32_bf16 v[160:163], a[224:227], a[144:147], v[160:163]
v_mfma_f32_16x16x32_bf16 v[160:163], a[228:231], a[148:151], v[160:163]
buffer_load_dwordx4 v33, s[16:19], s43 offen offset:1024 lds
v_mfma_f32_16x16x32_bf16 v[176:179], a[228:231], a[156:159], v[176:179]
v_mfma_f32_16x16x32_bf16 v[176:179], a[224:227], a[152:155], v[176:179]
s_waitcnt lgkmcnt(4)
v_mfma_f32_16x16x32_bf16 v[240:243], a[232:235], a[152:155], v[240:243]
ds_read_b64_tr_b16 a[224:225], v25 offset:49160
ds_read_b64_tr_b16 a[226:227], v25 offset:50184
v_mfma_f32_16x16x32_bf16 v[240:243], a[236:239], a[156:159], v[240:243]
ds_read_b64_tr_b16 a[228:229], v25 offset:57352
ds_read_b64_tr_b16 a[230:231], v25 offset:58376
v_mfma_f32_16x16x32_bf16 v[224:227], a[236:239], a[148:151], v[224:227]
v_mfma_f32_16x16x32_bf16 v[224:227], a[232:235], a[144:147], v[224:227]
buffer_load_dwordx4 v34, s[16:19], s43 offen offset:2048 lds
v_mfma_f32_16x16x32_bf16 v[208:211], a[232:235], a[136:139], v[208:211]
s_xor_b32 s86, s100, 5
v_mfma_f32_16x16x32_bf16 v[208:211], a[236:239], a[140:143], v[208:211]
buffer_load_dwordx4 v35, s[16:19], s43 offen offset:3072 lds
v_mfma_f32_16x16x32_bf16 v[192:195], a[236:239], a[132:135], v[192:195]
v_mfma_f32_16x16x32_bf16 v[192:195], a[232:235], a[128:131], v[192:195]
s_waitcnt lgkmcnt(4)
v_mfma_f32_16x16x32_bf16 v[132:135], a[240:243], a[128:131], v[132:135]
ds_read_b64_tr_b16 a[232:233], v26 offset:49152
ds_read_b64_tr_b16 a[234:235], v26 offset:50176
v_mfma_f32_16x16x32_bf16 v[132:135], a[244:247], a[132:135], v[132:135]
ds_read_b64_tr_b16 a[236:237], v26 offset:57344
ds_read_b64_tr_b16 a[238:239], v26 offset:58368
v_mfma_f32_16x16x32_bf16 v[148:151], a[244:247], a[140:143], v[148:151]
v_mfma_f32_16x16x32_bf16 v[148:151], a[240:243], a[136:139], v[148:151]
v_mfma_f32_16x16x32_bf16 v[164:167], a[240:243], a[144:147], v[164:167]
s_add_u32 m0, s41, 16384
s_mul_i32 s43, s86, 229376
v_mfma_f32_16x16x32_bf16 v[164:167], a[244:247], a[148:151], v[164:167]
buffer_load_dwordx4 v36, s[20:23], s43 offen lds
v_mfma_f32_16x16x32_bf16 v[180:183], a[244:247], a[156:159], v[180:183]
v_mfma_f32_16x16x32_bf16 v[180:183], a[240:243], a[152:155], v[180:183]
s_waitcnt lgkmcnt(4)
v_mfma_f32_16x16x32_bf16 v[244:247], a[224:227], a[152:155], v[244:247]
ds_read_b64_tr_b16 a[240:241], v26 offset:49160
ds_read_b64_tr_b16 a[242:243], v26 offset:50184
v_mfma_f32_16x16x32_bf16 v[244:247], a[228:231], a[156:159], v[244:247]
ds_read_b64_tr_b16 a[244:245], v26 offset:57352
ds_read_b64_tr_b16 a[246:247], v26 offset:58376
v_mfma_f32_16x16x32_bf16 v[228:231], a[228:231], a[148:151], v[228:231]
v_mfma_f32_16x16x32_bf16 v[228:231], a[224:227], a[144:147], v[228:231]
v_mfma_f32_16x16x32_bf16 v[212:215], a[224:227], a[136:139], v[212:215]
v_mfma_f32_16x16x32_bf16 v[212:215], a[228:231], a[140:143], v[212:215]
buffer_load_dwordx4 v37, s[20:23], s43 offen offset:1024 lds
v_mfma_f32_16x16x32_bf16 v[196:199], a[228:231], a[132:135], v[196:199]
v_mfma_f32_16x16x32_bf16 v[196:199], a[224:227], a[128:131], v[196:199]
s_waitcnt lgkmcnt(4)
v_mfma_f32_16x16x32_bf16 v[136:139], a[232:235], a[128:131], v[136:139]
ds_read_b64_tr_b16 a[224:225], v27 offset:49152
ds_read_b64_tr_b16 a[226:227], v27 offset:50176
v_mfma_f32_16x16x32_bf16 v[136:139], a[236:239], a[132:135], v[136:139]
ds_read_b64_tr_b16 a[228:229], v27 offset:57344
ds_read_b64_tr_b16 a[230:231], v27 offset:58368
v_mfma_f32_16x16x32_bf16 v[152:155], a[236:239], a[140:143], v[152:155]
v_mfma_f32_16x16x32_bf16 v[152:155], a[232:235], a[136:139], v[152:155]
v_mfma_f32_16x16x32_bf16 v[168:171], a[232:235], a[144:147], v[168:171]
s_add_u32 m0, s41, 24576
v_mfma_f32_16x16x32_bf16 v[168:171], a[236:239], a[148:151], v[168:171]
buffer_load_dwordx4 v36, s[24:27], s43 offen lds
v_mfma_f32_16x16x32_bf16 v[184:187], a[236:239], a[156:159], v[184:187]
v_mfma_f32_16x16x32_bf16 v[184:187], a[232:235], a[152:155], v[184:187]
s_waitcnt lgkmcnt(4)
v_mfma_f32_16x16x32_bf16 v[248:251], a[240:243], a[152:155], v[248:251]
ds_read_b64_tr_b16 a[232:233], v27 offset:49160
ds_read_b64_tr_b16 a[234:235], v27 offset:50184
v_mfma_f32_16x16x32_bf16 v[248:251], a[244:247], a[156:159], v[248:251]
ds_read_b64_tr_b16 a[236:237], v27 offset:57352
ds_read_b64_tr_b16 a[238:239], v27 offset:58376
v_mfma_f32_16x16x32_bf16 v[232:235], a[244:247], a[148:151], v[232:235]
v_mfma_f32_16x16x32_bf16 v[232:235], a[240:243], a[144:147], v[232:235]
v_mfma_f32_16x16x32_bf16 v[216:219], a[240:243], a[136:139], v[216:219]
v_mfma_f32_16x16x32_bf16 v[216:219], a[244:247], a[140:143], v[216:219]
buffer_load_dwordx4 v37, s[24:27], s43 offen offset:1024 lds
v_mfma_f32_16x16x32_bf16 v[200:203], a[244:247], a[132:135], v[200:203]
v_mfma_f32_16x16x32_bf16 v[200:203], a[240:243], a[128:131], v[200:203]
s_waitcnt lgkmcnt(4)
v_mfma_f32_16x16x32_bf16 v[140:143], a[224:227], a[128:131], v[140:143]
ds_read_b64_tr_b16 a[240:241], v28 offset:49152
ds_read_b64_tr_b16 a[242:243], v28 offset:49664
v_mfma_f32_16x16x32_bf16 v[140:143], a[228:231], a[132:135], v[140:143]
ds_read_b64_tr_b16 a[244:245], v28 offset:53248
ds_read_b64_tr_b16 a[246:247], v28 offset:53760
v_mfma_f32_16x16x32_bf16 v[156:159], a[228:231], a[140:143], v[156:159]
v_mfma_f32_16x16x32_bf16 v[156:159], a[224:227], a[136:139], v[156:159]
v_mfma_f32_16x16x32_bf16 v[172:175], a[224:227], a[144:147], v[172:175]
s_xor_b32 s44, s79, 10240
v_mfma_f32_16x16x32_bf16 v[172:175], a[228:231], a[148:151], v[172:175]
buffer_load_dwordx4 a[192:195], v40, s[28:31], s44 offen sc1
v_mfma_f32_16x16x32_bf16 v[188:191], a[228:231], a[156:159], v[188:191]
v_mfma_f32_16x16x32_bf16 v[188:191], a[224:227], a[152:155], v[188:191]
s_waitcnt lgkmcnt(4)
v_mfma_f32_16x16x32_bf16 v[252:255], a[232:235], a[152:155], v[252:255]
ds_read_b64_tr_b16 a[224:225], v29 offset:49152
ds_read_b64_tr_b16 a[226:227], v29 offset:49664
v_mfma_f32_16x16x32_bf16 v[252:255], a[236:239], a[156:159], v[252:255]
ds_read_b64_tr_b16 a[228:229], v29 offset:53248
ds_read_b64_tr_b16 a[230:231], v29 offset:53760
v_mfma_f32_16x16x32_bf16 v[236:239], a[236:239], a[148:151], v[236:239]
v_mfma_f32_16x16x32_bf16 v[236:239], a[232:235], a[144:147], v[236:239]
v_mfma_f32_16x16x32_bf16 v[220:223], a[232:235], a[136:139], v[220:223]
v_mfma_f32_16x16x32_bf16 v[220:223], a[236:239], a[140:143], v[220:223]
buffer_load_dwordx4 a[196:199], v40, s[28:31], s44 offen offset:1024 sc1
v_mfma_f32_16x16x32_bf16 v[204:207], a[236:239], a[132:135], v[204:207]
v_mfma_f32_16x16x32_bf16 v[204:207], a[232:235], a[128:131], v[204:207]
s_waitcnt lgkmcnt(4)
v_mfma_f32_16x16x32_bf16 v[64:67], a[240:243], a[128:131], v[64:67]
ds_read_b64_tr_b16 a[232:233], v30 offset:49152
ds_read_b64_tr_b16 a[234:235], v30 offset:49664
v_mfma_f32_16x16x32_bf16 v[64:67], a[244:247], a[132:135], v[64:67]
ds_read_b64_tr_b16 a[236:237], v30 offset:53248
ds_read_b64_tr_b16 a[238:239], v30 offset:53760
v_mfma_f32_16x16x32_bf16 v[80:83], a[244:247], a[140:143], v[80:83]
v_mfma_f32_16x16x32_bf16 v[80:83], a[240:243], a[136:139], v[80:83]
v_mfma_f32_16x16x32_bf16 v[96:99], a[240:243], a[144:147], v[96:99]
v_mfma_f32_16x16x32_bf16 v[96:99], a[244:247], a[148:151], v[96:99]
buffer_load_dwordx4 a[200:203], v41, s[28:31], s44 offen sc1
v_mfma_f32_16x16x32_bf16 v[112:115], a[244:247], a[156:159], v[112:115]
v_mfma_f32_16x16x32_bf16 v[112:115], a[240:243], a[152:155], v[112:115]
s_waitcnt lgkmcnt(4)
v_mfma_f32_16x16x32_bf16 v[116:119], a[224:227], a[152:155], v[116:119]
ds_read_b64_tr_b16 a[240:241], v28 offset:57344
ds_read_b64_tr_b16 a[242:243], v28 offset:57856
v_mfma_f32_16x16x32_bf16 v[116:119], a[228:231], a[156:159], v[116:119]
ds_read_b64_tr_b16 a[244:245], v28 offset:61440
ds_read_b64_tr_b16 a[246:247], v28 offset:61952
v_mfma_f32_16x16x32_bf16 v[100:103], a[228:231], a[148:151], v[100:103]
v_mfma_f32_16x16x32_bf16 v[100:103], a[224:227], a[144:147], v[100:103]
v_mfma_f32_16x16x32_bf16 v[84:87], a[224:227], a[136:139], v[84:87]
v_mfma_f32_16x16x32_bf16 v[84:87], a[228:231], a[140:143], v[84:87]
buffer_load_dwordx4 a[204:207], v41, s[28:31], s44 offen offset:1024 sc1
v_mfma_f32_16x16x32_bf16 v[68:71], a[228:231], a[132:135], v[68:71]
v_mfma_f32_16x16x32_bf16 v[68:71], a[224:227], a[128:131], v[68:71]
s_waitcnt lgkmcnt(4)
v_mfma_f32_16x16x32_bf16 v[72:75], a[232:235], a[128:131], v[72:75]
ds_read_b64_tr_b16 a[224:225], v29 offset:57344
ds_read_b64_tr_b16 a[226:227], v29 offset:57856
v_mfma_f32_16x16x32_bf16 v[72:75], a[236:239], a[132:135], v[72:75]
ds_read_b64_tr_b16 a[228:229], v29 offset:61440
ds_read_b64_tr_b16 a[230:231], v29 offset:61952
v_mfma_f32_16x16x32_bf16 v[88:91], a[236:239], a[140:143], v[88:91]
v_mfma_f32_16x16x32_bf16 v[88:91], a[232:235], a[136:139], v[88:91]
v_mfma_f32_16x16x32_bf16 v[104:107], a[232:235], a[144:147], v[104:107]
v_mfma_f32_16x16x32_bf16 v[104:107], a[236:239], a[148:151], v[104:107]
buffer_load_dwordx4 a[208:211], v42, s[28:31], s44 offen sc1
v_mfma_f32_16x16x32_bf16 v[120:123], a[236:239], a[156:159], v[120:123]
v_mfma_f32_16x16x32_bf16 v[120:123], a[232:235], a[152:155], v[120:123]
s_waitcnt lgkmcnt(4)
v_mfma_f32_16x16x32_bf16 a[48:51], a[240:243], a[152:155], a[48:51]
ds_read_b64_tr_b16 a[232:233], v30 offset:57344
ds_read_b64_tr_b16 a[234:235], v30 offset:57856
v_mfma_f32_16x16x32_bf16 a[48:51], a[244:247], a[156:159], a[48:51]
ds_read_b64_tr_b16 a[236:237], v30 offset:61440
ds_read_b64_tr_b16 a[238:239], v30 offset:61952
v_mfma_f32_16x16x32_bf16 a[32:35], a[244:247], a[148:151], a[32:35]
v_mfma_f32_16x16x32_bf16 a[32:35], a[240:243], a[144:147], a[32:35]
v_mfma_f32_16x16x32_bf16 a[16:19], a[240:243], a[136:139], a[16:19]
v_mfma_f32_16x16x32_bf16 a[16:19], a[244:247], a[140:143], a[16:19]
buffer_load_dwordx4 a[212:215], v42, s[28:31], s44 offen offset:1024 sc1
v_mfma_f32_16x16x32_bf16 a[0:3], a[244:247], a[132:135], a[0:3]
v_mfma_f32_16x16x32_bf16 a[0:3], a[240:243], a[128:131], a[0:3]
s_waitcnt vmcnt(14) lgkmcnt(4)
s_barrier
v_mfma_f32_16x16x32_bf16 a[4:7], a[224:227], a[128:131], a[4:7]
ds_read_b64_tr_b16 a[240:241], v24 offset:0
ds_read_b64_tr_b16 a[242:243], v24 offset:1024
v_mfma_f32_16x16x32_bf16 a[4:7], a[228:231], a[132:135], a[4:7]
ds_read_b64_tr_b16 a[244:245], v24 offset:8192
ds_read_b64_tr_b16 a[246:247], v24 offset:9216
v_mfma_f32_16x16x32_bf16 a[20:23], a[228:231], a[140:143], a[20:23]
v_mfma_f32_16x16x32_bf16 a[20:23], a[224:227], a[136:139], a[20:23]
v_mfma_f32_16x16x32_bf16 a[36:39], a[224:227], a[144:147], a[36:39]
v_mfma_f32_16x16x32_bf16 a[36:39], a[228:231], a[148:151], a[36:39]
buffer_load_dwordx4 a[216:219], v43, s[28:31], s44 offen sc1
v_mfma_f32_16x16x32_bf16 a[52:55], a[228:231], a[156:159], a[52:55]
v_mfma_f32_16x16x32_bf16 a[52:55], a[224:227], a[152:155], a[52:55]
s_waitcnt lgkmcnt(4)
v_mfma_f32_16x16x32_bf16 a[56:59], a[232:235], a[152:155], a[56:59]
ds_read_b64_tr_b16 a[224:225], v24 offset:8
ds_read_b64_tr_b16 a[226:227], v24 offset:1032
v_mfma_f32_16x16x32_bf16 a[56:59], a[236:239], a[156:159], a[56:59]
ds_read_b64_tr_b16 a[228:229], v24 offset:8200
ds_read_b64_tr_b16 a[230:231], v24 offset:9224
v_mfma_f32_16x16x32_bf16 a[40:43], a[236:239], a[148:151], a[40:43]
v_mfma_f32_16x16x32_bf16 a[40:43], a[232:235], a[144:147], a[40:43]
v_mfma_f32_16x16x32_bf16 a[24:27], a[232:235], a[136:139], a[24:27]
v_mfma_f32_16x16x32_bf16 a[24:27], a[236:239], a[140:143], a[24:27]
buffer_load_dwordx4 a[220:223], v43, s[28:31], s44 offen offset:1024 sc1
v_mfma_f32_16x16x32_bf16 a[8:11], a[236:239], a[132:135], a[8:11]
v_mfma_f32_16x16x32_bf16 a[8:11], a[232:235], a[128:131], a[8:11]
s_waitcnt lgkmcnt(4)
v_mfma_f32_16x16x32_bf16 v[128:131], a[240:243], a[160:163], v[128:131]
ds_read_b64_tr_b16 a[232:233], v25 offset:0
ds_read_b64_tr_b16 a[234:235], v25 offset:1024
v_mfma_f32_16x16x32_bf16 v[128:131], a[244:247], a[164:167], v[128:131]
ds_read_b64_tr_b16 a[236:237], v25 offset:8192
ds_read_b64_tr_b16 a[238:239], v25 offset:9216
v_mfma_f32_16x16x32_bf16 v[144:147], a[244:247], a[172:175], v[144:147]
s_add_u32 m0, s40, 32768
s_xor_b32 s43, s101, 3145728
v_mfma_f32_16x16x32_bf16 v[144:147], a[240:243], a[168:171], v[144:147]
buffer_load_dwordx4 v32, s[16:19], s43 offen lds
v_mfma_f32_16x16x32_bf16 v[160:163], a[240:243], a[176:179], v[160:163]
v_mfma_f32_16x16x32_bf16 v[160:163], a[244:247], a[180:183], v[160:163]
buffer_load_dwordx4 v33, s[16:19], s43 offen offset:1024 lds
v_mfma_f32_16x16x32_bf16 v[176:179], a[244:247], a[188:191], v[176:179]
v_mfma_f32_16x16x32_bf16 v[176:179], a[240:243], a[184:187], v[176:179]
s_waitcnt lgkmcnt(4)
v_mfma_f32_16x16x32_bf16 v[240:243], a[224:227], a[184:187], v[240:243]
ds_read_b64_tr_b16 a[240:241], v25 offset:8
ds_read_b64_tr_b16 a[242:243], v25 offset:1032
v_mfma_f32_16x16x32_bf16 v[240:243], a[228:231], a[188:191], v[240:243]
ds_read_b64_tr_b16 a[244:245], v25 offset:8200
ds_read_b64_tr_b16 a[246:247], v25 offset:9224
v_mfma_f32_16x16x32_bf16 v[224:227], a[228:231], a[180:183], v[224:227]
v_mfma_f32_16x16x32_bf16 v[224:227], a[224:227], a[176:179], v[224:227]
buffer_load_dwordx4 v34, s[16:19], s43 offen offset:2048 lds
v_mfma_f32_16x16x32_bf16 v[208:211], a[224:227], a[168:171], v[208:211]
s_xor_b32 s86, s100, 6
v_mfma_f32_16x16x32_bf16 v[208:211], a[228:231], a[172:175], v[208:211]
buffer_load_dwordx4 v35, s[16:19], s43 offen offset:3072 lds
v_mfma_f32_16x16x32_bf16 v[192:195], a[228:231], a[164:167], v[192:195]
v_mfma_f32_16x16x32_bf16 v[192:195], a[224:227], a[160:163], v[192:195]
s_waitcnt lgkmcnt(4)
v_mfma_f32_16x16x32_bf16 v[132:135], a[232:235], a[160:163], v[132:135]
ds_read_b64_tr_b16 a[224:225], v26 offset:0
ds_read_b64_tr_b16 a[226:227], v26 offset:1024
v_mfma_f32_16x16x32_bf16 v[132:135], a[236:239], a[164:167], v[132:135]
ds_read_b64_tr_b16 a[228:229], v26 offset:8192
ds_read_b64_tr_b16 a[230:231], v26 offset:9216
v_mfma_f32_16x16x32_bf16 v[148:151], a[236:239], a[172:175], v[148:151]
v_mfma_f32_16x16x32_bf16 v[148:151], a[232:235], a[168:171], v[148:151]
v_mfma_f32_16x16x32_bf16 v[164:167], a[232:235], a[176:179], v[164:167]
s_add_u32 m0, s41, 32768
s_mul_i32 s43, s86, 229376
v_mfma_f32_16x16x32_bf16 v[164:167], a[236:239], a[180:183], v[164:167]
buffer_load_dwordx4 v36, s[20:23], s43 offen lds
v_mfma_f32_16x16x32_bf16 v[180:183], a[236:239], a[188:191], v[180:183]
v_mfma_f32_16x16x32_bf16 v[180:183], a[232:235], a[184:187], v[180:183]
s_waitcnt lgkmcnt(4)
v_mfma_f32_16x16x32_bf16 v[244:247], a[240:243], a[184:187], v[244:247]
ds_read_b64_tr_b16 a[232:233], v26 offset:8
ds_read_b64_tr_b16 a[234:235], v26 offset:1032
v_mfma_f32_16x16x32_bf16 v[244:247], a[244:247], a[188:191], v[244:247]
ds_read_b64_tr_b16 a[236:237], v26 offset:8200
ds_read_b64_tr_b16 a[238:239], v26 offset:9224
v_mfma_f32_16x16x32_bf16 v[228:231], a[244:247], a[180:183], v[228:231]
v_mfma_f32_16x16x32_bf16 v[228:231], a[240:243], a[176:179], v[228:231]
v_mfma_f32_16x16x32_bf16 v[212:215], a[240:243], a[168:171], v[212:215]
v_mfma_f32_16x16x32_bf16 v[212:215], a[244:247], a[172:175], v[212:215]
buffer_load_dwordx4 v37, s[20:23], s43 offen offset:1024 lds
v_mfma_f32_16x16x32_bf16 v[196:199], a[244:247], a[164:167], v[196:199]
v_mfma_f32_16x16x32_bf16 v[196:199], a[240:243], a[160:163], v[196:199]
s_waitcnt lgkmcnt(4)
v_mfma_f32_16x16x32_bf16 v[136:139], a[224:227], a[160:163], v[136:139]
ds_read_b64_tr_b16 a[240:241], v27 offset:0
ds_read_b64_tr_b16 a[242:243], v27 offset:1024
v_mfma_f32_16x16x32_bf16 v[136:139], a[228:231], a[164:167], v[136:139]
ds_read_b64_tr_b16 a[244:245], v27 offset:8192
ds_read_b64_tr_b16 a[246:247], v27 offset:9216
v_mfma_f32_16x16x32_bf16 v[152:155], a[228:231], a[172:175], v[152:155]
v_mfma_f32_16x16x32_bf16 v[152:155], a[224:227], a[168:171], v[152:155]
v_mfma_f32_16x16x32_bf16 v[168:171], a[224:227], a[176:179], v[168:171]
s_add_u32 m0, s41, 40960
v_mfma_f32_16x16x32_bf16 v[168:171], a[228:231], a[180:183], v[168:171]
buffer_load_dwordx4 v36, s[24:27], s43 offen lds
v_mfma_f32_16x16x32_bf16 v[184:187], a[228:231], a[188:191], v[184:187]
v_mfma_f32_16x16x32_bf16 v[184:187], a[224:227], a[184:187], v[184:187]
s_waitcnt lgkmcnt(4)
v_mfma_f32_16x16x32_bf16 v[248:251], a[232:235], a[184:187], v[248:251]
ds_read_b64_tr_b16 a[224:225], v27 offset:8
ds_read_b64_tr_b16 a[226:227], v27 offset:1032
v_mfma_f32_16x16x32_bf16 v[248:251], a[236:239], a[188:191], v[248:251]
ds_read_b64_tr_b16 a[228:229], v27 offset:8200
ds_read_b64_tr_b16 a[230:231], v27 offset:9224
v_mfma_f32_16x16x32_bf16 v[232:235], a[236:239], a[180:183], v[232:235]
v_mfma_f32_16x16x32_bf16 v[232:235], a[232:235], a[176:179], v[232:235]
v_mfma_f32_16x16x32_bf16 v[216:219], a[232:235], a[168:171], v[216:219]
v_mfma_f32_16x16x32_bf16 v[216:219], a[236:239], a[172:175], v[216:219]
buffer_load_dwordx4 v37, s[24:27], s43 offen offset:1024 lds
v_mfma_f32_16x16x32_bf16 v[200:203], a[236:239], a[164:167], v[200:203]
v_mfma_f32_16x16x32_bf16 v[200:203], a[232:235], a[160:163], v[200:203]
s_waitcnt lgkmcnt(4)
v_mfma_f32_16x16x32_bf16 v[140:143], a[240:243], a[160:163], v[140:143]
ds_read_b64_tr_b16 a[232:233], v28 offset:0
ds_read_b64_tr_b16 a[234:235], v28 offset:512
v_mfma_f32_16x16x32_bf16 v[140:143], a[244:247], a[164:167], v[140:143]
ds_read_b64_tr_b16 a[236:237], v28 offset:4096
ds_read_b64_tr_b16 a[238:239], v28 offset:4608
v_mfma_f32_16x16x32_bf16 v[156:159], a[244:247], a[172:175], v[156:159]
v_mfma_f32_16x16x32_bf16 v[156:159], a[240:243], a[168:171], v[156:159]
v_mfma_f32_16x16x32_bf16 v[172:175], a[240:243], a[176:179], v[172:175]
s_xor_b32 s44, s79, 12288
v_mfma_f32_16x16x32_bf16 v[172:175], a[244:247], a[180:183], v[172:175]
buffer_load_dwordx4 a[128:131], v40, s[28:31], s44 offen sc1
v_mfma_f32_16x16x32_bf16 v[188:191], a[244:247], a[188:191], v[188:191]
v_mfma_f32_16x16x32_bf16 v[188:191], a[240:243], a[184:187], v[188:191]
s_waitcnt lgkmcnt(4)
v_mfma_f32_16x16x32_bf16 v[252:255], a[224:227], a[184:187], v[252:255]
ds_read_b64_tr_b16 a[240:241], v29 offset:0
ds_read_b64_tr_b16 a[242:243], v29 offset:512
v_mfma_f32_16x16x32_bf16 v[252:255], a[228:231], a[188:191], v[252:255]
ds_read_b64_tr_b16 a[244:245], v29 offset:4096
ds_read_b64_tr_b16 a[246:247], v29 offset:4608
v_mfma_f32_16x16x32_bf16 v[236:239], a[228:231], a[180:183], v[236:239]
v_mfma_f32_16x16x32_bf16 v[236:239], a[224:227], a[176:179], v[236:239]
v_mfma_f32_16x16x32_bf16 v[220:223], a[224:227], a[168:171], v[220:223]
v_mfma_f32_16x16x32_bf16 v[220:223], a[228:231], a[172:175], v[220:223]
buffer_load_dwordx4 a[132:135], v40, s[28:31], s44 offen offset:1024 sc1
v_mfma_f32_16x16x32_bf16 v[204:207], a[228:231], a[164:167], v[204:207]
v_mfma_f32_16x16x32_bf16 v[204:207], a[224:227], a[160:163], v[204:207]
s_waitcnt lgkmcnt(4)
v_mfma_f32_16x16x32_bf16 v[64:67], a[232:235], a[160:163], v[64:67]
ds_read_b64_tr_b16 a[224:225], v30 offset:0
ds_read_b64_tr_b16 a[226:227], v30 offset:512
v_mfma_f32_16x16x32_bf16 v[64:67], a[236:239], a[164:167], v[64:67]
ds_read_b64_tr_b16 a[228:229], v30 offset:4096
ds_read_b64_tr_b16 a[230:231], v30 offset:4608
v_mfma_f32_16x16x32_bf16 v[80:83], a[236:239], a[172:175], v[80:83]
L_pad2:
s_cbranch_execz L_walked0
v_mfma_f32_16x16x32_bf16 v[80:83], a[232:235], a[168:171], v[80:83]
v_mfma_f32_16x16x32_bf16 v[96:99], a[232:235], a[176:179], v[96:99]
v_mfma_f32_16x16x32_bf16 v[96:99], a[236:239], a[180:183], v[96:99]
buffer_load_dwordx4 a[136:139], v41, s[28:31], s44 offen sc1
v_mfma_f32_16x16x32_bf16 v[112:115], a[236:239], a[188:191], v[112:115]
v_mfma_f32_16x16x32_bf16 v[112:115], a[232:235], a[184:187], v[112:115]
s_waitcnt lgkmcnt(4)
v_mfma_f32_16x16x32_bf16 v[116:119], a[240:243], a[184:187], v[116:119]
ds_read_b64_tr_b16 a[232:233], v28 offset:8192
ds_read_b64_tr_b16 a[234:235], v28 offset:8704
v_mfma_f32_16x16x32_bf16 v[116:119], a[244:247], a[188:191], v[116:119]
ds_read_b64_tr_b16 a[236:237], v28 offset:12288
ds_read_b64_tr_b16 a[238:239], v28 offset:12800
v_mfma_f32_16x16x32_bf16 v[100:103], a[244:247], a[180:183], v[100:103]
v_mfma_f32_16x16x32_bf16 v[100:103], a[240:243], a[176:179], v[100:103]
v_mfma_f32_16x16x32_bf16 v[84:87], a[240:243], a[168:171], v[84:87]
v_mfma_f32_16x16x32_bf16 v[84:87], a[244:247], a[172:175], v[84:87]
buffer_load_dwordx4 a[140:143], v41, s[28:31], s44 offen offset:1024 sc1
v_mfma_f32_16x16x32_bf16 v[68:71], a[244:247], a[164:167], v[68:71]
v_mfma_f32_16x16x32_bf16 v[68:71], a[240:243], a[160:163], v[68:71]
s_waitcnt lgkmcnt(4)
v_mfma_f32_16x16x32_bf16 v[72:75], a[224:227], a[160:163], v[72:75]
ds_read_b64_tr_b16 a[240:241], v29 offset:8192
ds_read_b64_tr_b16 a[242:243], v29 offset:8704
v_mfma_f32_16x16x32_bf16 v[72:75], a[228:231], a[164:167], v[72:75]
ds_read_b64_tr_b16 a[244:245], v29 offset:12288
ds_read_b64_tr_b16 a[246:247], v29 offset:12800
v_mfma_f32_16x16x32_bf16 v[88:91], a[228:231], a[172:175], v[88:91]
v_mfma_f32_16x16x32_bf16 v[88:91], a[224:227], a[168:171], v[88:91]
v_mfma_f32_16x16x32_bf16 v[104:107], a[224:227], a[176:179], v[104:107]
v_mfma_f32_16x16x32_bf16 v[104:107], a[228:231], a[180:183], v[104:107]
buffer_load_dwordx4 a[144:147], v42, s[28:31], s44 offen sc1
v_mfma_f32_16x16x32_bf16 v[120:123], a[228:231], a[188:191], v[120:123]
v_mfma_f32_16x16x32_bf16 v[120:123], a[224:227], a[184:187], v[120:123]
s_waitcnt lgkmcnt(4)
v_mfma_f32_16x16x32_bf16 a[48:51], a[232:235], a[184:187], a[48:51]
ds_read_b64_tr_b16 a[224:225], v30 offset:8192
ds_read_b64_tr_b16 a[226:227], v30 offset:8704
v_mfma_f32_16x16x32_bf16 a[48:51], a[236:239], a[188:191], a[48:51]
ds_read_b64_tr_b16 a[228:229], v30 offset:12288
ds_read_b64_tr_b16 a[230:231], v30 offset:12800
v_mfma_f32_16x16x32_bf16 a[32:35], a[236:239], a[180:183], a[32:35]
v_mfma_f32_16x16x32_bf16 a[32:35], a[232:235], a[176:179], a[32:35]
v_mfma_f32_16x16x32_bf16 a[16:19], a[232:235], a[168:171], a[16:19]
v_mfma_f32_16x16x32_bf16 a[16:19], a[236:239], a[172:175], a[16:19]
buffer_load_dwordx4 a[148:151], v42, s[28:31], s44 offen offset:1024 sc1
v_mfma_f32_16x16x32_bf16 a[0:3], a[236:239], a[164:167], a[0:3]
v_mfma_f32_16x16x32_bf16 a[0:3], a[232:235], a[160:163], a[0:3]
s_waitcnt vmcnt(14) lgkmcnt(4)
s_barrier
v_mfma_f32_16x16x32_bf16 a[4:7], a[240:243], a[160:163], a[4:7]
ds_read_b64_tr_b16 a[232:233], v24 offset:16384
ds_read_b64_tr_b16 a[234:235], v24 offset:17408
v_mfma_f32_16x16x32_bf16 a[4:7], a[244:247], a[164:167], a[4:7]
ds_read_b64_tr_b16 a[236:237], v24 offset:24576
ds_read_b64_tr_b16 a[238:239], v24 offset:25600
v_mfma_f32_16x16x32_bf16 a[20:23], a[244:247], a[172:175], a[20:23]
v_mfma_f32_16x16x32_bf16 a[20:23], a[240:243], a[168:171], a[20:23]
v_mfma_f32_16x16x32_bf16 a[36:39], a[240:243], a[176:179], a[36:39]
v_mfma_f32_16x16x32_bf16 a[36:39], a[244:247], a[180:183], a[36:39]
buffer_load_dwordx4 a[152:155], v43, s[28:31], s44 offen sc1
v_mfma_f32_16x16x32_bf16 a[52:55], a[244:247], a[188:191], a[52:55]
v_mfma_f32_16x16x32_bf16 a[52:55], a[240:243], a[184:187], a[52:55]
s_waitcnt lgkmcnt(4)
v_mfma_f32_16x16x32_bf16 a[56:59], a[224:227], a[184:187], a[56:59]
ds_read_b64_tr_b16 a[240:241], v24 offset:16392
ds_read_b64_tr_b16 a[242:243], v24 offset:17416
v_mfma_f32_16x16x32_bf16 a[56:59], a[228:231], a[188:191], a[56:59]
ds_read_b64_tr_b16 a[244:245], v24 offset:24584
ds_read_b64_tr_b16 a[246:247], v24 offset:25608
v_mfma_f32_16x16x32_bf16 a[40:43], a[228:231], a[180:183], a[40:43]
v_mfma_f32_16x16x32_bf16 a[40:43], a[224:227], a[176:179], a[40:43]
v_mfma_f32_16x16x32_bf16 a[24:27], a[224:227], a[168:171], a[24:27]
v_mfma_f32_16x16x32_bf16 a[24:27], a[228:231], a[172:175], a[24:27]
buffer_load_dwordx4 a[156:159], v43, s[28:31], s44 offen offset:1024 sc1
v_mfma_f32_16x16x32_bf16 a[8:11], a[228:231], a[164:167], a[8:11]
v_mfma_f32_16x16x32_bf16 a[8:11], a[224:227], a[160:163], a[8:11]
s_waitcnt lgkmcnt(4)
v_mfma_f32_16x16x32_bf16 v[128:131], a[232:235], a[192:195], v[128:131]
ds_read_b64_tr_b16 a[224:225], v25 offset:16384
ds_read_b64_tr_b16 a[226:227], v25 offset:17408
v_mfma_f32_16x16x32_bf16 v[128:131], a[236:239], a[196:199], v[128:131]
ds_read_b64_tr_b16 a[228:229], v25 offset:24576
ds_read_b64_tr_b16 a[230:231], v25 offset:25600
v_mfma_f32_16x16x32_bf16 v[144:147], a[236:239], a[204:207], v[144:147]
s_add_u32 m0, s40, 49152
s_xor_b32 s43, s101, 3670016
v_mfma_f32_16x16x32_bf16 v[144:147], a[232:235], a[200:203], v[144:147]
buffer_load_dwordx4 v32, s[16:19], s43 offen lds
v_mfma_f32_16x16x32_bf16 v[160:163], a[232:235], a[208:211], v[160:163]
v_mfma_f32_16x16x32_bf16 v[160:163], a[236:239], a[212:215], v[160:163]
buffer_load_dwordx4 v33, s[16:19], s43 offen offset:1024 lds
v_mfma_f32_16x16x32_bf16 v[176:179], a[236:239], a[220:223], v[176:179]
v_mfma_f32_16x16x32_bf16 v[176:179], a[232:235], a[216:219], v[176:179]
s_waitcnt lgkmcnt(4)
v_mfma_f32_16x16x32_bf16 v[240:243], a[240:243], a[216:219], v[240:243]
ds_read_b64_tr_b16 a[232:233], v25 offset:16392
ds_read_b64_tr_b16 a[234:235], v25 offset:17416
v_mfma_f32_16x16x32_bf16 v[240:243], a[244:247], a[220:223], v[240:243]
ds_read_b64_tr_b16 a[236:237], v25 offset:24584
ds_read_b64_tr_b16 a[238:239], v25 offset:25608
v_mfma_f32_16x16x32_bf16 v[224:227], a[244:247], a[212:215], v[224:227]
v_mfma_f32_16x16x32_bf16 v[224:227], a[240:243], a[208:211], v[224:227]
buffer_load_dwordx4 v34, s[16:19], s43 offen offset:2048 lds
v_mfma_f32_16x16x32_bf16 v[208:211], a[240:243], a[200:203], v[208:211]
s_xor_b32 s86, s100, 7
v_mfma_f32_16x16x32_bf16 v[208:211], a[244:247], a[204:207], v[208:211]
buffer_load_dwordx4 v35, s[16:19], s43 offen offset:3072 lds
v_mfma_f32_16x16x32_bf16 v[192:195], a[244:247], a[196:199], v[192:195]
v_mfma_f32_16x16x32_bf16 v[192:195], a[240:243], a[192:195], v[192:195]
s_waitcnt lgkmcnt(4)
v_mfma_f32_16x16x32_bf16 v[132:135], a[224:227], a[192:195], v[132:135]
ds_read_b64_tr_b16 a[240:241], v26 offset:16384
ds_read_b64_tr_b16 a[242:243], v26 offset:17408
v_mfma_f32_16x16x32_bf16 v[132:135], a[228:231], a[196:199], v[132:135]
ds_read_b64_tr_b16 a[244:245], v26 offset:24576
ds_read_b64_tr_b16 a[246:247], v26 offset:25600
v_mfma_f32_16x16x32_bf16 v[148:151], a[228:231], a[204:207], v[148:151]
v_mfma_f32_16x16x32_bf16 v[148:151], a[224:227], a[200:203], v[148:151]
v_mfma_f32_16x16x32_bf16 v[164:167], a[224:227], a[208:211], v[164:167]
s_add_u32 m0, s41, 49152
s_mul_i32 s43, s86, 229376
v_mfma_f32_16x16x32_bf16 v[164:167], a[228:231], a[212:215], v[164:167]
buffer_load_dwordx4 v36, s[20:23], s43 offen lds
v_mfma_f32_16x16x32_bf16 v[180:183], a[228:231], a[220:223], v[180:183]
v_mfma_f32_16x16x32_bf16 v[180:183], a[224:227], a[216:219], v[180:183]
s_waitcnt lgkmcnt(4)
v_mfma_f32_16x16x32_bf16 v[244:247], a[232:235], a[216:219], v[244:247]
ds_read_b64_tr_b16 a[224:225], v26 offset:16392
ds_read_b64_tr_b16 a[226:227], v26 offset:17416
v_mfma_f32_16x16x32_bf16 v[244:247], a[236:239], a[220:223], v[244:247]
ds_read_b64_tr_b16 a[228:229], v26 offset:24584
ds_read_b64_tr_b16 a[230:231], v26 offset:25608
v_mfma_f32_16x16x32_bf16 v[228:231], a[236:239], a[212:215], v[228:231]
v_mfma_f32_16x16x32_bf16 v[228:231], a[232:235], a[208:211], v[228:231]
v_mfma_f32_16x16x32_bf16 v[212:215], a[232:235], a[200:203], v[212:215]
v_mfma_f32_16x16x32_bf16 v[212:215], a[236:239], a[204:207], v[212:215]
buffer_load_dwordx4 v37, s[20:23], s43 offen offset:1024 lds
v_mfma_f32_16x16x32_bf16 v[196:199], a[236:239], a[196:199], v[196:199]
v_mfma_f32_16x16x32_bf16 v[196:199], a[232:235], a[192:195], v[196:199]
s_waitcnt lgkmcnt(4)
v_mfma_f32_16x16x32_bf16 v[136:139], a[240:243], a[192:195], v[136:139]
ds_read_b64_tr_b16 a[232:233], v27 offset:16384
ds_read_b64_tr_b16 a[234:235], v27 offset:17408
v_mfma_f32_16x16x32_bf16 v[136:139], a[244:247], a[196:199], v[136:139]
ds_read_b64_tr_b16 a[236:237], v27 offset:24576
ds_read_b64_tr_b16 a[238:239], v27 offset:25600
v_mfma_f32_16x16x32_bf16 v[152:155], a[244:247], a[204:207], v[152:155]
v_mfma_f32_16x16x32_bf16 v[152:155], a[240:243], a[200:203], v[152:155]
v_mfma_f32_16x16x32_bf16 v[168:171], a[240:243], a[208:211], v[168:171]
s_add_u32 m0, s41, 57344
v_mfma_f32_16x16x32_bf16 v[168:171], a[244:247], a[212:215], v[168:171]
buffer_load_dwordx4 v36, s[24:27], s43 offen lds
v_mfma_f32_16x16x32_bf16 v[184:187], a[244:247], a[220:223], v[184:187]
v_mfma_f32_16x16x32_bf16 v[184:187], a[240:243], a[216:219], v[184:187]
s_waitcnt lgkmcnt(4)
v_mfma_f32_16x16x32_bf16 v[248:251], a[224:227], a[216:219], v[248:251]
ds_read_b64_tr_b16 a[240:241], v27 offset:16392
ds_read_b64_tr_b16 a[242:243], v27 offset:17416
v_mfma_f32_16x16x32_bf16 v[248:251], a[228:231], a[220:223], v[248:251]
ds_read_b64_tr_b16 a[244:245], v27 offset:24584
ds_read_b64_tr_b16 a[246:247], v27 offset:25608
v_mfma_f32_16x16x32_bf16 v[232:235], a[228:231], a[212:215], v[232:235]
v_mfma_f32_16x16x32_bf16 v[232:235], a[224:227], a[208:211], v[232:235]
v_mfma_f32_16x16x32_bf16 v[216:219], a[224:227], a[200:203], v[216:219]
v_mfma_f32_16x16x32_bf16 v[216:219], a[228:231], a[204:207], v[216:219]
buffer_load_dwordx4 v37, s[24:27], s43 offen offset:1024 lds
v_mfma_f32_16x16x32_bf16 v[200:203], a[228:231], a[196:199], v[200:203]
v_mfma_f32_16x16x32_bf16 v[200:203], a[224:227], a[192:195], v[200:203]
s_waitcnt lgkmcnt(4)
v_mfma_f32_16x16x32_bf16 v[140:143], a[232:235], a[192:195], v[140:143]
ds_read_b64_tr_b16 a[224:225], v28 offset:16384
ds_read_b64_tr_b16 a[226:227], v28 offset:16896
v_mfma_f32_16x16x32_bf16 v[140:143], a[236:239], a[196:199], v[140:143]
ds_read_b64_tr_b16 a[228:229], v28 offset:20480
ds_read_b64_tr_b16 a[230:231], v28 offset:20992
v_mfma_f32_16x16x32_bf16 v[156:159], a[236:239], a[204:207], v[156:159]
v_mfma_f32_16x16x32_bf16 v[156:159], a[232:235], a[200:203], v[156:159]
v_mfma_f32_16x16x32_bf16 v[172:175], a[232:235], a[208:211], v[172:175]
s_xor_b32 s44, s79, 14336
v_mfma_f32_16x16x32_bf16 v[172:175], a[236:239], a[212:215], v[172:175]
buffer_load_dwordx4 a[160:163], v40, s[28:31], s44 offen sc1
v_mfma_f32_16x16x32_bf16 v[188:191], a[236:239], a[220:223], v[188:191]
v_mfma_f32_16x16x32_bf16 v[188:191], a[232:235], a[216:219], v[188:191]
s_waitcnt lgkmcnt(4)
v_mfma_f32_16x16x32_bf16 v[252:255], a[240:243], a[216:219], v[252:255]
ds_read_b64_tr_b16 a[232:233], v29 offset:16384
ds_read_b64_tr_b16 a[234:235], v29 offset:16896
v_mfma_f32_16x16x32_bf16 v[252:255], a[244:247], a[220:223], v[252:255]
ds_read_b64_tr_b16 a[236:237], v29 offset:20480
ds_read_b64_tr_b16 a[238:239], v29 offset:20992
v_mfma_f32_16x16x32_bf16 v[236:239], a[244:247], a[212:215], v[236:239]
v_mfma_f32_16x16x32_bf16 v[236:239], a[240:243], a[208:211], v[236:239]
v_mfma_f32_16x16x32_bf16 v[220:223], a[240:243], a[200:203], v[220:223]
v_mfma_f32_16x16x32_bf16 v[220:223], a[244:247], a[204:207], v[220:223]
buffer_load_dwordx4 a[164:167], v40, s[28:31], s44 offen offset:1024 sc1
v_mfma_f32_16x16x32_bf16 v[204:207], a[244:247], a[196:199], v[204:207]
v_mfma_f32_16x16x32_bf16 v[204:207], a[240:243], a[192:195], v[204:207]
s_waitcnt lgkmcnt(4)
v_mfma_f32_16x16x32_bf16 v[64:67], a[224:227], a[192:195], v[64:67]
ds_read_b64_tr_b16 a[240:241], v30 offset:16384
ds_read_b64_tr_b16 a[242:243], v30 offset:16896
v_mfma_f32_16x16x32_bf16 v[64:67], a[228:231], a[196:199], v[64:67]
ds_read_b64_tr_b16 a[244:245], v30 offset:20480
ds_read_b64_tr_b16 a[246:247], v30 offset:20992
v_mfma_f32_16x16x32_bf16 v[80:83], a[228:231], a[204:207], v[80:83]
v_mfma_f32_16x16x32_bf16 v[80:83], a[224:227], a[200:203], v[80:83]
v_mfma_f32_16x16x32_bf16 v[96:99], a[224:227], a[208:211], v[96:99]
v_mfma_f32_16x16x32_bf16 v[96:99], a[228:231], a[212:215], v[96:99]
buffer_load_dwordx4 a[168:171], v41, s[28:31], s44 offen sc1
v_mfma_f32_16x16x32_bf16 v[112:115], a[228:231], a[220:223], v[112:115]
v_mfma_f32_16x16x32_bf16 v[112:115], a[224:227], a[216:219], v[112:115]
s_waitcnt lgkmcnt(4)
v_mfma_f32_16x16x32_bf16 v[116:119], a[232:235], a[216:219], v[116:119]
ds_read_b64_tr_b16 a[224:225], v28 offset:24576
ds_read_b64_tr_b16 a[226:227], v28 offset:25088
v_mfma_f32_16x16x32_bf16 v[116:119], a[236:239], a[220:223], v[116:119]
ds_read_b64_tr_b16 a[228:229], v28 offset:28672
ds_read_b64_tr_b16 a[230:231], v28 offset:29184
v_mfma_f32_16x16x32_bf16 v[100:103], a[236:239], a[212:215], v[100:103]
v_mfma_f32_16x16x32_bf16 v[100:103], a[232:235], a[208:211], v[100:103]
v_mfma_f32_16x16x32_bf16 v[84:87], a[232:235], a[200:203], v[84:87]
v_mfma_f32_16x16x32_bf16 v[84:87], a[236:239], a[204:207], v[84:87]
buffer_load_dwordx4 a[172:175], v41, s[28:31], s44 offen offset:1024 sc1
v_mfma_f32_16x16x32_bf16 v[68:71], a[236:239], a[196:199], v[68:71]
v_mfma_f32_16x16x32_bf16 v[68:71], a[232:235], a[192:195], v[68:71]
s_waitcnt lgkmcnt(4)
v_mfma_f32_16x16x32_bf16 v[72:75], a[240:243], a[192:195], v[72:75]
ds_read_b64_tr_b16 a[232:233], v29 offset:24576
ds_read_b64_tr_b16 a[234:235], v29 offset:25088
v_mfma_f32_16x16x32_bf16 v[72:75], a[244:247], a[196:199], v[72:75]
ds_read_b64_tr_b16 a[236:237], v29 offset:28672
ds_read_b64_tr_b16 a[238:239], v29 offset:29184
v_mfma_f32_16x16x32_bf16 v[88:91], a[244:247], a[204:207], v[88:91]
v_mfma_f32_16x16x32_bf16 v[88:91], a[240:243], a[200:203], v[88:91]
v_mfma_f32_16x16x32_bf16 v[104:107], a[240:243], a[208:211], v[104:107]
v_mfma_f32_16x16x32_bf16 v[104:107], a[244:247], a[212:215], v[104:107]
buffer_load_dwordx4 a[176:179], v42, s[28:31], s44 offen sc1
v_mfma_f32_16x16x32_bf16 v[120:123], a[244:247], a[220:223], v[120:123]
v_mfma_f32_16x16x32_bf16 v[120:123], a[240:243], a[216:219], v[120:123]
s_waitcnt lgkmcnt(4)
v_mfma_f32_16x16x32_bf16 a[48:51], a[224:227], a[216:219], a[48:51]
ds_read_b64_tr_b16 a[240:241], v30 offset:24576
ds_read_b64_tr_b16 a[242:243], v30 offset:25088
v_mfma_f32_16x16x32_bf16 a[48:51], a[228:231], a[220:223], a[48:51]
ds_read_b64_tr_b16 a[244:245], v30 offset:28672
ds_read_b64_tr_b16 a[246:247], v30 offset:29184
v_mfma_f32_16x16x32_bf16 a[32:35], a[228:231], a[212:215], a[32:35]
v_mfma_f32_16x16x32_bf16 a[32:35], a[224:227], a[208:211], a[32:35]
v_mfma_f32_16x16x32_bf16 a[16:19], a[224:227], a[200:203], a[16:19]
v_mfma_f32_16x16x32_bf16 a[16:19], a[228:231], a[204:207], a[16:19]
buffer_load_dwordx4 a[180:183], v42, s[28:31], s44 offen offset:1024 sc1
v_mfma_f32_16x16x32_bf16 a[0:3], a[228:231], a[196:199], a[0:3]
v_mfma_f32_16x16x32_bf16 a[0:3], a[224:227], a[192:195], a[0:3]
s_waitcnt vmcnt(14) lgkmcnt(4)
s_barrier
v_mfma_f32_16x16x32_bf16 a[4:7], a[232:235], a[192:195], a[4:7]
ds_read_b64_tr_b16 a[224:225], v24 offset:32768
ds_read_b64_tr_b16 a[226:227], v24 offset:33792
v_mfma_f32_16x16x32_bf16 a[4:7], a[236:239], a[196:199], a[4:7]
ds_read_b64_tr_b16 a[228:229], v24 offset:40960
ds_read_b64_tr_b16 a[230:231], v24 offset:41984
v_mfma_f32_16x16x32_bf16 a[20:23], a[236:239], a[204:207], a[20:23]
v_mfma_f32_16x16x32_bf16 a[20:23], a[232:235], a[200:203], a[20:23]
v_mfma_f32_16x16x32_bf16 a[36:39], a[232:235], a[208:211], a[36:39]
v_mfma_f32_16x16x32_bf16 a[36:39], a[236:239], a[212:215], a[36:39]
buffer_load_dwordx4 a[184:187], v43, s[28:31], s44 offen sc1
v_mfma_f32_16x16x32_bf16 a[52:55], a[236:239], a[220:223], a[52:55]
v_mfma_f32_16x16x32_bf16 a[52:55], a[232:235], a[216:219], a[52:55]
s_waitcnt lgkmcnt(4)
v_mfma_f32_16x16x32_bf16 a[56:59], a[240:243], a[216:219], a[56:59]
ds_read_b64_tr_b16 a[232:233], v24 offset:32776
ds_read_b64_tr_b16 a[234:235], v24 offset:33800
v_mfma_f32_16x16x32_bf16 a[56:59], a[244:247], a[220:223], a[56:59]
ds_read_b64_tr_b16 a[236:237], v24 offset:40968
ds_read_b64_tr_b16 a[238:239], v24 offset:41992
v_mfma_f32_16x16x32_bf16 a[40:43], a[244:247], a[212:215], a[40:43]
v_mfma_f32_16x16x32_bf16 a[40:43], a[240:243], a[208:211], a[40:43]
v_mfma_f32_16x16x32_bf16 a[24:27], a[240:243], a[200:203], a[24:27]
v_mfma_f32_16x16x32_bf16 a[24:27], a[244:247], a[204:207], a[24:27]
buffer_load_dwordx4 a[188:191], v43, s[28:31], s44 offen offset:1024 sc1
v_mfma_f32_16x16x32_bf16 a[8:11], a[244:247], a[196:199], a[8:11]
v_mfma_f32_16x16x32_bf16 a[8:11], a[240:243], a[192:195], a[8:11]
s_waitcnt lgkmcnt(4)
v_mfma_f32_16x16x32_bf16 v[128:131], a[224:227], a[128:131], v[128:131]
ds_read_b64_tr_b16 a[240:241], v25 offset:32768
ds_read_b64_tr_b16 a[242:243], v25 offset:33792
v_mfma_f32_16x16x32_bf16 v[128:131], a[228:231], a[132:135], v[128:131]
ds_read_b64_tr_b16 a[244:245], v25 offset:40960
ds_read_b64_tr_b16 a[246:247], v25 offset:41984
v_mfma_f32_16x16x32_bf16 v[144:147], a[228:231], a[140:143], v[144:147]
s_lshl_b32 s80, s85, 8
s_mul_i32 s81, s83, 458752
v_mfma_f32_16x16x32_bf16 v[144:147], a[224:227], a[136:139], v[144:147]
s_add_u32 s81, s81, s80
v_mfma_f32_16x16x32_bf16 v[160:163], a[224:227], a[144:147], v[160:163]
s_add_u32 m0, s40, 0
v_mfma_f32_16x16x32_bf16 v[160:163], a[228:231], a[148:151], v[160:163]
buffer_load_dwordx4 v16, s[8:11], 0 offen lds
v_mfma_f32_16x16x32_bf16 v[176:179], a[228:231], a[156:159], v[176:179]
s_add_u32 s16, s64, s81
s_addc_u32 s17, s65, 0
v_mfma_f32_16x16x32_bf16 v[176:179], a[224:227], a[152:155], v[176:179]
s_waitcnt lgkmcnt(4)
v_mfma_f32_16x16x32_bf16 v[240:243], a[232:235], a[152:155], v[240:243]
ds_read_b64_tr_b16 a[224:225], v25 offset:32776
ds_read_b64_tr_b16 a[226:227], v25 offset:33800
v_mfma_f32_16x16x32_bf16 v[240:243], a[236:239], a[156:159], v[240:243]
ds_read_b64_tr_b16 a[228:229], v25 offset:40968
ds_read_b64_tr_b16 a[230:231], v25 offset:41992
v_mfma_f32_16x16x32_bf16 v[224:227], a[236:239], a[148:151], v[224:227]
s_mov_b32 s18, 458752
s_mov_b32 s19, 0x20000
v_mfma_f32_16x16x32_bf16 v[224:227], a[232:235], a[144:147], v[224:227]
s_sub_u32 s18, s18, s80
v_mfma_f32_16x16x32_bf16 v[208:211], a[232:235], a[136:139], v[208:211]
v_lshl_add_u32 v52, v1, 4, v3
v_lshlrev_b32 v52, 10, v52
v_mfma_f32_16x16x32_bf16 v[208:211], a[236:239], a[140:143], v[208:211]
buffer_load_dwordx4 v17, s[8:11], 0 offen offset:1024 lds
v_mfma_f32_16x16x32_bf16 v[192:195], a[236:239], a[132:135], v[192:195]
v_lshlrev_b32 v53, 1, v3
v_xor_b32 v53, v2, v53
v_mfma_f32_16x16x32_bf16 v[192:195], a[232:235], a[128:131], v[192:195]
s_waitcnt lgkmcnt(4)
v_mfma_f32_16x16x32_bf16 v[132:135], a[240:243], a[128:131], v[132:135]
ds_read_b64_tr_b16 a[232:233], v26 offset:32768
ds_read_b64_tr_b16 a[234:235], v26 offset:33792
v_mfma_f32_16x16x32_bf16 v[132:135], a[244:247], a[132:135], v[132:135]
ds_read_b64_tr_b16 a[236:237], v26 offset:40960
ds_read_b64_tr_b16 a[238:239], v26 offset:41984
v_mfma_f32_16x16x32_bf16 v[148:151], a[244:247], a[140:143], v[148:151]
v_xor_b32 v54, 0, v53
v_lshl_add_u32 v32, v54, 4, v52
v_mfma_f32_16x16x32_bf16 v[148:151], a[240:243], a[136:139], v[148:151]
v_xor_b32 v54, 8, v53
v_lshl_add_u32 v33, v54, 4, v52
v_mfma_f32_16x16x32_bf16 v[164:167], a[240:243], a[144:147], v[164:167]
v_add_u32 v33, 3072, v33
v_xor_b32 v54, 0, v53
v_mfma_f32_16x16x32_bf16 v[164:167], a[244:247], a[148:151], v[164:167]
buffer_load_dwordx4 v18, s[8:11], 0 offen offset:2048 lds
v_mfma_f32_16x16x32_bf16 v[180:183], a[244:247], a[156:159], v[180:183]
v_lshl_add_u32 v34, v54, 4, v52
v_add_u32 v34, 6144, v34
v_mfma_f32_16x16x32_bf16 v[180:183], a[240:243], a[152:155], v[180:183]
s_waitcnt lgkmcnt(4)
v_mfma_f32_16x16x32_bf16 v[244:247], a[224:227], a[152:155], v[244:247]
ds_read_b64_tr_b16 a[240:241], v26 offset:32776
ds_read_b64_tr_b16 a[242:243], v26 offset:33800
v_mfma_f32_16x16x32_bf16 v[244:247], a[228:231], a[156:159], v[244:247]
ds_read_b64_tr_b16 a[244:245], v26 offset:40968
ds_read_b64_tr_b16 a[246:247], v26 offset:41992
v_mfma_f32_16x16x32_bf16 v[228:231], a[228:231], a[148:151], v[228:231]
v_xor_b32 v54, 8, v53
v_lshl_add_u32 v35, v54, 4, v52
v_mfma_f32_16x16x32_bf16 v[228:231], a[224:227], a[144:147], v[228:231]
v_add_u32 v35, 9216, v35
v_mfma_f32_16x16x32_bf16 v[212:215], a[224:227], a[136:139], v[212:215]
s_lshl_b32 s81, s83, 20
s_add_u32 s81, s81, s80
v_mfma_f32_16x16x32_bf16 v[212:215], a[228:231], a[140:143], v[212:215]
buffer_load_dwordx4 v19, s[8:11], 0 offen offset:3072 lds
v_mfma_f32_16x16x32_bf16 v[196:199], a[228:231], a[132:135], v[196:199]
s_add_u32 s20, s58, s81
s_addc_u32 s21, s59, 0
v_mfma_f32_16x16x32_bf16 v[196:199], a[224:227], a[128:131], v[196:199]
s_waitcnt lgkmcnt(4)
v_mfma_f32_16x16x32_bf16 v[136:139], a[232:235], a[128:131], v[136:139]
ds_read_b64_tr_b16 a[224:225], v27 offset:32768
ds_read_b64_tr_b16 a[226:227], v27 offset:33792
v_mfma_f32_16x16x32_bf16 v[136:139], a[236:239], a[132:135], v[136:139]
ds_read_b64_tr_b16 a[228:229], v27 offset:40960
ds_read_b64_tr_b16 a[230:231], v27 offset:41984
v_mfma_f32_16x16x32_bf16 v[152:155], a[236:239], a[140:143], v[152:155]
s_mov_b32 s22, 1048576
s_mov_b32 s23, 0x20000
v_mfma_f32_16x16x32_bf16 v[152:155], a[232:235], a[136:139], v[152:155]
s_sub_u32 s22, s22, s80
v_mfma_f32_16x16x32_bf16 v[168:171], a[232:235], a[144:147], v[168:171]
s_lshl_b32 s82, s76, 1
s_add_u32 s82, s82, s84
v_mfma_f32_16x16x32_bf16 v[168:171], a[236:239], a[148:151], v[168:171]
v_mfma_f32_16x16x32_bf16 v[184:187], a[236:239], a[156:159], v[184:187]
s_mul_i32 s80, s84, 466944
s_mul_i32 s81, s76, 2113536
v_mfma_f32_16x16x32_bf16 v[184:187], a[232:235], a[152:155], v[184:187]
s_waitcnt lgkmcnt(4)
v_mfma_f32_16x16x32_bf16 v[248:251], a[240:243], a[152:155], v[248:251]
ds_read_b64_tr_b16 a[232:233], v27 offset:32776
ds_read_b64_tr_b16 a[234:235], v27 offset:33800
v_mfma_f32_16x16x32_bf16 v[248:251], a[244:247], a[156:159], v[248:251]
ds_read_b64_tr_b16 a[236:237], v27 offset:40968
ds_read_b64_tr_b16 a[238:239], v27 offset:41992
v_mfma_f32_16x16x32_bf16 v[232:235], a[244:247], a[148:151], v[232:235]
s_add_u32 s80, s80, s81
s_mul_i32 s81, s83, 14336
v_mfma_f32_16x16x32_bf16 v[232:235], a[240:243], a[144:147], v[232:235]
s_add_u32 s80, s80, s81
s_add_u32 s80, s80, 524288
v_mfma_f32_16x16x32_bf16 v[216:219], a[240:243], a[136:139], v[216:219]
s_add_u32 s24, s70, s80
s_addc_u32 s25, s71, 0
v_mfma_f32_16x16x32_bf16 v[216:219], a[244:247], a[140:143], v[216:219]
v_mfma_f32_16x16x32_bf16 v[200:203], a[244:247], a[132:135], v[200:203]
s_mov_b32 s26, 466944
s_mov_b32 s27, 0x20000
v_mfma_f32_16x16x32_bf16 v[200:203], a[240:243], a[128:131], v[200:203]
s_waitcnt lgkmcnt(4)
v_mfma_f32_16x16x32_bf16 v[140:143], a[224:227], a[128:131], v[140:143]
ds_read_b64_tr_b16 a[240:241], v28 offset:32768
ds_read_b64_tr_b16 a[242:243], v28 offset:33280
v_mfma_f32_16x16x32_bf16 v[140:143], a[228:231], a[132:135], v[140:143]
ds_read_b64_tr_b16 a[244:245], v28 offset:36864
ds_read_b64_tr_b16 a[246:247], v28 offset:37376
v_mfma_f32_16x16x32_bf16 v[156:159], a[228:231], a[140:143], v[156:159]
s_mul_i32 s80, s82, 1048576
s_lshl_b32 s81, s83, 15
v_mfma_f32_16x16x32_bf16 v[156:159], a[224:227], a[136:139], v[156:159]
s_add_u32 s80, s80, s81
s_add_u32 s80, s80, 17825792
v_mfma_f32_16x16x32_bf16 v[172:175], a[224:227], a[144:147], v[172:175]
s_add_u32 s28, s70, s80
s_addc_u32 s29, s71, 0
v_mfma_f32_16x16x32_bf16 v[172:175], a[228:231], a[148:151], v[172:175]
v_mfma_f32_16x16x32_bf16 v[188:191], a[228:231], a[156:159], v[188:191]
s_mov_b32 s30, 1048576
s_mov_b32 s31, 0x20000
v_mfma_f32_16x16x32_bf16 v[188:191], a[224:227], a[152:155], v[188:191]
s_waitcnt lgkmcnt(4)
v_mfma_f32_16x16x32_bf16 v[252:255], a[232:235], a[152:155], v[252:255]
ds_read_b64_tr_b16 a[224:225], v29 offset:32768
ds_read_b64_tr_b16 a[226:227], v29 offset:33280
v_mfma_f32_16x16x32_bf16 v[252:255], a[236:239], a[156:159], v[252:255]
ds_read_b64_tr_b16 a[228:229], v29 offset:36864
ds_read_b64_tr_b16 a[230:231], v29 offset:37376
v_mfma_f32_16x16x32_bf16 v[236:239], a[236:239], a[148:151], v[236:239]
s_lshl_b32 s81, s82, 2
s_add_u32 s81, s81, s85
v_mfma_f32_16x16x32_bf16 v[236:239], a[232:235], a[144:147], v[236:239]
s_mul_i32 s80, s81, 196608
s_add_u32 s80, s80, 41943040
v_mfma_f32_16x16x32_bf16 v[220:223], a[232:235], a[136:139], v[220:223]
s_add_u32 s52, s70, s80
s_addc_u32 s53, s71, 0
v_mfma_f32_16x16x32_bf16 v[220:223], a[236:239], a[140:143], v[220:223]
v_mfma_f32_16x16x32_bf16 v[204:207], a[236:239], a[132:135], v[204:207]
s_mov_b32 s54, 196608
s_mov_b32 s55, 0x20000
v_mfma_f32_16x16x32_bf16 v[204:207], a[232:235], a[128:131], v[204:207]
s_waitcnt lgkmcnt(4)
v_mfma_f32_16x16x32_bf16 v[64:67], a[240:243], a[128:131], v[64:67]
ds_read_b64_tr_b16 a[232:233], v30 offset:32768
ds_read_b64_tr_b16 a[234:235], v30 offset:33280
v_mfma_f32_16x16x32_bf16 v[64:67], a[244:247], a[132:135], v[64:67]
ds_read_b64_tr_b16 a[236:237], v30 offset:36864
ds_read_b64_tr_b16 a[238:239], v30 offset:37376
v_mfma_f32_16x16x32_bf16 v[80:83], a[244:247], a[140:143], v[80:83]
s_and_b32 s81, s81, 7
s_lshl_b32 s79, s81, 14
v_mfma_f32_16x16x32_bf16 v[80:83], a[240:243], a[136:139], v[80:83]
s_lshl_b32 s80, s50, 10
s_add_u32 s79, s79, s80
v_mfma_f32_16x16x32_bf16 v[96:99], a[240:243], a[144:147], v[96:99]
s_add_u32 m0, s40, 131072
s_mov_b32 s43, 65536
v_mfma_f32_16x16x32_bf16 v[96:99], a[244:247], a[148:151], v[96:99]
buffer_load_dwordx4 v32, s[16:19], s43 offen lds
v_mfma_f32_16x16x32_bf16 v[112:115], a[244:247], a[156:159], v[112:115]
s_add_u32 s79, s79, 32768
s_lshl_b32 s80, s82, 17
v_mfma_f32_16x16x32_bf16 v[112:115], a[240:243], a[152:155], v[112:115]
s_waitcnt lgkmcnt(4)
v_mfma_f32_16x16x32_bf16 v[116:119], a[224:227], a[152:155], v[116:119]
ds_read_b64_tr_b16 a[240:241], v28 offset:40960
ds_read_b64_tr_b16 a[242:243], v28 offset:41472
v_mfma_f32_16x16x32_bf16 v[116:119], a[228:231], a[156:159], v[116:119]
ds_read_b64_tr_b16 a[244:245], v28 offset:45056
ds_read_b64_tr_b16 a[246:247], v28 offset:45568
v_mfma_f32_16x16x32_bf16 v[100:103], a[228:231], a[148:151], v[100:103]
s_lshl_b32 s81, s85, 2
s_add_u32 s81, s81, s83
v_mfma_f32_16x16x32_bf16 v[100:103], a[224:227], a[144:147], v[100:103]
s_lshl_b32 s81, s81, 6
s_add_u32 s80, s80, s81
v_mfma_f32_16x16x32_bf16 v[84:87], a[224:227], a[136:139], v[84:87]
s_add_u32 s60, s72, s80
s_addc_u32 s61, s73, 0
v_mfma_f32_16x16x32_bf16 v[84:87], a[228:231], a[140:143], v[84:87]
buffer_load_dwordx4 v33, s[16:19], s43 offen offset:1024 lds
v_mfma_f32_16x16x32_bf16 v[68:71], a[228:231], a[132:135], v[68:71]
s_mov_b32 s62, 2097152
s_mov_b32 s63, 0x20000
v_mfma_f32_16x16x32_bf16 v[68:71], a[224:227], a[128:131], v[68:71]
s_waitcnt lgkmcnt(4)
v_mfma_f32_16x16x32_bf16 v[72:75], a[232:235], a[128:131], v[72:75]
ds_read_b64_tr_b16 a[224:225], v29 offset:40960
ds_read_b64_tr_b16 a[226:227], v29 offset:41472
v_mfma_f32_16x16x32_bf16 v[72:75], a[236:239], a[132:135], v[72:75]
ds_read_b64_tr_b16 a[228:229], v29 offset:45056
ds_read_b64_tr_b16 a[230:231], v29 offset:45568
v_mfma_f32_16x16x32_bf16 v[88:91], a[236:239], a[140:143], v[88:91]
s_add_u32 s56, s66, s80
s_addc_u32 s57, s67, 0
v_mfma_f32_16x16x32_bf16 v[88:91], a[232:235], a[136:139], v[88:91]
s_mov_b32 s58, 2097152
s_mov_b32 s59, 0x20000
v_mfma_f32_16x16x32_bf16 v[104:107], a[232:235], a[144:147], v[104:107]
s_sub_u32 s62, s62, s80
s_mov_b32 s58, s62
v_mfma_f32_16x16x32_bf16 v[104:107], a[236:239], a[148:151], v[104:107]
buffer_load_dwordx4 v34, s[16:19], s43 offen offset:2048 lds
v_mfma_f32_16x16x32_bf16 v[120:123], a[236:239], a[156:159], v[120:123]
s_lshr_b32 s101, s83, 1
s_lshl_b32 s101, s101, 7
v_mfma_f32_16x16x32_bf16 v[120:123], a[232:235], a[152:155], v[120:123]
s_waitcnt lgkmcnt(4)
v_mfma_f32_16x16x32_bf16 a[48:51], a[240:243], a[152:155], a[48:51]
ds_read_b64_tr_b16 a[232:233], v30 offset:40960
ds_read_b64_tr_b16 a[234:235], v30 offset:41472
v_mfma_f32_16x16x32_bf16 a[48:51], a[244:247], a[156:159], a[48:51]
ds_read_b64_tr_b16 a[236:237], v30 offset:45056
ds_read_b64_tr_b16 a[238:239], v30 offset:45568
v_mfma_f32_16x16x32_bf16 a[32:35], a[244:247], a[148:151], a[32:35]
s_and_b32 s80, s76, 0
s_lshl_b32 s80, s80, 17
v_mfma_f32_16x16x32_bf16 a[32:35], a[240:243], a[144:147], a[32:35]
s_add_u32 s101, s101, s80
s_xor_b32 s100, s101, 128
v_mfma_f32_16x16x32_bf16 a[16:19], a[240:243], a[136:139], a[16:19]
v_and_b32 v52, 32, v0
v_lshlrev_b32 v52, 19, v52
v_mfma_f32_16x16x32_bf16 a[16:19], a[244:247], a[140:143], a[16:19]
buffer_load_dwordx4 v35, s[16:19], s43 offen offset:3072 lds
v_mfma_f32_16x16x32_bf16 a[0:3], a[244:247], a[132:135], a[0:3]
v_lshl_add_u32 v40, v0, 2, v52
v_lshlrev_b32 v41, 7, v0
v_mfma_f32_16x16x32_bf16 a[0:3], a[240:243], a[128:131], a[0:3]
s_waitcnt vmcnt(8) lgkmcnt(4)
s_barrier
v_mfma_f32_16x16x32_bf16 a[4:7], a[224:227], a[128:131], a[4:7]
ds_read_b64_tr_b16 a[240:241], v24 offset:49152
ds_read_b64_tr_b16 a[242:243], v24 offset:50176
v_mfma_f32_16x16x32_bf16 a[4:7], a[228:231], a[132:135], a[4:7]
ds_read_b64_tr_b16 a[244:245], v24 offset:57344
ds_read_b64_tr_b16 a[246:247], v24 offset:58368
v_mfma_f32_16x16x32_bf16 a[20:23], a[228:231], a[140:143], a[20:23]
s_add_u32 m0, s40, 147456
s_mov_b32 s43, 131072
v_mfma_f32_16x16x32_bf16 a[20:23], a[224:227], a[136:139], a[20:23]
buffer_load_dwordx4 v32, s[16:19], s43 offen lds
v_mfma_f32_16x16x32_bf16 a[36:39], a[224:227], a[144:147], a[36:39]
v_lshl_add_u32 v42, v1, 25, v40
v_mul_u32_u24 v52, 262144, v1
v_mfma_f32_16x16x32_bf16 a[36:39], a[228:231], a[148:151], a[36:39]
buffer_load_dwordx4 v33, s[16:19], s43 offen offset:1024 lds
v_mfma_f32_16x16x32_bf16 a[52:55], a[228:231], a[156:159], a[52:55]
L_pad3:
s_cbranch_execz L_pad4
v_lshl_add_u32 v36, v0, 4, v52
v_add_u32 v37, 131072, v36
v_mfma_f32_16x16x32_bf16 a[52:55], a[224:227], a[152:155], a[52:55]
s_waitcnt lgkmcnt(4)
v_mfma_f32_16x16x32_bf16 a[56:59], a[232:235], a[152:155], a[56:59]
ds_read_b64_tr_b16 a[224:225], v24 offset:49160
ds_read_b64_tr_b16 a[226:227], v24 offset:50184
v_mfma_f32_16x16x32_bf16 a[56:59], a[236:239], a[156:159], a[56:59]
ds_read_b64_tr_b16 a[228:229], v24 offset:57352
ds_read_b64_tr_b16 a[230:231], v24 offset:58376
v_mfma_f32_16x16x32_bf16 a[40:43], a[236:239], a[148:151], a[40:43]
s_lshl_b32 s80, s76, 15
s_sub_u32 s80, s80, 1048576
v_mfma_f32_16x16x32_bf16 a[40:43], a[232:235], a[144:147], a[40:43]
buffer_load_dwordx4 v34, s[16:19], s43 offen offset:2048 lds
v_mfma_f32_16x16x32_bf16 a[24:27], a[232:235], a[136:139], a[24:27]
v_lshrrev_b32 v52, 1, v2
v_lshl_add_u32 v52, v1, 3, v52
v_mfma_f32_16x16x32_bf16 a[24:27], a[236:239], a[140:143], a[24:27]
buffer_load_dwordx4 v35, s[16:19], s43 offen offset:3072 lds
v_mfma_f32_16x16x32_bf16 a[8:11], a[236:239], a[132:135], a[8:11]
v_lshlrev_b32 v52, 10, v52
v_and_b32 v53, 1, v0
v_mfma_f32_16x16x32_bf16 a[8:11], a[232:235], a[128:131], a[8:11]
s_waitcnt lgkmcnt(4)
v_mfma_f32_16x16x32_bf16 v[128:131], a[240:243], a[160:163], v[128:131]
ds_read_b64_tr_b16 a[232:233], v25 offset:49152
ds_read_b64_tr_b16 a[234:235], v25 offset:50176
v_mfma_f32_16x16x32_bf16 v[128:131], a[244:247], a[164:167], v[128:131]
ds_read_b64_tr_b16 a[236:237], v25 offset:57344
ds_read_b64_tr_b16 a[238:239], v25 offset:58368
v_mfma_f32_16x16x32_bf16 v[144:147], a[244:247], a[172:175], v[144:147]
v_lshl_add_u32 v52, v53, 7, v52
v_lshl_add_u32 v52, v3, 28, v52
v_mfma_f32_16x16x32_bf16 v[144:147], a[240:243], a[168:171], v[144:147]
v_add_u32 v38, s80, v52
s_mul_i32 s80, s76, 14336
v_mfma_f32_16x16x32_bf16 v[160:163], a[240:243], a[176:179], v[160:163]
s_movk_i32 s48, 16384
s_add_u32 m0, s40, 16384
s_movk_i32 s49, 0
v_mfma_f32_16x16x32_bf16 v[160:163], a[244:247], a[180:183], v[160:163]
buffer_load_dwordx4 v16, s[8:11], s48 offen lds
v_mfma_f32_16x16x32_bf16 v[176:179], a[244:247], a[188:191], v[176:179]
s_sub_u32 s80, s80, 458752
v_mul_u32_u24 v52, 7, v1
v_mfma_f32_16x16x32_bf16 v[176:179], a[240:243], a[184:187], v[176:179]
s_waitcnt lgkmcnt(4)
v_mfma_f32_16x16x32_bf16 v[240:243], a[224:227], a[184:187], v[240:243]
ds_read_b64_tr_b16 a[240:241], v25 offset:49160
ds_read_b64_tr_b16 a[242:243], v25 offset:50184
v_mfma_f32_16x16x32_bf16 v[240:243], a[228:231], a[188:191], v[240:243]
ds_read_b64_tr_b16 a[244:245], v25 offset:57352
ds_read_b64_tr_b16 a[246:247], v25 offset:58376
v_mfma_f32_16x16x32_bf16 v[224:227], a[228:231], a[180:183], v[224:227]
v_add_u32 v52, v52, v0
v_and_b32 v53, 1, v52
v_mfma_f32_16x16x32_bf16 v[224:227], a[224:227], a[176:179], v[224:227]
v_lshrrev_b32 v52, 1, v52
v_lshlrev_b32 v52, 10, v52
v_mfma_f32_16x16x32_bf16 v[208:211], a[224:227], a[168:171], v[208:211]
v_lshl_add_u32 v52, v53, 7, v52
v_add_u32 v53, 1, v0
v_mfma_f32_16x16x32_bf16 v[208:211], a[228:231], a[172:175], v[208:211]
buffer_load_dwordx4 v17, s[8:11], s48 offen offset:1024 lds
v_mfma_f32_16x16x32_bf16 v[192:195], a[228:231], a[164:167], v[192:195]
v_lshrrev_b32 v53, 3, v53
v_lshl_add_u32 v52, v53, 26, v52
v_mfma_f32_16x16x32_bf16 v[192:195], a[224:227], a[160:163], v[192:195]
s_waitcnt lgkmcnt(4)
v_mfma_f32_16x16x32_bf16 v[132:135], a[232:235], a[160:163], v[132:135]
ds_read_b64_tr_b16 a[224:225], v26 offset:49152
ds_read_b64_tr_b16 a[226:227], v26 offset:50176
v_mfma_f32_16x16x32_bf16 v[132:135], a[236:239], a[164:167], v[132:135]
ds_read_b64_tr_b16 a[228:229], v26 offset:57344
ds_read_b64_tr_b16 a[230:231], v26 offset:58368
v_mfma_f32_16x16x32_bf16 v[148:151], a[236:239], a[172:175], v[148:151]
v_add_u32 v39, s80, v52
s_lshr_b32 s80, s85, 1
v_mfma_f32_16x16x32_bf16 v[148:151], a[232:235], a[168:171], v[148:151]
s_mul_i32 s80, s80, 58368
s_and_b32 s81, s85, 1
v_mfma_f32_16x16x32_bf16 v[164:167], a[232:235], a[176:179], v[164:167]
s_mul_i32 s81, s81, 7168
s_add_u32 s80, s80, s81
v_mfma_f32_16x16x32_bf16 v[164:167], a[236:239], a[180:183], v[164:167]
buffer_load_dwordx4 v18, s[8:11], s48 offen offset:2048 lds
v_mfma_f32_16x16x32_bf16 v[180:183], a[236:239], a[188:191], v[180:183]
s_sub_u32 s80, s80, 466944
v_mul_u32_u24 v52, 14, v1
v_mfma_f32_16x16x32_bf16 v[180:183], a[232:235], a[184:187], v[180:183]
s_waitcnt lgkmcnt(4)
v_mfma_f32_16x16x32_bf16 v[244:247], a[240:243], a[184:187], v[244:247]
ds_read_b64_tr_b16 a[232:233], v26 offset:49160
ds_read_b64_tr_b16 a[234:235], v26 offset:50184
v_mfma_f32_16x16x32_bf16 v[244:247], a[244:247], a[188:191], v[244:247]
ds_read_b64_tr_b16 a[236:237], v26 offset:57352
ds_read_b64_tr_b16 a[238:239], v26 offset:58376
v_mfma_f32_16x16x32_bf16 v[228:231], a[244:247], a[180:183], v[228:231]
v_add_lshl_u32 v52, v52, v0, 7
v_add_u32 v53, 2, v0
v_mfma_f32_16x16x32_bf16 v[228:231], a[240:243], a[176:179], v[228:231]
v_lshrrev_b32 v53, 4, v53
v_lshl_add_u32 v52, v53, 26, v52
v_mfma_f32_16x16x32_bf16 v[212:215], a[240:243], a[168:171], v[212:215]
v_add_u32 v43, s80, v52
s_lshl_b32 s80, s77, 18
v_mfma_f32_16x16x32_bf16 v[212:215], a[244:247], a[172:175], v[212:215]
buffer_load_dwordx4 v19, s[8:11], s48 offen offset:3072 lds
v_mfma_f32_16x16x32_bf16 v[196:199], a[244:247], a[164:167], v[196:199]
v_add_u32 v52, s80, v42
s_and_b32 s64, s76, 0
v_mfma_f32_16x16x32_bf16 v[196:199], a[240:243], a[160:163], v[196:199]
s_waitcnt lgkmcnt(4)
v_mfma_f32_16x16x32_bf16 v[136:139], a[224:227], a[160:163], v[136:139]
ds_read_b64_tr_b16 a[240:241], v27 offset:49152
ds_read_b64_tr_b16 a[242:243], v27 offset:50176
v_mfma_f32_16x16x32_bf16 v[136:139], a[228:231], a[164:167], v[136:139]
ds_read_b64_tr_b16 a[244:245], v27 offset:57344
ds_read_b64_tr_b16 a[246:247], v27 offset:58368
v_mfma_f32_16x16x32_bf16 v[152:155], a[228:231], a[172:175], v[152:155]
s_xor_b32 s64, s64, s75
s_lshl_b32 s64, s64, 10
v_mfma_f32_16x16x32_bf16 v[152:155], a[224:227], a[168:171], v[152:155]
s_xor_b32 s65, s64, 1024
s_xor_b32 s66, s64, 2048
v_mfma_f32_16x16x32_bf16 v[168:171], a[224:227], a[176:179], v[168:171]
s_add_u32 m0, s42, 16384
v_mfma_f32_16x16x32_bf16 v[168:171], a[228:231], a[180:183], v[168:171]
buffer_load_dwordx4 v20, s[12:15], 0 offen lds
v_mfma_f32_16x16x32_bf16 v[184:187], a[228:231], a[188:191], v[184:187]
s_xor_b32 s67, s64, 3072
v_mfma_f32_16x16x32_bf16 v[184:187], a[224:227], a[184:187], v[184:187]
s_waitcnt lgkmcnt(4)
v_mfma_f32_16x16x32_bf16 v[248:251], a[232:235], a[184:187], v[248:251]
ds_read_b64_tr_b16 a[224:225], v27 offset:49160
ds_read_b64_tr_b16 a[226:227], v27 offset:50184
v_mfma_f32_16x16x32_bf16 v[248:251], a[236:239], a[188:191], v[248:251]
ds_read_b64_tr_b16 a[228:229], v27 offset:57352
ds_read_b64_tr_b16 a[230:231], v27 offset:58376
v_mfma_f32_16x16x32_bf16 v[232:235], a[236:239], a[180:183], v[232:235]
v_mov_b32 v60, s87
buffer_store_dword v60, v52, s[88:91], 0 offen sc1
v_mfma_f32_16x16x32_bf16 v[232:235], a[232:235], a[176:179], v[232:235]
v_accvgpr_write_b32 a128, 0
v_accvgpr_write_b32 a129, 0
v_mfma_f32_16x16x32_bf16 v[216:219], a[232:235], a[168:171], v[216:219]
v_accvgpr_write_b32 a130, 0
v_accvgpr_write_b32 a131, 0
v_mfma_f32_16x16x32_bf16 v[216:219], a[236:239], a[172:175], v[216:219]
buffer_load_dwordx4 v21, s[12:15], 0 offen offset:1024 lds
v_mfma_f32_16x16x32_bf16 v[200:203], a[236:239], a[164:167], v[200:203]
v_accvgpr_write_b32 a132, 0
v_accvgpr_write_b32 a133, 0
v_mfma_f32_16x16x32_bf16 v[200:203], a[232:235], a[160:163], v[200:203]
s_waitcnt lgkmcnt(4)
v_mfma_f32_16x16x32_bf16 v[140:143], a[240:243], a[160:163], v[140:143]
ds_read_b64_tr_b16 a[232:233], v28 offset:49152
ds_read_b64_tr_b16 a[234:235], v28 offset:49664
v_mfma_f32_16x16x32_bf16 v[140:143], a[244:247], a[164:167], v[140:143]
ds_read_b64_tr_b16 a[236:237], v28 offset:53248
ds_read_b64_tr_b16 a[238:239], v28 offset:53760
v_mfma_f32_16x16x32_bf16 v[156:159], a[244:247], a[172:175], v[156:159]
v_accvgpr_write_b32 a134, 0
v_accvgpr_write_b32 a135, 0
v_mfma_f32_16x16x32_bf16 v[156:159], a[240:243], a[168:171], v[156:159]
v_accvgpr_write_b32 a136, 0
v_accvgpr_write_b32 a137, 0
v_mfma_f32_16x16x32_bf16 v[172:175], a[240:243], a[176:179], v[172:175]
v_accvgpr_write_b32 a138, 0
v_accvgpr_write_b32 a139, 0
v_mfma_f32_16x16x32_bf16 v[172:175], a[244:247], a[180:183], v[172:175]
buffer_load_dwordx4 v20, s[12:15], 0 offen offset:2048 lds
v_mfma_f32_16x16x32_bf16 v[188:191], a[244:247], a[188:191], v[188:191]
v_accvgpr_write_b32 a140, 0
v_accvgpr_write_b32 a141, 0
v_mfma_f32_16x16x32_bf16 v[188:191], a[240:243], a[184:187], v[188:191]
s_waitcnt lgkmcnt(4)
v_mfma_f32_16x16x32_bf16 v[252:255], a[224:227], a[184:187], v[252:255]
ds_read_b64_tr_b16 a[240:241], v29 offset:49152
ds_read_b64_tr_b16 a[242:243], v29 offset:49664
v_mfma_f32_16x16x32_bf16 v[252:255], a[228:231], a[188:191], v[252:255]
ds_read_b64_tr_b16 a[244:245], v29 offset:53248
ds_read_b64_tr_b16 a[246:247], v29 offset:53760
v_mfma_f32_16x16x32_bf16 v[236:239], a[228:231], a[180:183], v[236:239]
v_accvgpr_write_b32 a142, 0
v_accvgpr_write_b32 a143, 0
v_mfma_f32_16x16x32_bf16 v[236:239], a[224:227], a[176:179], v[236:239]
v_mul_f32 v128, s46, v128
v_mul_f32 v129, s46, v129
v_mfma_f32_16x16x32_bf16 v[220:223], a[224:227], a[168:171], v[220:223]
v_mul_f32 v130, s46, v130
v_mul_f32 v131, s46, v131
v_mfma_f32_16x16x32_bf16 v[220:223], a[228:231], a[172:175], v[220:223]
buffer_load_dwordx4 v21, s[12:15], 0 offen offset:3072 lds
v_mfma_f32_16x16x32_bf16 v[204:207], a[228:231], a[164:167], v[204:207]
v_cvt_pk_bf16_f32 v128, v128, v129
v_cvt_pk_bf16_f32 v129, v130, v131
v_mfma_f32_16x16x32_bf16 v[204:207], a[224:227], a[160:163], v[204:207]
s_waitcnt lgkmcnt(4)
v_mfma_f32_16x16x32_bf16 v[64:67], a[232:235], a[160:163], v[64:67]
ds_read_b64_tr_b16 a[224:225], v30 offset:49152
ds_read_b64_tr_b16 a[226:227], v30 offset:49664
v_mfma_f32_16x16x32_bf16 v[64:67], a[236:239], a[164:167], v[64:67]
ds_read_b64_tr_b16 a[228:229], v30 offset:53248
ds_read_b64_tr_b16 a[230:231], v30 offset:53760
v_mfma_f32_16x16x32_bf16 v[80:83], a[236:239], a[172:175], v[80:83]
v_mul_f32 v144, s46, v144
v_mul_f32 v145, s46, v145
v_mfma_f32_16x16x32_bf16 v[80:83], a[232:235], a[168:171], v[80:83]
v_mul_f32 v146, s46, v146
v_mul_f32 v147, s46, v147
v_mfma_f32_16x16x32_bf16 v[96:99], a[232:235], a[176:179], v[96:99]
v_cvt_pk_bf16_f32 v144, v144, v145
v_cvt_pk_bf16_f32 v145, v146, v147
v_mfma_f32_16x16x32_bf16 v[96:99], a[236:239], a[180:183], v[96:99]
v_mul_f32 v160, s46, v160
v_mul_f32 v161, s46, v161
v_mfma_f32_16x16x32_bf16 v[112:115], a[236:239], a[188:191], v[112:115]
v_mul_f32 v162, s46, v162
v_mul_f32 v163, s46, v163
v_mfma_f32_16x16x32_bf16 v[112:115], a[232:235], a[184:187], v[112:115]
s_waitcnt lgkmcnt(4)
v_mfma_f32_16x16x32_bf16 v[116:119], a[240:243], a[184:187], v[116:119]
ds_read_b64_tr_b16 a[232:233], v28 offset:57344
ds_read_b64_tr_b16 a[234:235], v28 offset:57856
v_mfma_f32_16x16x32_bf16 v[116:119], a[244:247], a[188:191], v[116:119]
ds_read_b64_tr_b16 a[236:237], v28 offset:61440
ds_read_b64_tr_b16 a[238:239], v28 offset:61952
v_mfma_f32_16x16x32_bf16 v[100:103], a[244:247], a[180:183], v[100:103]
v_cvt_pk_bf16_f32 v160, v160, v161
v_cvt_pk_bf16_f32 v161, v162, v163
v_mfma_f32_16x16x32_bf16 v[100:103], a[240:243], a[176:179], v[100:103]
v_mul_f32 v176, s46, v176
v_mul_f32 v177, s46, v177
v_mfma_f32_16x16x32_bf16 v[84:87], a[240:243], a[168:171], v[84:87]
v_mul_f32 v178, s46, v178
v_mul_f32 v179, s46, v179
v_mfma_f32_16x16x32_bf16 v[84:87], a[244:247], a[172:175], v[84:87]
v_cvt_pk_bf16_f32 v176, v176, v177
v_cvt_pk_bf16_f32 v177, v178, v179
v_mfma_f32_16x16x32_bf16 v[68:71], a[244:247], a[164:167], v[68:71]
v_mul_f32 v192, s46, v192
v_mul_f32 v193, s46, v193
v_mfma_f32_16x16x32_bf16 v[68:71], a[240:243], a[160:163], v[68:71]
s_waitcnt lgkmcnt(4)
v_mfma_f32_16x16x32_bf16 v[72:75], a[224:227], a[160:163], v[72:75]
ds_read_b64_tr_b16 a[240:241], v29 offset:57344
ds_read_b64_tr_b16 a[242:243], v29 offset:57856
v_mfma_f32_16x16x32_bf16 v[72:75], a[228:231], a[164:167], v[72:75]
ds_read_b64_tr_b16 a[244:245], v29 offset:61440
ds_read_b64_tr_b16 a[246:247], v29 offset:61952
v_mfma_f32_16x16x32_bf16 v[88:91], a[228:231], a[172:175], v[88:91]
v_mul_f32 v194, s46, v194
v_mul_f32 v195, s46, v195
v_mfma_f32_16x16x32_bf16 v[88:91], a[224:227], a[168:171], v[88:91]
v_cvt_pk_bf16_f32 v130, v192, v193
v_cvt_pk_bf16_f32 v131, v194, v195
v_mfma_f32_16x16x32_bf16 v[104:107], a[224:227], a[176:179], v[104:107]
v_mul_f32 v208, s46, v208
v_mul_f32 v209, s46, v209
v_mfma_f32_16x16x32_bf16 v[104:107], a[228:231], a[180:183], v[104:107]
v_mul_f32 v210, s46, v210
v_mul_f32 v211, s46, v211
v_mfma_f32_16x16x32_bf16 v[120:123], a[228:231], a[188:191], v[120:123]
v_cvt_pk_bf16_f32 v146, v208, v209
v_cvt_pk_bf16_f32 v147, v210, v211
v_mfma_f32_16x16x32_bf16 v[120:123], a[224:227], a[184:187], v[120:123]
s_waitcnt lgkmcnt(4)
v_mfma_f32_16x16x32_bf16 a[48:51], a[232:235], a[184:187], a[48:51]
ds_read_b64_tr_b16 a[224:225], v30 offset:57344
ds_read_b64_tr_b16 a[226:227], v30 offset:57856
v_mfma_f32_16x16x32_bf16 a[48:51], a[236:239], a[188:191], a[48:51]
ds_read_b64_tr_b16 a[228:229], v30 offset:61440
ds_read_b64_tr_b16 a[230:231], v30 offset:61952
v_mfma_f32_16x16x32_bf16 a[32:35], a[236:239], a[180:183], a[32:35]
v_mul_f32 v224, s46, v224
v_mul_f32 v225, s46, v225
v_mfma_f32_16x16x32_bf16 a[32:35], a[232:235], a[176:179], a[32:35]
v_mul_f32 v226, s46, v226
v_mul_f32 v227, s46, v227
v_mfma_f32_16x16x32_bf16 a[16:19], a[232:235], a[168:171], a[16:19]
v_cvt_pk_bf16_f32 v162, v224, v225
v_cvt_pk_bf16_f32 v163, v226, v227
v_mfma_f32_16x16x32_bf16 a[16:19], a[236:239], a[172:175], a[16:19]
v_mul_f32 v240, s46, v240
v_mul_f32 v241, s46, v241
v_mfma_f32_16x16x32_bf16 a[0:3], a[236:239], a[164:167], a[0:3]
v_mul_f32 v242, s46, v242
v_mul_f32 v243, s46, v243
v_mfma_f32_16x16x32_bf16 a[0:3], a[232:235], a[160:163], a[0:3]
s_waitcnt lgkmcnt(4)
v_mfma_f32_16x16x32_bf16 a[4:7], a[240:243], a[160:163], a[4:7]
v_cvt_pk_bf16_f32 v178, v240, v241
v_cvt_pk_bf16_f32 v179, v242, v243
v_mfma_f32_16x16x32_bf16 a[4:7], a[244:247], a[164:167], a[4:7]
v_mul_f32 v132, s46, v132
v_mul_f32 v133, s46, v133
v_mfma_f32_16x16x32_bf16 a[20:23], a[244:247], a[172:175], a[20:23]
v_mul_f32 v134, s46, v134
v_mul_f32 v135, s46, v135
v_mfma_f32_16x16x32_bf16 a[20:23], a[240:243], a[168:171], a[20:23]
v_cvt_pk_bf16_f32 v132, v132, v133
v_cvt_pk_bf16_f32 v133, v134, v135
v_mfma_f32_16x16x32_bf16 a[36:39], a[240:243], a[176:179], a[36:39]
v_mul_f32 v148, s46, v148
v_mul_f32 v149, s46, v149
v_mfma_f32_16x16x32_bf16 a[36:39], a[244:247], a[180:183], a[36:39]
v_mul_f32 v150, s46, v150
v_mul_f32 v151, s46, v151
v_mfma_f32_16x16x32_bf16 a[52:55], a[244:247], a[188:191], a[52:55]
v_cvt_pk_bf16_f32 v148, v148, v149
v_cvt_pk_bf16_f32 v149, v150, v151
v_mfma_f32_16x16x32_bf16 a[52:55], a[240:243], a[184:187], a[52:55]
s_waitcnt lgkmcnt(0)
v_mfma_f32_16x16x32_bf16 a[56:59], a[224:227], a[184:187], a[56:59]
v_mul_f32 v164, s46, v164
v_mul_f32 v165, s46, v165
v_mfma_f32_16x16x32_bf16 a[56:59], a[228:231], a[188:191], a[56:59]
v_mul_f32 v166, s46, v166
v_mul_f32 v167, s46, v167
v_mfma_f32_16x16x32_bf16 a[40:43], a[228:231], a[180:183], a[40:43]
v_cvt_pk_bf16_f32 v164, v164, v165
v_cvt_pk_bf16_f32 v165, v166, v167
v_mfma_f32_16x16x32_bf16 a[40:43], a[224:227], a[176:179], a[40:43]
v_mul_f32 v180, s46, v180
v_mul_f32 v181, s46, v181
v_mfma_f32_16x16x32_bf16 a[24:27], a[224:227], a[168:171], a[24:27]
v_mul_f32 v182, s46, v182
v_mul_f32 v183, s46, v183
v_mfma_f32_16x16x32_bf16 a[24:27], a[228:231], a[172:175], a[24:27]
v_cvt_pk_bf16_f32 v180, v180, v181
v_cvt_pk_bf16_f32 v181, v182, v183
v_mfma_f32_16x16x32_bf16 a[8:11], a[228:231], a[164:167], a[8:11]
v_mfma_f32_16x16x32_bf16 a[8:11], a[224:227], a[160:163], a[8:11]
s_waitcnt vmcnt(16)
s_barrier
ds_read_b128 a[144:147], v4
ds_read_b128 a[148:151], v5
ds_read_b128 a[152:155], v6
ds_read_b128 a[156:159], v7
s_add_u32 m0, s40, 32768
s_add_u32 s48, s48, 16384
buffer_load_dwordx4 v16, s[8:11], s48 offen lds
buffer_load_dwordx4 v17, s[8:11], s48 offen offset:1024 lds
buffer_load_dwordx4 v18, s[8:11], s48 offen offset:2048 lds
buffer_load_dwordx4 v19, s[8:11], s48 offen offset:3072 lds
s_add_u32 m0, s42, 32768
s_add_u32 s49, s49, 16384
buffer_load_dwordx4 v20, s[12:15], s49 offen lds
buffer_load_dwordx4 v21, s[12:15], s49 offen offset:1024 lds
buffer_load_dwordx4 v20, s[12:15], s49 offen offset:2048 lds
buffer_load_dwordx4 v21, s[12:15], s49 offen offset:3072 lds
v_pk_mul_f32 v[196:197], v[196:197], s[46:47]
v_pk_mul_f32 v[198:199], v[198:199], s[46:47]
v_pk_mul_f32 v[212:213], v[212:213], s[46:47]
v_pk_mul_f32 v[214:215], v[214:215], s[46:47]
v_pk_mul_f32 v[228:229], v[228:229], s[46:47]
v_pk_mul_f32 v[230:231], v[230:231], s[46:47]
v_pk_mul_f32 v[244:245], v[244:245], s[46:47]
v_pk_mul_f32 v[246:247], v[246:247], s[46:47]
v_cvt_pk_bf16_f32 v134, v196, v197
v_cvt_pk_bf16_f32 v135, v198, v199
v_cvt_pk_bf16_f32 v150, v212, v213
v_cvt_pk_bf16_f32 v151, v214, v215
v_cvt_pk_bf16_f32 v166, v228, v229
v_cvt_pk_bf16_f32 v167, v230, v231
v_cvt_pk_bf16_f32 v182, v244, v245
v_cvt_pk_bf16_f32 v183, v246, v247
v_pk_mul_f32 v[136:137], v[136:137], s[46:47]
v_pk_mul_f32 v[138:139], v[138:139], s[46:47]
v_pk_mul_f32 v[152:153], v[152:153], s[46:47]
v_pk_mul_f32 v[154:155], v[154:155], s[46:47]
v_pk_mul_f32 v[168:169], v[168:169], s[46:47]
v_pk_mul_f32 v[170:171], v[170:171], s[46:47]
v_pk_mul_f32 v[184:185], v[184:185], s[46:47]
v_pk_mul_f32 v[186:187], v[186:187], s[46:47]
v_cvt_pk_bf16_f32 v136, v136, v137
v_cvt_pk_bf16_f32 v137, v138, v139
v_cvt_pk_bf16_f32 v152, v152, v153
v_cvt_pk_bf16_f32 v153, v154, v155
v_cvt_pk_bf16_f32 v168, v168, v169
v_cvt_pk_bf16_f32 v169, v170, v171
v_cvt_pk_bf16_f32 v184, v184, v185
v_cvt_pk_bf16_f32 v185, v186, v187
v_pk_mul_f32 v[200:201], v[200:201], s[46:47]
v_pk_mul_f32 v[202:203], v[202:203], s[46:47]
v_pk_mul_f32 v[216:217], v[216:217], s[46:47]
v_pk_mul_f32 v[218:219], v[218:219], s[46:47]
v_pk_mul_f32 v[232:233], v[232:233], s[46:47]
v_pk_mul_f32 v[234:235], v[234:235], s[46:47]
v_pk_mul_f32 v[248:249], v[248:249], s[46:47]
v_pk_mul_f32 v[250:251], v[250:251], s[46:47]
v_cvt_pk_bf16_f32 v138, v200, v201
v_cvt_pk_bf16_f32 v139, v202, v203
v_cvt_pk_bf16_f32 v154, v216, v217
v_cvt_pk_bf16_f32 v155, v218, v219
v_cvt_pk_bf16_f32 v170, v232, v233
v_cvt_pk_bf16_f32 v171, v234, v235
v_cvt_pk_bf16_f32 v186, v248, v249
v_cvt_pk_bf16_f32 v187, v250, v251
v_pk_mul_f32 v[140:141], v[140:141], s[46:47]
v_pk_mul_f32 v[142:143], v[142:143], s[46:47]
v_pk_mul_f32 v[156:157], v[156:157], s[46:47]
v_pk_mul_f32 v[158:159], v[158:159], s[46:47]
v_pk_mul_f32 v[172:173], v[172:173], s[46:47]
v_pk_mul_f32 v[174:175], v[174:175], s[46:47]
v_pk_mul_f32 v[188:189], v[188:189], s[46:47]
v_pk_mul_f32 v[190:191], v[190:191], s[46:47]
v_cvt_pk_bf16_f32 v140, v140, v141
v_cvt_pk_bf16_f32 v141, v142, v143
v_cvt_pk_bf16_f32 v156, v156, v157
v_cvt_pk_bf16_f32 v157, v158, v159
v_cvt_pk_bf16_f32 v172, v172, v173
v_cvt_pk_bf16_f32 v173, v174, v175
v_cvt_pk_bf16_f32 v188, v188, v189
v_cvt_pk_bf16_f32 v189, v190, v191
v_pk_mul_f32 v[204:205], v[204:205], s[46:47]
v_pk_mul_f32 v[206:207], v[206:207], s[46:47]
v_pk_mul_f32 v[220:221], v[220:221], s[46:47]
v_pk_mul_f32 v[222:223], v[222:223], s[46:47]
v_pk_mul_f32 v[236:237], v[236:237], s[46:47]
v_pk_mul_f32 v[238:239], v[238:239], s[46:47]
v_pk_mul_f32 v[252:253], v[252:253], s[46:47]
v_pk_mul_f32 v[254:255], v[254:255], s[46:47]
v_cvt_pk_bf16_f32 v142, v204, v205
v_cvt_pk_bf16_f32 v143, v206, v207
v_cvt_pk_bf16_f32 v158, v220, v221
v_cvt_pk_bf16_f32 v159, v222, v223
v_cvt_pk_bf16_f32 v174, v236, v237
v_cvt_pk_bf16_f32 v175, v238, v239
v_cvt_pk_bf16_f32 v190, v252, v253
v_cvt_pk_bf16_f32 v191, v254, v255
s_mov_b32 s46, 0xbfb8aa3b
s_mov_b32 s47, 0xbfb8aa3b
s_waitcnt lgkmcnt(0)
v_mfma_f32_16x16x32_bf16 v[192:195], a[144:147], v[128:131], 0
v_accvgpr_read_b32 v208, a0
v_accvgpr_read_b32 v209, a1
v_mfma_f32_16x16x32_bf16 v[192:195], a[148:151], v[132:135], v[192:195]
v_accvgpr_read_b32 v210, a2
v_accvgpr_read_b32 v211, a3
v_mfma_f32_16x16x32_bf16 v[192:195], a[152:155], v[136:139], v[192:195]
v_accvgpr_read_b32 v212, a4
v_accvgpr_read_b32 v213, a5
v_mfma_f32_16x16x32_bf16 v[192:195], a[156:159], v[140:143], v[192:195]
v_accvgpr_read_b32 v214, a6
v_accvgpr_read_b32 v215, a7
v_mfma_f32_16x16x32_bf16 v[196:199], a[144:147], v[144:147], 0
v_accvgpr_read_b32 v216, a8
v_accvgpr_read_b32 v217, a9
v_mfma_f32_16x16x32_bf16 v[196:199], a[148:151], v[148:151], v[196:199]
v_accvgpr_read_b32 v218, a10
v_accvgpr_read_b32 v219, a11
v_mfma_f32_16x16x32_bf16 v[196:199], a[152:155], v[152:155], v[196:199]
v_accvgpr_read_b32 v220, a12
v_accvgpr_read_b32 v221, a13
v_mfma_f32_16x16x32_bf16 v[196:199], a[156:159], v[156:159], v[196:199]
v_accvgpr_read_b32 v222, a14
v_accvgpr_read_b32 v223, a15
v_mfma_f32_16x16x32_bf16 v[200:203], a[144:147], v[160:163], 0
v_accvgpr_read_b32 v224, a16
v_accvgpr_read_b32 v225, a17
v_mfma_f32_16x16x32_bf16 v[200:203], a[148:151], v[164:167], v[200:203]
v_accvgpr_read_b32 v226, a18
v_accvgpr_read_b32 v227, a19
v_mfma_f32_16x16x32_bf16 v[200:203], a[152:155], v[168:171], v[200:203]
v_accvgpr_read_b32 v228, a20
v_accvgpr_read_b32 v229, a21
v_mfma_f32_16x16x32_bf16 v[200:203], a[156:159], v[172:175], v[200:203]
v_accvgpr_read_b32 v230, a22
v_accvgpr_read_b32 v231, a23
v_mfma_f32_16x16x32_bf16 v[204:207], a[144:147], v[176:179], 0
v_accvgpr_read_b32 v232, a24
v_accvgpr_read_b32 v233, a25
v_mfma_f32_16x16x32_bf16 v[204:207], a[148:151], v[180:183], v[204:207]
v_accvgpr_read_b32 v234, a26
v_accvgpr_read_b32 v235, a27
v_mfma_f32_16x16x32_bf16 v[204:207], a[152:155], v[184:187], v[204:207]
v_accvgpr_read_b32 v236, a28
v_accvgpr_read_b32 v237, a29
v_mfma_f32_16x16x32_bf16 v[204:207], a[156:159], v[188:191], v[204:207]
v_accvgpr_read_b32 v238, a30
v_accvgpr_read_b32 v239, a31
s_mul_i32 s80, s75, 3
s_add_u32 s80, s80, 17
s_lshr_b32 s80, s80, 1
s_lshl_b32 s80, s80, 10
s_lshr_b32 s81, s75, 1
s_mul_i32 s81, s81, 3072
s_and_b32 s82, s75, 1
s_lshl_b32 s82, s82, 9
s_add_u32 s81, s81, s82
s_add_u32 s81, s81, 9216
v_lshlrev_b32 v52, 3, v0
v_pk_mul_f32 v[240:241], v[64:65], s[46:47]
v_pk_mul_f32 v[242:243], v[66:67], s[46:47]
v_pk_mul_f32 v[244:245], v[68:69], s[46:47]
v_pk_mul_f32 v[246:247], v[70:71], s[46:47]
v_pk_mul_f32 v[248:249], v[72:73], s[46:47]
v_pk_mul_f32 v[250:251], v[74:75], s[46:47]
v_exp_f32 v240, v240
v_exp_f32 v241, v241
v_exp_f32 v242, v242
v_exp_f32 v243, v243
v_exp_f32 v244, v244
v_exp_f32 v245, v245
v_exp_f32 v246, v246
v_exp_f32 v247, v247
v_exp_f32 v248, v248
v_exp_f32 v249, v249
v_exp_f32 v250, v250
v_exp_f32 v251, v251
v_pk_mul_f32 v[64:65], v[64:65], v[208:209]
v_pk_mul_f32 v[66:67], v[66:67], v[210:211]
v_pk_mul_f32 v[68:69], v[68:69], v[212:213]
v_pk_mul_f32 v[70:71], v[70:71], v[214:215]
v_pk_mul_f32 v[72:73], v[72:73], v[216:217]
v_pk_mul_f32 v[74:75], v[74:75], v[218:219]
v_pk_add_f32 v[240:241], v[240:241], 1.0 op_sel_hi:[1,0]
v_pk_add_f32 v[242:243], v[242:243], 1.0 op_sel_hi:[1,0]
v_pk_add_f32 v[244:245], v[244:245], 1.0 op_sel_hi:[1,0]
v_pk_add_f32 v[246:247], v[246:247], 1.0 op_sel_hi:[1,0]
v_pk_add_f32 v[248:249], v[248:249], 1.0 op_sel_hi:[1,0]
v_pk_add_f32 v[250:251], v[250:251], 1.0 op_sel_hi:[1,0]
v_rcp_f32 v240, v240
v_rcp_f32 v241, v241
v_rcp_f32 v242, v242
v_rcp_f32 v243, v243
v_rcp_f32 v244, v244
v_rcp_f32 v245, v245
v_rcp_f32 v246, v246
v_rcp_f32 v247, v247
v_rcp_f32 v248, v248
v_rcp_f32 v249, v249
v_rcp_f32 v250, v250
v_rcp_f32 v251, v251
v_pk_mul_f32 v[64:65], v[64:65], v[240:241]
v_pk_mul_f32 v[66:67], v[66:67], v[242:243]
v_pk_mul_f32 v[68:69], v[68:69], v[244:245]
v_pk_mul_f32 v[70:71], v[70:71], v[246:247]
v_pk_mul_f32 v[72:73], v[72:73], v[248:249]
v_pk_mul_f32 v[74:75], v[74:75], v[250:251]
v_cvt_pk_bf16_f32 v24, v64, v65
v_cvt_pk_bf16_f32 v25, v66, v67
v_cvt_pk_bf16_f32 v26, v68, v69
v_cvt_pk_bf16_f32 v27, v70, v71
v_cvt_pk_bf16_f32 v68, v72, v73
v_cvt_pk_bf16_f32 v69, v74, v75
buffer_store_dwordx4 v[24:27], v44, s[32:35], s80 offen sc1
v_sub_u32 v53, v44, v52
buffer_store_dwordx2 v[68:69], v53, s[32:35], s81 offen sc1
v_pk_mul_f32 v[240:241], v[80:81], s[46:47]
v_pk_mul_f32 v[242:243], v[82:83], s[46:47]
v_pk_mul_f32 v[244:245], v[84:85], s[46:47]
v_pk_mul_f32 v[246:247], v[86:87], s[46:47]
v_pk_mul_f32 v[248:249], v[88:89], s[46:47]
v_pk_mul_f32 v[250:251], v[90:91], s[46:47]
v_exp_f32 v240, v240
v_exp_f32 v241, v241
v_exp_f32 v242, v242
v_exp_f32 v243, v243
v_exp_f32 v244, v244
v_exp_f32 v245, v245
v_exp_f32 v246, v246
v_exp_f32 v247, v247
v_exp_f32 v248, v248
v_exp_f32 v249, v249
v_exp_f32 v250, v250
v_exp_f32 v251, v251
v_pk_mul_f32 v[80:81], v[80:81], v[224:225]
v_pk_mul_f32 v[82:83], v[82:83], v[226:227]
v_pk_mul_f32 v[84:85], v[84:85], v[228:229]
v_pk_mul_f32 v[86:87], v[86:87], v[230:231]
v_pk_mul_f32 v[88:89], v[88:89], v[232:233]
v_pk_mul_f32 v[90:91], v[90:91], v[234:235]
v_pk_add_f32 v[240:241], v[240:241], 1.0 op_sel_hi:[1,0]
v_pk_add_f32 v[242:243], v[242:243], 1.0 op_sel_hi:[1,0]
v_pk_add_f32 v[244:245], v[244:245], 1.0 op_sel_hi:[1,0]
v_pk_add_f32 v[246:247], v[246:247], 1.0 op_sel_hi:[1,0]
v_pk_add_f32 v[248:249], v[248:249], 1.0 op_sel_hi:[1,0]
L_pad4:
s_cbranch_execz L_walked0
v_pk_add_f32 v[250:251], v[250:251], 1.0 op_sel_hi:[1,0]
v_rcp_f32 v240, v240
v_rcp_f32 v241, v241
v_rcp_f32 v242, v242
v_rcp_f32 v243, v243
v_rcp_f32 v244, v244
v_rcp_f32 v245, v245
v_rcp_f32 v246, v246
v_rcp_f32 v247, v247
v_rcp_f32 v248, v248
v_rcp_f32 v249, v249
v_rcp_f32 v250, v250
v_rcp_f32 v251, v251
v_pk_mul_f32 v[80:81], v[80:81], v[240:241]
v_pk_mul_f32 v[82:83], v[82:83], v[242:243]
v_pk_mul_f32 v[84:85], v[84:85], v[244:245]
v_pk_mul_f32 v[86:87], v[86:87], v[246:247]
v_pk_mul_f32 v[88:89], v[88:89], v[248:249]
v_pk_mul_f32 v[90:91], v[90:91], v[250:251]
v_cvt_pk_bf16_f32 v28, v80, v81
v_cvt_pk_bf16_f32 v29, v82, v83
v_cvt_pk_bf16_f32 v30, v84, v85
v_cvt_pk_bf16_f32 v31, v86, v87
v_cvt_pk_bf16_f32 v84, v88, v89
v_cvt_pk_bf16_f32 v85, v90, v91
buffer_store_dwordx4 v[28:31], v45, s[32:35], s80 offen sc1
v_sub_u32 v53, v45, v52
buffer_store_dwordx2 v[84:85], v53, s[32:35], s81 offen sc1
v_accvgpr_read_b32 v208, a32
v_accvgpr_read_b32 v209, a33
v_accvgpr_read_b32 v210, a34
v_accvgpr_read_b32 v211, a35
v_accvgpr_read_b32 v212, a36
v_accvgpr_read_b32 v213, a37
v_accvgpr_read_b32 v214, a38
v_accvgpr_read_b32 v215, a39
v_accvgpr_read_b32 v216, a40
v_accvgpr_read_b32 v217, a41
v_accvgpr_read_b32 v218, a42
v_accvgpr_read_b32 v219, a43
v_pk_mul_f32 v[240:241], v[96:97], s[46:47]
v_pk_mul_f32 v[242:243], v[98:99], s[46:47]
v_pk_mul_f32 v[244:245], v[100:101], s[46:47]
v_pk_mul_f32 v[246:247], v[102:103], s[46:47]
v_pk_mul_f32 v[248:249], v[104:105], s[46:47]
v_pk_mul_f32 v[250:251], v[106:107], s[46:47]
v_exp_f32 v240, v240
v_exp_f32 v241, v241
v_exp_f32 v242, v242
v_exp_f32 v243, v243
v_exp_f32 v244, v244
v_exp_f32 v245, v245
v_exp_f32 v246, v246
v_exp_f32 v247, v247
v_exp_f32 v248, v248
v_exp_f32 v249, v249
v_exp_f32 v250, v250
v_exp_f32 v251, v251
v_pk_mul_f32 v[96:97], v[96:97], v[208:209]
v_pk_mul_f32 v[98:99], v[98:99], v[210:211]
v_pk_mul_f32 v[100:101], v[100:101], v[212:213]
v_pk_mul_f32 v[102:103], v[102:103], v[214:215]
v_pk_mul_f32 v[104:105], v[104:105], v[216:217]
v_pk_mul_f32 v[106:107], v[106:107], v[218:219]
v_pk_add_f32 v[240:241], v[240:241], 1.0 op_sel_hi:[1,0]
v_pk_add_f32 v[242:243], v[242:243], 1.0 op_sel_hi:[1,0]
v_pk_add_f32 v[244:245], v[244:245], 1.0 op_sel_hi:[1,0]
v_pk_add_f32 v[246:247], v[246:247], 1.0 op_sel_hi:[1,0]
v_pk_add_f32 v[248:249], v[248:249], 1.0 op_sel_hi:[1,0]
v_pk_add_f32 v[250:251], v[250:251], 1.0 op_sel_hi:[1,0]
v_rcp_f32 v240, v240
v_rcp_f32 v241, v241
v_rcp_f32 v242, v242
v_rcp_f32 v243, v243
v_rcp_f32 v244, v244
v_rcp_f32 v245, v245
v_rcp_f32 v246, v246
v_rcp_f32 v247, v247
v_rcp_f32 v248, v248
v_rcp_f32 v249, v249
v_rcp_f32 v250, v250
v_rcp_f32 v251, v251
v_pk_mul_f32 v[96:97], v[96:97], v[240:241]
v_pk_mul_f32 v[98:99], v[98:99], v[242:243]
v_pk_mul_f32 v[100:101], v[100:101], v[244:245]
v_pk_mul_f32 v[102:103], v[102:103], v[246:247]
v_pk_mul_f32 v[104:105], v[104:105], v[248:249]
v_pk_mul_f32 v[106:107], v[106:107], v[250:251]
v_cvt_pk_bf16_f32 v96, v96, v97
v_cvt_pk_bf16_f32 v97, v98, v99
v_cvt_pk_bf16_f32 v98, v100, v101
v_cvt_pk_bf16_f32 v99, v102, v103
v_cvt_pk_bf16_f32 v100, v104, v105
v_cvt_pk_bf16_f32 v101, v106, v107
buffer_store_dwordx4 v[96:99], v46, s[32:35], s80 offen sc1
v_sub_u32 v53, v46, v52
buffer_store_dwordx2 v[100:101], v53, s[32:35], s81 offen sc1
v_accvgpr_read_b32 v224, a48
v_accvgpr_read_b32 v225, a49
v_accvgpr_read_b32 v226, a50
v_accvgpr_read_b32 v227, a51
v_accvgpr_read_b32 v228, a52
v_accvgpr_read_b32 v229, a53
v_accvgpr_read_b32 v230, a54
v_accvgpr_read_b32 v231, a55
v_accvgpr_read_b32 v232, a56
v_accvgpr_read_b32 v233, a57
v_accvgpr_read_b32 v234, a58
v_accvgpr_read_b32 v235, a59
v_pk_mul_f32 v[240:241], v[112:113], s[46:47]
v_pk_mul_f32 v[242:243], v[114:115], s[46:47]
v_pk_mul_f32 v[244:245], v[116:117], s[46:47]
v_pk_mul_f32 v[246:247], v[118:119], s[46:47]
v_pk_mul_f32 v[248:249], v[120:121], s[46:47]
v_pk_mul_f32 v[250:251], v[122:123], s[46:47]
v_exp_f32 v240, v240
v_exp_f32 v241, v241
v_exp_f32 v242, v242
v_exp_f32 v243, v243
v_exp_f32 v244, v244
v_exp_f32 v245, v245
v_exp_f32 v246, v246
v_exp_f32 v247, v247
v_exp_f32 v248, v248
v_exp_f32 v249, v249
v_exp_f32 v250, v250
v_exp_f32 v251, v251
v_pk_mul_f32 v[112:113], v[112:113], v[224:225]
v_pk_mul_f32 v[114:115], v[114:115], v[226:227]
v_pk_mul_f32 v[116:117], v[116:117], v[228:229]
v_pk_mul_f32 v[118:119], v[118:119], v[230:231]
v_pk_mul_f32 v[120:121], v[120:121], v[232:233]
v_pk_mul_f32 v[122:123], v[122:123], v[234:235]
v_pk_add_f32 v[240:241], v[240:241], 1.0 op_sel_hi:[1,0]
v_pk_add_f32 v[242:243], v[242:243], 1.0 op_sel_hi:[1,0]
v_pk_add_f32 v[244:245], v[244:245], 1.0 op_sel_hi:[1,0]
v_pk_add_f32 v[246:247], v[246:247], 1.0 op_sel_hi:[1,0]
v_pk_add_f32 v[248:249], v[248:249], 1.0 op_sel_hi:[1,0]
v_pk_add_f32 v[250:251], v[250:251], 1.0 op_sel_hi:[1,0]
v_rcp_f32 v240, v240
v_rcp_f32 v241, v241
v_rcp_f32 v242, v242
v_rcp_f32 v243, v243
v_rcp_f32 v244, v244
v_rcp_f32 v245, v245
v_rcp_f32 v246, v246
v_rcp_f32 v247, v247
v_rcp_f32 v248, v248
v_rcp_f32 v249, v249
v_rcp_f32 v250, v250
v_rcp_f32 v251, v251
v_pk_mul_f32 v[112:113], v[112:113], v[240:241]
v_pk_mul_f32 v[114:115], v[114:115], v[242:243]
v_pk_mul_f32 v[116:117], v[116:117], v[244:245]
v_pk_mul_f32 v[118:119], v[118:119], v[246:247]
v_pk_mul_f32 v[120:121], v[120:121], v[248:249]
v_pk_mul_f32 v[122:123], v[122:123], v[250:251]
v_cvt_pk_bf16_f32 v112, v112, v113
v_cvt_pk_bf16_f32 v113, v114, v115
v_cvt_pk_bf16_f32 v114, v116, v117
v_cvt_pk_bf16_f32 v115, v118, v119
v_cvt_pk_bf16_f32 v116, v120, v121
v_cvt_pk_bf16_f32 v117, v122, v123
buffer_store_dwordx4 v[112:115], v47, s[32:35], s80 offen sc1
v_sub_u32 v53, v47, v52
buffer_store_dwordx2 v[116:117], v53, s[32:35], s81 offen sc1
L_join:
L_pad5:
s_cbranch_execz L_walked0
v_max3_f32 v52, v192, v193, v194
v_max_f32 v52, v52, v195
v_max3_f32 v53, v196, v197, v198
v_max_f32 v53, v53, v199
v_max3_f32 v54, v200, v201, v202
v_max_f32 v54, v54, v203
v_max3_f32 v55, v204, v205, v206
v_max_f32 v55, v55, v207
s_mov_b32 s47, 0x07060302
v_mov_b32 v224, 0x3f803f80
v_mov_b32 v225, 0x3f803f80
v_mov_b32 v226, 0x3f803f80
v_mov_b32 v227, 0x3f803f80
v_and_b32 v56, 1, v0
v_mul_u32_u24 v56, 0xaaaa, v56
v_add_u32 v228, 0x4444, v56
L_attn:
v_mov_b32 v56, v52
v_mov_b32 v57, v53
v_mov_b32 v58, v54
v_mov_b32 v59, v55
s_nop 0
v_permlane32_swap_b32 v52, v56
v_permlane32_swap_b32 v53, v57
v_permlane32_swap_b32 v54, v58
v_permlane32_swap_b32 v55, v59
v_max_f32 v52, v52, v56
v_max_f32 v53, v53, v57
v_max_f32 v54, v54, v58
v_max_f32 v55, v55, v59
v_mov_b32 v56, v52
v_mov_b32 v57, v53
v_mov_b32 v58, v54
v_mov_b32 v59, v55
s_nop 0
v_permlane16_swap_b32 v52, v56
v_permlane16_swap_b32 v53, v57
v_permlane16_swap_b32 v54, v58
v_permlane16_swap_b32 v55, v59
v_max_f32 v52, v52, v56
v_max_f32 v53, v53, v57
v_max_f32 v54, v54, v58
v_max_f32 v55, v55, v59
v_sub_f32 v208, 0, v52
v_sub_f32 v209, 0, v52
v_sub_f32 v210, 0, v52
v_sub_f32 v211, 0, v52
v_sub_f32 v212, 0, v53
v_sub_f32 v213, 0, v53
v_sub_f32 v214, 0, v53
v_sub_f32 v215, 0, v53
v_sub_f32 v216, 0, v54
v_sub_f32 v217, 0, v54
v_sub_f32 v218, 0, v54
v_sub_f32 v219, 0, v54
v_sub_f32 v220, 0, v55
v_sub_f32 v221, 0, v55
v_sub_f32 v222, 0, v55
v_sub_f32 v223, 0, v55
ds_read_b128 a[160:163], v4 offset:4096
v_mfma_f32_16x16x32_bf16 v[192:195], a[144:147], v[128:131], v[208:211]
v_mfma_f32_16x16x32_bf16 v[192:195], a[148:151], v[132:135], v[192:195]
s_waitcnt lgkmcnt(1)
v_mfma_f32_16x16x32_bf16 v[192:195], a[152:155], v[136:139], v[192:195]
v_mfma_f32_16x16x32_bf16 v[192:195], a[156:159], v[140:143], v[192:195]
ds_read_b128 a[164:167], v5 offset:4096
v_mfma_f32_16x16x32_bf16 v[196:199], a[156:159], v[156:159], v[212:215]
v_mfma_f32_16x16x32_bf16 v[196:199], a[152:155], v[152:155], v[196:199]
v_mfma_f32_16x16x32_bf16 v[196:199], a[148:151], v[148:151], v[196:199]
v_mfma_f32_16x16x32_bf16 v[196:199], a[144:147], v[144:147], v[196:199]
ds_read_b128 a[168:171], v6 offset:4096
s_nop 1
v_mfma_f32_16x16x32_bf16 v[200:203], a[144:147], v[160:163], v[216:219]
v_exp_f32 v192, v192
v_mfma_f32_16x16x32_bf16 v[200:203], a[148:151], v[164:167], v[200:203]
s_waitcnt lgkmcnt(1)
v_exp_f32 v193, v193
v_mfma_f32_16x16x32_bf16 v[200:203], a[152:155], v[168:171], v[200:203]
v_exp_f32 v194, v194
v_cvt_pk_bf16_f32 v64, v192, v193
v_mfma_f32_16x16x32_bf16 v[200:203], a[156:159], v[172:175], v[200:203]
ds_read_b128 a[172:175], v7 offset:4096
v_exp_f32 v195, v195
v_mfma_f32_16x16x32_bf16 v[204:207], a[156:159], v[188:191], v[220:223]
v_cvt_pk_bf16_f32 v65, v194, v195
v_exp_f32 v196, v196
v_mfma_f32_16x16x32_bf16 v[204:207], a[152:155], v[184:187], v[204:207]
v_exp_f32 v197, v197
v_mfma_f32_16x16x32_bf16 v[204:207], a[148:151], v[180:183], v[204:207]
v_exp_f32 v198, v198
v_cvt_pk_bf16_f32 v72, v196, v197
v_mfma_f32_16x16x32_bf16 v[204:207], a[144:147], v[176:179], v[204:207]
ds_read_b128 a[144:147], v4 offset:8192
v_exp_f32 v199, v199
v_mfma_f32_16x16x32_bf16 v[192:195], a[160:163], v[128:131], v[208:211]
v_cvt_pk_bf16_f32 v73, v198, v199
v_exp_f32 v200, v200
v_mfma_f32_16x16x32_bf16 v[192:195], a[164:167], v[132:135], v[192:195]
s_waitcnt lgkmcnt(1)
v_exp_f32 v201, v201
v_mfma_f32_16x16x32_bf16 v[192:195], a[168:171], v[136:139], v[192:195]
v_exp_f32 v202, v202
v_cvt_pk_bf16_f32 v80, v200, v201
v_mfma_f32_16x16x32_bf16 v[192:195], a[172:175], v[140:143], v[192:195]
ds_read_b128 a[148:151], v5 offset:8192
v_exp_f32 v203, v203
v_mfma_f32_16x16x32_bf16 v[196:199], a[172:175], v[156:159], v[212:215]
v_cvt_pk_bf16_f32 v81, v202, v203
v_exp_f32 v204, v204
v_mfma_f32_16x16x32_bf16 v[196:199], a[168:171], v[152:155], v[196:199]
v_exp_f32 v205, v205
v_mfma_f32_16x16x32_bf16 v[196:199], a[164:167], v[148:151], v[196:199]
v_exp_f32 v206, v206
v_cvt_pk_bf16_f32 v88, v204, v205
v_mfma_f32_16x16x32_bf16 v[196:199], a[160:163], v[144:147], v[196:199]
ds_read_b128 a[152:155], v6 offset:8192
v_exp_f32 v207, v207
v_mfma_f32_16x16x32_bf16 v[200:203], a[160:163], v[160:163], v[216:219]
v_cvt_pk_bf16_f32 v89, v206, v207
v_exp_f32 v192, v192
v_mfma_f32_16x16x32_bf16 v[200:203], a[164:167], v[164:167], v[200:203]
s_waitcnt lgkmcnt(1)
v_exp_f32 v193, v193
v_mfma_f32_16x16x32_bf16 v[200:203], a[168:171], v[168:171], v[200:203]
v_exp_f32 v194, v194
v_cvt_pk_bf16_f32 v66, v192, v193
v_mfma_f32_16x16x32_bf16 v[200:203], a[172:175], v[172:175], v[200:203]
ds_read_b128 a[156:159], v7 offset:8192
v_exp_f32 v195, v195
v_mfma_f32_16x16x32_bf16 v[204:207], a[172:175], v[188:191], v[220:223]
v_cvt_pk_bf16_f32 v67, v194, v195
v_exp_f32 v196, v196
v_mfma_f32_16x16x32_bf16 v[204:207], a[168:171], v[184:187], v[204:207]
v_exp_f32 v197, v197
v_mfma_f32_16x16x32_bf16 v[204:207], a[164:167], v[180:183], v[204:207]
v_exp_f32 v198, v198
v_cvt_pk_bf16_f32 v74, v196, v197
v_mfma_f32_16x16x32_bf16 v[204:207], a[160:163], v[176:179], v[204:207]
ds_read_b128 a[160:163], v4 offset:12288
v_exp_f32 v199, v199
v_mfma_f32_16x16x32_bf16 v[192:195], a[144:147], v[128:131], v[208:211]
v_cvt_pk_bf16_f32 v75, v198, v199
v_exp_f32 v200, v200
v_mfma_f32_16x16x32_bf16 v[192:195], a[148:151], v[132:135], v[192:195]
s_waitcnt lgkmcnt(1)
v_exp_f32 v201, v201
v_mfma_f32_16x16x32_bf16 v[192:195], a[152:155], v[136:139], v[192:195]
v_exp_f32 v202, v202
v_cvt_pk_bf16_f32 v82, v200, v201
v_mfma_f32_16x16x32_bf16 v[192:195], a[156:159], v[140:143], v[192:195]
ds_read_b128 a[164:167], v5 offset:12288
v_exp_f32 v203, v203
v_mfma_f32_16x16x32_bf16 v[196:199], a[156:159], v[156:159], v[212:215]
v_cvt_pk_bf16_f32 v83, v202, v203
v_exp_f32 v204, v204
v_mfma_f32_16x16x32_bf16 v[196:199], a[152:155], v[152:155], v[196:199]
v_exp_f32 v205, v205
v_mfma_f32_16x16x32_bf16 v[196:199], a[148:151], v[148:151], v[196:199]
v_exp_f32 v206, v206
v_cvt_pk_bf16_f32 v90, v204, v205
v_mfma_f32_16x16x32_bf16 v[196:199], a[144:147], v[144:147], v[196:199]
ds_read_b128 a[168:171], v6 offset:12288
v_exp_f32 v207, v207
v_mfma_f32_16x16x32_bf16 v[200:203], a[144:147], v[160:163], v[216:219]
v_cvt_pk_bf16_f32 v91, v206, v207
v_exp_f32 v192, v192
v_mfma_f32_16x16x32_bf16 v[200:203], a[148:151], v[164:167], v[200:203]
s_waitcnt lgkmcnt(1)
v_exp_f32 v193, v193
v_mfma_f32_16x16x32_bf16 v[200:203], a[152:155], v[168:171], v[200:203]
v_exp_f32 v194, v194
v_cvt_pk_bf16_f32 v68, v192, v193
v_mfma_f32_16x16x32_bf16 v[200:203], a[156:159], v[172:175], v[200:203]
ds_read_b128 a[172:175], v7 offset:12288
v_exp_f32 v195, v195
v_mfma_f32_16x16x32_bf16 v[204:207], a[156:159], v[188:191], v[220:223]
v_cvt_pk_bf16_f32 v69, v194, v195
v_exp_f32 v196, v196
v_mfma_f32_16x16x32_bf16 v[204:207], a[152:155], v[184:187], v[204:207]
s_waitcnt vmcnt(16)
s_barrier
v_exp_f32 v197, v197
v_mfma_f32_16x16x32_bf16 v[204:207], a[148:151], v[180:183], v[204:207]
v_exp_f32 v198, v198
v_cvt_pk_bf16_f32 v76, v196, v197
v_mfma_f32_16x16x32_bf16 v[204:207], a[144:147], v[176:179], v[204:207]
ds_read_b128 a[144:147], v4 offset:16384
v_exp_f32 v199, v199
v_mfma_f32_16x16x32_bf16 v[192:195], a[160:163], v[128:131], v[208:211]
v_cvt_pk_bf16_f32 v77, v198, v199
v_exp_f32 v200, v200
v_mfma_f32_16x16x32_bf16 v[192:195], a[164:167], v[132:135], v[192:195]
s_waitcnt lgkmcnt(1)
v_exp_f32 v201, v201
v_mfma_f32_16x16x32_bf16 v[192:195], a[168:171], v[136:139], v[192:195]
v_exp_f32 v202, v202
v_cvt_pk_bf16_f32 v84, v200, v201
v_mfma_f32_16x16x32_bf16 v[192:195], a[172:175], v[140:143], v[192:195]
ds_read_b128 a[148:151], v5 offset:16384
v_exp_f32 v203, v203
v_mfma_f32_16x16x32_bf16 v[196:199], a[172:175], v[156:159], v[212:215]
v_cvt_pk_bf16_f32 v85, v202, v203
v_exp_f32 v204, v204
v_mfma_f32_16x16x32_bf16 v[196:199], a[168:171], v[152:155], v[196:199]
v_exp_f32 v205, v205
v_mfma_f32_16x16x32_bf16 v[196:199], a[164:167], v[148:151], v[196:199]
v_exp_f32 v206, v206
v_cvt_pk_bf16_f32 v92, v204, v205
v_mfma_f32_16x16x32_bf16 v[196:199], a[160:163], v[144:147], v[196:199]
ds_read_b128 a[152:155], v6 offset:16384
v_exp_f32 v207, v207
v_mfma_f32_16x16x32_bf16 v[200:203], a[160:163], v[160:163], v[216:219]
v_cvt_pk_bf16_f32 v93, v206, v207
v_exp_f32 v192, v192
v_mfma_f32_16x16x32_bf16 v[200:203], a[164:167], v[164:167], v[200:203]
s_waitcnt lgkmcnt(1)
ds_read_b64_tr_b16 a[176:177], v8 offset:16384
v_exp_f32 v193, v193
v_mfma_f32_16x16x32_bf16 v[200:203], a[168:171], v[168:171], v[200:203]
ds_read_b64_tr_b16 a[178:179], v8 offset:20480
v_exp_f32 v194, v194
v_cvt_pk_bf16_f32 v70, v192, v193
v_mfma_f32_16x16x32_bf16 v[200:203], a[172:175], v[172:175], v[200:203]
ds_read_b128 a[156:159], v7 offset:16384
v_exp_f32 v195, v195
v_mfma_f32_16x16x32_bf16 v[204:207], a[172:175], v[188:191], v[220:223]
v_cvt_pk_bf16_f32 v71, v194, v195
v_exp_f32 v196, v196
v_mfma_f32_16x16x32_bf16 v[204:207], a[168:171], v[184:187], v[204:207]
ds_read_b64_tr_b16 a[180:181], v8 offset:24576
v_exp_f32 v197, v197
v_mfma_f32_16x16x32_bf16 v[204:207], a[164:167], v[180:183], v[204:207]
ds_read_b64_tr_b16 a[182:183], v8 offset:28672
v_exp_f32 v198, v198
v_cvt_pk_bf16_f32 v78, v196, v197
v_mfma_f32_16x16x32_bf16 v[204:207], a[160:163], v[176:179], v[204:207]
ds_read_b128 a[160:163], v4 offset:20480
v_exp_f32 v199, v199
v_exp_f32 v200, v200
v_exp_f32 v201, v201
v_exp_f32 v202, v202
v_exp_f32 v203, v203
v_cvt_pk_bf16_f32 v79, v198, v199
v_cvt_pk_bf16_f32 v86, v200, v201
v_cvt_pk_bf16_f32 v87, v202, v203
v_mfma_f32_16x16x32_bf16 v[192:195], a[144:147], v[128:131], v[208:211]
v_exp_f32 v204, v204
v_mfma_f32_16x16x32_bf16 v[192:195], a[148:151], v[132:135], v[192:195]
s_waitcnt lgkmcnt(1)
ds_read_b64_tr_b16 a[184:185], v9 offset:16384
v_mfma_f32_16x16x32_bf16 v[192:195], a[152:155], v[136:139], v[192:195]
v_exp_f32 v205, v205
v_mfma_f32_16x16x32_bf16 v[192:195], a[156:159], v[140:143], v[192:195]
ds_read_b64_tr_b16 a[186:187], v9 offset:20480
v_cvt_pk_bf16_f32 v94, v204, v205
v_mfma_f32_16x16x32_bf16 v[196:199], a[156:159], v[156:159], v[212:215]
v_exp_f32 v206, v206
v_mfma_f32_16x16x32_bf16 v[196:199], a[152:155], v[152:155], v[196:199]
s_add_u32 s48, s48, 16384
s_add_u32 m0, s40, 49152
v_mfma_f32_16x16x32_bf16 v[196:199], a[148:151], v[148:151], v[196:199]
v_exp_f32 v207, v207
v_mfma_f32_16x16x32_bf16 v[196:199], a[144:147], v[144:147], v[196:199]
s_lshl_b32 s80, s83, 6
ds_read_b128 a[164:167], v5 offset:20480
v_cvt_pk_bf16_f32 v95, v206, v207
v_mfma_f32_16x16x32_bf16 a[0:3], a[176:179], v[64:67], 0
v_exp_f32 v192, v192
v_mfma_f32_16x16x32_bf16 a[0:3], a[180:183], v[68:71], a[0:3]
ds_read_b64_tr_b16 a[188:189], v9 offset:24576
v_xor_b32 v229, s80, v8
v_mfma_f32_16x16x32_bf16 a[4:7], a[180:183], v[76:79], 0
v_exp_f32 v193, v193
v_mfma_f32_16x16x32_bf16 a[4:7], a[176:179], v[72:75], a[4:7]
ds_read_b64_tr_b16 a[190:191], v9 offset:28672
v_cvt_pk_bf16_f32 v96, v192, v193
v_mfma_f32_16x16x32_bf16 a[8:11], a[176:179], v[80:83], 0
v_exp_f32 v194, v194
v_mfma_f32_16x16x32_bf16 a[8:11], a[180:183], v[84:87], a[8:11]
buffer_load_dwordx4 v16, s[8:11], s48 offen lds
v_mfma_f32_16x16x32_bf16 a[12:15], a[180:183], v[92:95], 0
v_exp_f32 v195, v195
v_mfma_f32_16x16x32_bf16 a[12:15], a[176:179], v[88:91], a[12:15]
ds_read_b128 a[168:171], v6 offset:20480
v_cvt_pk_bf16_f32 v97, v194, v195
v_subrev_u32 v24, 65536, v229
v_mfma_f32_16x16x32_bf16 v[200:203], a[144:147], v[160:163], v[216:219]
v_exp_f32 v196, v196
v_mfma_f32_16x16x32_bf16 v[200:203], a[148:151], v[164:167], v[200:203]
s_waitcnt lgkmcnt(1)
ds_read_b64_tr_b16 a[176:177], v10 offset:16384
v_mfma_f32_16x16x32_bf16 v[200:203], a[152:155], v[168:171], v[200:203]
v_exp_f32 v197, v197
v_mfma_f32_16x16x32_bf16 v[200:203], a[156:159], v[172:175], v[200:203]
ds_read_b64_tr_b16 a[178:179], v10 offset:20480
v_cvt_pk_bf16_f32 v104, v196, v197
v_mfma_f32_16x16x32_bf16 v[204:207], a[156:159], v[188:191], v[220:223]
v_exp_f32 v198, v198
v_mfma_f32_16x16x32_bf16 v[204:207], a[152:155], v[184:187], v[204:207]
buffer_load_dwordx4 v17, s[8:11], s48 offen offset:1024 lds
v_mfma_f32_16x16x32_bf16 v[204:207], a[148:151], v[180:183], v[204:207]
v_exp_f32 v199, v199
v_mfma_f32_16x16x32_bf16 v[204:207], a[144:147], v[176:179], v[204:207]
ds_read_b128 a[172:175], v7 offset:20480
v_cvt_pk_bf16_f32 v105, v198, v199
v_add_u32 v44, 65536, v229
v_smfmac_f32_16x16x64_bf16 a[128:131], v[224:227], v[64:71], v228
v_xor_b32 v230, s80, v9
v_subrev_u32 v25, 65536, v230
v_mfma_f32_16x16x32_bf16 a[16:19], a[184:187], v[64:67], 0
v_exp_f32 v200, v200
v_mfma_f32_16x16x32_bf16 a[16:19], a[188:191], v[68:71], a[16:19]
ds_read_b64_tr_b16 a[180:181], v10 offset:24576
s_add_u32 s49, s49, 16384
v_mfma_f32_16x16x32_bf16 a[20:23], a[188:191], v[76:79], 0
v_exp_f32 v201, v201
v_mfma_f32_16x16x32_bf16 a[20:23], a[184:187], v[72:75], a[20:23]
ds_read_b64_tr_b16 a[182:183], v10 offset:28672
v_cvt_pk_bf16_f32 v112, v200, v201
v_mfma_f32_16x16x32_bf16 a[24:27], a[184:187], v[80:83], 0
v_exp_f32 v202, v202
v_mfma_f32_16x16x32_bf16 a[24:27], a[188:191], v[84:87], a[24:27]
buffer_load_dwordx4 v18, s[8:11], s48 offen offset:2048 lds
v_mfma_f32_16x16x32_bf16 a[28:31], a[188:191], v[92:95], 0
v_exp_f32 v203, v203
v_mfma_f32_16x16x32_bf16 a[28:31], a[184:187], v[88:91], a[28:31]
ds_read_b128 a[144:147], v4 offset:24576
v_cvt_pk_bf16_f32 v113, v202, v203
v_add_u32 v45, 65536, v230
v_mfma_f32_16x16x32_bf16 v[192:195], a[160:163], v[128:131], v[208:211]
v_exp_f32 v204, v204
v_mfma_f32_16x16x32_bf16 v[192:195], a[164:167], v[132:135], v[192:195]
s_waitcnt lgkmcnt(1)
ds_read_b64_tr_b16 a[184:185], v11 offset:16384
v_mfma_f32_16x16x32_bf16 v[192:195], a[168:171], v[136:139], v[192:195]
v_exp_f32 v205, v205
v_mfma_f32_16x16x32_bf16 v[192:195], a[172:175], v[140:143], v[192:195]
ds_read_b64_tr_b16 a[186:187], v11 offset:20480
v_cvt_pk_bf16_f32 v120, v204, v205
v_mfma_f32_16x16x32_bf16 v[196:199], a[172:175], v[156:159], v[212:215]
v_exp_f32 v206, v206
v_mfma_f32_16x16x32_bf16 v[196:199], a[168:171], v[152:155], v[196:199]
buffer_load_dwordx4 v19, s[8:11], s48 offen offset:3072 lds
v_mfma_f32_16x16x32_bf16 v[196:199], a[164:167], v[148:151], v[196:199]
v_exp_f32 v207, v207
v_mfma_f32_16x16x32_bf16 v[196:199], a[160:163], v[144:147], v[196:199]
ds_read_b128 a[148:151], v5 offset:24576
v_cvt_pk_bf16_f32 v121, v206, v207
v_xor_b32 v231, s80, v10
v_mfma_f32_16x16x32_bf16 a[32:35], a[176:179], v[64:67], 0
v_exp_f32 v192, v192
v_mfma_f32_16x16x32_bf16 a[32:35], a[180:183], v[68:71], a[32:35]
ds_read_b64_tr_b16 a[188:189], v11 offset:24576
s_add_u32 m0, s42, 49152
v_mfma_f32_16x16x32_bf16 a[36:39], a[180:183], v[76:79], 0
v_exp_f32 v193, v193
v_mfma_f32_16x16x32_bf16 a[36:39], a[176:179], v[72:75], a[36:39]
ds_read_b64_tr_b16 a[190:191], v11 offset:28672
v_cvt_pk_bf16_f32 v98, v192, v193
v_mfma_f32_16x16x32_bf16 a[40:43], a[176:179], v[80:83], 0
v_exp_f32 v194, v194
v_mfma_f32_16x16x32_bf16 a[40:43], a[180:183], v[84:87], a[40:43]
buffer_load_dwordx4 v20, s[12:15], s49 offen lds
v_mfma_f32_16x16x32_bf16 a[44:47], a[180:183], v[92:95], 0
v_exp_f32 v195, v195
v_mfma_f32_16x16x32_bf16 a[44:47], a[176:179], v[88:91], a[44:47]
ds_read_b128 a[152:155], v6 offset:24576
v_cvt_pk_bf16_f32 v99, v194, v195
v_subrev_u32 v26, 65536, v231
v_mfma_f32_16x16x32_bf16 v[200:203], a[160:163], v[160:163], v[216:219]
v_exp_f32 v196, v196
v_mfma_f32_16x16x32_bf16 v[200:203], a[164:167], v[164:167], v[200:203]
s_waitcnt lgkmcnt(1)
ds_read_b64_tr_b16 a[176:177], v12 offset:16384
v_mfma_f32_16x16x32_bf16 v[200:203], a[168:171], v[168:171], v[200:203]
v_exp_f32 v197, v197
v_mfma_f32_16x16x32_bf16 v[200:203], a[172:175], v[172:175], v[200:203]
ds_read_b64_tr_b16 a[178:179], v12 offset:20480
v_cvt_pk_bf16_f32 v106, v196, v197
v_mfma_f32_16x16x32_bf16 v[204:207], a[172:175], v[188:191], v[220:223]
v_exp_f32 v198, v198
v_mfma_f32_16x16x32_bf16 v[204:207], a[168:171], v[184:187], v[204:207]
buffer_load_dwordx4 v21, s[12:15], s49 offen offset:1024 lds
v_mfma_f32_16x16x32_bf16 v[204:207], a[164:167], v[180:183], v[204:207]
v_exp_f32 v199, v199
v_mfma_f32_16x16x32_bf16 v[204:207], a[160:163], v[176:179], v[204:207]
ds_read_b128 a[156:159], v7 offset:24576
v_cvt_pk_bf16_f32 v107, v198, v199
v_add_u32 v46, 65536, v231
v_smfmac_f32_16x16x64_bf16 a[132:135], v[224:227], v[72:79], v228
v_xor_b32 v232, s80, v11
v_subrev_u32 v27, 65536, v232
v_mfma_f32_16x16x32_bf16 a[48:51], a[184:187], v[64:67], 0
v_exp_f32 v200, v200
v_mfma_f32_16x16x32_bf16 a[48:51], a[188:191], v[68:71], a[48:51]
ds_read_b64_tr_b16 a[180:181], v12 offset:24576
v_add_u32 v47, 65536, v232
v_mfma_f32_16x16x32_bf16 a[52:55], a[188:191], v[76:79], 0
v_exp_f32 v201, v201
v_mfma_f32_16x16x32_bf16 a[52:55], a[184:187], v[72:75], a[52:55]
ds_read_b64_tr_b16 a[182:183], v12 offset:28672
v_cvt_pk_bf16_f32 v114, v200, v201
v_mfma_f32_16x16x32_bf16 a[56:59], a[184:187], v[80:83], 0
v_exp_f32 v202, v202
v_mfma_f32_16x16x32_bf16 a[56:59], a[188:191], v[84:87], a[56:59]
buffer_load_dwordx4 v20, s[12:15], s49 offen offset:2048 lds
v_mfma_f32_16x16x32_bf16 a[60:63], a[188:191], v[92:95], 0
v_exp_f32 v203, v203
v_mfma_f32_16x16x32_bf16 a[60:63], a[184:187], v[88:91], a[60:63]
ds_read_b128 a[160:163], v4 offset:28672
v_cvt_pk_bf16_f32 v115, v202, v203
v_xor_b32 v233, s80, v12
v_mfma_f32_16x16x32_bf16 v[192:195], a[144:147], v[128:131], v[208:211]
v_exp_f32 v204, v204
v_mfma_f32_16x16x32_bf16 v[192:195], a[148:151], v[132:135], v[192:195]
s_waitcnt lgkmcnt(1)
ds_read_b64_tr_b16 a[184:185], v13 offset:16384
v_mfma_f32_16x16x32_bf16 v[192:195], a[152:155], v[136:139], v[192:195]
v_exp_f32 v205, v205
v_mfma_f32_16x16x32_bf16 v[192:195], a[156:159], v[140:143], v[192:195]
ds_read_b64_tr_b16 a[186:187], v13 offset:20480
v_cvt_pk_bf16_f32 v122, v204, v205
v_mfma_f32_16x16x32_bf16 v[196:199], a[156:159], v[156:159], v[212:215]
v_exp_f32 v206, v206
v_mfma_f32_16x16x32_bf16 v[196:199], a[152:155], v[152:155], v[196:199]
buffer_load_dwordx4 v21, s[12:15], s49 offen offset:3072 lds
v_mfma_f32_16x16x32_bf16 v[196:199], a[148:151], v[148:151], v[196:199]
v_exp_f32 v207, v207
v_mfma_f32_16x16x32_bf16 v[196:199], a[144:147], v[144:147], v[196:199]
ds_read_b128 a[164:167], v5 offset:28672
v_cvt_pk_bf16_f32 v123, v206, v207
v_subrev_u32 v28, 65536, v233
v_mfma_f32_16x16x32_bf16 a[64:67], a[176:179], v[64:67], 0
v_exp_f32 v192, v192
v_mfma_f32_16x16x32_bf16 a[64:67], a[180:183], v[68:71], a[64:67]
ds_read_b64_tr_b16 a[188:189], v13 offset:24576
v_add_u32 v237, 65536, v233
v_mfma_f32_16x16x32_bf16 a[68:71], a[180:183], v[76:79], 0
v_exp_f32 v193, v193
v_mfma_f32_16x16x32_bf16 a[68:71], a[176:179], v[72:75], a[68:71]
ds_read_b64_tr_b16 a[190:191], v13 offset:28672
v_cvt_pk_bf16_f32 v100, v192, v193
v_mfma_f32_16x16x32_bf16 a[72:75], a[176:179], v[80:83], 0
v_exp_f32 v194, v194
v_mfma_f32_16x16x32_bf16 a[72:75], a[180:183], v[84:87], a[72:75]
v_xor_b32 v234, s80, v13
v_subrev_u32 v29, 65536, v234
v_mfma_f32_16x16x32_bf16 a[76:79], a[180:183], v[92:95], 0
v_exp_f32 v195, v195
v_mfma_f32_16x16x32_bf16 a[76:79], a[176:179], v[88:91], a[76:79]
ds_read_b128 a[168:171], v6 offset:28672
v_cvt_pk_bf16_f32 v101, v194, v195
v_mfma_f32_16x16x32_bf16 v[200:203], a[144:147], v[160:163], v[216:219]
v_exp_f32 v196, v196
v_mfma_f32_16x16x32_bf16 v[200:203], a[148:151], v[164:167], v[200:203]
s_waitcnt lgkmcnt(1)
ds_read_b64_tr_b16 a[176:177], v14 offset:16384
v_mfma_f32_16x16x32_bf16 v[200:203], a[152:155], v[168:171], v[200:203]
v_exp_f32 v197, v197
v_mfma_f32_16x16x32_bf16 v[200:203], a[156:159], v[172:175], v[200:203]
ds_read_b64_tr_b16 a[178:179], v14 offset:20480
v_cvt_pk_bf16_f32 v108, v196, v197
v_mfma_f32_16x16x32_bf16 v[204:207], a[156:159], v[188:191], v[220:223]
v_exp_f32 v198, v198
v_mfma_f32_16x16x32_bf16 v[204:207], a[152:155], v[184:187], v[204:207]
L_pad6:
s_cbranch_execz L_pad7
s_lshl_b32 s81, s77, 7
s_add_u32 s81, s81, 8192
v_mfma_f32_16x16x32_bf16 v[204:207], a[148:151], v[180:183], v[204:207]
v_exp_f32 v199, v199
v_mfma_f32_16x16x32_bf16 v[204:207], a[144:147], v[176:179], v[204:207]
ds_read_b128 a[172:175], v7 offset:28672
v_cvt_pk_bf16_f32 v109, v198, v199
v_smfmac_f32_16x16x64_bf16 a[136:139], v[224:227], v[80:87], v228
v_lshl_add_u32 v52, v1, 25, v40
v_mov_b32 v60, s87
v_mfma_f32_16x16x32_bf16 a[80:83], a[184:187], v[64:67], 0
v_exp_f32 v200, v200
v_mfma_f32_16x16x32_bf16 a[80:83], a[188:191], v[68:71], a[80:83]
ds_read_b64_tr_b16 a[180:181], v14 offset:24576
v_add_u32 v238, 65536, v234
v_mfma_f32_16x16x32_bf16 a[84:87], a[188:191], v[76:79], 0
v_exp_f32 v201, v201
v_mfma_f32_16x16x32_bf16 a[84:87], a[184:187], v[72:75], a[84:87]
ds_read_b64_tr_b16 a[182:183], v14 offset:28672
v_cvt_pk_bf16_f32 v116, v200, v201
v_mfma_f32_16x16x32_bf16 a[88:91], a[184:187], v[80:83], 0
v_exp_f32 v202, v202
v_mfma_f32_16x16x32_bf16 a[88:91], a[188:191], v[84:87], a[88:91]
s_waitcnt vmcnt(8)
s_barrier
v_mfma_f32_16x16x32_bf16 a[92:95], a[188:191], v[92:95], 0
v_exp_f32 v203, v203
v_mfma_f32_16x16x32_bf16 a[92:95], a[184:187], v[88:91], a[92:95]
ds_read_b128 a[144:147], v4 offset:32768
v_cvt_pk_bf16_f32 v117, v202, v203
v_mfma_f32_16x16x32_bf16 v[192:195], a[160:163], v[128:131], v[208:211]
v_exp_f32 v204, v204
v_mfma_f32_16x16x32_bf16 v[192:195], a[164:167], v[132:135], v[192:195]
s_waitcnt lgkmcnt(1)
ds_read_b64_tr_b16 a[184:185], v15 offset:16384
v_mfma_f32_16x16x32_bf16 v[192:195], a[168:171], v[136:139], v[192:195]
v_exp_f32 v205, v205
v_mfma_f32_16x16x32_bf16 v[192:195], a[172:175], v[140:143], v[192:195]
ds_read_b64_tr_b16 a[186:187], v15 offset:20480
v_cvt_pk_bf16_f32 v124, v204, v205
v_mfma_f32_16x16x32_bf16 v[196:199], a[172:175], v[156:159], v[212:215]
v_exp_f32 v206, v206
v_mfma_f32_16x16x32_bf16 v[196:199], a[168:171], v[152:155], v[196:199]
buffer_store_dword v60, v52, s[88:91], s81 offen sc1
v_mfma_f32_16x16x32_bf16 v[196:199], a[164:167], v[148:151], v[196:199]
v_exp_f32 v207, v207
v_mfma_f32_16x16x32_bf16 v[196:199], a[160:163], v[144:147], v[196:199]
ds_read_b128 a[148:151], v5 offset:32768
v_cvt_pk_bf16_f32 v125, v206, v207
v_mfma_f32_16x16x32_bf16 a[96:99], a[176:179], v[64:67], 0
v_exp_f32 v192, v192
v_mfma_f32_16x16x32_bf16 a[96:99], a[180:183], v[68:71], a[96:99]
ds_read_b64_tr_b16 a[188:189], v15 offset:24576
v_xor_b32 v235, s80, v14
v_mfma_f32_16x16x32_bf16 a[100:103], a[180:183], v[76:79], 0
v_exp_f32 v193, v193
v_mfma_f32_16x16x32_bf16 a[100:103], a[176:179], v[72:75], a[100:103]
ds_read_b64_tr_b16 a[190:191], v15 offset:28672
v_cvt_pk_bf16_f32 v102, v192, v193
v_mfma_f32_16x16x32_bf16 a[104:107], a[176:179], v[80:83], 0
v_exp_f32 v194, v194
v_mfma_f32_16x16x32_bf16 a[104:107], a[180:183], v[84:87], a[104:107]
s_and_b32 s81, s81, 0xfffffc00
v_and_b32 v53, 1023, v41
v_mfma_f32_16x16x32_bf16 a[108:111], a[180:183], v[92:95], 0
v_exp_f32 v195, v195
v_mfma_f32_16x16x32_bf16 a[108:111], a[176:179], v[88:91], a[108:111]
ds_read_b128 a[152:155], v6 offset:32768
v_cvt_pk_bf16_f32 v103, v194, v195
v_mfma_f32_16x16x32_bf16 v[200:203], a[160:163], v[160:163], v[216:219]
v_exp_f32 v196, v196
v_mfma_f32_16x16x32_bf16 v[200:203], a[164:167], v[164:167], v[200:203]
s_waitcnt lgkmcnt(1)
ds_read_b64_tr_b16 a[176:177], v8 offset:32768
v_mfma_f32_16x16x32_bf16 v[200:203], a[168:171], v[168:171], v[200:203]
v_exp_f32 v197, v197
v_mfma_f32_16x16x32_bf16 v[200:203], a[172:175], v[172:175], v[200:203]
ds_read_b64_tr_b16 a[178:179], v8 offset:36864
v_cvt_pk_bf16_f32 v110, v196, v197
v_mfma_f32_16x16x32_bf16 v[204:207], a[172:175], v[188:191], v[220:223]
v_exp_f32 v198, v198
v_mfma_f32_16x16x32_bf16 v[204:207], a[168:171], v[184:187], v[204:207]
s_mov_b32 s82, s87
v_subrev_u32 v54, 7340032, v61
v_mfma_f32_16x16x32_bf16 v[204:207], a[164:167], v[180:183], v[204:207]
v_exp_f32 v199, v199
v_mfma_f32_16x16x32_bf16 v[204:207], a[160:163], v[176:179], v[204:207]
ds_read_b128 a[156:159], v7 offset:32768
v_cvt_pk_bf16_f32 v111, v198, v199
v_smfmac_f32_16x16x64_bf16 a[140:143], v[224:227], v[88:95], v228
v_subrev_u32 v30, 65536, v235
v_add_u32 v239, 65536, v235
v_mfma_f32_16x16x32_bf16 a[112:115], a[184:187], v[64:67], 0
v_exp_f32 v200, v200
v_mfma_f32_16x16x32_bf16 a[112:115], a[188:191], v[68:71], a[112:115]
ds_read_b64_tr_b16 a[180:181], v8 offset:40960
v_xor_b32 v236, s80, v15
v_mfma_f32_16x16x32_bf16 a[116:119], a[188:191], v[76:79], 0
v_exp_f32 v201, v201
v_mfma_f32_16x16x32_bf16 a[116:119], a[184:187], v[72:75], a[116:119]
ds_read_b64_tr_b16 a[182:183], v8 offset:45056
v_cvt_pk_bf16_f32 v118, v200, v201
v_mfma_f32_16x16x32_bf16 a[120:123], a[184:187], v[80:83], 0
v_exp_f32 v202, v202
v_mfma_f32_16x16x32_bf16 a[120:123], a[188:191], v[84:87], a[120:123]
v_subrev_u32 v31, 65536, v236
v_add_u32 v42, 65536, v236
v_mfma_f32_16x16x32_bf16 a[124:127], a[188:191], v[92:95], 0
v_exp_f32 v203, v203
v_mfma_f32_16x16x32_bf16 a[124:127], a[184:187], v[88:91], a[124:127]
ds_read_b128 a[160:163], v4 offset:36864
v_cvt_pk_bf16_f32 v119, v202, v203
s_movk_i32 s86, 7
L_attn_loop:
v_mfma_f32_16x16x32_bf16 v[192:195], a[144:147], v[128:131], v[208:211]
v_exp_f32 v204, v204
v_mfma_f32_16x16x32_bf16 v[192:195], a[148:151], v[132:135], v[192:195]
s_waitcnt lgkmcnt(1)
ds_read_b64_tr_b16 a[184:185], v9 offset:32768
v_mfma_f32_16x16x32_bf16 v[192:195], a[152:155], v[136:139], v[192:195]
v_exp_f32 v205, v205
v_mfma_f32_16x16x32_bf16 v[192:195], a[156:159], v[140:143], v[192:195]
ds_read_b64_tr_b16 a[186:187], v9 offset:36864
v_cvt_pk_bf16_f32 v126, v204, v205
v_mfma_f32_16x16x32_bf16 v[196:199], a[156:159], v[156:159], v[212:215]
v_exp_f32 v206, v206
v_mfma_f32_16x16x32_bf16 v[196:199], a[152:155], v[152:155], v[196:199]
s_add_u32 s48, s48, 16384
s_add_u32 m0, s40, 0
v_mfma_f32_16x16x32_bf16 v[196:199], a[148:151], v[148:151], v[196:199]
v_exp_f32 v207, v207
v_mfma_f32_16x16x32_bf16 v[196:199], a[144:147], v[144:147], v[196:199]
ds_read_b128 a[164:167], v5 offset:36864
v_cvt_pk_bf16_f32 v127, v206, v207
v_mfma_f32_16x16x32_bf16 a[0:3], a[176:179], v[96:99], a[0:3]
v_exp_f32 v192, v192
v_mfma_f32_16x16x32_bf16 a[0:3], a[180:183], v[100:103], a[0:3]
ds_read_b64_tr_b16 a[188:189], v9 offset:40960
v_mfma_f32_16x16x32_bf16 a[4:7], a[180:183], v[108:111], a[4:7]
v_exp_f32 v193, v193
v_mfma_f32_16x16x32_bf16 a[4:7], a[176:179], v[104:107], a[4:7]
ds_read_b64_tr_b16 a[190:191], v9 offset:45056
v_cvt_pk_bf16_f32 v64, v192, v193
v_mfma_f32_16x16x32_bf16 a[8:11], a[176:179], v[112:115], a[8:11]
v_exp_f32 v194, v194
v_mfma_f32_16x16x32_bf16 a[8:11], a[180:183], v[116:119], a[8:11]
buffer_load_dwordx4 v16, s[8:11], s48 offen lds
v_mfma_f32_16x16x32_bf16 a[12:15], a[180:183], v[124:127], a[12:15]
v_exp_f32 v195, v195
v_mfma_f32_16x16x32_bf16 a[12:15], a[176:179], v[120:123], a[12:15]
ds_read_b128 a[168:171], v6 offset:36864
v_cvt_pk_bf16_f32 v65, v194, v195
v_mfma_f32_16x16x32_bf16 v[200:203], a[144:147], v[160:163], v[216:219]
v_exp_f32 v196, v196
v_mfma_f32_16x16x32_bf16 v[200:203], a[148:151], v[164:167], v[200:203]
s_waitcnt lgkmcnt(1)
ds_read_b64_tr_b16 a[176:177], v10 offset:32768
v_mfma_f32_16x16x32_bf16 v[200:203], a[152:155], v[168:171], v[200:203]
v_exp_f32 v197, v197
v_mfma_f32_16x16x32_bf16 v[200:203], a[156:159], v[172:175], v[200:203]
ds_read_b64_tr_b16 a[178:179], v10 offset:36864
v_cvt_pk_bf16_f32 v72, v196, v197
v_mfma_f32_16x16x32_bf16 v[204:207], a[156:159], v[188:191], v[220:223]
v_exp_f32 v198, v198
v_mfma_f32_16x16x32_bf16 v[204:207], a[152:155], v[184:187], v[204:207]
buffer_load_dwordx4 v17, s[8:11], s48 offen offset:1024 lds
v_mfma_f32_16x16x32_bf16 v[204:207], a[148:151], v[180:183], v[204:207]
v_exp_f32 v199, v199
v_mfma_f32_16x16x32_bf16 v[204:207], a[144:147], v[176:179], v[204:207]
ds_read_b128 a[172:175], v7 offset:36864
v_cvt_pk_bf16_f32 v73, v198, v199
v_smfmac_f32_16x16x64_bf16 a[128:131], v[224:227], v[96:103], v228
v_mfma_f32_16x16x32_bf16 a[16:19], a[184:187], v[96:99], a[16:19]
v_exp_f32 v200, v200
v_mfma_f32_16x16x32_bf16 a[16:19], a[188:191], v[100:103], a[16:19]
ds_read_b64_tr_b16 a[180:181], v10 offset:40960
s_add_u32 s49, s49, 16384
v_mfma_f32_16x16x32_bf16 a[20:23], a[188:191], v[108:111], a[20:23]
v_exp_f32 v201, v201
v_mfma_f32_16x16x32_bf16 a[20:23], a[184:187], v[104:107], a[20:23]
ds_read_b64_tr_b16 a[182:183], v10 offset:45056
v_cvt_pk_bf16_f32 v80, v200, v201
v_mfma_f32_16x16x32_bf16 a[24:27], a[184:187], v[112:115], a[24:27]
v_exp_f32 v202, v202
v_mfma_f32_16x16x32_bf16 a[24:27], a[188:191], v[116:119], a[24:27]
buffer_load_dwordx4 v18, s[8:11], s48 offen offset:2048 lds
v_mfma_f32_16x16x32_bf16 a[28:31], a[188:191], v[124:127], a[28:31]
v_exp_f32 v203, v203
v_mfma_f32_16x16x32_bf16 a[28:31], a[184:187], v[120:123], a[28:31]
ds_read_b128 a[144:147], v4 offset:40960
v_cvt_pk_bf16_f32 v81, v202, v203
v_mfma_f32_16x16x32_bf16 v[192:195], a[160:163], v[128:131], v[208:211]
v_exp_f32 v204, v204
v_mfma_f32_16x16x32_bf16 v[192:195], a[164:167], v[132:135], v[192:195]
s_waitcnt lgkmcnt(1)
ds_read_b64_tr_b16 a[184:185], v11 offset:32768
v_mfma_f32_16x16x32_bf16 v[192:195], a[168:171], v[136:139], v[192:195]
v_exp_f32 v205, v205
v_mfma_f32_16x16x32_bf16 v[192:195], a[172:175], v[140:143], v[192:195]
ds_read_b64_tr_b16 a[186:187], v11 offset:36864
v_cvt_pk_bf16_f32 v88, v204, v205
v_mfma_f32_16x16x32_bf16 v[196:199], a[172:175], v[156:159], v[212:215]
v_exp_f32 v206, v206
v_mfma_f32_16x16x32_bf16 v[196:199], a[168:171], v[152:155], v[196:199]
buffer_load_dwordx4 v19, s[8:11], s48 offen offset:3072 lds
v_mfma_f32_16x16x32_bf16 v[196:199], a[164:167], v[148:151], v[196:199]
v_exp_f32 v207, v207
v_mfma_f32_16x16x32_bf16 v[196:199], a[160:163], v[144:147], v[196:199]
ds_read_b128 a[148:151], v5 offset:40960
v_cvt_pk_bf16_f32 v89, v206, v207
v_mfma_f32_16x16x32_bf16 a[32:35], a[176:179], v[96:99], a[32:35]
v_exp_f32 v192, v192
v_mfma_f32_16x16x32_bf16 a[32:35], a[180:183], v[100:103], a[32:35]
ds_read_b64_tr_b16 a[188:189], v11 offset:40960
s_add_u32 m0, s42, 0
v_mfma_f32_16x16x32_bf16 a[36:39], a[180:183], v[108:111], a[36:39]
v_exp_f32 v193, v193
v_mfma_f32_16x16x32_bf16 a[36:39], a[176:179], v[104:107], a[36:39]
ds_read_b64_tr_b16 a[190:191], v11 offset:45056
v_cvt_pk_bf16_f32 v66, v192, v193
v_mfma_f32_16x16x32_bf16 a[40:43], a[176:179], v[112:115], a[40:43]
v_exp_f32 v194, v194
v_mfma_f32_16x16x32_bf16 a[40:43], a[180:183], v[116:119], a[40:43]
buffer_load_dwordx4 v20, s[12:15], s49 offen lds
v_mfma_f32_16x16x32_bf16 a[44:47], a[180:183], v[124:127], a[44:47]
v_exp_f32 v195, v195
v_mfma_f32_16x16x32_bf16 a[44:47], a[176:179], v[120:123], a[44:47]
ds_read_b128 a[152:155], v6 offset:40960
v_cvt_pk_bf16_f32 v67, v194, v195
v_mfma_f32_16x16x32_bf16 v[200:203], a[160:163], v[160:163], v[216:219]
v_exp_f32 v196, v196
v_mfma_f32_16x16x32_bf16 v[200:203], a[164:167], v[164:167], v[200:203]
s_waitcnt lgkmcnt(1)
ds_read_b64_tr_b16 a[176:177], v12 offset:32768
v_mfma_f32_16x16x32_bf16 v[200:203], a[168:171], v[168:171], v[200:203]
v_exp_f32 v197, v197
v_mfma_f32_16x16x32_bf16 v[200:203], a[172:175], v[172:175], v[200:203]
ds_read_b64_tr_b16 a[178:179], v12 offset:36864
v_cvt_pk_bf16_f32 v74, v196, v197
v_mfma_f32_16x16x32_bf16 v[204:207], a[172:175], v[188:191], v[220:223]
v_exp_f32 v198, v198
v_mfma_f32_16x16x32_bf16 v[204:207], a[168:171], v[184:187], v[204:207]
buffer_load_dwordx4 v21, s[12:15], s49 offen offset:1024 lds
v_mfma_f32_16x16x32_bf16 v[204:207], a[164:167], v[180:183], v[204:207]
v_exp_f32 v199, v199
v_mfma_f32_16x16x32_bf16 v[204:207], a[160:163], v[176:179], v[204:207]
ds_read_b128 a[156:159], v7 offset:40960
v_cvt_pk_bf16_f32 v75, v198, v199
v_smfmac_f32_16x16x64_bf16 a[132:135], v[224:227], v[104:111], v228
v_mfma_f32_16x16x32_bf16 a[48:51], a[184:187], v[96:99], a[48:51]
v_exp_f32 v200, v200
v_mfma_f32_16x16x32_bf16 a[48:51], a[188:191], v[100:103], a[48:51]
ds_read_b64_tr_b16 a[180:181], v12 offset:40960
v_mfma_f32_16x16x32_bf16 a[52:55], a[188:191], v[108:111], a[52:55]
v_exp_f32 v201, v201
v_mfma_f32_16x16x32_bf16 a[52:55], a[184:187], v[104:107], a[52:55]
ds_read_b64_tr_b16 a[182:183], v12 offset:45056
v_cvt_pk_bf16_f32 v82, v200, v201
v_mfma_f32_16x16x32_bf16 a[56:59], a[184:187], v[112:115], a[56:59]
v_exp_f32 v202, v202
v_mfma_f32_16x16x32_bf16 a[56:59], a[188:191], v[116:119], a[56:59]
buffer_load_dwordx4 v20, s[12:15], s49 offen offset:2048 lds
v_mfma_f32_16x16x32_bf16 a[60:63], a[188:191], v[124:127], a[60:63]
v_exp_f32 v203, v203
v_mfma_f32_16x16x32_bf16 a[60:63], a[184:187], v[120:123], a[60:63]
ds_read_b128 a[160:163], v4 offset:45056
v_cvt_pk_bf16_f32 v83, v202, v203
v_mfma_f32_16x16x32_bf16 v[192:195], a[144:147], v[128:131], v[208:211]
v_exp_f32 v204, v204
v_mfma_f32_16x16x32_bf16 v[192:195], a[148:151], v[132:135], v[192:195]
s_waitcnt lgkmcnt(1)
ds_read_b64_tr_b16 a[184:185], v13 offset:32768
v_mfma_f32_16x16x32_bf16 v[192:195], a[152:155], v[136:139], v[192:195]
v_exp_f32 v205, v205
v_mfma_f32_16x16x32_bf16 v[192:195], a[156:159], v[140:143], v[192:195]
ds_read_b64_tr_b16 a[186:187], v13 offset:36864
v_cvt_pk_bf16_f32 v90, v204, v205
v_mfma_f32_16x16x32_bf16 v[196:199], a[156:159], v[156:159], v[212:215]
v_exp_f32 v206, v206
v_mfma_f32_16x16x32_bf16 v[196:199], a[152:155], v[152:155], v[196:199]
buffer_load_dwordx4 v21, s[12:15], s49 offen offset:3072 lds
v_mfma_f32_16x16x32_bf16 v[196:199], a[148:151], v[148:151], v[196:199]
v_exp_f32 v207, v207
v_mfma_f32_16x16x32_bf16 v[196:199], a[144:147], v[144:147], v[196:199]
ds_read_b128 a[164:167], v5 offset:45056
v_cvt_pk_bf16_f32 v91, v206, v207
v_mfma_f32_16x16x32_bf16 a[64:67], a[176:179], v[96:99], a[64:67]
v_exp_f32 v192, v192
v_mfma_f32_16x16x32_bf16 a[64:67], a[180:183], v[100:103], a[64:67]
ds_read_b64_tr_b16 a[188:189], v13 offset:40960
v_add_u32 v54, 1048576, v54
v_mfma_f32_16x16x32_bf16 a[68:71], a[180:183], v[108:111], a[68:71]
v_exp_f32 v193, v193
v_mfma_f32_16x16x32_bf16 a[68:71], a[176:179], v[104:107], a[68:71]
ds_read_b64_tr_b16 a[190:191], v13 offset:45056
v_cvt_pk_bf16_f32 v68, v192, v193
v_mfma_f32_16x16x32_bf16 a[72:75], a[176:179], v[112:115], a[72:75]
v_exp_f32 v194, v194
v_mfma_f32_16x16x32_bf16 a[72:75], a[180:183], v[116:119], a[72:75]
buffer_load_dword v57, v54, s[4:7], s3 offen
v_mfma_f32_16x16x32_bf16 a[76:79], a[180:183], v[124:127], a[76:79]
v_exp_f32 v195, v195
v_mfma_f32_16x16x32_bf16 a[76:79], a[176:179], v[120:123], a[76:79]
ds_read_b128 a[168:171], v6 offset:45056
v_cvt_pk_bf16_f32 v69, v194, v195
v_mfma_f32_16x16x32_bf16 v[200:203], a[144:147], v[160:163], v[216:219]
v_exp_f32 v196, v196
v_mfma_f32_16x16x32_bf16 v[200:203], a[148:151], v[164:167], v[200:203]
s_waitcnt lgkmcnt(1)
ds_read_b64_tr_b16 a[176:177], v14 offset:32768
v_mfma_f32_16x16x32_bf16 v[200:203], a[152:155], v[168:171], v[200:203]
v_exp_f32 v197, v197
v_mfma_f32_16x16x32_bf16 v[200:203], a[156:159], v[172:175], v[200:203]
ds_read_b64_tr_b16 a[178:179], v14 offset:36864
v_cvt_pk_bf16_f32 v76, v196, v197
v_mfma_f32_16x16x32_bf16 v[204:207], a[156:159], v[188:191], v[220:223]
v_exp_f32 v198, v198
v_mfma_f32_16x16x32_bf16 v[204:207], a[152:155], v[184:187], v[204:207]
v_mfma_f32_16x16x32_bf16 v[204:207], a[148:151], v[180:183], v[204:207]
v_exp_f32 v199, v199
v_mfma_f32_16x16x32_bf16 v[204:207], a[144:147], v[176:179], v[204:207]
ds_read_b128 a[172:175], v7 offset:45056
v_cvt_pk_bf16_f32 v77, v198, v199
v_smfmac_f32_16x16x64_bf16 a[136:139], v[224:227], v[112:119], v228
v_mfma_f32_16x16x32_bf16 a[80:83], a[184:187], v[96:99], a[80:83]
v_exp_f32 v200, v200
v_mfma_f32_16x16x32_bf16 a[80:83], a[188:191], v[100:103], a[80:83]
ds_read_b64_tr_b16 a[180:181], v14 offset:40960
v_mfma_f32_16x16x32_bf16 a[84:87], a[188:191], v[108:111], a[84:87]
v_exp_f32 v201, v201
v_mfma_f32_16x16x32_bf16 a[84:87], a[184:187], v[104:107], a[84:87]
ds_read_b64_tr_b16 a[182:183], v14 offset:45056
v_cvt_pk_bf16_f32 v84, v200, v201
v_mfma_f32_16x16x32_bf16 a[88:91], a[184:187], v[112:115], a[88:91]
v_exp_f32 v202, v202
v_mfma_f32_16x16x32_bf16 a[88:91], a[188:191], v[116:119], a[88:91]
s_waitcnt vmcnt(9)
s_barrier
v_mfma_f32_16x16x32_bf16 a[92:95], a[188:191], v[124:127], a[92:95]
v_exp_f32 v203, v203
v_mfma_f32_16x16x32_bf16 a[92:95], a[184:187], v[120:123], a[92:95]
ds_read_b128 a[144:147], v4 offset:49152
v_cvt_pk_bf16_f32 v85, v202, v203
v_mfma_f32_16x16x32_bf16 v[192:195], a[160:163], v[128:131], v[208:211]
v_exp_f32 v204, v204
v_mfma_f32_16x16x32_bf16 v[192:195], a[164:167], v[132:135], v[192:195]
s_waitcnt lgkmcnt(1)
ds_read_b64_tr_b16 a[184:185], v15 offset:32768
v_mfma_f32_16x16x32_bf16 v[192:195], a[168:171], v[136:139], v[192:195]
v_exp_f32 v205, v205
v_mfma_f32_16x16x32_bf16 v[192:195], a[172:175], v[140:143], v[192:195]
ds_read_b64_tr_b16 a[186:187], v15 offset:36864
v_cvt_pk_bf16_f32 v92, v204, v205
v_mfma_f32_16x16x32_bf16 v[196:199], a[172:175], v[156:159], v[212:215]
v_exp_f32 v206, v206
v_mfma_f32_16x16x32_bf16 v[196:199], a[168:171], v[152:155], v[196:199]
v_mfma_f32_16x16x32_bf16 v[196:199], a[164:167], v[148:151], v[196:199]
v_exp_f32 v207, v207
v_mfma_f32_16x16x32_bf16 v[196:199], a[160:163], v[144:147], v[196:199]
ds_read_b128 a[148:151], v5 offset:49152
v_cvt_pk_bf16_f32 v93, v206, v207
v_mfma_f32_16x16x32_bf16 a[96:99], a[176:179], v[96:99], a[96:99]
v_exp_f32 v192, v192
v_mfma_f32_16x16x32_bf16 a[96:99], a[180:183], v[100:103], a[96:99]
ds_read_b64_tr_b16 a[188:189], v15 offset:40960
v_mfma_f32_16x16x32_bf16 a[100:103], a[180:183], v[108:111], a[100:103]
v_exp_f32 v193, v193
v_mfma_f32_16x16x32_bf16 a[100:103], a[176:179], v[104:107], a[100:103]
ds_read_b64_tr_b16 a[190:191], v15 offset:45056
v_cvt_pk_bf16_f32 v70, v192, v193
v_mfma_f32_16x16x32_bf16 a[104:107], a[176:179], v[112:115], a[104:107]
v_exp_f32 v194, v194
v_mfma_f32_16x16x32_bf16 a[104:107], a[180:183], v[116:119], a[104:107]
v_mfma_f32_16x16x32_bf16 a[108:111], a[180:183], v[124:127], a[108:111]
v_exp_f32 v195, v195
v_mfma_f32_16x16x32_bf16 a[108:111], a[176:179], v[120:123], a[108:111]
ds_read_b128 a[152:155], v6 offset:49152
v_cvt_pk_bf16_f32 v71, v194, v195
v_mfma_f32_16x16x32_bf16 v[200:203], a[160:163], v[160:163], v[216:219]
v_exp_f32 v196, v196
v_mfma_f32_16x16x32_bf16 v[200:203], a[164:167], v[164:167], v[200:203]
s_waitcnt lgkmcnt(1)
ds_read_b64_tr_b16 a[176:177], v8 offset:49152
v_mfma_f32_16x16x32_bf16 v[200:203], a[168:171], v[168:171], v[200:203]
v_exp_f32 v197, v197
v_mfma_f32_16x16x32_bf16 v[200:203], a[172:175], v[172:175], v[200:203]
ds_read_b64_tr_b16 a[178:179], v8 offset:53248
v_cvt_pk_bf16_f32 v78, v196, v197
v_mfma_f32_16x16x32_bf16 v[204:207], a[172:175], v[188:191], v[220:223]
v_exp_f32 v198, v198
v_mfma_f32_16x16x32_bf16 v[204:207], a[168:171], v[184:187], v[204:207]
v_mfma_f32_16x16x32_bf16 v[204:207], a[164:167], v[180:183], v[204:207]
v_exp_f32 v199, v199
v_mfma_f32_16x16x32_bf16 v[204:207], a[160:163], v[176:179], v[204:207]
ds_read_b128 a[156:159], v7 offset:49152
v_cvt_pk_bf16_f32 v79, v198, v199
v_smfmac_f32_16x16x64_bf16 a[140:143], v[224:227], v[120:127], v228
v_mfma_f32_16x16x32_bf16 a[112:115], a[184:187], v[96:99], a[112:115]
v_exp_f32 v200, v200
v_mfma_f32_16x16x32_bf16 a[112:115], a[188:191], v[100:103], a[112:115]
ds_read_b64_tr_b16 a[180:181], v8 offset:57344
v_mfma_f32_16x16x32_bf16 a[116:119], a[188:191], v[108:111], a[116:119]
v_exp_f32 v201, v201
v_mfma_f32_16x16x32_bf16 a[116:119], a[184:187], v[104:107], a[116:119]
ds_read_b64_tr_b16 a[182:183], v8 offset:61440
v_cvt_pk_bf16_f32 v86, v200, v201
v_mfma_f32_16x16x32_bf16 a[120:123], a[184:187], v[112:115], a[120:123]
v_exp_f32 v202, v202
v_mfma_f32_16x16x32_bf16 a[120:123], a[188:191], v[116:119], a[120:123]
v_mfma_f32_16x16x32_bf16 a[124:127], a[188:191], v[124:127], a[124:127]
v_exp_f32 v203, v203
v_mfma_f32_16x16x32_bf16 a[124:127], a[184:187], v[120:123], a[124:127]
ds_read_b128 a[160:163], v4 offset:53248
v_cvt_pk_bf16_f32 v87, v202, v203
v_mfma_f32_16x16x32_bf16 v[192:195], a[144:147], v[128:131], v[208:211]
v_exp_f32 v204, v204
v_mfma_f32_16x16x32_bf16 v[192:195], a[148:151], v[132:135], v[192:195]
s_waitcnt lgkmcnt(1)
ds_read_b64_tr_b16 a[184:185], v9 offset:49152
v_mfma_f32_16x16x32_bf16 v[192:195], a[152:155], v[136:139], v[192:195]
v_exp_f32 v205, v205
v_mfma_f32_16x16x32_bf16 v[192:195], a[156:159], v[140:143], v[192:195]
ds_read_b64_tr_b16 a[186:187], v9 offset:53248
v_cvt_pk_bf16_f32 v94, v204, v205
v_mfma_f32_16x16x32_bf16 v[196:199], a[156:159], v[156:159], v[212:215]
v_exp_f32 v206, v206
v_mfma_f32_16x16x32_bf16 v[196:199], a[152:155], v[152:155], v[196:199]
s_add_u32 s48, s48, 16384
s_add_u32 m0, s40, 16384
v_mfma_f32_16x16x32_bf16 v[196:199], a[148:151], v[148:151], v[196:199]
v_exp_f32 v207, v207
v_mfma_f32_16x16x32_bf16 v[196:199], a[144:147], v[144:147], v[196:199]
ds_read_b128 a[164:167], v5 offset:53248
v_cvt_pk_bf16_f32 v95, v206, v207
v_mfma_f32_16x16x32_bf16 a[0:3], a[176:179], v[64:67], a[0:3]
v_exp_f32 v192, v192
v_mfma_f32_16x16x32_bf16 a[0:3], a[180:183], v[68:71], a[0:3]
ds_read_b64_tr_b16 a[188:189], v9 offset:57344
v_mfma_f32_16x16x32_bf16 a[4:7], a[180:183], v[76:79], a[4:7]
v_exp_f32 v193, v193
v_mfma_f32_16x16x32_bf16 a[4:7], a[176:179], v[72:75], a[4:7]
ds_read_b64_tr_b16 a[190:191], v9 offset:61440
v_cvt_pk_bf16_f32 v96, v192, v193
v_mfma_f32_16x16x32_bf16 a[8:11], a[176:179], v[80:83], a[8:11]
v_exp_f32 v194, v194
v_mfma_f32_16x16x32_bf16 a[8:11], a[180:183], v[84:87], a[8:11]
buffer_load_dwordx4 v16, s[8:11], s48 offen lds
v_mfma_f32_16x16x32_bf16 a[12:15], a[180:183], v[92:95], a[12:15]
v_exp_f32 v195, v195
v_mfma_f32_16x16x32_bf16 a[12:15], a[176:179], v[88:91], a[12:15]
ds_read_b128 a[168:171], v6 offset:53248
v_cvt_pk_bf16_f32 v97, v194, v195
v_mfma_f32_16x16x32_bf16 v[200:203], a[144:147], v[160:163], v[216:219]
v_exp_f32 v196, v196
v_mfma_f32_16x16x32_bf16 v[200:203], a[148:151], v[164:167], v[200:203]
s_waitcnt lgkmcnt(1)
ds_read_b64_tr_b16 a[176:177], v10 offset:49152
v_mfma_f32_16x16x32_bf16 v[200:203], a[152:155], v[168:171], v[200:203]
v_exp_f32 v197, v197
v_mfma_f32_16x16x32_bf16 v[200:203], a[156:159], v[172:175], v[200:203]
ds_read_b64_tr_b16 a[178:179], v10 offset:53248
v_cvt_pk_bf16_f32 v104, v196, v197
v_mfma_f32_16x16x32_bf16 v[204:207], a[156:159], v[188:191], v[220:223]
v_exp_f32 v198, v198
v_mfma_f32_16x16x32_bf16 v[204:207], a[152:155], v[184:187], v[204:207]
buffer_load_dwordx4 v17, s[8:11], s48 offen offset:1024 lds
v_mfma_f32_16x16x32_bf16 v[204:207], a[148:151], v[180:183], v[204:207]
v_exp_f32 v199, v199
v_mfma_f32_16x16x32_bf16 v[204:207], a[144:147], v[176:179], v[204:207]
ds_read_b128 a[172:175], v7 offset:53248
v_cvt_pk_bf16_f32 v105, v198, v199
v_smfmac_f32_16x16x64_bf16 a[128:131], v[224:227], v[64:71], v228
v_mfma_f32_16x16x32_bf16 a[16:19], a[184:187], v[64:67], a[16:19]
v_exp_f32 v200, v200
v_mfma_f32_16x16x32_bf16 a[16:19], a[188:191], v[68:71], a[16:19]
ds_read_b64_tr_b16 a[180:181], v10 offset:57344
s_add_u32 s49, s49, 16384
v_mfma_f32_16x16x32_bf16 a[20:23], a[188:191], v[76:79], a[20:23]
v_exp_f32 v201, v201
v_mfma_f32_16x16x32_bf16 a[20:23], a[184:187], v[72:75], a[20:23]
ds_read_b64_tr_b16 a[182:183], v10 offset:61440
v_cvt_pk_bf16_f32 v112, v200, v201
v_mfma_f32_16x16x32_bf16 a[24:27], a[184:187], v[80:83], a[24:27]
v_exp_f32 v202, v202
v_mfma_f32_16x16x32_bf16 a[24:27], a[188:191], v[84:87], a[24:27]
buffer_load_dwordx4 v18, s[8:11], s48 offen offset:2048 lds
v_mfma_f32_16x16x32_bf16 a[28:31], a[188:191], v[92:95], a[28:31]
v_exp_f32 v203, v203
v_mfma_f32_16x16x32_bf16 a[28:31], a[184:187], v[88:91], a[28:31]
ds_read_b128 a[144:147], v4 offset:57344
v_cvt_pk_bf16_f32 v113, v202, v203
v_mfma_f32_16x16x32_bf16 v[192:195], a[160:163], v[128:131], v[208:211]
v_exp_f32 v204, v204
v_mfma_f32_16x16x32_bf16 v[192:195], a[164:167], v[132:135], v[192:195]
s_waitcnt lgkmcnt(1)
ds_read_b64_tr_b16 a[184:185], v11 offset:49152
v_mfma_f32_16x16x32_bf16 v[192:195], a[168:171], v[136:139], v[192:195]
v_exp_f32 v205, v205
v_mfma_f32_16x16x32_bf16 v[192:195], a[172:175], v[140:143], v[192:195]
ds_read_b64_tr_b16 a[186:187], v11 offset:53248
v_cvt_pk_bf16_f32 v120, v204, v205
v_mfma_f32_16x16x32_bf16 v[196:199], a[172:175], v[156:159], v[212:215]
v_exp_f32 v206, v206
v_mfma_f32_16x16x32_bf16 v[196:199], a[168:171], v[152:155], v[196:199]
buffer_load_dwordx4 v19, s[8:11], s48 offen offset:3072 lds
v_mfma_f32_16x16x32_bf16 v[196:199], a[164:167], v[148:151], v[196:199]
v_exp_f32 v207, v207
v_mfma_f32_16x16x32_bf16 v[196:199], a[160:163], v[144:147], v[196:199]
ds_read_b128 a[148:151], v5 offset:57344
v_cvt_pk_bf16_f32 v121, v206, v207
v_mfma_f32_16x16x32_bf16 a[32:35], a[176:179], v[64:67], a[32:35]
v_exp_f32 v192, v192
v_mfma_f32_16x16x32_bf16 a[32:35], a[180:183], v[68:71], a[32:35]
ds_read_b64_tr_b16 a[188:189], v11 offset:57344
s_add_u32 m0, s42, 16384
v_mfma_f32_16x16x32_bf16 a[36:39], a[180:183], v[76:79], a[36:39]
v_exp_f32 v193, v193
v_mfma_f32_16x16x32_bf16 a[36:39], a[176:179], v[72:75], a[36:39]
ds_read_b64_tr_b16 a[190:191], v11 offset:61440
v_cvt_pk_bf16_f32 v98, v192, v193
v_mfma_f32_16x16x32_bf16 a[40:43], a[176:179], v[80:83], a[40:43]
v_exp_f32 v194, v194
v_mfma_f32_16x16x32_bf16 a[40:43], a[180:183], v[84:87], a[40:43]
buffer_load_dwordx4 v20, s[12:15], s49 offen lds
v_mfma_f32_16x16x32_bf16 a[44:47], a[180:183], v[92:95], a[44:47]
v_exp_f32 v195, v195
v_mfma_f32_16x16x32_bf16 a[44:47], a[176:179], v[88:91], a[44:47]
ds_read_b128 a[152:155], v6 offset:57344
v_cvt_pk_bf16_f32 v99, v194, v195
v_mfma_f32_16x16x32_bf16 v[200:203], a[160:163], v[160:163], v[216:219]
v_exp_f32 v196, v196
v_mfma_f32_16x16x32_bf16 v[200:203], a[164:167], v[164:167], v[200:203]
s_waitcnt lgkmcnt(1)
ds_read_b64_tr_b16 a[176:177], v12 offset:49152
v_mfma_f32_16x16x32_bf16 v[200:203], a[168:171], v[168:171], v[200:203]
v_exp_f32 v197, v197
v_mfma_f32_16x16x32_bf16 v[200:203], a[172:175], v[172:175], v[200:203]
ds_read_b64_tr_b16 a[178:179], v12 offset:53248
v_cvt_pk_bf16_f32 v106, v196, v197
v_mfma_f32_16x16x32_bf16 v[204:207], a[172:175], v[188:191], v[220:223]
v_exp_f32 v198, v198
v_mfma_f32_16x16x32_bf16 v[204:207], a[168:171], v[184:187], v[204:207]
buffer_load_dwordx4 v21, s[12:15], s49 offen offset:1024 lds
v_mfma_f32_16x16x32_bf16 v[204:207], a[164:167], v[180:183], v[204:207]
v_exp_f32 v199, v199
v_mfma_f32_16x16x32_bf16 v[204:207], a[160:163], v[176:179], v[204:207]
ds_read_b128 a[156:159], v7 offset:57344
v_cvt_pk_bf16_f32 v107, v198, v199
v_smfmac_f32_16x16x64_bf16 a[132:135], v[224:227], v[72:79], v228
v_mfma_f32_16x16x32_bf16 a[48:51], a[184:187], v[64:67], a[48:51]
v_exp_f32 v200, v200
v_mfma_f32_16x16x32_bf16 a[48:51], a[188:191], v[68:71], a[48:51]
ds_read_b64_tr_b16 a[180:181], v12 offset:57344
v_mfma_f32_16x16x32_bf16 a[52:55], a[188:191], v[76:79], a[52:55]
v_exp_f32 v201, v201
v_mfma_f32_16x16x32_bf16 a[52:55], a[184:187], v[72:75], a[52:55]
ds_read_b64_tr_b16 a[182:183], v12 offset:61440
v_cvt_pk_bf16_f32 v114, v200, v201
v_mfma_f32_16x16x32_bf16 a[56:59], a[184:187], v[80:83], a[56:59]
v_exp_f32 v202, v202
v_mfma_f32_16x16x32_bf16 a[56:59], a[188:191], v[84:87], a[56:59]
buffer_load_dwordx4 v20, s[12:15], s49 offen offset:2048 lds
v_mfma_f32_16x16x32_bf16 a[60:63], a[188:191], v[92:95], a[60:63]
v_exp_f32 v203, v203
v_mfma_f32_16x16x32_bf16 a[60:63], a[184:187], v[88:91], a[60:63]
ds_read_b128 a[160:163], v4 offset:61440
v_cvt_pk_bf16_f32 v115, v202, v203
v_mfma_f32_16x16x32_bf16 v[192:195], a[144:147], v[128:131], v[208:211]
v_exp_f32 v204, v204
v_mfma_f32_16x16x32_bf16 v[192:195], a[148:151], v[132:135], v[192:195]
s_waitcnt lgkmcnt(1)
ds_read_b64_tr_b16 a[184:185], v13 offset:49152
v_mfma_f32_16x16x32_bf16 v[192:195], a[152:155], v[136:139], v[192:195]
v_exp_f32 v205, v205
v_mfma_f32_16x16x32_bf16 v[192:195], a[156:159], v[140:143], v[192:195]
ds_read_b64_tr_b16 a[186:187], v13 offset:53248
v_cvt_pk_bf16_f32 v122, v204, v205
v_mfma_f32_16x16x32_bf16 v[196:199], a[156:159], v[156:159], v[212:215]
v_exp_f32 v206, v206
v_mfma_f32_16x16x32_bf16 v[196:199], a[152:155], v[152:155], v[196:199]
buffer_load_dwordx4 v21, s[12:15], s49 offen offset:3072 lds
v_mfma_f32_16x16x32_bf16 v[196:199], a[148:151], v[148:151], v[196:199]
v_exp_f32 v207, v207
v_mfma_f32_16x16x32_bf16 v[196:199], a[144:147], v[144:147], v[196:199]
ds_read_b128 a[164:167], v5 offset:61440
v_cvt_pk_bf16_f32 v123, v206, v207
L_pad7:
s_cbranch_execz L_walked0
v_mfma_f32_16x16x32_bf16 a[64:67], a[176:179], v[64:67], a[64:67]
v_exp_f32 v192, v192
v_mfma_f32_16x16x32_bf16 a[64:67], a[180:183], v[68:71], a[64:67]
ds_read_b64_tr_b16 a[188:189], v13 offset:57344
v_add_u32 v38, 262144, v38
v_mfma_f32_16x16x32_bf16 a[68:71], a[180:183], v[76:79], a[68:71]
v_exp_f32 v193, v193
v_mfma_f32_16x16x32_bf16 a[68:71], a[176:179], v[72:75], a[68:71]
ds_read_b64_tr_b16 a[190:191], v13 offset:61440
v_cvt_pk_bf16_f32 v100, v192, v193
v_mfma_f32_16x16x32_bf16 a[72:75], a[176:179], v[80:83], a[72:75]
v_exp_f32 v194, v194
v_mfma_f32_16x16x32_bf16 a[72:75], a[180:183], v[84:87], a[72:75]
buffer_load_dword v58, v38, s[20:23], 0 offen
v_mfma_f32_16x16x32_bf16 a[76:79], a[180:183], v[92:95], a[76:79]
v_exp_f32 v195, v195
v_mfma_f32_16x16x32_bf16 a[76:79], a[176:179], v[88:91], a[76:79]
ds_read_b128 a[168:171], v6 offset:61440
v_cvt_pk_bf16_f32 v101, v194, v195
v_mfma_f32_16x16x32_bf16 v[200:203], a[144:147], v[160:163], v[216:219]
v_exp_f32 v196, v196
v_mfma_f32_16x16x32_bf16 v[200:203], a[148:151], v[164:167], v[200:203]
s_waitcnt lgkmcnt(1)
ds_read_b64_tr_b16 a[176:177], v14 offset:49152
v_mfma_f32_16x16x32_bf16 v[200:203], a[152:155], v[168:171], v[200:203]
v_exp_f32 v197, v197
v_mfma_f32_16x16x32_bf16 v[200:203], a[156:159], v[172:175], v[200:203]
ds_read_b64_tr_b16 a[178:179], v14 offset:53248
v_cvt_pk_bf16_f32 v108, v196, v197
v_mfma_f32_16x16x32_bf16 v[204:207], a[156:159], v[188:191], v[220:223]
v_exp_f32 v198, v198
v_mfma_f32_16x16x32_bf16 v[204:207], a[152:155], v[184:187], v[204:207]
v_mfma_f32_16x16x32_bf16 v[204:207], a[148:151], v[180:183], v[204:207]
v_exp_f32 v199, v199
v_mfma_f32_16x16x32_bf16 v[204:207], a[144:147], v[176:179], v[204:207]
ds_read_b128 a[172:175], v7 offset:61440
v_cvt_pk_bf16_f32 v109, v198, v199
v_smfmac_f32_16x16x64_bf16 a[136:139], v[224:227], v[80:87], v228
v_mfma_f32_16x16x32_bf16 a[80:83], a[184:187], v[64:67], a[80:83]
v_exp_f32 v200, v200
v_mfma_f32_16x16x32_bf16 a[80:83], a[188:191], v[68:71], a[80:83]
ds_read_b64_tr_b16 a[180:181], v14 offset:57344
v_mfma_f32_16x16x32_bf16 a[84:87], a[188:191], v[76:79], a[84:87]
v_exp_f32 v201, v201
v_mfma_f32_16x16x32_bf16 a[84:87], a[184:187], v[72:75], a[84:87]
ds_read_b64_tr_b16 a[182:183], v14 offset:61440
v_cvt_pk_bf16_f32 v116, v200, v201
v_mfma_f32_16x16x32_bf16 a[88:91], a[184:187], v[80:83], a[88:91]
v_exp_f32 v202, v202
v_mfma_f32_16x16x32_bf16 a[88:91], a[188:191], v[84:87], a[88:91]
s_waitcnt vmcnt(9)
s_barrier
v_mfma_f32_16x16x32_bf16 a[92:95], a[188:191], v[92:95], a[92:95]
v_exp_f32 v203, v203
v_mfma_f32_16x16x32_bf16 a[92:95], a[184:187], v[88:91], a[92:95]
ds_read_b128 a[144:147], v4 offset:0
v_cvt_pk_bf16_f32 v117, v202, v203
v_mfma_f32_16x16x32_bf16 v[192:195], a[160:163], v[128:131], v[208:211]
v_exp_f32 v204, v204
v_mfma_f32_16x16x32_bf16 v[192:195], a[164:167], v[132:135], v[192:195]
s_waitcnt lgkmcnt(1)
ds_read_b64_tr_b16 a[184:185], v15 offset:49152
v_mfma_f32_16x16x32_bf16 v[192:195], a[168:171], v[136:139], v[192:195]
v_exp_f32 v205, v205
v_mfma_f32_16x16x32_bf16 v[192:195], a[172:175], v[140:143], v[192:195]
ds_read_b64_tr_b16 a[186:187], v15 offset:53248
v_cvt_pk_bf16_f32 v124, v204, v205
v_mfma_f32_16x16x32_bf16 v[196:199], a[172:175], v[156:159], v[212:215]
v_exp_f32 v206, v206
v_mfma_f32_16x16x32_bf16 v[196:199], a[168:171], v[152:155], v[196:199]
v_mfma_f32_16x16x32_bf16 v[196:199], a[164:167], v[148:151], v[196:199]
v_exp_f32 v207, v207
v_mfma_f32_16x16x32_bf16 v[196:199], a[160:163], v[144:147], v[196:199]
ds_read_b128 a[148:151], v5 offset:0
v_cvt_pk_bf16_f32 v125, v206, v207
v_mfma_f32_16x16x32_bf16 a[96:99], a[176:179], v[64:67], a[96:99]
v_exp_f32 v192, v192
v_mfma_f32_16x16x32_bf16 a[96:99], a[180:183], v[68:71], a[96:99]
ds_read_b64_tr_b16 a[188:189], v15 offset:57344
v_mfma_f32_16x16x32_bf16 a[100:103], a[180:183], v[76:79], a[100:103]
v_exp_f32 v193, v193
v_mfma_f32_16x16x32_bf16 a[100:103], a[176:179], v[72:75], a[100:103]
ds_read_b64_tr_b16 a[190:191], v15 offset:61440
v_cvt_pk_bf16_f32 v102, v192, v193
v_mfma_f32_16x16x32_bf16 a[104:107], a[176:179], v[80:83], a[104:107]
v_exp_f32 v194, v194
v_mfma_f32_16x16x32_bf16 a[104:107], a[180:183], v[84:87], a[104:107]
v_mfma_f32_16x16x32_bf16 a[108:111], a[180:183], v[92:95], a[108:111]
v_exp_f32 v195, v195
v_mfma_f32_16x16x32_bf16 a[108:111], a[176:179], v[88:91], a[108:111]
ds_read_b128 a[152:155], v6 offset:0
v_cvt_pk_bf16_f32 v103, v194, v195
v_mfma_f32_16x16x32_bf16 v[200:203], a[160:163], v[160:163], v[216:219]
v_exp_f32 v196, v196
v_mfma_f32_16x16x32_bf16 v[200:203], a[164:167], v[164:167], v[200:203]
s_waitcnt lgkmcnt(1)
ds_read_b64_tr_b16 a[176:177], v8 offset:0
v_mfma_f32_16x16x32_bf16 v[200:203], a[168:171], v[168:171], v[200:203]
v_exp_f32 v197, v197
v_mfma_f32_16x16x32_bf16 v[200:203], a[172:175], v[172:175], v[200:203]
ds_read_b64_tr_b16 a[178:179], v8 offset:4096
v_cvt_pk_bf16_f32 v110, v196, v197
v_mfma_f32_16x16x32_bf16 v[204:207], a[172:175], v[188:191], v[220:223]
v_exp_f32 v198, v198
v_mfma_f32_16x16x32_bf16 v[204:207], a[168:171], v[184:187], v[204:207]
v_mfma_f32_16x16x32_bf16 v[204:207], a[164:167], v[180:183], v[204:207]
v_exp_f32 v199, v199
v_mfma_f32_16x16x32_bf16 v[204:207], a[160:163], v[176:179], v[204:207]
ds_read_b128 a[156:159], v7 offset:0
v_cvt_pk_bf16_f32 v111, v198, v199
v_smfmac_f32_16x16x64_bf16 a[140:143], v[224:227], v[88:95], v228
v_mfma_f32_16x16x32_bf16 a[112:115], a[184:187], v[64:67], a[112:115]
v_exp_f32 v200, v200
v_mfma_f32_16x16x32_bf16 a[112:115], a[188:191], v[68:71], a[112:115]
ds_read_b64_tr_b16 a[180:181], v8 offset:8192
v_mfma_f32_16x16x32_bf16 a[116:119], a[188:191], v[76:79], a[116:119]
v_exp_f32 v201, v201
v_mfma_f32_16x16x32_bf16 a[116:119], a[184:187], v[72:75], a[116:119]
ds_read_b64_tr_b16 a[182:183], v8 offset:12288
v_cvt_pk_bf16_f32 v118, v200, v201
v_mfma_f32_16x16x32_bf16 a[120:123], a[184:187], v[80:83], a[120:123]
v_exp_f32 v202, v202
v_mfma_f32_16x16x32_bf16 a[120:123], a[188:191], v[84:87], a[120:123]
v_mfma_f32_16x16x32_bf16 a[124:127], a[188:191], v[92:95], a[124:127]
v_exp_f32 v203, v203
v_mfma_f32_16x16x32_bf16 a[124:127], a[184:187], v[88:91], a[124:127]
ds_read_b128 a[160:163], v4 offset:4096
v_cvt_pk_bf16_f32 v119, v202, v203
v_mfma_f32_16x16x32_bf16 v[192:195], a[144:147], v[128:131], v[208:211]
v_exp_f32 v204, v204
v_mfma_f32_16x16x32_bf16 v[192:195], a[148:151], v[132:135], v[192:195]
s_waitcnt lgkmcnt(1)
ds_read_b64_tr_b16 a[184:185], v9 offset:0
v_mfma_f32_16x16x32_bf16 v[192:195], a[152:155], v[136:139], v[192:195]
v_exp_f32 v205, v205
v_mfma_f32_16x16x32_bf16 v[192:195], a[156:159], v[140:143], v[192:195]
ds_read_b64_tr_b16 a[186:187], v9 offset:4096
v_cvt_pk_bf16_f32 v126, v204, v205
v_mfma_f32_16x16x32_bf16 v[196:199], a[156:159], v[156:159], v[212:215]
v_exp_f32 v206, v206
v_mfma_f32_16x16x32_bf16 v[196:199], a[152:155], v[152:155], v[196:199]
s_add_u32 s48, s48, 16384
s_add_u32 m0, s40, 32768
v_mfma_f32_16x16x32_bf16 v[196:199], a[148:151], v[148:151], v[196:199]
v_exp_f32 v207, v207
v_mfma_f32_16x16x32_bf16 v[196:199], a[144:147], v[144:147], v[196:199]
ds_read_b128 a[164:167], v5 offset:4096
v_cvt_pk_bf16_f32 v127, v206, v207
v_mfma_f32_16x16x32_bf16 a[0:3], a[176:179], v[96:99], a[0:3]
v_exp_f32 v192, v192
v_mfma_f32_16x16x32_bf16 a[0:3], a[180:183], v[100:103], a[0:3]
ds_read_b64_tr_b16 a[188:189], v9 offset:8192
v_mfma_f32_16x16x32_bf16 a[4:7], a[180:183], v[108:111], a[4:7]
v_exp_f32 v193, v193
v_mfma_f32_16x16x32_bf16 a[4:7], a[176:179], v[104:107], a[4:7]
ds_read_b64_tr_b16 a[190:191], v9 offset:12288
v_cvt_pk_bf16_f32 v64, v192, v193
v_mfma_f32_16x16x32_bf16 a[8:11], a[176:179], v[112:115], a[8:11]
v_exp_f32 v194, v194
v_mfma_f32_16x16x32_bf16 a[8:11], a[180:183], v[116:119], a[8:11]
buffer_load_dwordx4 v16, s[8:11], s48 offen lds
v_mfma_f32_16x16x32_bf16 a[12:15], a[180:183], v[124:127], a[12:15]
v_exp_f32 v195, v195
v_mfma_f32_16x16x32_bf16 a[12:15], a[176:179], v[120:123], a[12:15]
ds_read_b128 a[168:171], v6 offset:4096
v_cvt_pk_bf16_f32 v65, v194, v195
v_mfma_f32_16x16x32_bf16 v[200:203], a[144:147], v[160:163], v[216:219]
v_exp_f32 v196, v196
v_mfma_f32_16x16x32_bf16 v[200:203], a[148:151], v[164:167], v[200:203]
s_waitcnt lgkmcnt(1)
ds_read_b64_tr_b16 a[176:177], v10 offset:0
v_mfma_f32_16x16x32_bf16 v[200:203], a[152:155], v[168:171], v[200:203]
v_exp_f32 v197, v197
v_mfma_f32_16x16x32_bf16 v[200:203], a[156:159], v[172:175], v[200:203]
ds_read_b64_tr_b16 a[178:179], v10 offset:4096
v_cvt_pk_bf16_f32 v72, v196, v197
v_mfma_f32_16x16x32_bf16 v[204:207], a[156:159], v[188:191], v[220:223]
v_exp_f32 v198, v198
v_mfma_f32_16x16x32_bf16 v[204:207], a[152:155], v[184:187], v[204:207]
buffer_load_dwordx4 v17, s[8:11], s48 offen offset:1024 lds
v_mfma_f32_16x16x32_bf16 v[204:207], a[148:151], v[180:183], v[204:207]
v_exp_f32 v199, v199
v_mfma_f32_16x16x32_bf16 v[204:207], a[144:147], v[176:179], v[204:207]
ds_read_b128 a[172:175], v7 offset:4096
v_cvt_pk_bf16_f32 v73, v198, v199
v_smfmac_f32_16x16x64_bf16 a[128:131], v[224:227], v[96:103], v228
buffer_load_dword v60, v53, s[88:91], s81 offen sc1
v_mfma_f32_16x16x32_bf16 a[16:19], a[184:187], v[96:99], a[16:19]
v_exp_f32 v200, v200
v_mfma_f32_16x16x32_bf16 a[16:19], a[188:191], v[100:103], a[16:19]
ds_read_b64_tr_b16 a[180:181], v10 offset:8192
s_add_u32 s49, s49, 16384
v_mfma_f32_16x16x32_bf16 a[20:23], a[188:191], v[108:111], a[20:23]
v_exp_f32 v201, v201
v_mfma_f32_16x16x32_bf16 a[20:23], a[184:187], v[104:107], a[20:23]
ds_read_b64_tr_b16 a[182:183], v10 offset:12288
v_cvt_pk_bf16_f32 v80, v200, v201
v_mfma_f32_16x16x32_bf16 a[24:27], a[184:187], v[112:115], a[24:27]
v_exp_f32 v202, v202
v_mfma_f32_16x16x32_bf16 a[24:27], a[188:191], v[116:119], a[24:27]
buffer_load_dwordx4 v18, s[8:11], s48 offen offset:2048 lds
v_mfma_f32_16x16x32_bf16 a[28:31], a[188:191], v[124:127], a[28:31]
v_exp_f32 v203, v203
v_mfma_f32_16x16x32_bf16 a[28:31], a[184:187], v[120:123], a[28:31]
ds_read_b128 a[144:147], v4 offset:8192
v_cvt_pk_bf16_f32 v81, v202, v203
v_mfma_f32_16x16x32_bf16 v[192:195], a[160:163], v[128:131], v[208:211]
v_exp_f32 v204, v204
v_mfma_f32_16x16x32_bf16 v[192:195], a[164:167], v[132:135], v[192:195]
s_waitcnt lgkmcnt(1)
ds_read_b64_tr_b16 a[184:185], v11 offset:0
v_mfma_f32_16x16x32_bf16 v[192:195], a[168:171], v[136:139], v[192:195]
v_exp_f32 v205, v205
v_mfma_f32_16x16x32_bf16 v[192:195], a[172:175], v[140:143], v[192:195]
ds_read_b64_tr_b16 a[186:187], v11 offset:4096
v_cvt_pk_bf16_f32 v88, v204, v205
v_mfma_f32_16x16x32_bf16 v[196:199], a[172:175], v[156:159], v[212:215]
v_exp_f32 v206, v206
v_mfma_f32_16x16x32_bf16 v[196:199], a[168:171], v[152:155], v[196:199]
buffer_load_dwordx4 v19, s[8:11], s48 offen offset:3072 lds
v_mfma_f32_16x16x32_bf16 v[196:199], a[164:167], v[148:151], v[196:199]
v_exp_f32 v207, v207
v_mfma_f32_16x16x32_bf16 v[196:199], a[160:163], v[144:147], v[196:199]
ds_read_b128 a[148:151], v5 offset:8192
v_cvt_pk_bf16_f32 v89, v206, v207
v_mfma_f32_16x16x32_bf16 a[32:35], a[176:179], v[96:99], a[32:35]
v_exp_f32 v192, v192
v_mfma_f32_16x16x32_bf16 a[32:35], a[180:183], v[100:103], a[32:35]
ds_read_b64_tr_b16 a[188:189], v11 offset:8192
s_add_u32 m0, s42, 32768
v_mfma_f32_16x16x32_bf16 a[36:39], a[180:183], v[108:111], a[36:39]
v_exp_f32 v193, v193
v_mfma_f32_16x16x32_bf16 a[36:39], a[176:179], v[104:107], a[36:39]
ds_read_b64_tr_b16 a[190:191], v11 offset:12288
v_cvt_pk_bf16_f32 v66, v192, v193
v_mfma_f32_16x16x32_bf16 a[40:43], a[176:179], v[112:115], a[40:43]
v_exp_f32 v194, v194
v_mfma_f32_16x16x32_bf16 a[40:43], a[180:183], v[116:119], a[40:43]
buffer_load_dwordx4 v20, s[12:15], s49 offen lds
v_mfma_f32_16x16x32_bf16 a[44:47], a[180:183], v[124:127], a[44:47]
v_exp_f32 v195, v195
v_mfma_f32_16x16x32_bf16 a[44:47], a[176:179], v[120:123], a[44:47]
ds_read_b128 a[152:155], v6 offset:8192
v_cvt_pk_bf16_f32 v67, v194, v195
v_mfma_f32_16x16x32_bf16 v[200:203], a[160:163], v[160:163], v[216:219]
v_exp_f32 v196, v196
v_mfma_f32_16x16x32_bf16 v[200:203], a[164:167], v[164:167], v[200:203]
s_waitcnt lgkmcnt(1)
ds_read_b64_tr_b16 a[176:177], v12 offset:0
v_mfma_f32_16x16x32_bf16 v[200:203], a[168:171], v[168:171], v[200:203]
v_exp_f32 v197, v197
v_mfma_f32_16x16x32_bf16 v[200:203], a[172:175], v[172:175], v[200:203]
ds_read_b64_tr_b16 a[178:179], v12 offset:4096
v_cvt_pk_bf16_f32 v74, v196, v197
v_mfma_f32_16x16x32_bf16 v[204:207], a[172:175], v[188:191], v[220:223]
v_exp_f32 v198, v198
v_mfma_f32_16x16x32_bf16 v[204:207], a[168:171], v[184:187], v[204:207]
buffer_load_dwordx4 v21, s[12:15], s49 offen offset:1024 lds
v_mfma_f32_16x16x32_bf16 v[204:207], a[164:167], v[180:183], v[204:207]
v_exp_f32 v199, v199
v_mfma_f32_16x16x32_bf16 v[204:207], a[160:163], v[176:179], v[204:207]
ds_read_b128 a[156:159], v7 offset:8192
v_cvt_pk_bf16_f32 v75, v198, v199
v_smfmac_f32_16x16x64_bf16 a[132:135], v[224:227], v[104:111], v228
v_mfma_f32_16x16x32_bf16 a[48:51], a[184:187], v[96:99], a[48:51]
v_exp_f32 v200, v200
v_mfma_f32_16x16x32_bf16 a[48:51], a[188:191], v[100:103], a[48:51]
ds_read_b64_tr_b16 a[180:181], v12 offset:8192
v_mfma_f32_16x16x32_bf16 a[52:55], a[188:191], v[108:111], a[52:55]
v_exp_f32 v201, v201
v_mfma_f32_16x16x32_bf16 a[52:55], a[184:187], v[104:107], a[52:55]
ds_read_b64_tr_b16 a[182:183], v12 offset:12288
v_cvt_pk_bf16_f32 v82, v200, v201
v_mfma_f32_16x16x32_bf16 a[56:59], a[184:187], v[112:115], a[56:59]
v_exp_f32 v202, v202
v_mfma_f32_16x16x32_bf16 a[56:59], a[188:191], v[116:119], a[56:59]
buffer_load_dwordx4 v20, s[12:15], s49 offen offset:2048 lds
v_mfma_f32_16x16x32_bf16 a[60:63], a[188:191], v[124:127], a[60:63]
v_exp_f32 v203, v203
v_mfma_f32_16x16x32_bf16 a[60:63], a[184:187], v[120:123], a[60:63]
ds_read_b128 a[160:163], v4 offset:12288
v_cvt_pk_bf16_f32 v83, v202, v203
v_mfma_f32_16x16x32_bf16 v[192:195], a[144:147], v[128:131], v[208:211]
v_exp_f32 v204, v204
v_mfma_f32_16x16x32_bf16 v[192:195], a[148:151], v[132:135], v[192:195]
s_waitcnt lgkmcnt(1)
ds_read_b64_tr_b16 a[184:185], v13 offset:0
v_mfma_f32_16x16x32_bf16 v[192:195], a[152:155], v[136:139], v[192:195]
v_exp_f32 v205, v205
v_mfma_f32_16x16x32_bf16 v[192:195], a[156:159], v[140:143], v[192:195]
ds_read_b64_tr_b16 a[186:187], v13 offset:4096
v_cvt_pk_bf16_f32 v90, v204, v205
v_mfma_f32_16x16x32_bf16 v[196:199], a[156:159], v[156:159], v[212:215]
v_exp_f32 v206, v206
v_mfma_f32_16x16x32_bf16 v[196:199], a[152:155], v[152:155], v[196:199]
buffer_load_dwordx4 v21, s[12:15], s49 offen offset:3072 lds
v_mfma_f32_16x16x32_bf16 v[196:199], a[148:151], v[148:151], v[196:199]
v_exp_f32 v207, v207
v_mfma_f32_16x16x32_bf16 v[196:199], a[144:147], v[144:147], v[196:199]
ds_read_b128 a[164:167], v5 offset:12288
v_cvt_pk_bf16_f32 v91, v206, v207
v_mfma_f32_16x16x32_bf16 a[64:67], a[176:179], v[96:99], a[64:67]
v_exp_f32 v192, v192
v_mfma_f32_16x16x32_bf16 a[64:67], a[180:183], v[100:103], a[64:67]
ds_read_b64_tr_b16 a[188:189], v13 offset:8192
v_add_u32 v39, 114688, v39
v_mfma_f32_16x16x32_bf16 a[68:71], a[180:183], v[108:111], a[68:71]
v_exp_f32 v193, v193
v_mfma_f32_16x16x32_bf16 a[68:71], a[176:179], v[104:107], a[68:71]
ds_read_b64_tr_b16 a[190:191], v13 offset:12288
v_cvt_pk_bf16_f32 v68, v192, v193
v_mfma_f32_16x16x32_bf16 a[72:75], a[176:179], v[112:115], a[72:75]
v_exp_f32 v194, v194
v_mfma_f32_16x16x32_bf16 a[72:75], a[180:183], v[116:119], a[72:75]
buffer_load_dword v59, v39, s[16:19], 0 offen
v_mfma_f32_16x16x32_bf16 a[76:79], a[180:183], v[124:127], a[76:79]
v_exp_f32 v195, v195
v_mfma_f32_16x16x32_bf16 a[76:79], a[176:179], v[120:123], a[76:79]
ds_read_b128 a[168:171], v6 offset:12288
v_cvt_pk_bf16_f32 v69, v194, v195
v_mfma_f32_16x16x32_bf16 v[200:203], a[144:147], v[160:163], v[216:219]
v_exp_f32 v196, v196
v_mfma_f32_16x16x32_bf16 v[200:203], a[148:151], v[164:167], v[200:203]
s_waitcnt lgkmcnt(1)
ds_read_b64_tr_b16 a[176:177], v14 offset:0
v_mfma_f32_16x16x32_bf16 v[200:203], a[152:155], v[168:171], v[200:203]
v_exp_f32 v197, v197
v_mfma_f32_16x16x32_bf16 v[200:203], a[156:159], v[172:175], v[200:203]
ds_read_b64_tr_b16 a[178:179], v14 offset:4096
v_cvt_pk_bf16_f32 v76, v196, v197
v_mfma_f32_16x16x32_bf16 v[204:207], a[156:159], v[188:191], v[220:223]
v_exp_f32 v198, v198
v_mfma_f32_16x16x32_bf16 v[204:207], a[152:155], v[184:187], v[204:207]
v_mfma_f32_16x16x32_bf16 v[204:207], a[148:151], v[180:183], v[204:207]
v_exp_f32 v199, v199
v_mfma_f32_16x16x32_bf16 v[204:207], a[144:147], v[176:179], v[204:207]
ds_read_b128 a[172:175], v7 offset:12288
v_cvt_pk_bf16_f32 v77, v198, v199
v_smfmac_f32_16x16x64_bf16 a[136:139], v[224:227], v[112:119], v228
v_mfma_f32_16x16x32_bf16 a[80:83], a[184:187], v[96:99], a[80:83]
v_exp_f32 v200, v200
v_mfma_f32_16x16x32_bf16 a[80:83], a[188:191], v[100:103], a[80:83]
ds_read_b64_tr_b16 a[180:181], v14 offset:8192
v_mfma_f32_16x16x32_bf16 a[84:87], a[188:191], v[108:111], a[84:87]
v_exp_f32 v201, v201
v_mfma_f32_16x16x32_bf16 a[84:87], a[184:187], v[104:107], a[84:87]
ds_read_b64_tr_b16 a[182:183], v14 offset:12288
v_cvt_pk_bf16_f32 v84, v200, v201
v_mfma_f32_16x16x32_bf16 a[88:91], a[184:187], v[112:115], a[88:91]
v_exp_f32 v202, v202
v_mfma_f32_16x16x32_bf16 a[88:91], a[188:191], v[116:119], a[88:91]
s_waitcnt vmcnt(10)
s_barrier
v_mfma_f32_16x16x32_bf16 a[92:95], a[188:191], v[124:127], a[92:95]
v_exp_f32 v203, v203
v_mfma_f32_16x16x32_bf16 a[92:95], a[184:187], v[120:123], a[92:95]
ds_read_b128 a[144:147], v4 offset:16384
v_cvt_pk_bf16_f32 v85, v202, v203
v_mfma_f32_16x16x32_bf16 v[192:195], a[160:163], v[128:131], v[208:211]
v_exp_f32 v204, v204
v_mfma_f32_16x16x32_bf16 v[192:195], a[164:167], v[132:135], v[192:195]
s_waitcnt lgkmcnt(1)
ds_read_b64_tr_b16 a[184:185], v15 offset:0
v_mfma_f32_16x16x32_bf16 v[192:195], a[168:171], v[136:139], v[192:195]
v_exp_f32 v205, v205
v_mfma_f32_16x16x32_bf16 v[192:195], a[172:175], v[140:143], v[192:195]
ds_read_b64_tr_b16 a[186:187], v15 offset:4096
v_cvt_pk_bf16_f32 v92, v204, v205
v_mfma_f32_16x16x32_bf16 v[196:199], a[172:175], v[156:159], v[212:215]
v_exp_f32 v206, v206
v_mfma_f32_16x16x32_bf16 v[196:199], a[168:171], v[152:155], v[196:199]
v_mfma_f32_16x16x32_bf16 v[196:199], a[164:167], v[148:151], v[196:199]
v_exp_f32 v207, v207
v_mfma_f32_16x16x32_bf16 v[196:199], a[160:163], v[144:147], v[196:199]
ds_read_b128 a[148:151], v5 offset:16384
v_cvt_pk_bf16_f32 v93, v206, v207
v_mfma_f32_16x16x32_bf16 a[96:99], a[176:179], v[96:99], a[96:99]
v_exp_f32 v192, v192
v_mfma_f32_16x16x32_bf16 a[96:99], a[180:183], v[100:103], a[96:99]
ds_read_b64_tr_b16 a[188:189], v15 offset:8192
v_mfma_f32_16x16x32_bf16 a[100:103], a[180:183], v[108:111], a[100:103]
v_exp_f32 v193, v193
v_mfma_f32_16x16x32_bf16 a[100:103], a[176:179], v[104:107], a[100:103]
ds_read_b64_tr_b16 a[190:191], v15 offset:12288
v_cvt_pk_bf16_f32 v70, v192, v193
v_mfma_f32_16x16x32_bf16 a[104:107], a[176:179], v[112:115], a[104:107]
v_exp_f32 v194, v194
v_mfma_f32_16x16x32_bf16 a[104:107], a[180:183], v[116:119], a[104:107]
v_mfma_f32_16x16x32_bf16 a[108:111], a[180:183], v[124:127], a[108:111]
v_exp_f32 v195, v195
v_mfma_f32_16x16x32_bf16 a[108:111], a[176:179], v[120:123], a[108:111]
ds_read_b128 a[152:155], v6 offset:16384
v_cvt_pk_bf16_f32 v71, v194, v195
v_mfma_f32_16x16x32_bf16 v[200:203], a[160:163], v[160:163], v[216:219]
v_exp_f32 v196, v196
v_mfma_f32_16x16x32_bf16 v[200:203], a[164:167], v[164:167], v[200:203]
s_waitcnt lgkmcnt(1)
ds_read_b64_tr_b16 a[176:177], v8 offset:16384
v_mfma_f32_16x16x32_bf16 v[200:203], a[168:171], v[168:171], v[200:203]
v_exp_f32 v197, v197
v_mfma_f32_16x16x32_bf16 v[200:203], a[172:175], v[172:175], v[200:203]
ds_read_b64_tr_b16 a[178:179], v8 offset:20480
v_cvt_pk_bf16_f32 v78, v196, v197
v_mfma_f32_16x16x32_bf16 v[204:207], a[172:175], v[188:191], v[220:223]
v_exp_f32 v198, v198
v_mfma_f32_16x16x32_bf16 v[204:207], a[168:171], v[184:187], v[204:207]
v_mfma_f32_16x16x32_bf16 v[204:207], a[164:167], v[180:183], v[204:207]
v_exp_f32 v199, v199
v_mfma_f32_16x16x32_bf16 v[204:207], a[160:163], v[176:179], v[204:207]
ds_read_b128 a[156:159], v7 offset:16384
v_cvt_pk_bf16_f32 v79, v198, v199
v_smfmac_f32_16x16x64_bf16 a[140:143], v[224:227], v[120:127], v228
v_mfma_f32_16x16x32_bf16 a[112:115], a[184:187], v[96:99], a[112:115]
v_exp_f32 v200, v200
v_mfma_f32_16x16x32_bf16 a[112:115], a[188:191], v[100:103], a[112:115]
ds_read_b64_tr_b16 a[180:181], v8 offset:24576
v_mfma_f32_16x16x32_bf16 a[116:119], a[188:191], v[108:111], a[116:119]
v_exp_f32 v201, v201
v_mfma_f32_16x16x32_bf16 a[116:119], a[184:187], v[104:107], a[116:119]
ds_read_b64_tr_b16 a[182:183], v8 offset:28672
v_cvt_pk_bf16_f32 v86, v200, v201
v_mfma_f32_16x16x32_bf16 a[120:123], a[184:187], v[112:115], a[120:123]
v_exp_f32 v202, v202
v_mfma_f32_16x16x32_bf16 a[120:123], a[188:191], v[116:119], a[120:123]
v_mfma_f32_16x16x32_bf16 a[124:127], a[188:191], v[124:127], a[124:127]
v_exp_f32 v203, v203
v_mfma_f32_16x16x32_bf16 a[124:127], a[184:187], v[120:123], a[124:127]
ds_read_b128 a[160:163], v4 offset:20480
v_cvt_pk_bf16_f32 v87, v202, v203
v_mfma_f32_16x16x32_bf16 v[192:195], a[144:147], v[128:131], v[208:211]
v_exp_f32 v204, v204
v_mfma_f32_16x16x32_bf16 v[192:195], a[148:151], v[132:135], v[192:195]
s_waitcnt lgkmcnt(1)
ds_read_b64_tr_b16 a[184:185], v9 offset:16384
v_mfma_f32_16x16x32_bf16 v[192:195], a[152:155], v[136:139], v[192:195]
v_exp_f32 v205, v205
v_mfma_f32_16x16x32_bf16 v[192:195], a[156:159], v[140:143], v[192:195]
ds_read_b64_tr_b16 a[186:187], v9 offset:20480
v_cvt_pk_bf16_f32 v94, v204, v205
v_mfma_f32_16x16x32_bf16 v[196:199], a[156:159], v[156:159], v[212:215]
v_exp_f32 v206, v206
v_mfma_f32_16x16x32_bf16 v[196:199], a[152:155], v[152:155], v[196:199]
s_add_u32 s48, s48, 16384
s_add_u32 m0, s40, 49152
v_mfma_f32_16x16x32_bf16 v[196:199], a[148:151], v[148:151], v[196:199]
v_exp_f32 v207, v207
v_mfma_f32_16x16x32_bf16 v[196:199], a[144:147], v[144:147], v[196:199]
ds_read_b128 a[164:167], v5 offset:20480
v_cvt_pk_bf16_f32 v95, v206, v207
v_mfma_f32_16x16x32_bf16 a[0:3], a[176:179], v[64:67], a[0:3]
v_exp_f32 v192, v192
v_mfma_f32_16x16x32_bf16 a[0:3], a[180:183], v[68:71], a[0:3]
ds_read_b64_tr_b16 a[188:189], v9 offset:24576
v_mfma_f32_16x16x32_bf16 a[4:7], a[180:183], v[76:79], a[4:7]
v_exp_f32 v193, v193
v_mfma_f32_16x16x32_bf16 a[4:7], a[176:179], v[72:75], a[4:7]
ds_read_b64_tr_b16 a[190:191], v9 offset:28672
v_cvt_pk_bf16_f32 v96, v192, v193
v_mfma_f32_16x16x32_bf16 a[8:11], a[176:179], v[80:83], a[8:11]
v_exp_f32 v194, v194
v_mfma_f32_16x16x32_bf16 a[8:11], a[180:183], v[84:87], a[8:11]
buffer_load_dwordx4 v16, s[8:11], s48 offen lds
v_mfma_f32_16x16x32_bf16 a[12:15], a[180:183], v[92:95], a[12:15]
v_exp_f32 v195, v195
v_mfma_f32_16x16x32_bf16 a[12:15], a[176:179], v[88:91], a[12:15]
ds_read_b128 a[168:171], v6 offset:20480
v_cvt_pk_bf16_f32 v97, v194, v195
v_mfma_f32_16x16x32_bf16 v[200:203], a[144:147], v[160:163], v[216:219]
v_exp_f32 v196, v196
v_mfma_f32_16x16x32_bf16 v[200:203], a[148:151], v[164:167], v[200:203]
s_waitcnt lgkmcnt(1)
ds_read_b64_tr_b16 a[176:177], v10 offset:16384
v_mfma_f32_16x16x32_bf16 v[200:203], a[152:155], v[168:171], v[200:203]
v_exp_f32 v197, v197
v_mfma_f32_16x16x32_bf16 v[200:203], a[156:159], v[172:175], v[200:203]
ds_read_b64_tr_b16 a[178:179], v10 offset:20480
v_cvt_pk_bf16_f32 v104, v196, v197
v_mfma_f32_16x16x32_bf16 v[204:207], a[156:159], v[188:191], v[220:223]
v_exp_f32 v198, v198
v_mfma_f32_16x16x32_bf16 v[204:207], a[152:155], v[184:187], v[204:207]
buffer_load_dwordx4 v17, s[8:11], s48 offen offset:1024 lds
v_mfma_f32_16x16x32_bf16 v[204:207], a[148:151], v[180:183], v[204:207]
v_exp_f32 v199, v199
v_mfma_f32_16x16x32_bf16 v[204:207], a[144:147], v[176:179], v[204:207]
ds_read_b128 a[172:175], v7 offset:20480
v_cvt_pk_bf16_f32 v105, v198, v199
v_smfmac_f32_16x16x64_bf16 a[128:131], v[224:227], v[64:71], v228
v_mfma_f32_16x16x32_bf16 a[16:19], a[184:187], v[64:67], a[16:19]
v_exp_f32 v200, v200
v_mfma_f32_16x16x32_bf16 a[16:19], a[188:191], v[68:71], a[16:19]
ds_read_b64_tr_b16 a[180:181], v10 offset:24576
s_add_u32 s49, s49, 16384
v_mfma_f32_16x16x32_bf16 a[20:23], a[188:191], v[76:79], a[20:23]
v_exp_f32 v201, v201
v_mfma_f32_16x16x32_bf16 a[20:23], a[184:187], v[72:75], a[20:23]
ds_read_b64_tr_b16 a[182:183], v10 offset:28672
v_cvt_pk_bf16_f32 v112, v200, v201
v_mfma_f32_16x16x32_bf16 a[24:27], a[184:187], v[80:83], a[24:27]
v_exp_f32 v202, v202
v_mfma_f32_16x16x32_bf16 a[24:27], a[188:191], v[84:87], a[24:27]
buffer_load_dwordx4 v18, s[8:11], s48 offen offset:2048 lds
v_mfma_f32_16x16x32_bf16 a[28:31], a[188:191], v[92:95], a[28:31]
v_exp_f32 v203, v203
v_mfma_f32_16x16x32_bf16 a[28:31], a[184:187], v[88:91], a[28:31]
ds_read_b128 a[144:147], v4 offset:24576
v_cvt_pk_bf16_f32 v113, v202, v203
v_mfma_f32_16x16x32_bf16 v[192:195], a[160:163], v[128:131], v[208:211]
v_exp_f32 v204, v204
v_mfma_f32_16x16x32_bf16 v[192:195], a[164:167], v[132:135], v[192:195]
s_waitcnt lgkmcnt(1)
ds_read_b64_tr_b16 a[184:185], v11 offset:16384
v_mfma_f32_16x16x32_bf16 v[192:195], a[168:171], v[136:139], v[192:195]
v_exp_f32 v205, v205
v_mfma_f32_16x16x32_bf16 v[192:195], a[172:175], v[140:143], v[192:195]
ds_read_b64_tr_b16 a[186:187], v11 offset:20480
v_cvt_pk_bf16_f32 v120, v204, v205
v_mfma_f32_16x16x32_bf16 v[196:199], a[172:175], v[156:159], v[212:215]
v_exp_f32 v206, v206
v_mfma_f32_16x16x32_bf16 v[196:199], a[168:171], v[152:155], v[196:199]
buffer_load_dwordx4 v19, s[8:11], s48 offen offset:3072 lds
v_mfma_f32_16x16x32_bf16 v[196:199], a[164:167], v[148:151], v[196:199]
v_exp_f32 v207, v207
v_mfma_f32_16x16x32_bf16 v[196:199], a[160:163], v[144:147], v[196:199]
ds_read_b128 a[148:151], v5 offset:24576
v_cvt_pk_bf16_f32 v121, v206, v207
v_mfma_f32_16x16x32_bf16 a[32:35], a[176:179], v[64:67], a[32:35]
v_exp_f32 v192, v192
v_mfma_f32_16x16x32_bf16 a[32:35], a[180:183], v[68:71], a[32:35]
ds_read_b64_tr_b16 a[188:189], v11 offset:24576
s_add_u32 m0, s42, 49152
v_mfma_f32_16x16x32_bf16 a[36:39], a[180:183], v[76:79], a[36:39]
v_exp_f32 v193, v193
v_mfma_f32_16x16x32_bf16 a[36:39], a[176:179], v[72:75], a[36:39]
ds_read_b64_tr_b16 a[190:191], v11 offset:28672
v_cvt_pk_bf16_f32 v98, v192, v193
v_mfma_f32_16x16x32_bf16 a[40:43], a[176:179], v[80:83], a[40:43]
v_exp_f32 v194, v194
v_mfma_f32_16x16x32_bf16 a[40:43], a[180:183], v[84:87], a[40:43]
buffer_load_dwordx4 v20, s[12:15], s49 offen lds
v_mfma_f32_16x16x32_bf16 a[44:47], a[180:183], v[92:95], a[44:47]
v_exp_f32 v195, v195
v_mfma_f32_16x16x32_bf16 a[44:47], a[176:179], v[88:91], a[44:47]
ds_read_b128 a[152:155], v6 offset:24576
v_cvt_pk_bf16_f32 v99, v194, v195
v_mfma_f32_16x16x32_bf16 v[200:203], a[160:163], v[160:163], v[216:219]
v_exp_f32 v196, v196
v_mfma_f32_16x16x32_bf16 v[200:203], a[164:167], v[164:167], v[200:203]
s_waitcnt lgkmcnt(1)
ds_read_b64_tr_b16 a[176:177], v12 offset:16384
v_mfma_f32_16x16x32_bf16 v[200:203], a[168:171], v[168:171], v[200:203]
v_exp_f32 v197, v197
v_mfma_f32_16x16x32_bf16 v[200:203], a[172:175], v[172:175], v[200:203]
ds_read_b64_tr_b16 a[178:179], v12 offset:20480
v_cvt_pk_bf16_f32 v106, v196, v197
v_mfma_f32_16x16x32_bf16 v[204:207], a[172:175], v[188:191], v[220:223]
v_exp_f32 v198, v198
v_mfma_f32_16x16x32_bf16 v[204:207], a[168:171], v[184:187], v[204:207]
buffer_load_dwordx4 v21, s[12:15], s49 offen offset:1024 lds
v_mfma_f32_16x16x32_bf16 v[204:207], a[164:167], v[180:183], v[204:207]
v_exp_f32 v199, v199
v_mfma_f32_16x16x32_bf16 v[204:207], a[160:163], v[176:179], v[204:207]
ds_read_b128 a[156:159], v7 offset:24576
v_cvt_pk_bf16_f32 v107, v198, v199
v_smfmac_f32_16x16x64_bf16 a[132:135], v[224:227], v[72:79], v228
v_mfma_f32_16x16x32_bf16 a[48:51], a[184:187], v[64:67], a[48:51]
v_exp_f32 v200, v200
v_mfma_f32_16x16x32_bf16 a[48:51], a[188:191], v[68:71], a[48:51]
ds_read_b64_tr_b16 a[180:181], v12 offset:24576
v_mfma_f32_16x16x32_bf16 a[52:55], a[188:191], v[76:79], a[52:55]
v_exp_f32 v201, v201
v_mfma_f32_16x16x32_bf16 a[52:55], a[184:187], v[72:75], a[52:55]
ds_read_b64_tr_b16 a[182:183], v12 offset:28672
v_cvt_pk_bf16_f32 v114, v200, v201
v_mfma_f32_16x16x32_bf16 a[56:59], a[184:187], v[80:83], a[56:59]
v_exp_f32 v202, v202
v_mfma_f32_16x16x32_bf16 a[56:59], a[188:191], v[84:87], a[56:59]
buffer_load_dwordx4 v20, s[12:15], s49 offen offset:2048 lds
v_mfma_f32_16x16x32_bf16 a[60:63], a[188:191], v[92:95], a[60:63]
v_exp_f32 v203, v203
v_mfma_f32_16x16x32_bf16 a[60:63], a[184:187], v[88:91], a[60:63]
ds_read_b128 a[160:163], v4 offset:28672
v_cvt_pk_bf16_f32 v115, v202, v203
v_mfma_f32_16x16x32_bf16 v[192:195], a[144:147], v[128:131], v[208:211]
L_pad8:
s_cbranch_execz L_pad9
v_exp_f32 v204, v204
v_mfma_f32_16x16x32_bf16 v[192:195], a[148:151], v[132:135], v[192:195]
s_waitcnt lgkmcnt(1)
ds_read_b64_tr_b16 a[184:185], v13 offset:16384
v_mfma_f32_16x16x32_bf16 v[192:195], a[152:155], v[136:139], v[192:195]
v_exp_f32 v205, v205
v_mfma_f32_16x16x32_bf16 v[192:195], a[156:159], v[140:143], v[192:195]
ds_read_b64_tr_b16 a[186:187], v13 offset:20480
v_cvt_pk_bf16_f32 v122, v204, v205
v_mfma_f32_16x16x32_bf16 v[196:199], a[156:159], v[156:159], v[212:215]
v_exp_f32 v206, v206
v_mfma_f32_16x16x32_bf16 v[196:199], a[152:155], v[152:155], v[196:199]
buffer_load_dwordx4 v21, s[12:15], s49 offen offset:3072 lds
v_mfma_f32_16x16x32_bf16 v[196:199], a[148:151], v[148:151], v[196:199]
v_exp_f32 v207, v207
v_mfma_f32_16x16x32_bf16 v[196:199], a[144:147], v[144:147], v[196:199]
ds_read_b128 a[164:167], v5 offset:28672
v_cvt_pk_bf16_f32 v123, v206, v207
v_mfma_f32_16x16x32_bf16 a[64:67], a[176:179], v[64:67], a[64:67]
v_exp_f32 v192, v192
v_mfma_f32_16x16x32_bf16 a[64:67], a[180:183], v[68:71], a[64:67]
ds_read_b64_tr_b16 a[188:189], v13 offset:24576
v_add_u32 v43, 116736, v43
v_mfma_f32_16x16x32_bf16 a[68:71], a[180:183], v[76:79], a[68:71]
v_exp_f32 v193, v193
v_mfma_f32_16x16x32_bf16 a[68:71], a[176:179], v[72:75], a[68:71]
ds_read_b64_tr_b16 a[190:191], v13 offset:28672
v_cvt_pk_bf16_f32 v100, v192, v193
v_mfma_f32_16x16x32_bf16 a[72:75], a[176:179], v[80:83], a[72:75]
v_exp_f32 v194, v194
v_mfma_f32_16x16x32_bf16 a[72:75], a[180:183], v[84:87], a[72:75]
buffer_load_dword v56, v43, s[24:27], 0 offen sc1
v_mfma_f32_16x16x32_bf16 a[76:79], a[180:183], v[92:95], a[76:79]
v_exp_f32 v195, v195
v_mfma_f32_16x16x32_bf16 a[76:79], a[176:179], v[88:91], a[76:79]
ds_read_b128 a[168:171], v6 offset:28672
v_cvt_pk_bf16_f32 v101, v194, v195
v_mfma_f32_16x16x32_bf16 v[200:203], a[144:147], v[160:163], v[216:219]
v_exp_f32 v196, v196
v_mfma_f32_16x16x32_bf16 v[200:203], a[148:151], v[164:167], v[200:203]
s_waitcnt lgkmcnt(1)
ds_read_b64_tr_b16 a[176:177], v14 offset:16384
v_mfma_f32_16x16x32_bf16 v[200:203], a[152:155], v[168:171], v[200:203]
v_exp_f32 v197, v197
v_mfma_f32_16x16x32_bf16 v[200:203], a[156:159], v[172:175], v[200:203]
ds_read_b64_tr_b16 a[178:179], v14 offset:20480
v_cvt_pk_bf16_f32 v108, v196, v197
v_mfma_f32_16x16x32_bf16 v[204:207], a[156:159], v[188:191], v[220:223]
v_exp_f32 v198, v198
v_mfma_f32_16x16x32_bf16 v[204:207], a[152:155], v[184:187], v[204:207]
v_mfma_f32_16x16x32_bf16 v[204:207], a[148:151], v[180:183], v[204:207]
v_exp_f32 v199, v199
v_mfma_f32_16x16x32_bf16 v[204:207], a[144:147], v[176:179], v[204:207]
ds_read_b128 a[172:175], v7 offset:28672
v_cvt_pk_bf16_f32 v109, v198, v199
v_smfmac_f32_16x16x64_bf16 a[136:139], v[224:227], v[80:87], v228
v_mfma_f32_16x16x32_bf16 a[80:83], a[184:187], v[64:67], a[80:83]
v_exp_f32 v200, v200
v_mfma_f32_16x16x32_bf16 a[80:83], a[188:191], v[68:71], a[80:83]
ds_read_b64_tr_b16 a[180:181], v14 offset:24576
v_mfma_f32_16x16x32_bf16 a[84:87], a[188:191], v[76:79], a[84:87]
v_exp_f32 v201, v201
v_mfma_f32_16x16x32_bf16 a[84:87], a[184:187], v[72:75], a[84:87]
ds_read_b64_tr_b16 a[182:183], v14 offset:28672
v_cvt_pk_bf16_f32 v116, v200, v201
v_mfma_f32_16x16x32_bf16 a[88:91], a[184:187], v[80:83], a[88:91]
v_exp_f32 v202, v202
v_mfma_f32_16x16x32_bf16 a[88:91], a[188:191], v[84:87], a[88:91]
s_waitcnt vmcnt(9)
s_barrier
v_mfma_f32_16x16x32_bf16 a[92:95], a[188:191], v[92:95], a[92:95]
v_exp_f32 v203, v203
v_mfma_f32_16x16x32_bf16 a[92:95], a[184:187], v[88:91], a[92:95]
ds_read_b128 a[144:147], v4 offset:32768
v_cvt_pk_bf16_f32 v117, v202, v203
v_mfma_f32_16x16x32_bf16 v[192:195], a[160:163], v[128:131], v[208:211]
v_exp_f32 v204, v204
v_mfma_f32_16x16x32_bf16 v[192:195], a[164:167], v[132:135], v[192:195]
s_waitcnt lgkmcnt(1)
ds_read_b64_tr_b16 a[184:185], v15 offset:16384
v_mfma_f32_16x16x32_bf16 v[192:195], a[168:171], v[136:139], v[192:195]
v_exp_f32 v205, v205
v_mfma_f32_16x16x32_bf16 v[192:195], a[172:175], v[140:143], v[192:195]
ds_read_b64_tr_b16 a[186:187], v15 offset:20480
v_cvt_pk_bf16_f32 v124, v204, v205
v_mfma_f32_16x16x32_bf16 v[196:199], a[172:175], v[156:159], v[212:215]
v_exp_f32 v206, v206
v_mfma_f32_16x16x32_bf16 v[196:199], a[168:171], v[152:155], v[196:199]
v_cmp_ne_u32 vcc, s82, v60
v_mfma_f32_16x16x32_bf16 v[196:199], a[164:167], v[148:151], v[196:199]
v_exp_f32 v207, v207
v_mfma_f32_16x16x32_bf16 v[196:199], a[160:163], v[144:147], v[196:199]
ds_read_b128 a[148:151], v5 offset:32768
v_cvt_pk_bf16_f32 v125, v206, v207
v_mfma_f32_16x16x32_bf16 a[96:99], a[176:179], v[64:67], a[96:99]
v_exp_f32 v192, v192
v_mfma_f32_16x16x32_bf16 a[96:99], a[180:183], v[68:71], a[96:99]
ds_read_b64_tr_b16 a[188:189], v15 offset:24576
v_mfma_f32_16x16x32_bf16 a[100:103], a[180:183], v[76:79], a[100:103]
v_exp_f32 v193, v193
v_mfma_f32_16x16x32_bf16 a[100:103], a[176:179], v[72:75], a[100:103]
ds_read_b64_tr_b16 a[190:191], v15 offset:28672
v_cvt_pk_bf16_f32 v102, v192, v193
v_mfma_f32_16x16x32_bf16 a[104:107], a[176:179], v[80:83], a[104:107]
v_exp_f32 v194, v194
v_mfma_f32_16x16x32_bf16 a[104:107], a[180:183], v[84:87], a[104:107]
s_cbranch_vccnz L_hwait
L_hok:
v_mfma_f32_16x16x32_bf16 a[108:111], a[180:183], v[92:95], a[108:111]
v_exp_f32 v195, v195
v_mfma_f32_16x16x32_bf16 a[108:111], a[176:179], v[88:91], a[108:111]
ds_read_b128 a[152:155], v6 offset:32768
v_cvt_pk_bf16_f32 v103, v194, v195
v_mfma_f32_16x16x32_bf16 v[200:203], a[160:163], v[160:163], v[216:219]
v_exp_f32 v196, v196
v_mfma_f32_16x16x32_bf16 v[200:203], a[164:167], v[164:167], v[200:203]
s_waitcnt lgkmcnt(1)
ds_read_b64_tr_b16 a[176:177], v8 offset:32768
v_mfma_f32_16x16x32_bf16 v[200:203], a[168:171], v[168:171], v[200:203]
v_exp_f32 v197, v197
v_mfma_f32_16x16x32_bf16 v[200:203], a[172:175], v[172:175], v[200:203]
ds_read_b64_tr_b16 a[178:179], v8 offset:36864
v_cvt_pk_bf16_f32 v110, v196, v197
v_mfma_f32_16x16x32_bf16 v[204:207], a[172:175], v[188:191], v[220:223]
v_exp_f32 v198, v198
v_mfma_f32_16x16x32_bf16 v[204:207], a[168:171], v[184:187], v[204:207]
s_mov_b32 s82, 0
v_bfrev_b32 v53, 2
v_mfma_f32_16x16x32_bf16 v[204:207], a[164:167], v[180:183], v[204:207]
v_exp_f32 v199, v199
v_mfma_f32_16x16x32_bf16 v[204:207], a[160:163], v[176:179], v[204:207]
ds_read_b128 a[156:159], v7 offset:32768
v_cvt_pk_bf16_f32 v111, v198, v199
v_mfma_f32_16x16x32_bf16 a[112:115], a[184:187], v[64:67], a[112:115]
v_exp_f32 v200, v200
v_mfma_f32_16x16x32_bf16 a[112:115], a[188:191], v[68:71], a[112:115]
ds_read_b64_tr_b16 a[180:181], v8 offset:40960
v_mfma_f32_16x16x32_bf16 a[116:119], a[188:191], v[76:79], a[116:119]
v_exp_f32 v201, v201
v_mfma_f32_16x16x32_bf16 a[116:119], a[184:187], v[72:75], a[116:119]
ds_read_b64_tr_b16 a[182:183], v8 offset:45056
v_cvt_pk_bf16_f32 v118, v200, v201
v_mfma_f32_16x16x32_bf16 a[120:123], a[184:187], v[80:83], a[120:123]
v_exp_f32 v202, v202
v_mfma_f32_16x16x32_bf16 a[120:123], a[188:191], v[84:87], a[120:123]
s_sub_u32 s86, s86, 1
s_cmp_lg_u32 s86, 0
v_mfma_f32_16x16x32_bf16 a[124:127], a[188:191], v[92:95], a[124:127]
v_exp_f32 v203, v203
v_mfma_f32_16x16x32_bf16 a[124:127], a[184:187], v[88:91], a[124:127]
ds_read_b128 a[160:163], v4 offset:36864
v_cvt_pk_bf16_f32 v119, v202, v203
v_smfmac_f32_16x16x64_bf16 a[140:143], v[224:227], v[88:95], v228
s_cbranch_scc1 L_attn_loop
v_mfma_f32_16x16x32_bf16 v[192:195], a[144:147], v[128:131], v[208:211]
v_exp_f32 v204, v204
v_mfma_f32_16x16x32_bf16 v[192:195], a[148:151], v[132:135], v[192:195]
s_waitcnt lgkmcnt(1)
ds_read_b64_tr_b16 a[184:185], v9 offset:32768
v_mfma_f32_16x16x32_bf16 v[192:195], a[152:155], v[136:139], v[192:195]
v_exp_f32 v205, v205
v_mfma_f32_16x16x32_bf16 v[192:195], a[156:159], v[140:143], v[192:195]
ds_read_b64_tr_b16 a[186:187], v9 offset:36864
v_cvt_pk_bf16_f32 v126, v204, v205
v_mfma_f32_16x16x32_bf16 v[196:199], a[156:159], v[156:159], v[212:215]
v_exp_f32 v206, v206
v_mfma_f32_16x16x32_bf16 v[196:199], a[152:155], v[152:155], v[196:199]
s_add_u32 m0, s40, 0
s_mov_b32 s43, 0
v_mfma_f32_16x16x32_bf16 v[196:199], a[148:151], v[148:151], v[196:199]
v_exp_f32 v207, v207
v_mfma_f32_16x16x32_bf16 v[196:199], a[144:147], v[144:147], v[196:199]
ds_read_b128 a[164:167], v5 offset:36864
v_cvt_pk_bf16_f32 v127, v206, v207
v_mfma_f32_16x16x32_bf16 a[0:3], a[176:179], v[96:99], a[0:3]
v_exp_f32 v192, v192
v_mfma_f32_16x16x32_bf16 a[0:3], a[180:183], v[100:103], a[0:3]
ds_read_b64_tr_b16 a[188:189], v9 offset:40960
s_movk_i32 s44, 0
v_mfma_f32_16x16x32_bf16 a[4:7], a[180:183], v[108:111], a[4:7]
v_exp_f32 v193, v193
v_mfma_f32_16x16x32_bf16 a[4:7], a[176:179], v[104:107], a[4:7]
ds_read_b64_tr_b16 a[190:191], v9 offset:45056
v_cvt_pk_bf16_f32 v64, v192, v193
v_mfma_f32_16x16x32_bf16 a[8:11], a[176:179], v[112:115], a[8:11]
v_exp_f32 v194, v194
v_mfma_f32_16x16x32_bf16 a[8:11], a[180:183], v[116:119], a[8:11]
buffer_load_dwordx4 v32, s[16:19], s43 offen lds
v_mfma_f32_16x16x32_bf16 a[12:15], a[180:183], v[124:127], a[12:15]
v_exp_f32 v195, v195
v_mfma_f32_16x16x32_bf16 a[12:15], a[176:179], v[120:123], a[12:15]
ds_read_b128 a[168:171], v6 offset:36864
v_cvt_pk_bf16_f32 v65, v194, v195
v_mfma_f32_16x16x32_bf16 v[200:203], a[144:147], v[160:163], v[216:219]
v_exp_f32 v196, v196
v_mfma_f32_16x16x32_bf16 v[200:203], a[148:151], v[164:167], v[200:203]
s_waitcnt lgkmcnt(1)
ds_read_b64_tr_b16 a[176:177], v10 offset:32768
v_mfma_f32_16x16x32_bf16 v[200:203], a[152:155], v[168:171], v[200:203]
v_exp_f32 v197, v197
v_mfma_f32_16x16x32_bf16 v[200:203], a[156:159], v[172:175], v[200:203]
ds_read_b64_tr_b16 a[178:179], v10 offset:36864
v_cvt_pk_bf16_f32 v72, v196, v197
v_mfma_f32_16x16x32_bf16 v[204:207], a[156:159], v[188:191], v[220:223]
v_exp_f32 v198, v198
v_mfma_f32_16x16x32_bf16 v[204:207], a[152:155], v[184:187], v[204:207]
buffer_load_dwordx4 v33, s[16:19], s43 offen offset:1024 lds
v_mfma_f32_16x16x32_bf16 v[204:207], a[148:151], v[180:183], v[204:207]
v_exp_f32 v199, v199
v_mfma_f32_16x16x32_bf16 v[204:207], a[144:147], v[176:179], v[204:207]
ds_read_b128 a[172:175], v7 offset:36864
v_cvt_pk_bf16_f32 v73, v198, v199
v_smfmac_f32_16x16x64_bf16 a[128:131], v[224:227], v[96:103], v228
buffer_load_dwordx4 a[192:195], v22, s[24:27], s44 offen sc1
v_mfma_f32_16x16x32_bf16 a[16:19], a[184:187], v[96:99], a[16:19]
v_exp_f32 v200, v200
v_mfma_f32_16x16x32_bf16 a[16:19], a[188:191], v[100:103], a[16:19]
ds_read_b64_tr_b16 a[180:181], v10 offset:40960
s_add_u32 s49, s49, 16384
v_mfma_f32_16x16x32_bf16 a[20:23], a[188:191], v[108:111], a[20:23]
v_exp_f32 v201, v201
v_mfma_f32_16x16x32_bf16 a[20:23], a[184:187], v[104:107], a[20:23]
ds_read_b64_tr_b16 a[182:183], v10 offset:45056
v_cvt_pk_bf16_f32 v80, v200, v201
v_mfma_f32_16x16x32_bf16 a[24:27], a[184:187], v[112:115], a[24:27]
v_exp_f32 v202, v202
v_mfma_f32_16x16x32_bf16 a[24:27], a[188:191], v[116:119], a[24:27]
buffer_load_dwordx4 v34, s[16:19], s43 offen offset:2048 lds
v_mfma_f32_16x16x32_bf16 a[28:31], a[188:191], v[124:127], a[28:31]
v_exp_f32 v203, v203
v_mfma_f32_16x16x32_bf16 a[28:31], a[184:187], v[120:123], a[28:31]
ds_read_b128 a[144:147], v4 offset:40960
v_cvt_pk_bf16_f32 v81, v202, v203
v_mfma_f32_16x16x32_bf16 v[192:195], a[160:163], v[128:131], v[208:211]
v_exp_f32 v204, v204
v_mfma_f32_16x16x32_bf16 v[192:195], a[164:167], v[132:135], v[192:195]
s_waitcnt lgkmcnt(1)
ds_read_b64_tr_b16 a[184:185], v11 offset:32768
v_mfma_f32_16x16x32_bf16 v[192:195], a[168:171], v[136:139], v[192:195]
v_exp_f32 v205, v205
v_mfma_f32_16x16x32_bf16 v[192:195], a[172:175], v[140:143], v[192:195]
ds_read_b64_tr_b16 a[186:187], v11 offset:36864
v_cvt_pk_bf16_f32 v88, v204, v205
v_mfma_f32_16x16x32_bf16 v[196:199], a[172:175], v[156:159], v[212:215]
v_exp_f32 v206, v206
v_mfma_f32_16x16x32_bf16 v[196:199], a[168:171], v[152:155], v[196:199]
buffer_load_dwordx4 v35, s[16:19], s43 offen offset:3072 lds
v_mfma_f32_16x16x32_bf16 v[196:199], a[164:167], v[148:151], v[196:199]
v_exp_f32 v207, v207
v_mfma_f32_16x16x32_bf16 v[196:199], a[160:163], v[144:147], v[196:199]
ds_read_b128 a[148:151], v5 offset:40960
v_cvt_pk_bf16_f32 v89, v206, v207
v_mfma_f32_16x16x32_bf16 a[32:35], a[176:179], v[96:99], a[32:35]
v_exp_f32 v192, v192
v_mfma_f32_16x16x32_bf16 a[32:35], a[180:183], v[100:103], a[32:35]
ds_read_b64_tr_b16 a[188:189], v11 offset:40960
s_add_u32 m0, s42, 0
v_mfma_f32_16x16x32_bf16 a[36:39], a[180:183], v[108:111], a[36:39]
v_exp_f32 v193, v193
v_mfma_f32_16x16x32_bf16 a[36:39], a[176:179], v[104:107], a[36:39]
ds_read_b64_tr_b16 a[190:191], v11 offset:45056
v_cvt_pk_bf16_f32 v66, v192, v193
v_mfma_f32_16x16x32_bf16 a[40:43], a[176:179], v[112:115], a[40:43]
v_exp_f32 v194, v194
v_mfma_f32_16x16x32_bf16 a[40:43], a[180:183], v[116:119], a[40:43]
buffer_load_dwordx4 v20, s[12:15], s49 offen lds
v_mfma_f32_16x16x32_bf16 a[44:47], a[180:183], v[124:127], a[44:47]
v_exp_f32 v195, v195
v_mfma_f32_16x16x32_bf16 a[44:47], a[176:179], v[120:123], a[44:47]
ds_read_b128 a[152:155], v6 offset:40960
v_cvt_pk_bf16_f32 v67, v194, v195
v_mfma_f32_16x16x32_bf16 v[200:203], a[160:163], v[160:163], v[216:219]
v_exp_f32 v196, v196
v_mfma_f32_16x16x32_bf16 v[200:203], a[164:167], v[164:167], v[200:203]
s_waitcnt lgkmcnt(1)
ds_read_b64_tr_b16 a[176:177], v12 offset:32768
v_mfma_f32_16x16x32_bf16 v[200:203], a[168:171], v[168:171], v[200:203]
v_exp_f32 v197, v197
v_mfma_f32_16x16x32_bf16 v[200:203], a[172:175], v[172:175], v[200:203]
ds_read_b64_tr_b16 a[178:179], v12 offset:36864
v_cvt_pk_bf16_f32 v74, v196, v197
v_mfma_f32_16x16x32_bf16 v[204:207], a[172:175], v[188:191], v[220:223]
v_exp_f32 v198, v198
v_mfma_f32_16x16x32_bf16 v[204:207], a[168:171], v[184:187], v[204:207]
buffer_load_dwordx4 v21, s[12:15], s49 offen offset:1024 lds
v_mfma_f32_16x16x32_bf16 v[204:207], a[164:167], v[180:183], v[204:207]
v_exp_f32 v199, v199
v_mfma_f32_16x16x32_bf16 v[204:207], a[160:163], v[176:179], v[204:207]
ds_read_b128 a[156:159], v7 offset:40960
v_cvt_pk_bf16_f32 v75, v198, v199
v_smfmac_f32_16x16x64_bf16 a[132:135], v[224:227], v[104:111], v228
buffer_load_dwordx4 a[196:199], v22, s[24:27], s44 offen offset:1024 sc1
v_mfma_f32_16x16x32_bf16 a[48:51], a[184:187], v[96:99], a[48:51]
v_exp_f32 v200, v200
v_mfma_f32_16x16x32_bf16 a[48:51], a[188:191], v[100:103], a[48:51]
ds_read_b64_tr_b16 a[180:181], v12 offset:40960
v_lshlrev_b32 v55, 3, v0
v_mfma_f32_16x16x32_bf16 a[52:55], a[188:191], v[108:111], a[52:55]
v_exp_f32 v201, v201
v_mfma_f32_16x16x32_bf16 a[52:55], a[184:187], v[104:107], a[52:55]
ds_read_b64_tr_b16 a[182:183], v12 offset:45056
v_cvt_pk_bf16_f32 v82, v200, v201
v_mfma_f32_16x16x32_bf16 a[56:59], a[184:187], v[112:115], a[56:59]
v_exp_f32 v202, v202
v_mfma_f32_16x16x32_bf16 a[56:59], a[188:191], v[116:119], a[56:59]
buffer_load_dwordx4 v20, s[12:15], s49 offen offset:2048 lds
v_mfma_f32_16x16x32_bf16 a[60:63], a[188:191], v[124:127], a[60:63]
v_exp_f32 v203, v203
v_mfma_f32_16x16x32_bf16 a[60:63], a[184:187], v[120:123], a[60:63]
ds_read_b128 a[160:163], v4 offset:45056
v_cvt_pk_bf16_f32 v83, v202, v203
v_mfma_f32_16x16x32_bf16 v[192:195], a[144:147], v[128:131], v[208:211]
v_exp_f32 v204, v204
v_mfma_f32_16x16x32_bf16 v[192:195], a[148:151], v[132:135], v[192:195]
s_waitcnt lgkmcnt(1)
ds_read_b64_tr_b16 a[184:185], v13 offset:32768
v_mfma_f32_16x16x32_bf16 v[192:195], a[152:155], v[136:139], v[192:195]
v_exp_f32 v205, v205
v_mfma_f32_16x16x32_bf16 v[192:195], a[156:159], v[140:143], v[192:195]
ds_read_b64_tr_b16 a[186:187], v13 offset:36864
v_cvt_pk_bf16_f32 v90, v204, v205
v_mfma_f32_16x16x32_bf16 v[196:199], a[156:159], v[156:159], v[212:215]
v_exp_f32 v206, v206
v_mfma_f32_16x16x32_bf16 v[196:199], a[152:155], v[152:155], v[196:199]
buffer_load_dwordx4 v21, s[12:15], s49 offen offset:3072 lds
v_mfma_f32_16x16x32_bf16 v[196:199], a[148:151], v[148:151], v[196:199]
v_exp_f32 v207, v207
v_mfma_f32_16x16x32_bf16 v[196:199], a[144:147], v[144:147], v[196:199]
ds_read_b128 a[164:167], v5 offset:45056
v_cvt_pk_bf16_f32 v91, v206, v207
v_mfma_f32_16x16x32_bf16 a[64:67], a[176:179], v[96:99], a[64:67]
v_exp_f32 v192, v192
v_mfma_f32_16x16x32_bf16 a[64:67], a[180:183], v[100:103], a[64:67]
ds_read_b64_tr_b16 a[188:189], v13 offset:40960
v_sub_u32 v54, v22, v55
v_mfma_f32_16x16x32_bf16 a[68:71], a[180:183], v[108:111], a[68:71]
v_exp_f32 v193, v193
v_mfma_f32_16x16x32_bf16 a[68:71], a[176:179], v[104:107], a[68:71]
ds_read_b64_tr_b16 a[190:191], v13 offset:45056
v_cvt_pk_bf16_f32 v68, v192, v193
v_mfma_f32_16x16x32_bf16 a[72:75], a[176:179], v[112:115], a[72:75]
v_exp_f32 v194, v194
v_mfma_f32_16x16x32_bf16 a[72:75], a[180:183], v[116:119], a[72:75]
buffer_load_dwordx4 a[200:203], v23, s[24:27], s44 offen sc1
v_mfma_f32_16x16x32_bf16 a[76:79], a[180:183], v[124:127], a[76:79]
v_exp_f32 v195, v195
v_mfma_f32_16x16x32_bf16 a[76:79], a[176:179], v[120:123], a[76:79]
ds_read_b128 a[168:171], v6 offset:45056
v_cvt_pk_bf16_f32 v69, v194, v195
v_mfma_f32_16x16x32_bf16 v[200:203], a[144:147], v[160:163], v[216:219]
v_exp_f32 v196, v196
v_mfma_f32_16x16x32_bf16 v[200:203], a[148:151], v[164:167], v[200:203]
s_waitcnt lgkmcnt(1)
ds_read_b64_tr_b16 a[176:177], v14 offset:32768
v_mfma_f32_16x16x32_bf16 v[200:203], a[152:155], v[168:171], v[200:203]
v_exp_f32 v197, v197
v_mfma_f32_16x16x32_bf16 v[200:203], a[156:159], v[172:175], v[200:203]
ds_read_b64_tr_b16 a[178:179], v14 offset:36864
v_cvt_pk_bf16_f32 v76, v196, v197
v_mfma_f32_16x16x32_bf16 v[204:207], a[156:159], v[188:191], v[220:223]
v_exp_f32 v198, v198
v_mfma_f32_16x16x32_bf16 v[204:207], a[152:155], v[184:187], v[204:207]
buffer_load_dwordx4 a[204:207], v23, s[24:27], s44 offen offset:1024 sc1
v_mfma_f32_16x16x32_bf16 v[204:207], a[148:151], v[180:183], v[204:207]
v_exp_f32 v199, v199
v_mfma_f32_16x16x32_bf16 v[204:207], a[144:147], v[176:179], v[204:207]
ds_read_b128 a[172:175], v7 offset:45056
v_cvt_pk_bf16_f32 v77, v198, v199
v_smfmac_f32_16x16x64_bf16 a[136:139], v[224:227], v[112:119], v228
s_movk_i32 s44, 2048
buffer_load_dwordx4 a[208:211], v22, s[24:27], s44 offen sc1
v_mfma_f32_16x16x32_bf16 a[80:83], a[184:187], v[96:99], a[80:83]
v_exp_f32 v200, v200
v_mfma_f32_16x16x32_bf16 a[80:83], a[188:191], v[100:103], a[80:83]
ds_read_b64_tr_b16 a[180:181], v14 offset:40960
v_sub_u32 v55, v23, v55
v_mfma_f32_16x16x32_bf16 a[84:87], a[188:191], v[108:111], a[84:87]
v_exp_f32 v201, v201
v_mfma_f32_16x16x32_bf16 a[84:87], a[184:187], v[104:107], a[84:87]
ds_read_b64_tr_b16 a[182:183], v14 offset:45056
v_cvt_pk_bf16_f32 v84, v200, v201
v_mfma_f32_16x16x32_bf16 a[88:91], a[184:187], v[112:115], a[88:91]
v_exp_f32 v202, v202
v_mfma_f32_16x16x32_bf16 a[88:91], a[188:191], v[116:119], a[88:91]
s_waitcnt vmcnt(13)
s_barrier
v_mfma_f32_16x16x32_bf16 a[92:95], a[188:191], v[124:127], a[92:95]
v_exp_f32 v203, v203
v_mfma_f32_16x16x32_bf16 a[92:95], a[184:187], v[120:123], a[92:95]
ds_read_b128 a[144:147], v4 offset:49152
v_cvt_pk_bf16_f32 v85, v202, v203
v_mfma_f32_16x16x32_bf16 v[192:195], a[160:163], v[128:131], v[208:211]
v_exp_f32 v204, v204
v_mfma_f32_16x16x32_bf16 v[192:195], a[164:167], v[132:135], v[192:195]
s_waitcnt lgkmcnt(1)
ds_read_b64_tr_b16 a[184:185], v15 offset:32768
v_mfma_f32_16x16x32_bf16 v[192:195], a[168:171], v[136:139], v[192:195]
v_exp_f32 v205, v205
v_mfma_f32_16x16x32_bf16 v[192:195], a[172:175], v[140:143], v[192:195]
ds_read_b64_tr_b16 a[186:187], v15 offset:36864
v_cvt_pk_bf16_f32 v92, v204, v205
v_mfma_f32_16x16x32_bf16 v[196:199], a[172:175], v[156:159], v[212:215]
v_exp_f32 v206, v206
v_mfma_f32_16x16x32_bf16 v[196:199], a[168:171], v[152:155], v[196:199]
buffer_load_dwordx4 a[212:215], v22, s[24:27], s44 offen offset:1024 sc1
v_mfma_f32_16x16x32_bf16 v[196:199], a[164:167], v[148:151], v[196:199]
v_exp_f32 v207, v207
v_mfma_f32_16x16x32_bf16 v[196:199], a[160:163], v[144:147], v[196:199]
ds_read_b128 a[148:151], v5 offset:49152
v_cvt_pk_bf16_f32 v93, v206, v207
v_mfma_f32_16x16x32_bf16 a[96:99], a[176:179], v[96:99], a[96:99]
v_exp_f32 v192, v192
v_mfma_f32_16x16x32_bf16 a[96:99], a[180:183], v[100:103], a[96:99]
ds_read_b64_tr_b16 a[188:189], v15 offset:40960
v_mfma_f32_16x16x32_bf16 a[100:103], a[180:183], v[108:111], a[100:103]
v_exp_f32 v193, v193
v_mfma_f32_16x16x32_bf16 a[100:103], a[176:179], v[104:107], a[100:103]
ds_read_b64_tr_b16 a[190:191], v15 offset:45056
v_cvt_pk_bf16_f32 v70, v192, v193
v_mfma_f32_16x16x32_bf16 a[104:107], a[176:179], v[112:115], a[104:107]
v_exp_f32 v194, v194
v_mfma_f32_16x16x32_bf16 a[104:107], a[180:183], v[116:119], a[104:107]
buffer_load_dwordx4 a[216:219], v23, s[24:27], s44 offen sc1
v_mfma_f32_16x16x32_bf16 a[108:111], a[180:183], v[124:127], a[108:111]
v_exp_f32 v195, v195
v_mfma_f32_16x16x32_bf16 a[108:111], a[176:179], v[120:123], a[108:111]
ds_read_b128 a[152:155], v6 offset:49152
v_cvt_pk_bf16_f32 v71, v194, v195
v_mfma_f32_16x16x32_bf16 v[200:203], a[160:163], v[160:163], v[216:219]
v_exp_f32 v196, v196
v_mfma_f32_16x16x32_bf16 v[200:203], a[164:167], v[164:167], v[200:203]
s_waitcnt lgkmcnt(1)
ds_read_b64_tr_b16 a[176:177], v8 offset:49152
v_mfma_f32_16x16x32_bf16 v[200:203], a[168:171], v[168:171], v[200:203]
v_exp_f32 v197, v197
v_mfma_f32_16x16x32_bf16 v[200:203], a[172:175], v[172:175], v[200:203]
ds_read_b64_tr_b16 a[178:179], v8 offset:53248
v_cvt_pk_bf16_f32 v78, v196, v197
v_mfma_f32_16x16x32_bf16 v[204:207], a[172:175], v[188:191], v[220:223]
v_exp_f32 v198, v198
v_mfma_f32_16x16x32_bf16 v[204:207], a[168:171], v[184:187], v[204:207]
buffer_load_dwordx4 a[220:223], v23, s[24:27], s44 offen offset:1024 sc1
v_mfma_f32_16x16x32_bf16 v[204:207], a[164:167], v[180:183], v[204:207]
v_exp_f32 v199, v199
v_mfma_f32_16x16x32_bf16 v[204:207], a[160:163], v[176:179], v[204:207]
ds_read_b128 a[156:159], v7 offset:49152
v_cvt_pk_bf16_f32 v79, v198, v199
v_smfmac_f32_16x16x64_bf16 a[140:143], v[224:227], v[120:127], v228
s_movk_i32 s44, 4096
buffer_load_dwordx4 a[224:227], v22, s[24:27], s44 offen sc1
v_mfma_f32_16x16x32_bf16 a[112:115], a[184:187], v[96:99], a[112:115]
v_exp_f32 v200, v200
v_mfma_f32_16x16x32_bf16 a[112:115], a[188:191], v[100:103], a[112:115]
ds_read_b64_tr_b16 a[180:181], v8 offset:57344
v_mfma_f32_16x16x32_bf16 a[116:119], a[188:191], v[108:111], a[116:119]
v_exp_f32 v201, v201
v_mfma_f32_16x16x32_bf16 a[116:119], a[184:187], v[104:107], a[116:119]
ds_read_b64_tr_b16 a[182:183], v8 offset:61440
v_cvt_pk_bf16_f32 v86, v200, v201
v_mfma_f32_16x16x32_bf16 a[120:123], a[184:187], v[112:115], a[120:123]
v_exp_f32 v202, v202
v_mfma_f32_16x16x32_bf16 a[120:123], a[188:191], v[116:119], a[120:123]
buffer_load_dwordx4 a[228:231], v22, s[24:27], s44 offen offset:1024 sc1
v_mfma_f32_16x16x32_bf16 a[124:127], a[188:191], v[124:127], a[124:127]
v_exp_f32 v203, v203
v_mfma_f32_16x16x32_bf16 a[124:127], a[184:187], v[120:123], a[124:127]
ds_read_b128 a[160:163], v4 offset:53248
v_cvt_pk_bf16_f32 v87, v202, v203
v_mfma_f32_16x16x32_bf16 v[192:195], a[144:147], v[128:131], v[208:211]
v_exp_f32 v204, v204
v_mfma_f32_16x16x32_bf16 v[192:195], a[148:151], v[132:135], v[192:195]
s_waitcnt lgkmcnt(1)
ds_read_b64_tr_b16 a[184:185], v9 offset:49152
v_mfma_f32_16x16x32_bf16 v[192:195], a[152:155], v[136:139], v[192:195]
v_exp_f32 v205, v205
v_mfma_f32_16x16x32_bf16 v[192:195], a[156:159], v[140:143], v[192:195]
ds_read_b64_tr_b16 a[186:187], v9 offset:53248
v_cvt_pk_bf16_f32 v94, v204, v205
v_mfma_f32_16x16x32_bf16 v[196:199], a[156:159], v[156:159], v[212:215]
v_exp_f32 v206, v206
v_mfma_f32_16x16x32_bf16 v[196:199], a[152:155], v[152:155], v[196:199]
s_add_u32 m0, s40, 16384
s_mov_b32 s43, 196608
v_mfma_f32_16x16x32_bf16 v[196:199], a[148:151], v[148:151], v[196:199]
v_exp_f32 v207, v207
v_mfma_f32_16x16x32_bf16 v[196:199], a[144:147], v[144:147], v[196:199]
ds_read_b128 a[164:167], v5 offset:53248
v_cvt_pk_bf16_f32 v95, v206, v207
v_mfma_f32_16x16x32_bf16 a[0:3], a[176:179], v[64:67], a[0:3]
v_exp_f32 v192, v192
v_mfma_f32_16x16x32_bf16 a[0:3], a[180:183], v[68:71], a[0:3]
ds_read_b64_tr_b16 a[188:189], v9 offset:57344
buffer_load_dwordx4 a[232:235], v23, s[24:27], s44 offen sc1
v_mfma_f32_16x16x32_bf16 a[4:7], a[180:183], v[76:79], a[4:7]
v_exp_f32 v193, v193
v_mfma_f32_16x16x32_bf16 a[4:7], a[176:179], v[72:75], a[4:7]
ds_read_b64_tr_b16 a[190:191], v9 offset:61440
v_cvt_pk_bf16_f32 v96, v192, v193
v_mfma_f32_16x16x32_bf16 a[8:11], a[176:179], v[80:83], a[8:11]
v_exp_f32 v194, v194
v_mfma_f32_16x16x32_bf16 a[8:11], a[180:183], v[84:87], a[8:11]
buffer_load_dwordx4 v32, s[16:19], s43 offen lds
v_mfma_f32_16x16x32_bf16 a[12:15], a[180:183], v[92:95], a[12:15]
v_exp_f32 v195, v195
v_mfma_f32_16x16x32_bf16 a[12:15], a[176:179], v[88:91], a[12:15]
ds_read_b128 a[168:171], v6 offset:53248
v_cvt_pk_bf16_f32 v97, v194, v195
v_mfma_f32_16x16x32_bf16 v[200:203], a[144:147], v[160:163], v[216:219]
v_exp_f32 v196, v196
v_mfma_f32_16x16x32_bf16 v[200:203], a[148:151], v[164:167], v[200:203]
s_waitcnt lgkmcnt(1)
ds_read_b64_tr_b16 a[176:177], v10 offset:49152
v_mfma_f32_16x16x32_bf16 v[200:203], a[152:155], v[168:171], v[200:203]
v_exp_f32 v197, v197
v_mfma_f32_16x16x32_bf16 v[200:203], a[156:159], v[172:175], v[200:203]
ds_read_b64_tr_b16 a[178:179], v10 offset:53248
v_cvt_pk_bf16_f32 v104, v196, v197
v_mfma_f32_16x16x32_bf16 v[204:207], a[156:159], v[188:191], v[220:223]
v_exp_f32 v198, v198
v_mfma_f32_16x16x32_bf16 v[204:207], a[152:155], v[184:187], v[204:207]
buffer_load_dwordx4 v33, s[16:19], s43 offen offset:1024 lds
v_mfma_f32_16x16x32_bf16 v[204:207], a[148:151], v[180:183], v[204:207]
v_exp_f32 v199, v199
v_mfma_f32_16x16x32_bf16 v[204:207], a[144:147], v[176:179], v[204:207]
ds_read_b128 a[172:175], v7 offset:53248
v_cvt_pk_bf16_f32 v105, v198, v199
v_smfmac_f32_16x16x64_bf16 a[128:131], v[224:227], v[64:71], v228
buffer_load_dwordx4 a[236:239], v23, s[24:27], s44 offen offset:1024 sc1
v_mfma_f32_16x16x32_bf16 a[16:19], a[184:187], v[64:67], a[16:19]
v_exp_f32 v200, v200
v_mfma_f32_16x16x32_bf16 a[16:19], a[188:191], v[68:71], a[16:19]
ds_read_b64_tr_b16 a[180:181], v10 offset:57344
s_movk_i32 s44, 8192
buffer_load_dwordx4 a[240:243], v22, s[24:27], s44 offen sc1
v_mfma_f32_16x16x32_bf16 a[20:23], a[188:191], v[76:79], a[20:23]
v_exp_f32 v201, v201
v_mfma_f32_16x16x32_bf16 a[20:23], a[184:187], v[72:75], a[20:23]
ds_read_b64_tr_b16 a[182:183], v10 offset:61440
v_cvt_pk_bf16_f32 v112, v200, v201
v_mfma_f32_16x16x32_bf16 a[24:27], a[184:187], v[80:83], a[24:27]
v_exp_f32 v202, v202
v_mfma_f32_16x16x32_bf16 a[24:27], a[188:191], v[84:87], a[24:27]
buffer_load_dwordx4 v34, s[16:19], s43 offen offset:2048 lds
v_mfma_f32_16x16x32_bf16 a[28:31], a[188:191], v[92:95], a[28:31]
v_exp_f32 v203, v203
v_mfma_f32_16x16x32_bf16 a[28:31], a[184:187], v[88:91], a[28:31]
ds_read_b128 a[144:147], v4 offset:57344
v_cvt_pk_bf16_f32 v113, v202, v203
v_mfma_f32_16x16x32_bf16 v[192:195], a[160:163], v[128:131], v[208:211]
v_exp_f32 v204, v204
v_mfma_f32_16x16x32_bf16 v[192:195], a[164:167], v[132:135], v[192:195]
s_waitcnt lgkmcnt(1)
ds_read_b64_tr_b16 a[184:185], v11 offset:49152
v_mfma_f32_16x16x32_bf16 v[192:195], a[168:171], v[136:139], v[192:195]
v_exp_f32 v205, v205
v_mfma_f32_16x16x32_bf16 v[192:195], a[172:175], v[140:143], v[192:195]
ds_read_b64_tr_b16 a[186:187], v11 offset:53248
v_cvt_pk_bf16_f32 v120, v204, v205
v_mfma_f32_16x16x32_bf16 v[196:199], a[172:175], v[156:159], v[212:215]
v_exp_f32 v206, v206
v_mfma_f32_16x16x32_bf16 v[196:199], a[168:171], v[152:155], v[196:199]
buffer_load_dwordx4 v35, s[16:19], s43 offen offset:3072 lds
v_mfma_f32_16x16x32_bf16 v[196:199], a[164:167], v[148:151], v[196:199]
v_exp_f32 v207, v207
v_mfma_f32_16x16x32_bf16 v[196:199], a[160:163], v[144:147], v[196:199]
ds_read_b128 a[148:151], v5 offset:57344
v_cvt_pk_bf16_f32 v121, v206, v207
v_mfma_f32_16x16x32_bf16 a[32:35], a[176:179], v[64:67], a[32:35]
v_exp_f32 v192, v192
v_mfma_f32_16x16x32_bf16 a[32:35], a[180:183], v[68:71], a[32:35]
ds_read_b64_tr_b16 a[188:189], v11 offset:57344
s_add_u32 m0, s40, 81920
s_mov_b32 s43, 262144
v_mfma_f32_16x16x32_bf16 a[36:39], a[180:183], v[76:79], a[36:39]
v_exp_f32 v193, v193
v_mfma_f32_16x16x32_bf16 a[36:39], a[176:179], v[72:75], a[36:39]
ds_read_b64_tr_b16 a[190:191], v11 offset:61440
v_cvt_pk_bf16_f32 v98, v192, v193
v_mfma_f32_16x16x32_bf16 a[40:43], a[176:179], v[80:83], a[40:43]
v_exp_f32 v194, v194
v_mfma_f32_16x16x32_bf16 a[40:43], a[180:183], v[84:87], a[40:43]
buffer_load_dwordx4 v32, s[16:19], s43 offen lds
v_mfma_f32_16x16x32_bf16 a[44:47], a[180:183], v[92:95], a[44:47]
v_exp_f32 v195, v195
v_mfma_f32_16x16x32_bf16 a[44:47], a[176:179], v[88:91], a[44:47]
ds_read_b128 a[152:155], v6 offset:57344
v_cvt_pk_bf16_f32 v99, v194, v195
v_mfma_f32_16x16x32_bf16 v[200:203], a[160:163], v[160:163], v[216:219]
v_exp_f32 v196, v196
v_mfma_f32_16x16x32_bf16 v[200:203], a[164:167], v[164:167], v[200:203]
s_waitcnt lgkmcnt(1)
ds_read_b64_tr_b16 a[176:177], v12 offset:49152
L_pad9:
s_cbranch_execz L_walked
v_mfma_f32_16x16x32_bf16 v[200:203], a[168:171], v[168:171], v[200:203]
v_exp_f32 v197, v197
v_mfma_f32_16x16x32_bf16 v[200:203], a[172:175], v[172:175], v[200:203]
ds_read_b64_tr_b16 a[178:179], v12 offset:53248
v_cvt_pk_bf16_f32 v106, v196, v197
v_mfma_f32_16x16x32_bf16 v[204:207], a[172:175], v[188:191], v[220:223]
v_exp_f32 v198, v198
v_mfma_f32_16x16x32_bf16 v[204:207], a[168:171], v[184:187], v[204:207]
buffer_load_dwordx4 v33, s[16:19], s43 offen offset:1024 lds
v_mfma_f32_16x16x32_bf16 v[204:207], a[164:167], v[180:183], v[204:207]
v_exp_f32 v199, v199
v_mfma_f32_16x16x32_bf16 v[204:207], a[160:163], v[176:179], v[204:207]
ds_read_b128 a[156:159], v7 offset:57344
v_cvt_pk_bf16_f32 v107, v198, v199
v_smfmac_f32_16x16x64_bf16 a[132:135], v[224:227], v[72:79], v228
buffer_load_dwordx2 a[244:245], v54, s[24:27], s44 offen offset:1024 sc1
v_mfma_f32_16x16x32_bf16 a[48:51], a[184:187], v[64:67], a[48:51]
v_exp_f32 v200, v200
v_mfma_f32_16x16x32_bf16 a[48:51], a[188:191], v[68:71], a[48:51]
ds_read_b64_tr_b16 a[180:181], v12 offset:57344
buffer_load_dwordx2 a[246:247], v54, s[24:27], s44 offen offset:1536 sc1
v_mfma_f32_16x16x32_bf16 a[52:55], a[188:191], v[76:79], a[52:55]
v_exp_f32 v201, v201
v_mfma_f32_16x16x32_bf16 a[52:55], a[184:187], v[72:75], a[52:55]
ds_read_b64_tr_b16 a[182:183], v12 offset:61440
v_cvt_pk_bf16_f32 v114, v200, v201
v_mfma_f32_16x16x32_bf16 a[56:59], a[184:187], v[80:83], a[56:59]
v_exp_f32 v202, v202
v_mfma_f32_16x16x32_bf16 a[56:59], a[188:191], v[84:87], a[56:59]
buffer_load_dwordx4 v34, s[16:19], s43 offen offset:2048 lds
v_mfma_f32_16x16x32_bf16 a[60:63], a[188:191], v[92:95], a[60:63]
v_exp_f32 v203, v203
v_mfma_f32_16x16x32_bf16 a[60:63], a[184:187], v[88:91], a[60:63]
ds_read_b128 a[160:163], v4 offset:61440
v_cvt_pk_bf16_f32 v115, v202, v203
v_mfma_f32_16x16x32_bf16 v[192:195], a[144:147], v[128:131], v[208:211]
v_exp_f32 v204, v204
v_mfma_f32_16x16x32_bf16 v[192:195], a[148:151], v[132:135], v[192:195]
s_waitcnt lgkmcnt(1)
ds_read_b64_tr_b16 a[184:185], v13 offset:49152
v_mfma_f32_16x16x32_bf16 v[192:195], a[152:155], v[136:139], v[192:195]
v_exp_f32 v205, v205
v_mfma_f32_16x16x32_bf16 v[192:195], a[156:159], v[140:143], v[192:195]
ds_read_b64_tr_b16 a[186:187], v13 offset:53248
v_cvt_pk_bf16_f32 v122, v204, v205
v_mfma_f32_16x16x32_bf16 v[196:199], a[156:159], v[156:159], v[212:215]
v_exp_f32 v206, v206
v_mfma_f32_16x16x32_bf16 v[196:199], a[152:155], v[152:155], v[196:199]
buffer_load_dwordx4 v35, s[16:19], s43 offen offset:3072 lds
v_mfma_f32_16x16x32_bf16 v[196:199], a[148:151], v[148:151], v[196:199]
v_exp_f32 v207, v207
v_mfma_f32_16x16x32_bf16 v[196:199], a[144:147], v[144:147], v[196:199]
ds_read_b128 a[164:167], v5 offset:61440
v_cvt_pk_bf16_f32 v123, v206, v207
v_mfma_f32_16x16x32_bf16 a[64:67], a[176:179], v[64:67], a[64:67]
v_exp_f32 v192, v192
v_mfma_f32_16x16x32_bf16 a[64:67], a[180:183], v[68:71], a[64:67]
ds_read_b64_tr_b16 a[188:189], v13 offset:57344
buffer_load_dwordx4 a[248:251], v23, s[24:27], s44 offen sc1
v_mfma_f32_16x16x32_bf16 a[68:71], a[180:183], v[76:79], a[68:71]
v_exp_f32 v193, v193
v_mfma_f32_16x16x32_bf16 a[68:71], a[176:179], v[72:75], a[68:71]
ds_read_b64_tr_b16 a[190:191], v13 offset:61440
v_cvt_pk_bf16_f32 v100, v192, v193
v_mfma_f32_16x16x32_bf16 a[72:75], a[176:179], v[80:83], a[72:75]
v_exp_f32 v194, v194
v_mfma_f32_16x16x32_bf16 a[72:75], a[180:183], v[84:87], a[72:75]
buffer_load_dwordx2 a[252:253], v55, s[24:27], s44 offen offset:1024 sc1
v_mfma_f32_16x16x32_bf16 a[76:79], a[180:183], v[92:95], a[76:79]
v_exp_f32 v195, v195
v_mfma_f32_16x16x32_bf16 a[76:79], a[176:179], v[88:91], a[76:79]
ds_read_b128 a[168:171], v6 offset:61440
v_cvt_pk_bf16_f32 v101, v194, v195
v_mfma_f32_16x16x32_bf16 v[200:203], a[144:147], v[160:163], v[216:219]
v_exp_f32 v196, v196
v_mfma_f32_16x16x32_bf16 v[200:203], a[148:151], v[164:167], v[200:203]
s_waitcnt lgkmcnt(1)
ds_read_b64_tr_b16 a[176:177], v14 offset:49152
v_mfma_f32_16x16x32_bf16 v[200:203], a[152:155], v[168:171], v[200:203]
v_exp_f32 v197, v197
v_mfma_f32_16x16x32_bf16 v[200:203], a[156:159], v[172:175], v[200:203]
ds_read_b64_tr_b16 a[178:179], v14 offset:53248
v_cvt_pk_bf16_f32 v108, v196, v197
v_mfma_f32_16x16x32_bf16 v[204:207], a[156:159], v[188:191], v[220:223]
v_exp_f32 v198, v198
v_mfma_f32_16x16x32_bf16 v[204:207], a[152:155], v[184:187], v[204:207]
buffer_load_dwordx2 a[254:255], v55, s[24:27], s44 offen offset:1536 sc1
v_mfma_f32_16x16x32_bf16 v[204:207], a[148:151], v[180:183], v[204:207]
v_exp_f32 v199, v199
v_mfma_f32_16x16x32_bf16 v[204:207], a[144:147], v[176:179], v[204:207]
ds_read_b128 a[172:175], v7 offset:61440
v_cvt_pk_bf16_f32 v109, v198, v199
v_smfmac_f32_16x16x64_bf16 a[136:139], v[224:227], v[80:87], v228
s_movk_i32 s44, 12288
buffer_load_dwordx2 v[240:241], v54, s[24:27], s44 offen sc1
v_mfma_f32_16x16x32_bf16 a[80:83], a[184:187], v[64:67], a[80:83]
v_exp_f32 v200, v200
v_mfma_f32_16x16x32_bf16 a[80:83], a[188:191], v[68:71], a[80:83]
ds_read_b64_tr_b16 a[180:181], v14 offset:57344
buffer_load_dwordx2 v[242:243], v54, s[24:27], s44 offen offset:512 sc1
v_mfma_f32_16x16x32_bf16 a[84:87], a[188:191], v[76:79], a[84:87]
v_exp_f32 v201, v201
v_mfma_f32_16x16x32_bf16 a[84:87], a[184:187], v[72:75], a[84:87]
ds_read_b64_tr_b16 a[182:183], v14 offset:61440
v_cvt_pk_bf16_f32 v116, v200, v201
v_mfma_f32_16x16x32_bf16 a[88:91], a[184:187], v[80:83], a[88:91]
v_exp_f32 v202, v202
v_mfma_f32_16x16x32_bf16 a[88:91], a[188:191], v[84:87], a[88:91]
s_waitcnt vmcnt(26)
s_barrier
v_mfma_f32_16x16x32_bf16 a[92:95], a[188:191], v[92:95], a[92:95]
v_exp_f32 v203, v203
v_mfma_f32_16x16x32_bf16 a[92:95], a[184:187], v[88:91], a[92:95]
s_add_u32 m0, s40, 32768
s_mov_b32 s43, 327680
v_cvt_pk_bf16_f32 v117, v202, v203
v_mfma_f32_16x16x32_bf16 v[192:195], a[160:163], v[128:131], v[208:211]
v_exp_f32 v204, v204
v_mfma_f32_16x16x32_bf16 v[192:195], a[164:167], v[132:135], v[192:195]
s_waitcnt lgkmcnt(0)
ds_read_b64_tr_b16 a[184:185], v15 offset:49152
v_mfma_f32_16x16x32_bf16 v[192:195], a[168:171], v[136:139], v[192:195]
v_exp_f32 v205, v205
v_mfma_f32_16x16x32_bf16 v[192:195], a[172:175], v[140:143], v[192:195]
ds_read_b64_tr_b16 a[186:187], v15 offset:53248
v_cvt_pk_bf16_f32 v124, v204, v205
v_mfma_f32_16x16x32_bf16 v[196:199], a[172:175], v[156:159], v[212:215]
v_exp_f32 v206, v206
v_mfma_f32_16x16x32_bf16 v[196:199], a[168:171], v[152:155], v[196:199]
buffer_load_dwordx4 v32, s[16:19], s43 offen lds
v_mfma_f32_16x16x32_bf16 v[196:199], a[164:167], v[148:151], v[196:199]
v_exp_f32 v207, v207
v_mfma_f32_16x16x32_bf16 v[196:199], a[160:163], v[144:147], v[196:199]
buffer_load_dwordx4 v[244:247], v22, s[24:27], s44 offen offset:1024 sc1
v_cvt_pk_bf16_f32 v125, v206, v207
v_mfma_f32_16x16x32_bf16 a[96:99], a[176:179], v[64:67], a[96:99]
v_exp_f32 v192, v192
v_mfma_f32_16x16x32_bf16 a[96:99], a[180:183], v[68:71], a[96:99]
ds_read_b64_tr_b16 a[188:189], v15 offset:57344
buffer_load_dwordx4 v33, s[16:19], s43 offen offset:1024 lds
v_mfma_f32_16x16x32_bf16 a[100:103], a[180:183], v[76:79], a[100:103]
v_exp_f32 v193, v193
v_mfma_f32_16x16x32_bf16 a[100:103], a[176:179], v[72:75], a[100:103]
ds_read_b64_tr_b16 a[190:191], v15 offset:61440
v_cvt_pk_bf16_f32 v102, v192, v193
v_mfma_f32_16x16x32_bf16 a[104:107], a[176:179], v[80:83], a[104:107]
v_exp_f32 v194, v194
v_mfma_f32_16x16x32_bf16 a[104:107], a[180:183], v[84:87], a[104:107]
buffer_load_dwordx4 v34, s[16:19], s43 offen offset:2048 lds
v_mfma_f32_16x16x32_bf16 a[108:111], a[180:183], v[92:95], a[108:111]
v_exp_f32 v195, v195
v_mfma_f32_16x16x32_bf16 a[108:111], a[176:179], v[88:91], a[108:111]
buffer_load_dwordx2 v[248:249], v55, s[24:27], s44 offen sc1
v_cvt_pk_bf16_f32 v103, v194, v195
v_mfma_f32_16x16x32_bf16 v[200:203], a[160:163], v[160:163], v[216:219]
v_exp_f32 v196, v196
v_mfma_f32_16x16x32_bf16 v[200:203], a[164:167], v[164:167], v[200:203]
s_waitcnt lgkmcnt(0)
ds_read_b64_tr_b16 a[176:177], v8 offset:0
v_mfma_f32_16x16x32_bf16 v[200:203], a[168:171], v[168:171], v[200:203]
v_exp_f32 v197, v197
v_mfma_f32_16x16x32_bf16 v[200:203], a[172:175], v[172:175], v[200:203]
ds_read_b64_tr_b16 a[178:179], v8 offset:4096
v_cvt_pk_bf16_f32 v110, v196, v197
v_mfma_f32_16x16x32_bf16 v[204:207], a[172:175], v[188:191], v[220:223]
v_exp_f32 v198, v198
v_mfma_f32_16x16x32_bf16 v[204:207], a[168:171], v[184:187], v[204:207]
buffer_load_dwordx4 v35, s[16:19], s43 offen offset:3072 lds
v_mfma_f32_16x16x32_bf16 v[204:207], a[164:167], v[180:183], v[204:207]
v_exp_f32 v199, v199
v_mfma_f32_16x16x32_bf16 v[204:207], a[160:163], v[176:179], v[204:207]
buffer_load_dwordx2 v[250:251], v55, s[24:27], s44 offen offset:512 sc1
v_cvt_pk_bf16_f32 v111, v198, v199
v_smfmac_f32_16x16x64_bf16 a[140:143], v[224:227], v[88:95], v228
s_add_u32 m0, s40, 98304
s_mov_b32 s43, 393216
v_mfma_f32_16x16x32_bf16 a[112:115], a[184:187], v[64:67], a[112:115]
v_exp_f32 v200, v200
v_mfma_f32_16x16x32_bf16 a[112:115], a[188:191], v[68:71], a[112:115]
ds_read_b64_tr_b16 a[180:181], v8 offset:8192
buffer_load_dwordx4 v32, s[16:19], s43 offen lds
v_mfma_f32_16x16x32_bf16 a[116:119], a[188:191], v[76:79], a[116:119]
v_exp_f32 v201, v201
v_mfma_f32_16x16x32_bf16 a[116:119], a[184:187], v[72:75], a[116:119]
ds_read_b64_tr_b16 a[182:183], v8 offset:12288
v_cvt_pk_bf16_f32 v118, v200, v201
v_mfma_f32_16x16x32_bf16 a[120:123], a[184:187], v[80:83], a[120:123]
v_exp_f32 v202, v202
v_mfma_f32_16x16x32_bf16 a[120:123], a[188:191], v[84:87], a[120:123]
buffer_load_dwordx4 v33, s[16:19], s43 offen offset:1024 lds
v_mfma_f32_16x16x32_bf16 a[124:127], a[188:191], v[92:95], a[124:127]
v_exp_f32 v203, v203
v_mfma_f32_16x16x32_bf16 a[124:127], a[184:187], v[88:91], a[124:127]
buffer_load_dwordx4 v[252:255], v23, s[24:27], s44 offen offset:1024 sc1
v_cvt_pk_bf16_f32 v119, v202, v203
v_smfmac_f32_16x16x64_bf16 a[128:131], v[224:227], v[96:103], v228
v_exp_f32 v204, v204
v_smfmac_f32_16x16x64_bf16 a[132:135], v[224:227], v[104:111], v228
v_exp_f32 v205, v205
v_smfmac_f32_16x16x64_bf16 a[136:139], v[224:227], v[112:119], v228
v_exp_f32 v206, v206
s_waitcnt lgkmcnt(0)
v_mfma_f32_16x16x32_bf16 a[0:3], a[176:179], v[96:99], a[0:3]
ds_read_b64_tr_b16 a[184:185], v9 offset:0
v_exp_f32 v207, v207
v_mfma_f32_16x16x32_bf16 a[0:3], a[180:183], v[100:103], a[0:3]
ds_read_b64_tr_b16 a[186:187], v9 offset:4096
v_cvt_pk_bf16_f32 v126, v204, v205
v_mfma_f32_16x16x32_bf16 a[4:7], a[180:183], v[108:111], a[4:7]
ds_read_b64_tr_b16 a[188:189], v9 offset:8192
v_cvt_pk_bf16_f32 v127, v206, v207
v_mfma_f32_16x16x32_bf16 a[4:7], a[176:179], v[104:107], a[4:7]
ds_read_b64_tr_b16 a[190:191], v9 offset:12288
buffer_load_dwordx4 v34, s[16:19], s43 offen offset:2048 lds
s_nop 0
v_smfmac_f32_16x16x64_bf16 a[140:143], v[224:227], v[120:127], v228
v_mfma_f32_16x16x32_bf16 a[8:11], a[176:179], v[112:115], a[8:11]
v_mfma_f32_16x16x32_bf16 a[8:11], a[180:183], v[116:119], a[8:11]
buffer_load_dwordx4 v35, s[16:19], s43 offen offset:3072 lds
v_mfma_f32_16x16x32_bf16 a[12:15], a[180:183], v[124:127], a[12:15]
v_mfma_f32_16x16x32_bf16 a[12:15], a[176:179], v[120:123], a[12:15]
s_movk_i32 s44, 6144
buffer_load_dwordx4 a[144:147], v22, s[24:27], s44 offen sc1
s_waitcnt lgkmcnt(0)
v_mfma_f32_16x16x32_bf16 a[16:19], a[184:187], v[96:99], a[16:19]
ds_read_b64_tr_b16 a[176:177], v10 offset:0
v_accvgpr_read_b32 v52, a128
v_accvgpr_read_b32 v53, a129
v_accvgpr_read_b32 v54, a132
v_mfma_f32_16x16x32_bf16 a[16:19], a[188:191], v[100:103], a[16:19]
ds_read_b64_tr_b16 a[178:179], v10 offset:4096
v_accvgpr_read_b32 v55, a133
v_accvgpr_read_b32 v56, a136
v_accvgpr_read_b32 v57, a137
v_mfma_f32_16x16x32_bf16 a[20:23], a[188:191], v[108:111], a[20:23]
ds_read_b64_tr_b16 a[180:181], v10 offset:8192
v_accvgpr_read_b32 v58, a140
v_accvgpr_read_b32 v59, a141
v_add_f32 v52, v52, v53
v_mfma_f32_16x16x32_bf16 a[20:23], a[184:187], v[104:107], a[20:23]
ds_read_b64_tr_b16 a[182:183], v10 offset:12288
buffer_load_dwordx4 a[148:151], v22, s[24:27], s44 offen offset:1024 sc1
v_add_f32 v54, v54, v55
v_add_f32 v56, v56, v57
v_add_f32 v58, v58, v59
v_mfma_f32_16x16x32_bf16 a[24:27], a[184:187], v[112:115], a[24:27]
v_add_f32 v53, v52, v54
v_add_f32 v55, v56, v58
v_add_f32 v53, v53, v55
v_mfma_f32_16x16x32_bf16 a[24:27], a[188:191], v[116:119], a[24:27]
buffer_load_dwordx4 a[152:155], v23, s[24:27], s44 offen sc1
v_cmp_nge_f32 vcc, 0x53800000, v53
v_rcp_f32 v52, v52
v_rcp_f32 v54, v54
v_mfma_f32_16x16x32_bf16 a[28:31], a[188:191], v[124:127], a[28:31]
v_rcp_f32 v56, v56
v_rcp_f32 v58, v58
s_or_b32 s80, vcc_lo, vcc_hi
v_mfma_f32_16x16x32_bf16 a[28:31], a[184:187], v[120:123], a[28:31]
buffer_load_dwordx4 a[156:159], v23, s[24:27], s44 offen offset:1024 sc1
v_lshlrev_b32 v53, 2, v1
v_mov_b32 v55, s80
ds_write_b32 v53, v55 offset:49152
s_waitcnt vmcnt(21) lgkmcnt(0)
s_barrier
v_mfma_f32_16x16x32_bf16 a[32:35], a[176:179], v[96:99], a[32:35]
ds_read_b64_tr_b16 a[184:185], v11 offset:0
v_and_b32 v57, 12, v40
v_accvgpr_read_b32 v64, a0
v_accvgpr_read_b32 v65, a1
v_accvgpr_read_b32 v66, a2
v_accvgpr_read_b32 v67, a3
v_mfma_f32_16x16x32_bf16 a[32:35], a[180:183], v[100:103], a[32:35]
ds_read_b64_tr_b16 a[186:187], v11 offset:4096
v_accvgpr_read_b32 v68, a16
v_accvgpr_read_b32 v69, a17
v_accvgpr_read_b32 v70, a18
v_accvgpr_read_b32 v71, a19
v_mfma_f32_16x16x32_bf16 a[36:39], a[180:183], v[108:111], a[36:39]
ds_read_b64_tr_b16 a[188:189], v11 offset:8192
v_mul_f32 v64, v64, v52
v_mul_f32 v65, v65, v52
v_mul_f32 v66, v66, v52
v_mul_f32 v67, v67, v52
v_mfma_f32_16x16x32_bf16 a[36:39], a[176:179], v[104:107], a[36:39]
ds_read_b64_tr_b16 a[190:191], v11 offset:12288
s_movk_i32 s44, 10240
buffer_load_dwordx4 a[160:163], v22, s[24:27], s44 offen sc1
v_mul_f32 v68, v68, v52
v_mul_f32 v69, v69, v52
v_mul_f32 v70, v70, v52
v_mul_f32 v71, v71, v52
v_mfma_f32_16x16x32_bf16 a[40:43], a[176:179], v[112:115], a[40:43]
ds_read_b32 v57, v57 offset:49152
v_cvt_pk_bf16_f32 v80, v64, v65
v_cvt_pk_bf16_f32 v81, v66, v67
v_cvt_pk_bf16_f32 v82, v68, v69
v_cvt_pk_bf16_f32 v83, v70, v71
v_mfma_f32_16x16x32_bf16 a[40:43], a[180:183], v[116:119], a[40:43]
buffer_load_dwordx4 a[164:167], v22, s[24:27], s44 offen offset:1024 sc1
v_accvgpr_read_b32 v72, a4
v_accvgpr_read_b32 v73, a5
v_accvgpr_read_b32 v74, a6
v_mfma_f32_16x16x32_bf16 a[44:47], a[180:183], v[124:127], a[44:47]
buffer_store_dwordx4 v[80:83], v48, s[36:39], s64 offen sc1
v_accvgpr_read_b32 v75, a7
v_accvgpr_read_b32 v76, a20
v_accvgpr_read_b32 v77, a21
v_accvgpr_read_b32 v78, a22
v_mfma_f32_16x16x32_bf16 a[44:47], a[176:179], v[120:123], a[44:47]
buffer_load_dwordx4 a[168:171], v23, s[24:27], s44 offen sc1
v_accvgpr_read_b32 v79, a23
v_mul_f32 v72, v72, v54
v_mul_f32 v73, v73, v54
v_mul_f32 v74, v74, v54
s_waitcnt lgkmcnt(0)
v_mfma_f32_16x16x32_bf16 a[48:51], a[184:187], v[96:99], a[48:51]
ds_read_b64_tr_b16 a[176:177], v12 offset:0
v_cmp_ne_u32 vcc, 0, v57
v_mul_f32 v75, v75, v54
v_mul_f32 v76, v76, v54
v_mul_f32 v77, v77, v54
v_mul_f32 v78, v78, v54
v_mfma_f32_16x16x32_bf16 a[48:51], a[188:191], v[100:103], a[48:51]
ds_read_b64_tr_b16 a[178:179], v12 offset:4096
s_cbranch_vccnz L_fallback
L_nofb:
v_mul_f32 v79, v79, v54
v_cvt_pk_bf16_f32 v84, v72, v73
v_cvt_pk_bf16_f32 v85, v74, v75
v_cvt_pk_bf16_f32 v86, v76, v77
v_mfma_f32_16x16x32_bf16 a[52:55], a[188:191], v[108:111], a[52:55]
ds_read_b64_tr_b16 a[180:181], v12 offset:8192
v_cvt_pk_bf16_f32 v87, v78, v79
v_accvgpr_read_b32 v64, a8
v_accvgpr_read_b32 v65, a9
v_mfma_f32_16x16x32_bf16 a[52:55], a[184:187], v[104:107], a[52:55]
ds_read_b64_tr_b16 a[182:183], v12 offset:12288
buffer_load_dwordx4 a[172:175], v23, s[24:27], s44 offen offset:1024 sc1
buffer_store_dwordx4 v[84:87], v49, s[36:39], s64 offen sc1
v_accvgpr_read_b32 v66, a10
v_accvgpr_read_b32 v67, a11
v_accvgpr_read_b32 v68, a24
v_accvgpr_read_b32 v69, a25
v_mfma_f32_16x16x32_bf16 a[56:59], a[184:187], v[112:115], a[56:59]
v_accvgpr_read_b32 v70, a26
v_accvgpr_read_b32 v71, a27
v_mul_f32 v64, v64, v56
v_mul_f32 v65, v65, v56
v_mfma_f32_16x16x32_bf16 a[56:59], a[188:191], v[116:119], a[56:59]
v_mul_f32 v66, v66, v56
v_mul_f32 v67, v67, v56
v_mul_f32 v68, v68, v56
v_mul_f32 v69, v69, v56
v_mfma_f32_16x16x32_bf16 a[60:63], a[188:191], v[124:127], a[60:63]
v_mul_f32 v70, v70, v56
v_mul_f32 v71, v71, v56
v_cvt_pk_bf16_f32 v88, v64, v65
v_cvt_pk_bf16_f32 v89, v66, v67
v_mfma_f32_16x16x32_bf16 a[60:63], a[184:187], v[120:123], a[60:63]
v_cvt_pk_bf16_f32 v90, v68, v69
v_cvt_pk_bf16_f32 v91, v70, v71
s_waitcnt lgkmcnt(0)
v_mfma_f32_16x16x32_bf16 a[64:67], a[176:179], v[96:99], a[64:67]
ds_read_b64_tr_b16 a[184:185], v13 offset:0
buffer_store_dwordx4 v[88:91], v50, s[36:39], s64 offen sc1
v_accvgpr_read_b32 v72, a12
v_accvgpr_read_b32 v73, a13
v_accvgpr_read_b32 v74, a14
v_accvgpr_read_b32 v75, a15
v_mfma_f32_16x16x32_bf16 a[64:67], a[180:183], v[100:103], a[64:67]
ds_read_b64_tr_b16 a[186:187], v13 offset:4096
v_accvgpr_read_b32 v76, a28
v_accvgpr_read_b32 v77, a29
v_accvgpr_read_b32 v78, a30
v_accvgpr_read_b32 v79, a31
v_mfma_f32_16x16x32_bf16 a[68:71], a[180:183], v[108:111], a[68:71]
ds_read_b64_tr_b16 a[188:189], v13 offset:8192
v_mul_f32 v72, v72, v58
v_mul_f32 v73, v73, v58
v_mul_f32 v74, v74, v58
v_mul_f32 v75, v75, v58
v_mfma_f32_16x16x32_bf16 a[68:71], a[176:179], v[104:107], a[68:71]
ds_read_b64_tr_b16 a[190:191], v13 offset:12288
v_mul_f32 v76, v76, v58
v_mul_f32 v77, v77, v58
v_mul_f32 v78, v78, v58
v_mul_f32 v79, v79, v58
v_mfma_f32_16x16x32_bf16 a[72:75], a[176:179], v[112:115], a[72:75]
v_cvt_pk_bf16_f32 v92, v72, v73
v_cvt_pk_bf16_f32 v93, v74, v75
v_cvt_pk_bf16_f32 v94, v76, v77
v_cvt_pk_bf16_f32 v95, v78, v79
v_mfma_f32_16x16x32_bf16 a[72:75], a[180:183], v[116:119], a[72:75]
v_accvgpr_read_b32 v64, a32
v_accvgpr_read_b32 v65, a33
v_accvgpr_read_b32 v66, a34
v_mfma_f32_16x16x32_bf16 a[76:79], a[180:183], v[124:127], a[76:79]
buffer_store_dwordx4 v[92:95], v51, s[36:39], s64 offen sc1
v_accvgpr_read_b32 v67, a35
v_accvgpr_read_b32 v68, a48
v_accvgpr_read_b32 v69, a49
v_accvgpr_read_b32 v70, a50
v_mfma_f32_16x16x32_bf16 a[76:79], a[176:179], v[120:123], a[76:79]
v_accvgpr_read_b32 v71, a51
v_mul_f32 v64, v64, v52
v_mul_f32 v65, v65, v52
v_mul_f32 v66, v66, v52
s_waitcnt lgkmcnt(0)
v_mfma_f32_16x16x32_bf16 a[80:83], a[184:187], v[96:99], a[80:83]
ds_read_b64_tr_b16 a[176:177], v14 offset:0
v_mul_f32 v67, v67, v52
v_mul_f32 v68, v68, v52
v_mul_f32 v69, v69, v52
v_mul_f32 v70, v70, v52
v_mfma_f32_16x16x32_bf16 a[80:83], a[188:191], v[100:103], a[80:83]
ds_read_b64_tr_b16 a[178:179], v14 offset:4096
v_mul_f32 v71, v71, v52
v_cvt_pk_bf16_f32 v80, v64, v65
v_cvt_pk_bf16_f32 v81, v66, v67
v_cvt_pk_bf16_f32 v82, v68, v69
v_mfma_f32_16x16x32_bf16 a[84:87], a[188:191], v[108:111], a[84:87]
ds_read_b64_tr_b16 a[180:181], v14 offset:8192
v_cvt_pk_bf16_f32 v83, v70, v71
v_accvgpr_read_b32 v72, a36
v_accvgpr_read_b32 v73, a37
v_mfma_f32_16x16x32_bf16 a[84:87], a[184:187], v[104:107], a[84:87]
ds_read_b64_tr_b16 a[182:183], v14 offset:12288
buffer_store_dwordx4 v[80:83], v48, s[36:39], s65 offen sc1
v_accvgpr_read_b32 v74, a38
v_accvgpr_read_b32 v75, a39
v_accvgpr_read_b32 v76, a52
v_accvgpr_read_b32 v77, a53
v_mfma_f32_16x16x32_bf16 a[88:91], a[184:187], v[112:115], a[88:91]
v_accvgpr_read_b32 v78, a54
v_accvgpr_read_b32 v79, a55
v_mul_f32 v72, v72, v54
v_mul_f32 v73, v73, v54
v_mfma_f32_16x16x32_bf16 a[88:91], a[188:191], v[116:119], a[88:91]
v_mul_f32 v74, v74, v54
v_mul_f32 v75, v75, v54
v_mul_f32 v76, v76, v54
v_mul_f32 v77, v77, v54
v_mfma_f32_16x16x32_bf16 a[92:95], a[188:191], v[124:127], a[92:95]
v_mul_f32 v78, v78, v54
v_mul_f32 v79, v79, v54
v_cvt_pk_bf16_f32 v84, v72, v73
v_cvt_pk_bf16_f32 v85, v74, v75
v_mfma_f32_16x16x32_bf16 a[92:95], a[184:187], v[120:123], a[92:95]
v_cvt_pk_bf16_f32 v86, v76, v77
v_cvt_pk_bf16_f32 v87, v78, v79
s_waitcnt lgkmcnt(0)
v_mfma_f32_16x16x32_bf16 a[96:99], a[176:179], v[96:99], a[96:99]
ds_read_b64_tr_b16 a[184:185], v15 offset:0
buffer_store_dwordx4 v[84:87], v49, s[36:39], s65 offen sc1
v_accvgpr_read_b32 v64, a40
v_accvgpr_read_b32 v65, a41
v_accvgpr_read_b32 v66, a42
v_accvgpr_read_b32 v67, a43
v_mfma_f32_16x16x32_bf16 a[96:99], a[180:183], v[100:103], a[96:99]
ds_read_b64_tr_b16 a[186:187], v15 offset:4096
v_accvgpr_read_b32 v68, a56
v_accvgpr_read_b32 v69, a57
v_accvgpr_read_b32 v70, a58
v_accvgpr_read_b32 v71, a59
v_mfma_f32_16x16x32_bf16 a[100:103], a[180:183], v[108:111], a[100:103]
ds_read_b64_tr_b16 a[188:189], v15 offset:8192
v_mul_f32 v64, v64, v56
v_mul_f32 v65, v65, v56
v_mul_f32 v66, v66, v56
v_mul_f32 v67, v67, v56
v_mfma_f32_16x16x32_bf16 a[100:103], a[176:179], v[104:107], a[100:103]
ds_read_b64_tr_b16 a[190:191], v15 offset:12288
v_mul_f32 v68, v68, v56
v_mul_f32 v69, v69, v56
v_mul_f32 v70, v70, v56
v_mul_f32 v71, v71, v56
v_mfma_f32_16x16x32_bf16 a[104:107], a[176:179], v[112:115], a[104:107]
ds_read_b64_tr_b16 v[192:193], v24 offset:0
v_cvt_pk_bf16_f32 v88, v64, v65
v_cvt_pk_bf16_f32 v89, v66, v67
v_cvt_pk_bf16_f32 v90, v68, v69
v_cvt_pk_bf16_f32 v91, v70, v71
v_mfma_f32_16x16x32_bf16 a[104:107], a[180:183], v[116:119], a[104:107]
ds_read_b64_tr_b16 v[194:195], v24 offset:4096
v_accvgpr_read_b32 v72, a44
v_accvgpr_read_b32 v73, a45
v_accvgpr_read_b32 v74, a46
v_mfma_f32_16x16x32_bf16 a[108:111], a[180:183], v[124:127], a[108:111]
ds_read_b64_tr_b16 v[196:197], v24 offset:8192
buffer_store_dwordx4 v[88:91], v50, s[36:39], s65 offen sc1
v_accvgpr_read_b32 v75, a47
v_accvgpr_read_b32 v76, a60
v_accvgpr_read_b32 v77, a61
v_accvgpr_read_b32 v78, a62
v_mfma_f32_16x16x32_bf16 a[108:111], a[176:179], v[120:123], a[108:111]
ds_read_b64_tr_b16 v[198:199], v24 offset:12288
v_accvgpr_read_b32 v79, a63
v_mul_f32 v72, v72, v58
v_mul_f32 v73, v73, v58
v_mul_f32 v74, v74, v58
s_waitcnt lgkmcnt(4)
v_mfma_f32_16x16x32_bf16 a[112:115], a[184:187], v[96:99], a[112:115]
ds_read_b64_tr_b16 v[200:201], v25 offset:0
v_mul_f32 v75, v75, v58
v_mul_f32 v76, v76, v58
v_mul_f32 v77, v77, v58
v_mul_f32 v78, v78, v58
v_mfma_f32_16x16x32_bf16 a[112:115], a[188:191], v[100:103], a[112:115]
ds_read_b64_tr_b16 v[202:203], v25 offset:4096
v_mul_f32 v79, v79, v58
v_cvt_pk_bf16_f32 v92, v72, v73
v_cvt_pk_bf16_f32 v93, v74, v75
v_cvt_pk_bf16_f32 v94, v76, v77
v_mfma_f32_16x16x32_bf16 a[116:119], a[188:191], v[108:111], a[116:119]
ds_read_b64_tr_b16 v[204:205], v25 offset:8192
v_cvt_pk_bf16_f32 v95, v78, v79
v_accvgpr_read_b32 v64, a64
v_accvgpr_read_b32 v65, a65
v_mfma_f32_16x16x32_bf16 a[116:119], a[184:187], v[104:107], a[116:119]
ds_read_b64_tr_b16 v[206:207], v25 offset:12288
buffer_store_dwordx4 v[92:95], v51, s[36:39], s65 offen sc1
v_accvgpr_read_b32 v66, a66
v_accvgpr_read_b32 v67, a67
v_accvgpr_read_b32 v68, a80
v_accvgpr_read_b32 v69, a81
v_mfma_f32_16x16x32_bf16 a[120:123], a[184:187], v[112:115], a[120:123]
ds_read_b64_tr_b16 v[208:209], v26 offset:0
v_accvgpr_read_b32 v70, a82
v_accvgpr_read_b32 v71, a83
v_mul_f32 v64, v64, v52
v_mul_f32 v65, v65, v52
v_mfma_f32_16x16x32_bf16 a[120:123], a[188:191], v[116:119], a[120:123]
ds_read_b64_tr_b16 v[210:211], v26 offset:4096
v_mul_f32 v66, v66, v52
v_mul_f32 v67, v67, v52
v_mul_f32 v68, v68, v52
v_mul_f32 v69, v69, v52
v_mfma_f32_16x16x32_bf16 a[124:127], a[188:191], v[124:127], a[124:127]
ds_read_b64_tr_b16 v[212:213], v26 offset:8192
v_mul_f32 v70, v70, v52
v_mul_f32 v71, v71, v52
v_cvt_pk_bf16_f32 v80, v64, v65
v_cvt_pk_bf16_f32 v81, v66, v67
v_mfma_f32_16x16x32_bf16 a[124:127], a[184:187], v[120:123], a[124:127]
ds_read_b64_tr_b16 v[214:215], v26 offset:12288
v_cvt_pk_bf16_f32 v82, v68, v69
v_cvt_pk_bf16_f32 v83, v70, v71
buffer_store_dwordx4 v[80:83], v48, s[36:39], s66 offen sc1
s_waitcnt vmcnt(19) lgkmcnt(8)
v_mfma_f32_16x16x32_bf16 v[128:131], v[192:195], a[192:195], 0
ds_read_b64_tr_b16 v[216:217], v27 offset:0
ds_read_b64_tr_b16 v[218:219], v27 offset:4096
v_accvgpr_read_b32 v72, a68
v_accvgpr_read_b32 v73, a69
v_mfma_f32_16x16x32_bf16 v[128:131], v[196:199], a[196:199], v[128:131]
v_lshrrev_b32 v224, 3, v0
v_accvgpr_read_b32 v74, a70
v_accvgpr_read_b32 v75, a71
v_accvgpr_read_b32 v76, a84
v_mfma_f32_16x16x32_bf16 v[160:163], v[196:199], a[204:207], 0
ds_read_b64_tr_b16 v[220:221], v27 offset:8192
v_and_b32 v225, 7, v0
v_accvgpr_read_b32 v77, a85
v_accvgpr_read_b32 v78, a86
v_accvgpr_read_b32 v79, a87
v_mfma_f32_16x16x32_bf16 v[160:163], v[192:195], a[200:203], v[160:163]
ds_read_b64_tr_b16 v[222:223], v27 offset:12288
v_mul_f32 v72, v72, v54
v_mul_f32 v73, v73, v54
s_waitcnt lgkmcnt(8)
v_mfma_f32_16x16x32_bf16 v[164:167], v[200:203], a[200:203], 0
ds_read_b64_tr_b16 v[192:193], v28 offset:0
ds_read_b64_tr_b16 v[194:195], v28 offset:4096
v_mul_f32 v74, v74, v54
v_mul_f32 v75, v75, v54
v_mfma_f32_16x16x32_bf16 v[164:167], v[204:207], a[204:207], v[164:167]
v_mul_f32 v76, v76, v54
v_mul_f32 v77, v77, v54
v_mul_f32 v78, v78, v54
v_mfma_f32_16x16x32_bf16 v[132:135], v[204:207], a[196:199], 0
ds_read_b64_tr_b16 v[196:197], v28 offset:8192
v_and_b32 v226, 6, v224
v_mul_f32 v79, v79, v54
v_cvt_pk_bf16_f32 v84, v72, v73
v_cvt_pk_bf16_f32 v85, v74, v75
v_mfma_f32_16x16x32_bf16 v[132:135], v[200:203], a[192:195], v[132:135]
ds_read_b64_tr_b16 v[198:199], v28 offset:12288
v_cvt_pk_bf16_f32 v86, v76, v77
v_cvt_pk_bf16_f32 v87, v78, v79
s_waitcnt lgkmcnt(8)
v_mfma_f32_16x16x32_bf16 v[136:139], v[208:211], a[192:195], 0
ds_read_b64_tr_b16 v[200:201], v29 offset:0
ds_read_b64_tr_b16 v[202:203], v29 offset:4096
v_mfma_f32_16x16x32_bf16 v[136:139], v[212:215], a[196:199], v[136:139]
L_pad10:
s_cbranch_execz L_pad11
buffer_store_dwordx4 v[84:87], v49, s[36:39], s66 offen sc1
v_accvgpr_read_b32 v64, a72
v_accvgpr_read_b32 v65, a73
v_accvgpr_read_b32 v66, a74
v_mfma_f32_16x16x32_bf16 v[168:171], v[212:215], a[204:207], 0
ds_read_b64_tr_b16 v[204:205], v29 offset:8192
v_xor_b32 v225, v225, v226
v_accvgpr_read_b32 v67, a75
v_accvgpr_read_b32 v68, a88
v_accvgpr_read_b32 v69, a89
v_mfma_f32_16x16x32_bf16 v[168:171], v[208:211], a[200:203], v[168:171]
ds_read_b64_tr_b16 v[206:207], v29 offset:12288
v_accvgpr_read_b32 v70, a90
v_accvgpr_read_b32 v71, a91
s_waitcnt lgkmcnt(8)
v_mfma_f32_16x16x32_bf16 v[172:175], v[216:219], a[200:203], 0
ds_read_b64_tr_b16 v[208:209], v30 offset:0
ds_read_b64_tr_b16 v[210:211], v30 offset:4096
v_mul_f32 v64, v64, v56
v_mul_f32 v65, v65, v56
v_mfma_f32_16x16x32_bf16 v[172:175], v[220:223], a[204:207], v[172:175]
v_lshl_add_u32 v224, v1, 5, v224
v_mul_f32 v66, v66, v56
v_mul_f32 v67, v67, v56
v_mul_f32 v68, v68, v56
v_mfma_f32_16x16x32_bf16 v[140:143], v[220:223], a[196:199], 0
ds_read_b64_tr_b16 v[212:213], v30 offset:8192
v_lshlrev_b32 v224, 10, v224
v_mul_f32 v69, v69, v56
v_mul_f32 v70, v70, v56
v_mul_f32 v71, v71, v56
v_mfma_f32_16x16x32_bf16 v[140:143], v[216:219], a[192:195], v[140:143]
ds_read_b64_tr_b16 v[214:215], v30 offset:12288
v_cvt_pk_bf16_f32 v88, v64, v65
v_cvt_pk_bf16_f32 v89, v66, v67
s_waitcnt lgkmcnt(8)
v_mfma_f32_16x16x32_bf16 v[144:147], v[192:195], a[192:195], 0
ds_read_b64_tr_b16 v[216:217], v31 offset:0
ds_read_b64_tr_b16 v[218:219], v31 offset:4096
v_cvt_pk_bf16_f32 v90, v68, v69
v_cvt_pk_bf16_f32 v91, v70, v71
v_mfma_f32_16x16x32_bf16 v[144:147], v[196:199], a[196:199], v[144:147]
v_mfma_f32_16x16x32_bf16 v[176:179], v[196:199], a[204:207], 0
ds_read_b64_tr_b16 v[220:221], v31 offset:8192
buffer_store_dwordx4 v[88:91], v50, s[36:39], s66 offen sc1
v_lshl_add_u32 v16, v225, 4, v224
v_accvgpr_read_b32 v72, a76
v_accvgpr_read_b32 v73, a77
v_accvgpr_read_b32 v74, a78
v_mfma_f32_16x16x32_bf16 v[176:179], v[192:195], a[200:203], v[176:179]
ds_read_b64_tr_b16 v[222:223], v31 offset:12288
v_accvgpr_read_b32 v75, a79
v_accvgpr_read_b32 v76, a92
s_waitcnt lgkmcnt(8)
v_mfma_f32_16x16x32_bf16 v[180:183], v[200:203], a[200:203], 0
ds_read_b64_tr_b16 v[192:193], v44 offset:0
ds_read_b64_tr_b16 v[194:195], v44 offset:4096
v_accvgpr_read_b32 v77, a93
v_accvgpr_read_b32 v78, a94
v_mfma_f32_16x16x32_bf16 v[180:183], v[204:207], a[204:207], v[180:183]
v_accvgpr_read_b32 v79, a95
v_mul_f32 v72, v72, v58
v_mul_f32 v73, v73, v58
v_mfma_f32_16x16x32_bf16 v[148:151], v[204:207], a[196:199], 0
ds_read_b64_tr_b16 v[196:197], v44 offset:8192
v_add_u32 v17, 7168, v16
v_mul_f32 v74, v74, v58
v_mul_f32 v75, v75, v58
v_mul_f32 v76, v76, v58
v_mfma_f32_16x16x32_bf16 v[148:151], v[200:203], a[192:195], v[148:151]
ds_read_b64_tr_b16 v[198:199], v44 offset:12288
v_mul_f32 v77, v77, v58
v_mul_f32 v78, v78, v58
s_waitcnt lgkmcnt(8)
v_mfma_f32_16x16x32_bf16 v[152:155], v[208:211], a[192:195], 0
ds_read_b64_tr_b16 v[200:201], v45 offset:0
ds_read_b64_tr_b16 v[202:203], v45 offset:4096
v_mul_f32 v79, v79, v58
v_cvt_pk_bf16_f32 v92, v72, v73
v_mfma_f32_16x16x32_bf16 v[152:155], v[212:215], a[196:199], v[152:155]
v_add_u32 v18, 14336, v16
v_cvt_pk_bf16_f32 v93, v74, v75
v_cvt_pk_bf16_f32 v94, v76, v77
v_cvt_pk_bf16_f32 v95, v78, v79
v_mfma_f32_16x16x32_bf16 v[184:187], v[212:215], a[204:207], 0
ds_read_b64_tr_b16 v[204:205], v45 offset:8192
v_add_u32 v19, 21504, v16
v_mfma_f32_16x16x32_bf16 v[184:187], v[208:211], a[200:203], v[184:187]
ds_read_b64_tr_b16 v[206:207], v45 offset:12288
buffer_store_dwordx4 v[92:95], v51, s[36:39], s66 offen sc1
v_accvgpr_read_b32 v64, a96
v_accvgpr_read_b32 v65, a97
s_waitcnt lgkmcnt(8)
v_mfma_f32_16x16x32_bf16 v[188:191], v[216:219], a[200:203], 0
ds_read_b64_tr_b16 v[208:209], v46 offset:0
ds_read_b64_tr_b16 v[210:211], v46 offset:4096
v_accvgpr_read_b32 v66, a98
v_accvgpr_read_b32 v67, a99
v_mfma_f32_16x16x32_bf16 v[188:191], v[220:223], a[204:207], v[188:191]
v_accvgpr_read_b32 v68, a112
v_accvgpr_read_b32 v69, a113
v_accvgpr_read_b32 v70, a114
v_mfma_f32_16x16x32_bf16 v[156:159], v[220:223], a[196:199], 0
ds_read_b64_tr_b16 v[212:213], v46 offset:8192
s_lshl_b32 s82, s83, 2
s_add_u32 s81, s82, s50
v_accvgpr_read_b32 v71, a115
v_mul_f32 v64, v64, v52
v_mul_f32 v65, v65, v52
v_mfma_f32_16x16x32_bf16 v[156:159], v[216:219], a[192:195], v[156:159]
ds_read_b64_tr_b16 v[214:215], v46 offset:12288
v_mul_f32 v66, v66, v52
v_mul_f32 v67, v67, v52
s_waitcnt lgkmcnt(8)
v_mfma_f32_16x16x32_bf16 v[128:131], v[192:195], a[208:211], v[128:131]
ds_read_b64_tr_b16 v[216:217], v47 offset:0
ds_read_b64_tr_b16 v[218:219], v47 offset:4096
v_mul_f32 v68, v68, v52
v_mul_f32 v69, v69, v52
v_mfma_f32_16x16x32_bf16 v[128:131], v[196:199], a[212:215], v[128:131]
v_mul_f32 v70, v70, v52
v_mul_f32 v71, v71, v52
v_cvt_pk_bf16_f32 v80, v64, v65
v_mfma_f32_16x16x32_bf16 v[160:163], v[196:199], a[220:223], v[160:163]
ds_read_b64_tr_b16 v[220:221], v47 offset:8192
s_lshl_b32 s81, s81, 3
s_and_b32 s82, s77, 7
v_cvt_pk_bf16_f32 v81, v66, v67
v_cvt_pk_bf16_f32 v82, v68, v69
v_cvt_pk_bf16_f32 v83, v70, v71
v_mfma_f32_16x16x32_bf16 v[160:163], v[192:195], a[216:219], v[160:163]
ds_read_b64_tr_b16 v[222:223], v47 offset:12288
s_waitcnt lgkmcnt(8)
v_mfma_f32_16x16x32_bf16 v[164:167], v[200:203], a[216:219], v[164:167]
ds_read_b64_tr_b16 v[192:193], v237 offset:0
ds_read_b64_tr_b16 v[194:195], v237 offset:4096
buffer_store_dwordx4 v[80:83], v48, s[36:39], s67 offen sc1
v_accvgpr_read_b32 v72, a100
v_accvgpr_read_b32 v73, a101
v_mfma_f32_16x16x32_bf16 v[164:167], v[204:207], a[220:223], v[164:167]
s_add_u32 s81, s81, s82
s_lshl_b32 s81, s81, 7
v_accvgpr_read_b32 v74, a102
v_accvgpr_read_b32 v75, a103
v_accvgpr_read_b32 v76, a116
v_mfma_f32_16x16x32_bf16 v[132:135], v[204:207], a[212:215], v[132:135]
ds_read_b64_tr_b16 v[196:197], v237 offset:8192
s_add_u32 s81, s81, 16384
v_accvgpr_read_b32 v77, a117
v_accvgpr_read_b32 v78, a118
v_accvgpr_read_b32 v79, a119
v_mfma_f32_16x16x32_bf16 v[132:135], v[200:203], a[208:211], v[132:135]
ds_read_b64_tr_b16 v[198:199], v237 offset:12288
v_mul_f32 v72, v72, v54
v_mul_f32 v73, v73, v54
s_waitcnt lgkmcnt(8)
v_mfma_f32_16x16x32_bf16 v[136:139], v[208:211], a[208:211], v[136:139]
ds_read_b64_tr_b16 v[200:201], v238 offset:0
ds_read_b64_tr_b16 v[202:203], v238 offset:4096
v_mul_f32 v74, v74, v54
v_mul_f32 v75, v75, v54
v_mfma_f32_16x16x32_bf16 v[136:139], v[212:215], a[212:215], v[136:139]
v_mul_f32 v76, v76, v54
v_mul_f32 v77, v77, v54
v_mul_f32 v78, v78, v54
v_mfma_f32_16x16x32_bf16 v[168:171], v[212:215], a[220:223], v[168:171]
ds_read_b64_tr_b16 v[204:205], v238 offset:8192
s_and_b32 s46, s76, 0
s_lshl_b32 s46, s46, 12
v_mul_f32 v79, v79, v54
v_cvt_pk_bf16_f32 v84, v72, v73
v_cvt_pk_bf16_f32 v85, v74, v75
v_mfma_f32_16x16x32_bf16 v[168:171], v[208:211], a[216:219], v[168:171]
ds_read_b64_tr_b16 v[206:207], v238 offset:12288
v_cvt_pk_bf16_f32 v86, v76, v77
v_cvt_pk_bf16_f32 v87, v78, v79
s_waitcnt lgkmcnt(8)
v_mfma_f32_16x16x32_bf16 v[172:175], v[216:219], a[216:219], v[172:175]
ds_read_b64_tr_b16 v[208:209], v239 offset:0
ds_read_b64_tr_b16 v[210:211], v239 offset:4096
v_mfma_f32_16x16x32_bf16 v[172:175], v[220:223], a[220:223], v[172:175]
buffer_store_dwordx4 v[84:87], v49, s[36:39], s67 offen sc1
v_accvgpr_read_b32 v64, a104
v_accvgpr_read_b32 v65, a105
v_accvgpr_read_b32 v66, a106
v_mfma_f32_16x16x32_bf16 v[140:143], v[220:223], a[212:215], v[140:143]
ds_read_b64_tr_b16 v[212:213], v239 offset:8192
s_and_b32 s80, s83, 1
s_lshl_b32 s80, s80, 1
v_accvgpr_read_b32 v67, a107
v_accvgpr_read_b32 v68, a120
v_accvgpr_read_b32 v69, a121
v_mfma_f32_16x16x32_bf16 v[140:143], v[216:219], a[208:211], v[140:143]
ds_read_b64_tr_b16 v[214:215], v239 offset:12288
v_accvgpr_read_b32 v70, a122
v_accvgpr_read_b32 v71, a123
s_waitcnt lgkmcnt(8)
v_mfma_f32_16x16x32_bf16 v[144:147], v[192:195], a[208:211], v[144:147]
ds_read_b64_tr_b16 v[216:217], v42 offset:0
ds_read_b64_tr_b16 v[218:219], v42 offset:4096
v_mul_f32 v64, v64, v56
v_mul_f32 v65, v65, v56
v_mfma_f32_16x16x32_bf16 v[144:147], v[196:199], a[212:215], v[144:147]
v_lshrrev_b32 v224, 2, v2
v_mul_f32 v66, v66, v56
v_mul_f32 v67, v67, v56
v_mul_f32 v68, v68, v56
v_mfma_f32_16x16x32_bf16 v[176:179], v[196:199], a[220:223], v[176:179]
ds_read_b64_tr_b16 v[220:221], v42 offset:8192
v_and_b32 v225, 3, v2
v_mul_f32 v69, v69, v56
v_mul_f32 v70, v70, v56
v_mul_f32 v71, v71, v56
v_mfma_f32_16x16x32_bf16 v[176:179], v[192:195], a[216:219], v[176:179]
ds_read_b64_tr_b16 v[222:223], v42 offset:12288
v_cvt_pk_bf16_f32 v88, v64, v65
v_cvt_pk_bf16_f32 v89, v66, v67
s_waitcnt lgkmcnt(8)
v_mfma_f32_16x16x32_bf16 v[180:183], v[200:203], a[216:219], v[180:183]
ds_read_b64_tr_b16 v[192:193], v44 offset:16384
ds_read_b64_tr_b16 v[194:195], v44 offset:20480
v_cvt_pk_bf16_f32 v90, v68, v69
v_cvt_pk_bf16_f32 v91, v70, v71
v_mfma_f32_16x16x32_bf16 v[180:183], v[204:207], a[220:223], v[180:183]
v_mfma_f32_16x16x32_bf16 v[148:151], v[204:207], a[212:215], v[148:151]
ds_read_b64_tr_b16 v[196:197], v44 offset:24576
buffer_store_dwordx4 v[88:91], v50, s[36:39], s67 offen sc1
v_lshl_add_u32 v226, v3, 2, v224
v_accvgpr_read_b32 v72, a108
v_accvgpr_read_b32 v73, a109
v_accvgpr_read_b32 v74, a110
v_mfma_f32_16x16x32_bf16 v[148:151], v[200:203], a[208:211], v[148:151]
ds_read_b64_tr_b16 v[198:199], v44 offset:28672
v_accvgpr_read_b32 v75, a111
v_accvgpr_read_b32 v76, a124
s_waitcnt lgkmcnt(8)
v_mfma_f32_16x16x32_bf16 v[152:155], v[208:211], a[208:211], v[152:155]
ds_read_b64_tr_b16 v[200:201], v45 offset:16384
ds_read_b64_tr_b16 v[202:203], v45 offset:20480
v_accvgpr_read_b32 v77, a125
v_accvgpr_read_b32 v78, a126
v_mfma_f32_16x16x32_bf16 v[152:155], v[212:215], a[212:215], v[152:155]
v_accvgpr_read_b32 v79, a127
v_mul_f32 v72, v72, v58
v_mul_f32 v73, v73, v58
v_mfma_f32_16x16x32_bf16 v[184:187], v[212:215], a[220:223], v[184:187]
ds_read_b64_tr_b16 v[204:205], v45 offset:24576
v_bfe_u32 v227, v226, 1, 2
v_mul_f32 v74, v74, v58
v_mul_f32 v75, v75, v58
v_mul_f32 v76, v76, v58
v_mfma_f32_16x16x32_bf16 v[184:187], v[208:211], a[216:219], v[184:187]
ds_read_b64_tr_b16 v[206:207], v45 offset:28672
v_mul_f32 v77, v77, v58
v_mul_f32 v78, v78, v58
s_waitcnt lgkmcnt(8)
v_mfma_f32_16x16x32_bf16 v[188:191], v[216:219], a[216:219], v[188:191]
ds_read_b64_tr_b16 v[208:209], v46 offset:16384
ds_read_b64_tr_b16 v[210:211], v46 offset:20480
v_mul_f32 v79, v79, v58
v_cvt_pk_bf16_f32 v92, v72, v73
v_mfma_f32_16x16x32_bf16 v[188:191], v[220:223], a[220:223], v[188:191]
v_xor_b32 v227, s80, v227
v_cvt_pk_bf16_f32 v93, v74, v75
v_cvt_pk_bf16_f32 v94, v76, v77
v_cvt_pk_bf16_f32 v95, v78, v79
v_mfma_f32_16x16x32_bf16 v[156:159], v[220:223], a[212:215], v[156:159]
ds_read_b64_tr_b16 v[212:213], v46 offset:24576
v_lshlrev_b32 v228, 7, v226
v_mfma_f32_16x16x32_bf16 v[156:159], v[216:219], a[208:211], v[156:159]
ds_read_b64_tr_b16 v[214:215], v46 offset:28672
buffer_store_dwordx4 v[92:95], v51, s[36:39], s67 offen sc1
s_waitcnt lgkmcnt(8)
v_mfma_f32_16x16x32_bf16 v[128:131], v[192:195], a[224:227], v[128:131]
ds_read_b64_tr_b16 v[216:217], v47 offset:16384
ds_read_b64_tr_b16 v[218:219], v47 offset:20480
v_mfma_f32_16x16x32_bf16 v[128:131], v[196:199], a[228:231], v[128:131]
v_lshl_add_u32 v228, v225, 3, v228
v_xor_b32 v224, 0, v227
v_mfma_f32_16x16x32_bf16 v[160:163], v[196:199], a[236:239], v[160:163]
ds_read_b64_tr_b16 v[220:221], v47 offset:24576
v_lshl_add_u32 v4, v224, 5, v228
v_mfma_f32_16x16x32_bf16 v[160:163], v[192:195], a[232:235], v[160:163]
ds_read_b64_tr_b16 v[222:223], v47 offset:28672
s_waitcnt lgkmcnt(8)
v_mfma_f32_16x16x32_bf16 v[164:167], v[200:203], a[232:235], v[164:167]
ds_read_b64_tr_b16 v[192:193], v237 offset:16384
ds_read_b64_tr_b16 v[194:195], v237 offset:20480
v_mfma_f32_16x16x32_bf16 v[164:167], v[204:207], a[236:239], v[164:167]
v_add_u32 v8, 65536, v4
v_add_u32 v12, 131072, v4
v_mfma_f32_16x16x32_bf16 v[132:135], v[204:207], a[228:231], v[132:135]
ds_read_b64_tr_b16 v[196:197], v237 offset:24576
v_xor_b32 v224, 1, v227
v_mfma_f32_16x16x32_bf16 v[132:135], v[200:203], a[224:227], v[132:135]
ds_read_b64_tr_b16 v[198:199], v237 offset:28672
s_waitcnt lgkmcnt(8)
v_mfma_f32_16x16x32_bf16 v[136:139], v[208:211], a[224:227], v[136:139]
ds_read_b64_tr_b16 v[200:201], v238 offset:16384
ds_read_b64_tr_b16 v[202:203], v238 offset:20480
v_mfma_f32_16x16x32_bf16 v[136:139], v[212:215], a[228:231], v[136:139]
v_lshl_add_u32 v5, v224, 5, v228
v_add_u32 v9, 65536, v5
v_mfma_f32_16x16x32_bf16 v[168:171], v[212:215], a[236:239], v[168:171]
ds_read_b64_tr_b16 v[204:205], v238 offset:24576
v_add_u32 v13, 131072, v5
v_mfma_f32_16x16x32_bf16 v[168:171], v[208:211], a[232:235], v[168:171]
ds_read_b64_tr_b16 v[206:207], v238 offset:28672
s_waitcnt lgkmcnt(8)
v_mfma_f32_16x16x32_bf16 v[172:175], v[216:219], a[232:235], v[172:175]
ds_read_b64_tr_b16 v[208:209], v239 offset:16384
ds_read_b64_tr_b16 v[210:211], v239 offset:20480
v_mfma_f32_16x16x32_bf16 v[172:175], v[220:223], a[236:239], v[172:175]
v_xor_b32 v224, 2, v227
v_lshl_add_u32 v6, v224, 5, v228
v_mfma_f32_16x16x32_bf16 v[140:143], v[220:223], a[228:231], v[140:143]
ds_read_b64_tr_b16 v[212:213], v239 offset:24576
v_add_u32 v10, 65536, v6
v_mfma_f32_16x16x32_bf16 v[140:143], v[216:219], a[224:227], v[140:143]
ds_read_b64_tr_b16 v[214:215], v239 offset:28672
s_waitcnt lgkmcnt(8)
v_mfma_f32_16x16x32_bf16 v[144:147], v[192:195], a[224:227], v[144:147]
ds_read_b64_tr_b16 v[216:217], v42 offset:16384
ds_read_b64_tr_b16 v[218:219], v42 offset:20480
v_mfma_f32_16x16x32_bf16 v[144:147], v[196:199], a[228:231], v[144:147]
v_add_u32 v14, 131072, v6
v_xor_b32 v224, 3, v227
v_mfma_f32_16x16x32_bf16 v[176:179], v[196:199], a[236:239], v[176:179]
ds_read_b64_tr_b16 v[220:221], v42 offset:24576
v_lshl_add_u32 v7, v224, 5, v228
v_mfma_f32_16x16x32_bf16 v[176:179], v[192:195], a[232:235], v[176:179]
ds_read_b64_tr_b16 v[222:223], v42 offset:28672
s_waitcnt lgkmcnt(8)
v_mfma_f32_16x16x32_bf16 v[180:183], v[200:203], a[232:235], v[180:183]
ds_read_b64_tr_b16 v[192:193], v24 offset:16384
ds_read_b64_tr_b16 v[194:195], v24 offset:20480
v_mfma_f32_16x16x32_bf16 v[180:183], v[204:207], a[236:239], v[180:183]
v_add_u32 v11, 65536, v7
v_add_u32 v15, 131072, v7
v_mfma_f32_16x16x32_bf16 v[148:151], v[204:207], a[228:231], v[148:151]
ds_read_b64_tr_b16 v[196:197], v24 offset:24576
s_lshl_b32 s82, s83, 1
s_add_u32 s82, s82, s84
v_mfma_f32_16x16x32_bf16 v[148:151], v[200:203], a[224:227], v[148:151]
ds_read_b64_tr_b16 v[198:199], v24 offset:28672
s_waitcnt lgkmcnt(8)
v_mfma_f32_16x16x32_bf16 v[152:155], v[208:211], a[224:227], v[152:155]
ds_read_b64_tr_b16 v[200:201], v25 offset:16384
ds_read_b64_tr_b16 v[202:203], v25 offset:20480
v_mfma_f32_16x16x32_bf16 v[152:155], v[212:215], a[228:231], v[152:155]
s_lshl_b32 s82, s82, 1
s_lshr_b32 s80, s50, 1
s_add_u32 s82, s82, s80
s_lshl_b32 s82, s82, 10
v_mfma_f32_16x16x32_bf16 v[184:187], v[212:215], a[236:239], v[184:187]
ds_read_b64_tr_b16 v[204:205], v25 offset:24576
s_add_u32 s82, s82, 16384
v_and_b32 v224, 511, v41
v_mfma_f32_16x16x32_bf16 v[184:187], v[208:211], a[232:235], v[184:187]
ds_read_b64_tr_b16 v[206:207], v25 offset:28672
s_waitcnt lgkmcnt(8)
v_mfma_f32_16x16x32_bf16 v[188:191], v[216:219], a[232:235], v[188:191]
ds_read_b64_tr_b16 v[208:209], v26 offset:16384
ds_read_b64_tr_b16 v[210:211], v26 offset:20480
v_mfma_f32_16x16x32_bf16 v[188:191], v[220:223], a[236:239], v[188:191]
v_mfma_f32_16x16x32_bf16 v[156:159], v[220:223], a[228:231], v[156:159]
ds_read_b64_tr_b16 v[212:213], v26 offset:24576
v_mfma_f32_16x16x32_bf16 v[156:159], v[216:219], a[224:227], v[156:159]
ds_read_b64_tr_b16 v[214:215], v26 offset:28672
s_waitcnt vmcnt(15) lgkmcnt(8)
v_mfma_f32_16x16x32_bf16 v[128:131], v[192:195], a[144:147], v[128:131]
ds_read_b64_tr_b16 v[216:217], v27 offset:16384
ds_read_b64_tr_b16 v[218:219], v27 offset:20480
v_mfma_f32_16x16x32_bf16 v[128:131], v[196:199], a[148:151], v[128:131]
v_mfma_f32_16x16x32_bf16 v[160:163], v[196:199], a[156:159], v[160:163]
ds_read_b64_tr_b16 v[220:221], v27 offset:24576
v_mfma_f32_16x16x32_bf16 v[160:163], v[192:195], a[152:155], v[160:163]
ds_read_b64_tr_b16 v[222:223], v27 offset:28672
s_waitcnt lgkmcnt(8)
v_mfma_f32_16x16x32_bf16 v[164:167], v[200:203], a[152:155], v[164:167]
ds_read_b64_tr_b16 v[192:193], v28 offset:16384
ds_read_b64_tr_b16 v[194:195], v28 offset:20480
v_mfma_f32_16x16x32_bf16 v[164:167], v[204:207], a[156:159], v[164:167]
v_mfma_f32_16x16x32_bf16 v[132:135], v[204:207], a[148:151], v[132:135]
ds_read_b64_tr_b16 v[196:197], v28 offset:24576
v_mfma_f32_16x16x32_bf16 v[132:135], v[200:203], a[144:147], v[132:135]
ds_read_b64_tr_b16 v[198:199], v28 offset:28672
s_waitcnt lgkmcnt(8)
v_mfma_f32_16x16x32_bf16 v[136:139], v[208:211], a[144:147], v[136:139]
ds_read_b64_tr_b16 v[200:201], v29 offset:16384
ds_read_b64_tr_b16 v[202:203], v29 offset:20480
v_mfma_f32_16x16x32_bf16 v[136:139], v[212:215], a[148:151], v[136:139]
v_mfma_f32_16x16x32_bf16 v[168:171], v[212:215], a[156:159], v[168:171]
ds_read_b64_tr_b16 v[204:205], v29 offset:24576
v_mfma_f32_16x16x32_bf16 v[168:171], v[208:211], a[152:155], v[168:171]
ds_read_b64_tr_b16 v[206:207], v29 offset:28672
s_waitcnt lgkmcnt(8)
v_mfma_f32_16x16x32_bf16 v[172:175], v[216:219], a[152:155], v[172:175]
ds_read_b64_tr_b16 v[208:209], v30 offset:16384
ds_read_b64_tr_b16 v[210:211], v30 offset:20480
v_mfma_f32_16x16x32_bf16 v[172:175], v[220:223], a[156:159], v[172:175]
v_mfma_f32_16x16x32_bf16 v[140:143], v[220:223], a[148:151], v[140:143]
ds_read_b64_tr_b16 v[212:213], v30 offset:24576
v_mfma_f32_16x16x32_bf16 v[140:143], v[216:219], a[144:147], v[140:143]
ds_read_b64_tr_b16 v[214:215], v30 offset:28672
s_waitcnt lgkmcnt(8)
v_mfma_f32_16x16x32_bf16 v[144:147], v[192:195], a[144:147], v[144:147]
ds_read_b64_tr_b16 v[216:217], v31 offset:16384
ds_read_b64_tr_b16 v[218:219], v31 offset:20480
v_mfma_f32_16x16x32_bf16 v[144:147], v[196:199], a[148:151], v[144:147]
v_mfma_f32_16x16x32_bf16 v[176:179], v[196:199], a[156:159], v[176:179]
ds_read_b64_tr_b16 v[220:221], v31 offset:24576
v_mfma_f32_16x16x32_bf16 v[176:179], v[192:195], a[152:155], v[176:179]
ds_read_b64_tr_b16 v[222:223], v31 offset:28672
s_waitcnt lgkmcnt(8)
s_waitcnt vmcnt(0)
v_mov_b32 v60, s87
buffer_store_dword v60, v40, s[88:91], s81 offen sc1
v_mfma_f32_16x16x32_bf16 v[180:183], v[200:203], a[152:155], v[180:183]
ds_read_b64_tr_b16 v[192:193], v229 offset:16384
ds_read_b64_tr_b16 v[194:195], v229 offset:20480
v_mfma_f32_16x16x32_bf16 v[180:183], v[204:207], a[156:159], v[180:183]
v_mfma_f32_16x16x32_bf16 v[148:151], v[204:207], a[148:151], v[148:151]
ds_read_b64_tr_b16 v[196:197], v229 offset:24576
v_mfma_f32_16x16x32_bf16 v[148:151], v[200:203], a[144:147], v[148:151]
ds_read_b64_tr_b16 v[198:199], v229 offset:28672
s_waitcnt lgkmcnt(8)
s_waitcnt vmcnt(24)
s_barrier
v_mfma_f32_16x16x32_bf16 v[152:155], v[208:211], a[144:147], v[152:155]
ds_read_b64_tr_b16 v[200:201], v230 offset:16384
ds_read_b64_tr_b16 v[202:203], v230 offset:20480
v_mfma_f32_16x16x32_bf16 v[152:155], v[212:215], a[148:151], v[152:155]
s_add_u32 m0, s40, 114688
s_xor_b32 s43, s100, 0
buffer_load_dwordx4 v16, s[20:23], s43 offen lds
v_mfma_f32_16x16x32_bf16 v[184:187], v[212:215], a[156:159], v[184:187]
ds_read_b64_tr_b16 v[204:205], v230 offset:24576
v_mfma_f32_16x16x32_bf16 v[184:187], v[208:211], a[152:155], v[184:187]
ds_read_b64_tr_b16 v[206:207], v230 offset:28672
s_waitcnt lgkmcnt(8)
v_mfma_f32_16x16x32_bf16 v[188:191], v[216:219], a[152:155], v[188:191]
ds_read_b64_tr_b16 v[208:209], v231 offset:16384
ds_read_b64_tr_b16 v[210:211], v231 offset:20480
v_mfma_f32_16x16x32_bf16 v[188:191], v[220:223], a[156:159], v[188:191]
buffer_load_dwordx4 v17, s[20:23], s43 offen offset:1024 lds
v_mfma_f32_16x16x32_bf16 v[156:159], v[220:223], a[148:151], v[156:159]
ds_read_b64_tr_b16 v[212:213], v231 offset:24576
v_mfma_f32_16x16x32_bf16 v[156:159], v[216:219], a[144:147], v[156:159]
ds_read_b64_tr_b16 v[214:215], v231 offset:28672
s_waitcnt lgkmcnt(8)
v_mfma_f32_16x16x32_bf16 v[128:131], v[192:195], a[240:243], v[128:131]
ds_read_b64_tr_b16 v[216:217], v232 offset:16384
ds_read_b64_tr_b16 v[218:219], v232 offset:20480
v_mfma_f32_16x16x32_bf16 v[128:131], v[196:199], a[244:247], v[128:131]
buffer_load_dwordx4 v18, s[20:23], s43 offen offset:2048 lds
v_mfma_f32_16x16x32_bf16 v[160:163], v[196:199], a[252:255], v[160:163]
ds_read_b64_tr_b16 v[220:221], v232 offset:24576
v_mfma_f32_16x16x32_bf16 v[160:163], v[192:195], a[248:251], v[160:163]
ds_read_b64_tr_b16 v[222:223], v232 offset:28672
s_waitcnt lgkmcnt(8)
v_mfma_f32_16x16x32_bf16 v[164:167], v[200:203], a[248:251], v[164:167]
ds_read_b64_tr_b16 v[192:193], v233 offset:16384
ds_read_b64_tr_b16 v[194:195], v233 offset:20480
v_mfma_f32_16x16x32_bf16 v[164:167], v[204:207], a[252:255], v[164:167]
buffer_load_dwordx4 v19, s[20:23], s43 offen offset:3072 lds
v_mfma_f32_16x16x32_bf16 v[132:135], v[204:207], a[244:247], v[132:135]
ds_read_b64_tr_b16 v[196:197], v233 offset:24576
s_add_u32 m0, s40, 65536
s_xor_b32 s43, s101, 0
buffer_load_dwordx4 v16, s[20:23], s43 offen lds
v_mfma_f32_16x16x32_bf16 v[132:135], v[200:203], a[240:243], v[132:135]
ds_read_b64_tr_b16 v[198:199], v233 offset:28672
s_waitcnt lgkmcnt(8)
v_mfma_f32_16x16x32_bf16 v[136:139], v[208:211], a[240:243], v[136:139]
ds_read_b64_tr_b16 v[200:201], v234 offset:16384
ds_read_b64_tr_b16 v[202:203], v234 offset:20480
v_mfma_f32_16x16x32_bf16 v[136:139], v[212:215], a[244:247], v[136:139]
buffer_load_dwordx4 v17, s[20:23], s43 offen offset:1024 lds
v_mfma_f32_16x16x32_bf16 v[168:171], v[212:215], a[252:255], v[168:171]
ds_read_b64_tr_b16 v[204:205], v234 offset:24576
v_mfma_f32_16x16x32_bf16 v[168:171], v[208:211], a[248:251], v[168:171]
ds_read_b64_tr_b16 v[206:207], v234 offset:28672
s_waitcnt lgkmcnt(8)
v_mfma_f32_16x16x32_bf16 v[172:175], v[216:219], a[248:251], v[172:175]
ds_read_b64_tr_b16 v[208:209], v235 offset:16384
ds_read_b64_tr_b16 v[210:211], v235 offset:20480
v_mfma_f32_16x16x32_bf16 v[172:175], v[220:223], a[252:255], v[172:175]
buffer_load_dwordx4 v18, s[20:23], s43 offen offset:2048 lds
v_mfma_f32_16x16x32_bf16 v[140:143], v[220:223], a[244:247], v[140:143]
ds_read_b64_tr_b16 v[212:213], v235 offset:24576
v_mfma_f32_16x16x32_bf16 v[140:143], v[216:219], a[240:243], v[140:143]
ds_read_b64_tr_b16 v[214:215], v235 offset:28672
s_waitcnt lgkmcnt(8)
v_mfma_f32_16x16x32_bf16 v[144:147], v[192:195], a[240:243], v[144:147]
ds_read_b64_tr_b16 v[216:217], v236 offset:16384
ds_read_b64_tr_b16 v[218:219], v236 offset:20480
v_mfma_f32_16x16x32_bf16 v[144:147], v[196:199], a[244:247], v[144:147]
buffer_load_dwordx4 v19, s[20:23], s43 offen offset:3072 lds
v_mfma_f32_16x16x32_bf16 v[176:179], v[196:199], a[252:255], v[176:179]
ds_read_b64_tr_b16 v[220:221], v236 offset:24576
v_mfma_f32_16x16x32_bf16 v[176:179], v[192:195], a[248:251], v[176:179]
ds_read_b64_tr_b16 v[222:223], v236 offset:28672
s_waitcnt lgkmcnt(8)
v_mfma_f32_16x16x32_bf16 v[180:183], v[200:203], a[248:251], v[180:183]
ds_read_b64_tr_b16 v[192:193], v24 offset:32768
ds_read_b64_tr_b16 v[194:195], v24 offset:36864
v_mfma_f32_16x16x32_bf16 v[180:183], v[204:207], a[252:255], v[180:183]
s_add_u32 m0, s40, 49152
s_xor_b32 s43, s100, 131072
buffer_load_dwordx4 v16, s[20:23], s43 offen lds
v_mfma_f32_16x16x32_bf16 v[148:151], v[204:207], a[244:247], v[148:151]
ds_read_b64_tr_b16 v[196:197], v24 offset:40960
buffer_load_dwordx4 v17, s[20:23], s43 offen offset:1024 lds
v_mfma_f32_16x16x32_bf16 v[148:151], v[200:203], a[240:243], v[148:151]
ds_read_b64_tr_b16 v[198:199], v24 offset:45056
s_waitcnt lgkmcnt(8)
v_mfma_f32_16x16x32_bf16 v[152:155], v[208:211], a[240:243], v[152:155]
ds_read_b64_tr_b16 v[200:201], v25 offset:32768
ds_read_b64_tr_b16 v[202:203], v25 offset:36864
v_mfma_f32_16x16x32_bf16 v[152:155], v[212:215], a[244:247], v[152:155]
buffer_load_dwordx4 v18, s[20:23], s43 offen offset:2048 lds
v_mfma_f32_16x16x32_bf16 v[184:187], v[212:215], a[252:255], v[184:187]
ds_read_b64_tr_b16 v[204:205], v25 offset:40960
v_mfma_f32_16x16x32_bf16 v[184:187], v[208:211], a[248:251], v[184:187]
ds_read_b64_tr_b16 v[206:207], v25 offset:45056
s_waitcnt lgkmcnt(8)
v_mfma_f32_16x16x32_bf16 v[188:191], v[216:219], a[248:251], v[188:191]
ds_read_b64_tr_b16 v[208:209], v26 offset:32768
ds_read_b64_tr_b16 v[210:211], v26 offset:36864
v_mfma_f32_16x16x32_bf16 v[188:191], v[220:223], a[252:255], v[188:191]
buffer_load_dwordx4 v19, s[20:23], s43 offen offset:3072 lds
v_mfma_f32_16x16x32_bf16 v[156:159], v[220:223], a[244:247], v[156:159]
ds_read_b64_tr_b16 v[212:213], v26 offset:40960
v_mfma_f32_16x16x32_bf16 v[156:159], v[216:219], a[240:243], v[156:159]
ds_read_b64_tr_b16 v[214:215], v26 offset:45056
s_waitcnt lgkmcnt(8)
v_mfma_f32_16x16x32_bf16 v[128:131], v[192:195], a[160:163], v[128:131]
ds_read_b64_tr_b16 v[216:217], v27 offset:32768
ds_read_b64_tr_b16 v[218:219], v27 offset:36864
v_mfma_f32_16x16x32_bf16 v[128:131], v[196:199], a[164:167], v[128:131]
s_add_u32 m0, s40, 0
s_xor_b32 s43, s101, 131072
buffer_load_dwordx4 v16, s[20:23], s43 offen lds
v_mfma_f32_16x16x32_bf16 v[160:163], v[196:199], a[172:175], v[160:163]
ds_read_b64_tr_b16 v[220:221], v27 offset:40960
v_mfma_f32_16x16x32_bf16 v[160:163], v[192:195], a[168:171], v[160:163]
ds_read_b64_tr_b16 v[222:223], v27 offset:45056
s_waitcnt lgkmcnt(8)
v_mfma_f32_16x16x32_bf16 v[164:167], v[200:203], a[168:171], v[164:167]
ds_read_b64_tr_b16 v[192:193], v28 offset:32768
ds_read_b64_tr_b16 v[194:195], v28 offset:36864
v_mfma_f32_16x16x32_bf16 v[164:167], v[204:207], a[172:175], v[164:167]
buffer_load_dwordx4 v17, s[20:23], s43 offen offset:1024 lds
v_mfma_f32_16x16x32_bf16 v[132:135], v[204:207], a[164:167], v[132:135]
ds_read_b64_tr_b16 v[196:197], v28 offset:40960
buffer_load_dwordx4 v18, s[20:23], s43 offen offset:2048 lds
v_mfma_f32_16x16x32_bf16 v[132:135], v[200:203], a[160:163], v[132:135]
ds_read_b64_tr_b16 v[198:199], v28 offset:45056
s_waitcnt lgkmcnt(8)
buffer_load_dword v60, v224, s[88:91], s82 offen sc1
v_mfma_f32_16x16x32_bf16 v[136:139], v[208:211], a[160:163], v[136:139]
ds_read_b64_tr_b16 v[200:201], v29 offset:32768
ds_read_b64_tr_b16 v[202:203], v29 offset:36864
v_mfma_f32_16x16x32_bf16 v[136:139], v[212:215], a[164:167], v[136:139]
buffer_load_dwordx4 v19, s[20:23], s43 offen offset:3072 lds
v_mfma_f32_16x16x32_bf16 v[168:171], v[212:215], a[172:175], v[168:171]
ds_read_b64_tr_b16 v[204:205], v29 offset:40960
v_mfma_f32_16x16x32_bf16 v[168:171], v[208:211], a[168:171], v[168:171]
ds_read_b64_tr_b16 v[206:207], v29 offset:45056
s_waitcnt lgkmcnt(8)
v_mfma_f32_16x16x32_bf16 v[172:175], v[216:219], a[168:171], v[172:175]
L_pad11:
s_cbranch_execz L_walked
ds_read_b64_tr_b16 v[208:209], v30 offset:32768
ds_read_b64_tr_b16 v[210:211], v30 offset:36864
v_mfma_f32_16x16x32_bf16 v[172:175], v[220:223], a[172:175], v[172:175]
s_add_u32 m0, s40, 131072
s_xor_b32 s43, s100, 262144
buffer_load_dwordx4 v16, s[20:23], s43 offen lds
v_mfma_f32_16x16x32_bf16 v[140:143], v[220:223], a[164:167], v[140:143]
ds_read_b64_tr_b16 v[212:213], v30 offset:40960
v_mfma_f32_16x16x32_bf16 v[140:143], v[216:219], a[160:163], v[140:143]
ds_read_b64_tr_b16 v[214:215], v30 offset:45056
s_waitcnt lgkmcnt(8)
v_mfma_f32_16x16x32_bf16 v[144:147], v[192:195], a[160:163], v[144:147]
ds_read_b64_tr_b16 v[216:217], v31 offset:32768
ds_read_b64_tr_b16 v[218:219], v31 offset:36864
v_mfma_f32_16x16x32_bf16 v[144:147], v[196:199], a[164:167], v[144:147]
buffer_load_dwordx4 v17, s[20:23], s43 offen offset:1024 lds
v_mfma_f32_16x16x32_bf16 v[176:179], v[196:199], a[172:175], v[176:179]
ds_read_b64_tr_b16 v[220:221], v31 offset:40960
v_mfma_f32_16x16x32_bf16 v[176:179], v[192:195], a[168:171], v[176:179]
ds_read_b64_tr_b16 v[222:223], v31 offset:45056
s_waitcnt lgkmcnt(8)
v_mfma_f32_16x16x32_bf16 v[180:183], v[200:203], a[168:171], v[180:183]
ds_read_b64_tr_b16 v[192:193], v229 offset:32768
ds_read_b64_tr_b16 v[194:195], v229 offset:36864
v_mfma_f32_16x16x32_bf16 v[180:183], v[204:207], a[172:175], v[180:183]
buffer_load_dwordx4 v18, s[20:23], s43 offen offset:2048 lds
v_mfma_f32_16x16x32_bf16 v[148:151], v[204:207], a[164:167], v[148:151]
ds_read_b64_tr_b16 v[196:197], v229 offset:40960
buffer_load_dwordx4 v19, s[20:23], s43 offen offset:3072 lds
v_mfma_f32_16x16x32_bf16 v[148:151], v[200:203], a[160:163], v[148:151]
ds_read_b64_tr_b16 v[198:199], v229 offset:45056
s_waitcnt lgkmcnt(8)
v_mfma_f32_16x16x32_bf16 v[152:155], v[208:211], a[160:163], v[152:155]
ds_read_b64_tr_b16 v[200:201], v230 offset:32768
ds_read_b64_tr_b16 v[202:203], v230 offset:36864
v_mfma_f32_16x16x32_bf16 v[152:155], v[212:215], a[164:167], v[152:155]
s_add_u32 m0, s40, 147456
s_xor_b32 s43, s101, 262144
buffer_load_dwordx4 v16, s[20:23], s43 offen lds
v_mfma_f32_16x16x32_bf16 v[184:187], v[212:215], a[172:175], v[184:187]
ds_read_b64_tr_b16 v[204:205], v230 offset:40960
v_mfma_f32_16x16x32_bf16 v[184:187], v[208:211], a[168:171], v[184:187]
ds_read_b64_tr_b16 v[206:207], v230 offset:45056
s_waitcnt lgkmcnt(8)
v_mfma_f32_16x16x32_bf16 v[188:191], v[216:219], a[168:171], v[188:191]
ds_read_b64_tr_b16 v[208:209], v231 offset:32768
ds_read_b64_tr_b16 v[210:211], v231 offset:36864
v_mfma_f32_16x16x32_bf16 v[188:191], v[220:223], a[172:175], v[188:191]
buffer_load_dwordx4 v17, s[20:23], s43 offen offset:1024 lds
v_mfma_f32_16x16x32_bf16 v[156:159], v[220:223], a[164:167], v[156:159]
ds_read_b64_tr_b16 v[212:213], v231 offset:40960
v_mfma_f32_16x16x32_bf16 v[156:159], v[216:219], a[160:163], v[156:159]
ds_read_b64_tr_b16 v[214:215], v231 offset:45056
s_waitcnt lgkmcnt(8)
s_waitcnt vmcnt(7)
v_cmp_ne_u32 vcc, s87, v60
s_cbranch_vccnz L_owait
L_ook:
v_mfma_f32_16x16x32_bf16 v[128:131], v[192:195], v[240:243], v[128:131]
ds_read_b64_tr_b16 v[216:217], v232 offset:32768
ds_read_b64_tr_b16 v[218:219], v232 offset:36864
v_mfma_f32_16x16x32_bf16 v[128:131], v[196:199], v[244:247], v[128:131]
s_xor_b32 s44, s46, 0
buffer_load_dwordx4 a[0:3], v36, s[28:31], s44 offen sc1
v_mfma_f32_16x16x32_bf16 v[160:163], v[196:199], v[252:255], v[160:163]
ds_read_b64_tr_b16 v[220:221], v232 offset:40960
v_lshlrev_b32 v20, 4, v0
v_mfma_f32_16x16x32_bf16 v[160:163], v[192:195], v[248:251], v[160:163]
ds_read_b64_tr_b16 v[222:223], v232 offset:45056
s_waitcnt lgkmcnt(8)
v_mfma_f32_16x16x32_bf16 v[164:167], v[200:203], v[248:251], v[164:167]
ds_read_b64_tr_b16 v[192:193], v233 offset:32768
ds_read_b64_tr_b16 v[194:195], v233 offset:36864
v_mfma_f32_16x16x32_bf16 v[164:167], v[204:207], v[252:255], v[164:167]
buffer_load_dwordx4 a[4:7], v36, s[28:31], s44 offen offset:1024 sc1
v_mfma_f32_16x16x32_bf16 v[132:135], v[204:207], v[244:247], v[132:135]
ds_read_b64_tr_b16 v[196:197], v233 offset:40960
buffer_load_dwordx4 a[8:11], v36, s[28:31], s44 offen offset:2048 sc1
v_mfma_f32_16x16x32_bf16 v[132:135], v[200:203], v[240:243], v[132:135]
ds_read_b64_tr_b16 v[198:199], v233 offset:45056
s_waitcnt lgkmcnt(8)
v_mfma_f32_16x16x32_bf16 v[136:139], v[208:211], v[240:243], v[136:139]
ds_read_b64_tr_b16 v[200:201], v234 offset:32768
ds_read_b64_tr_b16 v[202:203], v234 offset:36864
v_mfma_f32_16x16x32_bf16 v[136:139], v[212:215], v[244:247], v[136:139]
buffer_load_dwordx4 a[12:15], v36, s[28:31], s44 offen offset:3072 sc1
v_mfma_f32_16x16x32_bf16 v[168:171], v[212:215], v[252:255], v[168:171]
ds_read_b64_tr_b16 v[204:205], v234 offset:40960
v_lshl_add_u32 v20, v1, 11, v20
v_mfma_f32_16x16x32_bf16 v[168:171], v[208:211], v[248:251], v[168:171]
ds_read_b64_tr_b16 v[206:207], v234 offset:45056
s_waitcnt lgkmcnt(8)
v_mfma_f32_16x16x32_bf16 v[172:175], v[216:219], v[248:251], v[172:175]
ds_read_b64_tr_b16 v[208:209], v235 offset:32768
ds_read_b64_tr_b16 v[210:211], v235 offset:36864
v_mfma_f32_16x16x32_bf16 v[172:175], v[220:223], v[252:255], v[172:175]
buffer_load_dwordx4 a[16:19], v37, s[28:31], s44 offen sc1
v_mfma_f32_16x16x32_bf16 v[140:143], v[220:223], v[244:247], v[140:143]
ds_read_b64_tr_b16 v[212:213], v235 offset:40960
v_lshl_add_u32 v21, v1, 5, v2
v_mfma_f32_16x16x32_bf16 v[140:143], v[216:219], v[240:243], v[140:143]
ds_read_b64_tr_b16 v[214:215], v235 offset:45056
s_waitcnt lgkmcnt(8)
v_mfma_f32_16x16x32_bf16 v[144:147], v[192:195], v[240:243], v[144:147]
ds_read_b64_tr_b16 v[216:217], v236 offset:32768
ds_read_b64_tr_b16 v[218:219], v236 offset:36864
v_mfma_f32_16x16x32_bf16 v[144:147], v[196:199], v[244:247], v[144:147]
buffer_load_dwordx4 a[20:23], v37, s[28:31], s44 offen offset:1024 sc1
v_mfma_f32_16x16x32_bf16 v[176:179], v[196:199], v[252:255], v[176:179]
ds_read_b64_tr_b16 v[220:221], v236 offset:40960
v_lshlrev_b32 v21, 10, v21
v_mfma_f32_16x16x32_bf16 v[176:179], v[192:195], v[248:251], v[176:179]
ds_read_b64_tr_b16 v[222:223], v236 offset:45056
s_waitcnt lgkmcnt(8)
s_waitcnt vmcnt(21)
s_barrier
v_mfma_f32_16x16x32_bf16 v[180:183], v[200:203], v[248:251], v[180:183]
ds_read_b64_tr_b16 v[192:193], v8 offset:49152
ds_read_b64_tr_b16 v[194:195], v8 offset:51200
v_mfma_f32_16x16x32_bf16 v[180:183], v[204:207], v[252:255], v[180:183]
buffer_load_dwordx4 a[24:27], v37, s[28:31], s44 offen offset:2048 sc1
v_mfma_f32_16x16x32_bf16 v[148:151], v[204:207], v[244:247], v[148:151]
ds_read_b64_tr_b16 v[196:197], v8 offset:53248
buffer_load_dwordx4 a[28:31], v37, s[28:31], s44 offen offset:3072 sc1
v_mfma_f32_16x16x32_bf16 v[148:151], v[200:203], v[240:243], v[148:151]
ds_read_b64_tr_b16 v[198:199], v8 offset:55296
s_waitcnt lgkmcnt(8)
v_mfma_f32_16x16x32_bf16 v[152:155], v[208:211], v[240:243], v[152:155]
ds_read_b64_tr_b16 v[200:201], v8 offset:57344
ds_read_b64_tr_b16 v[202:203], v8 offset:59392
v_mfma_f32_16x16x32_bf16 v[152:155], v[212:215], v[244:247], v[152:155]
s_xor_b32 s44, s46, 4096
buffer_load_dwordx4 a[32:35], v36, s[28:31], s44 offen offset:1024 sc1
v_mfma_f32_16x16x32_bf16 v[184:187], v[212:215], v[252:255], v[184:187]
ds_read_b64_tr_b16 v[204:205], v8 offset:61440
v_lshl_add_u32 v21, v3, 4, v21
v_mfma_f32_16x16x32_bf16 v[184:187], v[208:211], v[248:251], v[184:187]
ds_read_b64_tr_b16 v[206:207], v8 offset:63488
s_waitcnt lgkmcnt(8)
v_mfma_f32_16x16x32_bf16 v[188:191], v[216:219], v[248:251], v[188:191]
ds_read_b64_tr_b16 v[208:209], v9 offset:49152
ds_read_b64_tr_b16 v[210:211], v9 offset:51200
v_mfma_f32_16x16x32_bf16 v[188:191], v[220:223], v[252:255], v[188:191]
buffer_load_dwordx4 a[36:39], v36, s[28:31], s44 offen sc1
v_mfma_f32_16x16x32_bf16 v[156:159], v[220:223], v[244:247], v[156:159]
ds_read_b64_tr_b16 v[212:213], v9 offset:53248
v_mfma_f32_16x16x32_bf16 v[156:159], v[216:219], v[240:243], v[156:159]
ds_read_b64_tr_b16 v[214:215], v9 offset:55296
s_waitcnt lgkmcnt(8)
s_waitcnt vmcnt(2)
v_mfma_f32_16x16x32_bf16 v[80:83], v[192:195], a[0:3], 0
ds_read_b64_tr_b16 v[216:217], v9 offset:57344
ds_read_b64_tr_b16 v[218:219], v9 offset:59392
v_mfma_f32_16x16x32_bf16 v[80:83], v[196:199], a[4:7], v[80:83]
buffer_load_dwordx4 a[40:43], v36, s[28:31], s44 offen offset:3072 sc1
v_mfma_f32_16x16x32_bf16 v[112:115], v[196:199], a[20:23], 0
ds_read_b64_tr_b16 v[220:221], v9 offset:61440
v_mfma_f32_16x16x32_bf16 v[112:115], v[192:195], a[16:19], v[112:115]
ds_read_b64_tr_b16 v[222:223], v9 offset:63488
s_waitcnt lgkmcnt(8)
v_mfma_f32_16x16x32_bf16 v[112:115], v[200:203], a[24:27], v[112:115]
ds_read_b64_tr_b16 v[192:193], v10 offset:49152
ds_read_b64_tr_b16 v[194:195], v10 offset:51200
v_mfma_f32_16x16x32_bf16 v[112:115], v[204:207], a[28:31], v[112:115]
buffer_load_dwordx4 a[44:47], v36, s[28:31], s44 offen offset:2048 sc1
v_mfma_f32_16x16x32_bf16 v[80:83], v[204:207], a[12:15], v[80:83]
ds_read_b64_tr_b16 v[196:197], v10 offset:53248
buffer_load_dwordx4 a[48:51], v37, s[28:31], s44 offen offset:1024 sc1
v_mfma_f32_16x16x32_bf16 v[80:83], v[200:203], a[8:11], v[80:83]
ds_read_b64_tr_b16 v[198:199], v10 offset:55296
s_waitcnt lgkmcnt(8)
v_mfma_f32_16x16x32_bf16 v[84:87], v[208:211], a[0:3], 0
ds_read_b64_tr_b16 v[200:201], v10 offset:57344
ds_read_b64_tr_b16 v[202:203], v10 offset:59392
v_mfma_f32_16x16x32_bf16 v[84:87], v[212:215], a[4:7], v[84:87]
buffer_load_dwordx4 a[52:55], v37, s[28:31], s44 offen sc1
v_mfma_f32_16x16x32_bf16 v[116:119], v[212:215], a[20:23], 0
ds_read_b64_tr_b16 v[204:205], v10 offset:61440
s_xor_b32 s80, s83, 1
s_mul_i32 s80, s80, 49152
v_mfma_f32_16x16x32_bf16 v[116:119], v[208:211], a[16:19], v[116:119]
ds_read_b64_tr_b16 v[206:207], v10 offset:63488
s_waitcnt lgkmcnt(8)
v_mfma_f32_16x16x32_bf16 v[116:119], v[216:219], a[24:27], v[116:119]
ds_read_b64_tr_b16 v[208:209], v11 offset:49152
ds_read_b64_tr_b16 v[210:211], v11 offset:51200
v_mfma_f32_16x16x32_bf16 v[116:119], v[220:223], a[28:31], v[116:119]
buffer_load_dwordx4 a[56:59], v37, s[28:31], s44 offen offset:3072 sc1
v_mfma_f32_16x16x32_bf16 v[84:87], v[220:223], a[12:15], v[84:87]
ds_read_b64_tr_b16 v[212:213], v11 offset:53248
s_add_u32 s80, s80, 0
v_mfma_f32_16x16x32_bf16 v[84:87], v[216:219], a[8:11], v[84:87]
ds_read_b64_tr_b16 v[214:215], v11 offset:55296
s_waitcnt lgkmcnt(8)
v_mfma_f32_16x16x32_bf16 v[88:91], v[192:195], a[0:3], 0
ds_read_b64_tr_b16 v[216:217], v11 offset:57344
ds_read_b64_tr_b16 v[218:219], v11 offset:59392
v_mfma_f32_16x16x32_bf16 v[88:91], v[196:199], a[4:7], v[88:91]
buffer_load_dwordx4 a[60:63], v37, s[28:31], s44 offen offset:2048 sc1
v_mfma_f32_16x16x32_bf16 v[120:123], v[196:199], a[20:23], 0
ds_read_b64_tr_b16 v[220:221], v11 offset:61440
buffer_load_dwordx4 v18, s[20:23], s43 offen offset:2048 lds
v_mfma_f32_16x16x32_bf16 v[120:123], v[192:195], a[16:19], v[120:123]
ds_read_b64_tr_b16 v[222:223], v11 offset:63488
s_waitcnt lgkmcnt(8)
v_mfma_f32_16x16x32_bf16 v[120:123], v[200:203], a[24:27], v[120:123]
ds_read_b64_tr_b16 v[192:193], v10 offset:0
ds_read_b64_tr_b16 v[194:195], v10 offset:2048
v_mfma_f32_16x16x32_bf16 v[120:123], v[204:207], a[28:31], v[120:123]
buffer_load_dwordx4 v19, s[20:23], s43 offen offset:3072 lds
v_mfma_f32_16x16x32_bf16 v[88:91], v[204:207], a[12:15], v[88:91]
ds_read_b64_tr_b16 v[196:197], v10 offset:4096
v_cvt_pk_bf16_f32 v136, v136, v137
v_mfma_f32_16x16x32_bf16 v[88:91], v[200:203], a[8:11], v[88:91]
ds_read_b64_tr_b16 v[198:199], v10 offset:6144
s_waitcnt lgkmcnt(8)
v_mfma_f32_16x16x32_bf16 v[92:95], v[208:211], a[0:3], 0
ds_read_b64_tr_b16 v[200:201], v10 offset:8192
ds_read_b64_tr_b16 v[202:203], v10 offset:10240
v_mfma_f32_16x16x32_bf16 v[92:95], v[212:215], a[4:7], v[92:95]
s_xor_b32 s44, s46, 8192
buffer_load_dwordx4 a[64:67], v36, s[28:31], s44 offen offset:2048 sc1
v_mfma_f32_16x16x32_bf16 v[124:127], v[212:215], a[20:23], 0
ds_read_b64_tr_b16 v[204:205], v10 offset:12288
v_cvt_pk_bf16_f32 v137, v138, v139
v_mfma_f32_16x16x32_bf16 v[124:127], v[208:211], a[16:19], v[124:127]
ds_read_b64_tr_b16 v[206:207], v10 offset:14336
s_waitcnt lgkmcnt(8)
v_mfma_f32_16x16x32_bf16 v[124:127], v[216:219], a[24:27], v[124:127]
ds_read_b64_tr_b16 v[208:209], v11 offset:0
ds_read_b64_tr_b16 v[210:211], v11 offset:2048
v_mfma_f32_16x16x32_bf16 v[124:127], v[220:223], a[28:31], v[124:127]
buffer_load_dwordx4 a[68:71], v36, s[28:31], s44 offen offset:3072 sc1
v_mfma_f32_16x16x32_bf16 v[92:95], v[220:223], a[12:15], v[92:95]
ds_read_b64_tr_b16 v[212:213], v11 offset:4096
buffer_load_dwordx4 a[72:75], v36, s[28:31], s44 offen sc1
v_mfma_f32_16x16x32_bf16 v[92:95], v[216:219], a[8:11], v[92:95]
ds_read_b64_tr_b16 v[214:215], v11 offset:6144
s_waitcnt lgkmcnt(8)
v_mfma_f32_16x16x32_bf16 v[72:75], v[192:195], a[0:3], 0
ds_read_b64_tr_b16 v[216:217], v11 offset:8192
ds_read_b64_tr_b16 v[218:219], v11 offset:10240
v_mfma_f32_16x16x32_bf16 v[72:75], v[196:199], a[4:7], v[72:75]
buffer_load_dwordx4 a[76:79], v36, s[28:31], s44 offen offset:1024 sc1
v_mfma_f32_16x16x32_bf16 v[104:107], v[196:199], a[20:23], 0
ds_read_b64_tr_b16 v[220:221], v11 offset:12288
v_cvt_pk_bf16_f32 v138, v140, v141
v_mfma_f32_16x16x32_bf16 v[104:107], v[192:195], a[16:19], v[104:107]
ds_read_b64_tr_b16 v[222:223], v11 offset:14336
s_waitcnt lgkmcnt(8)
v_mfma_f32_16x16x32_bf16 v[104:107], v[200:203], a[24:27], v[104:107]
ds_read_b64_tr_b16 v[192:193], v8 offset:0
ds_read_b64_tr_b16 v[194:195], v8 offset:2048
v_mfma_f32_16x16x32_bf16 v[104:107], v[204:207], a[28:31], v[104:107]
buffer_load_dwordx4 a[80:83], v37, s[28:31], s44 offen offset:2048 sc1
v_mfma_f32_16x16x32_bf16 v[72:75], v[204:207], a[12:15], v[72:75]
ds_read_b64_tr_b16 v[196:197], v8 offset:4096
v_cvt_pk_bf16_f32 v139, v142, v143
v_mfma_f32_16x16x32_bf16 v[72:75], v[200:203], a[8:11], v[72:75]
ds_read_b64_tr_b16 v[198:199], v8 offset:6144
s_waitcnt lgkmcnt(8)
v_mfma_f32_16x16x32_bf16 v[76:79], v[208:211], a[0:3], 0
ds_read_b64_tr_b16 v[200:201], v8 offset:8192
ds_read_b64_tr_b16 v[202:203], v8 offset:10240
v_mfma_f32_16x16x32_bf16 v[76:79], v[212:215], a[4:7], v[76:79]
buffer_load_dwordx4 a[84:87], v37, s[28:31], s44 offen offset:3072 sc1
v_mfma_f32_16x16x32_bf16 v[108:111], v[212:215], a[20:23], 0
ds_read_b64_tr_b16 v[204:205], v8 offset:12288
buffer_load_dwordx4 a[88:91], v37, s[28:31], s44 offen sc1
v_mfma_f32_16x16x32_bf16 v[108:111], v[208:211], a[16:19], v[108:111]
ds_read_b64_tr_b16 v[206:207], v8 offset:14336
s_waitcnt lgkmcnt(8)
v_mfma_f32_16x16x32_bf16 v[108:111], v[216:219], a[24:27], v[108:111]
ds_read_b64_tr_b16 v[208:209], v9 offset:0
ds_read_b64_tr_b16 v[210:211], v9 offset:2048
v_mfma_f32_16x16x32_bf16 v[108:111], v[220:223], a[28:31], v[108:111]
buffer_load_dwordx4 a[92:95], v37, s[28:31], s44 offen offset:1024 sc1
v_mfma_f32_16x16x32_bf16 v[76:79], v[220:223], a[12:15], v[76:79]
ds_read_b64_tr_b16 v[212:213], v9 offset:4096
buffer_store_dwordx4 v[136:139], v20, s[52:55], s80 offen sc1
v_mfma_f32_16x16x32_bf16 v[76:79], v[216:219], a[8:11], v[76:79]
ds_read_b64_tr_b16 v[214:215], v9 offset:6144
s_waitcnt lgkmcnt(8)
v_mfma_f32_16x16x32_bf16 v[64:67], v[192:195], a[0:3], 0
ds_read_b64_tr_b16 v[216:217], v9 offset:8192
ds_read_b64_tr_b16 v[218:219], v9 offset:10240
v_mfma_f32_16x16x32_bf16 v[64:67], v[196:199], a[4:7], v[64:67]
v_cvt_pk_bf16_f32 v168, v168, v169
v_mfma_f32_16x16x32_bf16 v[96:99], v[196:199], a[20:23], 0
ds_read_b64_tr_b16 v[220:221], v9 offset:12288
v_mfma_f32_16x16x32_bf16 v[96:99], v[192:195], a[16:19], v[96:99]
ds_read_b64_tr_b16 v[222:223], v9 offset:14336
s_waitcnt lgkmcnt(8)
s_waitcnt vmcnt(33)
s_barrier
v_mfma_f32_16x16x32_bf16 v[96:99], v[200:203], a[24:27], v[96:99]
ds_read_b64_tr_b16 v[192:193], v4 offset:49152
ds_read_b64_tr_b16 v[194:195], v4 offset:51200
v_mfma_f32_16x16x32_bf16 v[96:99], v[204:207], a[28:31], v[96:99]
s_add_u32 m0, s40, 16384
s_xor_b32 s43, s100, 393216
buffer_load_dwordx4 v16, s[20:23], s43 offen lds
v_mfma_f32_16x16x32_bf16 v[64:67], v[204:207], a[12:15], v[64:67]
ds_read_b64_tr_b16 v[196:197], v4 offset:53248
buffer_load_dwordx4 v17, s[20:23], s43 offen offset:1024 lds
v_mfma_f32_16x16x32_bf16 v[64:67], v[200:203], a[8:11], v[64:67]
ds_read_b64_tr_b16 v[198:199], v4 offset:55296
s_waitcnt lgkmcnt(8)
v_mfma_f32_16x16x32_bf16 v[68:71], v[208:211], a[0:3], 0
ds_read_b64_tr_b16 v[200:201], v4 offset:57344
ds_read_b64_tr_b16 v[202:203], v4 offset:59392
v_mfma_f32_16x16x32_bf16 v[68:71], v[212:215], a[4:7], v[68:71]
buffer_load_dwordx4 v18, s[20:23], s43 offen offset:2048 lds
v_mfma_f32_16x16x32_bf16 v[100:103], v[212:215], a[20:23], 0
ds_read_b64_tr_b16 v[204:205], v4 offset:61440
v_cvt_pk_bf16_f32 v169, v170, v171
v_mfma_f32_16x16x32_bf16 v[100:103], v[208:211], a[16:19], v[100:103]
ds_read_b64_tr_b16 v[206:207], v4 offset:63488
s_waitcnt lgkmcnt(8)
v_mfma_f32_16x16x32_bf16 v[100:103], v[216:219], a[24:27], v[100:103]
ds_read_b64_tr_b16 v[208:209], v5 offset:49152
ds_read_b64_tr_b16 v[210:211], v5 offset:51200
v_mfma_f32_16x16x32_bf16 v[100:103], v[220:223], a[28:31], v[100:103]
buffer_load_dwordx4 v19, s[20:23], s43 offen offset:3072 lds
v_mfma_f32_16x16x32_bf16 v[68:71], v[220:223], a[12:15], v[68:71]
ds_read_b64_tr_b16 v[212:213], v5 offset:53248
v_cvt_pk_bf16_f32 v170, v172, v173
v_mfma_f32_16x16x32_bf16 v[68:71], v[216:219], a[8:11], v[68:71]
ds_read_b64_tr_b16 v[214:215], v5 offset:55296
s_waitcnt vmcnt(15) lgkmcnt(8)
buffer_load_dword v60, v224, s[88:91], s82 offen offset:512 sc1
v_mfma_f32_16x16x32_bf16 v[80:83], v[192:195], a[32:35], v[80:83]
ds_read_b64_tr_b16 v[216:217], v5 offset:57344
ds_read_b64_tr_b16 v[218:219], v5 offset:59392
v_mfma_f32_16x16x32_bf16 v[80:83], v[196:199], a[36:39], v[80:83]
s_add_u32 m0, s40, 81920
s_xor_b32 s43, s101, 393216
buffer_load_dwordx4 v16, s[20:23], s43 offen lds
v_mfma_f32_16x16x32_bf16 v[112:115], v[196:199], a[52:55], v[112:115]
ds_read_b64_tr_b16 v[220:221], v5 offset:61440
v_cvt_pk_bf16_f32 v171, v174, v175
v_mfma_f32_16x16x32_bf16 v[112:115], v[192:195], a[48:51], v[112:115]
ds_read_b64_tr_b16 v[222:223], v5 offset:63488
s_waitcnt lgkmcnt(8)
v_mfma_f32_16x16x32_bf16 v[112:115], v[200:203], a[56:59], v[112:115]
ds_read_b64_tr_b16 v[192:193], v6 offset:49152
ds_read_b64_tr_b16 v[194:195], v6 offset:51200
v_mfma_f32_16x16x32_bf16 v[112:115], v[204:207], a[60:63], v[112:115]
buffer_load_dwordx4 v17, s[20:23], s43 offen offset:1024 lds
v_mfma_f32_16x16x32_bf16 v[80:83], v[204:207], a[44:47], v[80:83]
ds_read_b64_tr_b16 v[196:197], v6 offset:53248
buffer_store_dwordx4 v[168:171], v20, s[52:55], s80 offen offset:1024 sc1
v_mfma_f32_16x16x32_bf16 v[80:83], v[200:203], a[40:43], v[80:83]
ds_read_b64_tr_b16 v[198:199], v6 offset:55296
s_waitcnt lgkmcnt(8)
v_mfma_f32_16x16x32_bf16 v[84:87], v[208:211], a[32:35], v[84:87]
ds_read_b64_tr_b16 v[200:201], v6 offset:57344
ds_read_b64_tr_b16 v[202:203], v6 offset:59392
v_mfma_f32_16x16x32_bf16 v[84:87], v[212:215], a[36:39], v[84:87]
s_xor_b32 s80, s83, 2
s_mul_i32 s80, s80, 49152
v_mfma_f32_16x16x32_bf16 v[116:119], v[212:215], a[52:55], v[116:119]
ds_read_b64_tr_b16 v[204:205], v6 offset:61440
v_mfma_f32_16x16x32_bf16 v[116:119], v[208:211], a[48:51], v[116:119]
ds_read_b64_tr_b16 v[206:207], v6 offset:63488
s_waitcnt lgkmcnt(8)
v_mfma_f32_16x16x32_bf16 v[116:119], v[216:219], a[56:59], v[116:119]
ds_read_b64_tr_b16 v[208:209], v7 offset:49152
ds_read_b64_tr_b16 v[210:211], v7 offset:51200
v_mfma_f32_16x16x32_bf16 v[116:119], v[220:223], a[60:63], v[116:119]
buffer_load_dwordx4 v18, s[20:23], s43 offen offset:2048 lds
v_mfma_f32_16x16x32_bf16 v[84:87], v[220:223], a[44:47], v[84:87]
ds_read_b64_tr_b16 v[212:213], v7 offset:53248
buffer_load_dwordx4 v19, s[20:23], s43 offen offset:3072 lds
v_mfma_f32_16x16x32_bf16 v[84:87], v[216:219], a[40:43], v[84:87]
ds_read_b64_tr_b16 v[214:215], v7 offset:55296
s_waitcnt lgkmcnt(8)
v_mfma_f32_16x16x32_bf16 v[88:91], v[192:195], a[32:35], v[88:91]
ds_read_b64_tr_b16 v[216:217], v7 offset:57344
ds_read_b64_tr_b16 v[218:219], v7 offset:59392
v_mfma_f32_16x16x32_bf16 v[88:91], v[196:199], a[36:39], v[88:91]
s_xor_b32 s44, s46, 12288
buffer_load_dwordx4 a[96:99], v36, s[28:31], s44 offen offset:3072 sc1
v_mfma_f32_16x16x32_bf16 v[120:123], v[196:199], a[52:55], v[120:123]
ds_read_b64_tr_b16 v[220:221], v7 offset:61440
s_add_u32 s80, s80, 16384
v_mfma_f32_16x16x32_bf16 v[120:123], v[192:195], a[48:51], v[120:123]
ds_read_b64_tr_b16 v[222:223], v7 offset:63488
s_waitcnt lgkmcnt(8)
v_mfma_f32_16x16x32_bf16 v[120:123], v[200:203], a[56:59], v[120:123]
ds_read_b64_tr_b16 v[192:193], v6 offset:0
ds_read_b64_tr_b16 v[194:195], v6 offset:2048
v_mfma_f32_16x16x32_bf16 v[120:123], v[204:207], a[60:63], v[120:123]
buffer_load_dwordx4 a[100:103], v36, s[28:31], s44 offen offset:2048 sc1
v_mfma_f32_16x16x32_bf16 v[88:91], v[204:207], a[44:47], v[88:91]
ds_read_b64_tr_b16 v[196:197], v6 offset:4096
v_cvt_pk_bf16_f32 v144, v144, v145
v_mfma_f32_16x16x32_bf16 v[88:91], v[200:203], a[40:43], v[88:91]
ds_read_b64_tr_b16 v[198:199], v6 offset:6144
s_waitcnt lgkmcnt(8)
v_mfma_f32_16x16x32_bf16 v[92:95], v[208:211], a[32:35], v[92:95]
ds_read_b64_tr_b16 v[200:201], v6 offset:8192
ds_read_b64_tr_b16 v[202:203], v6 offset:10240
v_mfma_f32_16x16x32_bf16 v[92:95], v[212:215], a[36:39], v[92:95]
buffer_load_dwordx4 a[104:107], v36, s[28:31], s44 offen offset:1024 sc1
v_mfma_f32_16x16x32_bf16 v[124:127], v[212:215], a[52:55], v[124:127]
ds_read_b64_tr_b16 v[204:205], v6 offset:12288
buffer_load_dwordx4 a[108:111], v36, s[28:31], s44 offen sc1
v_mfma_f32_16x16x32_bf16 v[124:127], v[208:211], a[48:51], v[124:127]
ds_read_b64_tr_b16 v[206:207], v6 offset:14336
s_waitcnt lgkmcnt(8)
v_mfma_f32_16x16x32_bf16 v[124:127], v[216:219], a[56:59], v[124:127]
ds_read_b64_tr_b16 v[208:209], v7 offset:0
ds_read_b64_tr_b16 v[210:211], v7 offset:2048
v_mfma_f32_16x16x32_bf16 v[124:127], v[220:223], a[60:63], v[124:127]
buffer_load_dwordx4 a[112:115], v37, s[28:31], s44 offen offset:3072 sc1
v_mfma_f32_16x16x32_bf16 v[92:95], v[220:223], a[44:47], v[92:95]
ds_read_b64_tr_b16 v[212:213], v7 offset:4096
v_cvt_pk_bf16_f32 v145, v146, v147
v_mfma_f32_16x16x32_bf16 v[92:95], v[216:219], a[40:43], v[92:95]
ds_read_b64_tr_b16 v[214:215], v7 offset:6144
s_waitcnt lgkmcnt(8)
v_mfma_f32_16x16x32_bf16 v[72:75], v[192:195], a[32:35], v[72:75]
ds_read_b64_tr_b16 v[216:217], v7 offset:8192
ds_read_b64_tr_b16 v[218:219], v7 offset:10240
v_mfma_f32_16x16x32_bf16 v[72:75], v[196:199], a[36:39], v[72:75]
buffer_load_dwordx4 a[116:119], v37, s[28:31], s44 offen offset:2048 sc1
v_mfma_f32_16x16x32_bf16 v[104:107], v[196:199], a[52:55], v[104:107]
ds_read_b64_tr_b16 v[220:221], v7 offset:12288
v_cvt_pk_bf16_f32 v146, v148, v149
v_mfma_f32_16x16x32_bf16 v[104:107], v[192:195], a[48:51], v[104:107]
ds_read_b64_tr_b16 v[222:223], v7 offset:14336
s_waitcnt lgkmcnt(8)
s_waitcnt vmcnt(25)
s_barrier
v_mfma_f32_16x16x32_bf16 v[104:107], v[200:203], a[56:59], v[104:107]
ds_read_b64_tr_b16 v[192:193], v12 offset:0
ds_read_b64_tr_b16 v[194:195], v12 offset:2048
v_mfma_f32_16x16x32_bf16 v[104:107], v[204:207], a[60:63], v[104:107]
buffer_load_dwordx4 a[120:123], v37, s[28:31], s44 offen offset:1024 sc1
v_mfma_f32_16x16x32_bf16 v[72:75], v[204:207], a[44:47], v[72:75]
ds_read_b64_tr_b16 v[196:197], v12 offset:4096
buffer_load_dwordx4 a[124:127], v37, s[28:31], s44 offen sc1
v_mfma_f32_16x16x32_bf16 v[72:75], v[200:203], a[40:43], v[72:75]
ds_read_b64_tr_b16 v[198:199], v12 offset:6144
s_waitcnt lgkmcnt(8)
s_waitcnt vmcnt(13)
v_cmp_ne_u32 vcc, s87, v60
s_cbranch_vccnz L_owait2
L_ook2:
v_mfma_f32_16x16x32_bf16 v[76:79], v[208:211], a[32:35], v[76:79]
ds_read_b64_tr_b16 v[200:201], v12 offset:8192
ds_read_b64_tr_b16 v[202:203], v12 offset:10240
v_mfma_f32_16x16x32_bf16 v[76:79], v[212:215], a[36:39], v[76:79]
s_add_u32 m0, s40, 32768
s_xor_b32 s43, s100, 524288
buffer_load_dwordx4 v16, s[20:23], s43 offen lds
v_mfma_f32_16x16x32_bf16 v[108:111], v[212:215], a[52:55], v[108:111]
ds_read_b64_tr_b16 v[204:205], v12 offset:12288
v_cvt_pk_bf16_f32 v147, v150, v151
v_mfma_f32_16x16x32_bf16 v[108:111], v[208:211], a[48:51], v[108:111]
ds_read_b64_tr_b16 v[206:207], v12 offset:14336
s_waitcnt lgkmcnt(8)
v_mfma_f32_16x16x32_bf16 v[108:111], v[216:219], a[56:59], v[108:111]
ds_read_b64_tr_b16 v[208:209], v13 offset:0
ds_read_b64_tr_b16 v[210:211], v13 offset:2048
v_mfma_f32_16x16x32_bf16 v[108:111], v[220:223], a[60:63], v[108:111]
buffer_load_dwordx4 v17, s[20:23], s43 offen offset:1024 lds
v_mfma_f32_16x16x32_bf16 v[76:79], v[220:223], a[44:47], v[76:79]
ds_read_b64_tr_b16 v[212:213], v13 offset:4096
buffer_store_dwordx4 v[144:147], v20, s[52:55], s80 offen sc1
v_mfma_f32_16x16x32_bf16 v[76:79], v[216:219], a[40:43], v[76:79]
ds_read_b64_tr_b16 v[214:215], v13 offset:6144
s_waitcnt vmcnt(22) lgkmcnt(8)
v_mfma_f32_16x16x32_bf16 v[80:83], v[192:195], a[64:67], v[80:83]
ds_read_b64_tr_b16 v[216:217], v13 offset:8192
ds_read_b64_tr_b16 v[218:219], v13 offset:10240
v_mfma_f32_16x16x32_bf16 v[80:83], v[196:199], a[68:71], v[80:83]
buffer_load_dwordx4 v18, s[20:23], s43 offen offset:2048 lds
v_mfma_f32_16x16x32_bf16 v[112:115], v[196:199], a[84:87], v[112:115]
ds_read_b64_tr_b16 v[220:221], v13 offset:12288
v_cvt_pk_bf16_f32 v176, v176, v177
v_mfma_f32_16x16x32_bf16 v[112:115], v[192:195], a[80:83], v[112:115]
ds_read_b64_tr_b16 v[222:223], v13 offset:14336
s_waitcnt lgkmcnt(8)
v_mfma_f32_16x16x32_bf16 v[112:115], v[200:203], a[88:91], v[112:115]
ds_read_b64_tr_b16 v[192:193], v14 offset:0
ds_read_b64_tr_b16 v[194:195], v14 offset:2048
v_mfma_f32_16x16x32_bf16 v[112:115], v[204:207], a[92:95], v[112:115]
buffer_load_dwordx4 v19, s[20:23], s43 offen offset:3072 lds
v_mfma_f32_16x16x32_bf16 v[80:83], v[204:207], a[76:79], v[80:83]
ds_read_b64_tr_b16 v[196:197], v14 offset:4096
v_cvt_pk_bf16_f32 v177, v178, v179
v_mfma_f32_16x16x32_bf16 v[80:83], v[200:203], a[72:75], v[80:83]
ds_read_b64_tr_b16 v[198:199], v14 offset:6144
s_waitcnt lgkmcnt(8)
v_mfma_f32_16x16x32_bf16 v[84:87], v[208:211], a[64:67], v[84:87]
ds_read_b64_tr_b16 v[200:201], v14 offset:8192
ds_read_b64_tr_b16 v[202:203], v14 offset:10240
v_mfma_f32_16x16x32_bf16 v[84:87], v[212:215], a[68:71], v[84:87]
s_add_u32 m0, s40, 98304
s_xor_b32 s43, s101, 524288
buffer_load_dwordx4 v16, s[20:23], s43 offen lds
v_mfma_f32_16x16x32_bf16 v[116:119], v[212:215], a[84:87], v[116:119]
ds_read_b64_tr_b16 v[204:205], v14 offset:12288
v_cvt_pk_bf16_f32 v178, v180, v181
v_mfma_f32_16x16x32_bf16 v[116:119], v[208:211], a[80:83], v[116:119]
ds_read_b64_tr_b16 v[206:207], v14 offset:14336
s_waitcnt lgkmcnt(8)
v_mfma_f32_16x16x32_bf16 v[116:119], v[216:219], a[88:91], v[116:119]
ds_read_b64_tr_b16 v[208:209], v15 offset:0
ds_read_b64_tr_b16 v[210:211], v15 offset:2048
v_mfma_f32_16x16x32_bf16 v[116:119], v[220:223], a[92:95], v[116:119]
buffer_load_dwordx4 v17, s[20:23], s43 offen offset:1024 lds
v_mfma_f32_16x16x32_bf16 v[84:87], v[220:223], a[76:79], v[84:87]
ds_read_b64_tr_b16 v[212:213], v15 offset:4096
buffer_load_dwordx4 v18, s[20:23], s43 offen offset:2048 lds
v_mfma_f32_16x16x32_bf16 v[84:87], v[216:219], a[72:75], v[84:87]
ds_read_b64_tr_b16 v[214:215], v15 offset:6144
s_waitcnt lgkmcnt(8)
v_mfma_f32_16x16x32_bf16 v[88:91], v[192:195], a[64:67], v[88:91]
ds_read_b64_tr_b16 v[216:217], v15 offset:8192
ds_read_b64_tr_b16 v[218:219], v15 offset:10240
v_mfma_f32_16x16x32_bf16 v[88:91], v[196:199], a[68:71], v[88:91]
buffer_load_dwordx4 v19, s[20:23], s43 offen offset:3072 lds
v_mfma_f32_16x16x32_bf16 v[120:123], v[196:199], a[84:87], v[120:123]
ds_read_b64_tr_b16 v[220:221], v15 offset:12288
v_cvt_pk_bf16_f32 v179, v182, v183
v_mfma_f32_16x16x32_bf16 v[120:123], v[192:195], a[80:83], v[120:123]
ds_read_b64_tr_b16 v[222:223], v15 offset:14336
s_waitcnt lgkmcnt(8)
v_mfma_f32_16x16x32_bf16 v[120:123], v[200:203], a[88:91], v[120:123]
ds_read_b64_tr_b16 v[192:193], v14 offset:16384
ds_read_b64_tr_b16 v[194:195], v14 offset:18432
v_mfma_f32_16x16x32_bf16 v[120:123], v[204:207], a[92:95], v[120:123]
s_xor_b32 s44, s46, 16384
buffer_load_dwordx4 a[128:131], v36, s[28:31], s44 offen sc1
v_mfma_f32_16x16x32_bf16 v[88:91], v[204:207], a[76:79], v[88:91]
ds_read_b64_tr_b16 v[196:197], v14 offset:20480
buffer_store_dwordx4 v[176:179], v20, s[52:55], s80 offen offset:1024 sc1
v_mfma_f32_16x16x32_bf16 v[88:91], v[200:203], a[72:75], v[88:91]
ds_read_b64_tr_b16 v[198:199], v14 offset:22528
s_waitcnt lgkmcnt(8)
v_mfma_f32_16x16x32_bf16 v[92:95], v[208:211], a[64:67], v[92:95]
ds_read_b64_tr_b16 v[200:201], v14 offset:24576
ds_read_b64_tr_b16 v[202:203], v14 offset:26624
v_mfma_f32_16x16x32_bf16 v[92:95], v[212:215], a[68:71], v[92:95]
L_pad12:
s_cbranch_execz L_pad13
buffer_load_dwordx4 a[132:135], v36, s[28:31], s44 offen offset:1024 sc1
v_mfma_f32_16x16x32_bf16 v[124:127], v[212:215], a[84:87], v[124:127]
ds_read_b64_tr_b16 v[204:205], v14 offset:28672
s_xor_b32 s80, s83, 3
s_mul_i32 s80, s80, 49152
v_mfma_f32_16x16x32_bf16 v[124:127], v[208:211], a[80:83], v[124:127]
ds_read_b64_tr_b16 v[206:207], v14 offset:30720
s_waitcnt lgkmcnt(8)
v_mfma_f32_16x16x32_bf16 v[124:127], v[216:219], a[88:91], v[124:127]
ds_read_b64_tr_b16 v[208:209], v15 offset:16384
ds_read_b64_tr_b16 v[210:211], v15 offset:18432
v_mfma_f32_16x16x32_bf16 v[124:127], v[220:223], a[92:95], v[124:127]
buffer_load_dwordx4 a[136:139], v36, s[28:31], s44 offen offset:2048 sc1
v_mfma_f32_16x16x32_bf16 v[92:95], v[220:223], a[76:79], v[92:95]
ds_read_b64_tr_b16 v[212:213], v15 offset:20480
s_add_u32 s80, s80, 32768
v_mfma_f32_16x16x32_bf16 v[92:95], v[216:219], a[72:75], v[92:95]
ds_read_b64_tr_b16 v[214:215], v15 offset:22528
s_waitcnt lgkmcnt(8)
v_mfma_f32_16x16x32_bf16 v[72:75], v[192:195], a[64:67], v[72:75]
ds_read_b64_tr_b16 v[216:217], v15 offset:24576
ds_read_b64_tr_b16 v[218:219], v15 offset:26624
v_mfma_f32_16x16x32_bf16 v[72:75], v[196:199], a[68:71], v[72:75]
buffer_load_dwordx4 a[140:143], v36, s[28:31], s44 offen offset:3072 sc1
v_mfma_f32_16x16x32_bf16 v[104:107], v[196:199], a[84:87], v[104:107]
ds_read_b64_tr_b16 v[220:221], v15 offset:28672
v_cvt_pk_bf16_f32 v152, v152, v153
v_mfma_f32_16x16x32_bf16 v[104:107], v[192:195], a[80:83], v[104:107]
ds_read_b64_tr_b16 v[222:223], v15 offset:30720
s_waitcnt lgkmcnt(8)
s_waitcnt vmcnt(22)
s_barrier
v_mfma_f32_16x16x32_bf16 v[104:107], v[200:203], a[88:91], v[104:107]
ds_read_b64_tr_b16 v[192:193], v4 offset:16384
ds_read_b64_tr_b16 v[194:195], v4 offset:18432
v_mfma_f32_16x16x32_bf16 v[104:107], v[204:207], a[92:95], v[104:107]
buffer_load_dwordx4 a[144:147], v37, s[28:31], s44 offen sc1
v_mfma_f32_16x16x32_bf16 v[72:75], v[204:207], a[76:79], v[72:75]
ds_read_b64_tr_b16 v[196:197], v4 offset:20480
buffer_load_dwordx4 a[148:151], v37, s[28:31], s44 offen offset:1024 sc1
v_mfma_f32_16x16x32_bf16 v[72:75], v[200:203], a[72:75], v[72:75]
ds_read_b64_tr_b16 v[198:199], v4 offset:22528
s_waitcnt lgkmcnt(8)
v_mfma_f32_16x16x32_bf16 v[76:79], v[208:211], a[64:67], v[76:79]
ds_read_b64_tr_b16 v[200:201], v4 offset:24576
ds_read_b64_tr_b16 v[202:203], v4 offset:26624
v_mfma_f32_16x16x32_bf16 v[76:79], v[212:215], a[68:71], v[76:79]
buffer_load_dwordx4 a[152:155], v37, s[28:31], s44 offen offset:2048 sc1
v_mfma_f32_16x16x32_bf16 v[108:111], v[212:215], a[84:87], v[108:111]
ds_read_b64_tr_b16 v[204:205], v4 offset:28672
v_cvt_pk_bf16_f32 v153, v154, v155
v_mfma_f32_16x16x32_bf16 v[108:111], v[208:211], a[80:83], v[108:111]
ds_read_b64_tr_b16 v[206:207], v4 offset:30720
s_waitcnt lgkmcnt(8)
v_mfma_f32_16x16x32_bf16 v[108:111], v[216:219], a[88:91], v[108:111]
ds_read_b64_tr_b16 v[208:209], v5 offset:16384
ds_read_b64_tr_b16 v[210:211], v5 offset:18432
v_mfma_f32_16x16x32_bf16 v[108:111], v[220:223], a[92:95], v[108:111]
buffer_load_dwordx4 a[156:159], v37, s[28:31], s44 offen offset:3072 sc1
v_mfma_f32_16x16x32_bf16 v[76:79], v[220:223], a[76:79], v[76:79]
ds_read_b64_tr_b16 v[212:213], v5 offset:20480
v_cvt_pk_bf16_f32 v154, v156, v157
v_mfma_f32_16x16x32_bf16 v[76:79], v[216:219], a[72:75], v[76:79]
ds_read_b64_tr_b16 v[214:215], v5 offset:22528
s_waitcnt vmcnt(18) lgkmcnt(8)
v_mfma_f32_16x16x32_bf16 v[80:83], v[192:195], a[96:99], v[80:83]
ds_read_b64_tr_b16 v[216:217], v5 offset:24576
ds_read_b64_tr_b16 v[218:219], v5 offset:26624
v_mfma_f32_16x16x32_bf16 v[80:83], v[196:199], a[100:103], v[80:83]
s_add_u32 m0, s40, 114688
s_xor_b32 s43, s100, 655360
buffer_load_dwordx4 v16, s[20:23], s43 offen lds
v_mfma_f32_16x16x32_bf16 v[112:115], v[196:199], a[116:119], v[112:115]
ds_read_b64_tr_b16 v[220:221], v5 offset:28672
buffer_load_dwordx4 v17, s[20:23], s43 offen offset:1024 lds
v_mfma_f32_16x16x32_bf16 v[112:115], v[192:195], a[112:115], v[112:115]
ds_read_b64_tr_b16 v[222:223], v5 offset:30720
s_waitcnt lgkmcnt(8)
v_mfma_f32_16x16x32_bf16 v[112:115], v[200:203], a[120:123], v[112:115]
ds_read_b64_tr_b16 v[192:193], v6 offset:16384
ds_read_b64_tr_b16 v[194:195], v6 offset:18432
v_mfma_f32_16x16x32_bf16 v[112:115], v[204:207], a[124:127], v[112:115]
buffer_load_dwordx4 v18, s[20:23], s43 offen offset:2048 lds
v_mfma_f32_16x16x32_bf16 v[80:83], v[204:207], a[108:111], v[80:83]
ds_read_b64_tr_b16 v[196:197], v6 offset:20480
v_cvt_pk_bf16_f32 v155, v158, v159
v_mfma_f32_16x16x32_bf16 v[80:83], v[200:203], a[104:107], v[80:83]
ds_read_b64_tr_b16 v[198:199], v6 offset:22528
s_waitcnt lgkmcnt(8)
v_mfma_f32_16x16x32_bf16 v[84:87], v[208:211], a[96:99], v[84:87]
ds_read_b64_tr_b16 v[200:201], v6 offset:24576
ds_read_b64_tr_b16 v[202:203], v6 offset:26624
v_mfma_f32_16x16x32_bf16 v[84:87], v[212:215], a[100:103], v[84:87]
buffer_load_dwordx4 v19, s[20:23], s43 offen offset:3072 lds
v_mfma_f32_16x16x32_bf16 v[116:119], v[212:215], a[116:119], v[116:119]
ds_read_b64_tr_b16 v[204:205], v6 offset:28672
buffer_store_dwordx4 v[152:155], v20, s[52:55], s80 offen sc1
v_mfma_f32_16x16x32_bf16 v[116:119], v[208:211], a[112:115], v[116:119]
ds_read_b64_tr_b16 v[206:207], v6 offset:30720
s_waitcnt lgkmcnt(8)
v_mfma_f32_16x16x32_bf16 v[116:119], v[216:219], a[120:123], v[116:119]
ds_read_b64_tr_b16 v[208:209], v7 offset:16384
ds_read_b64_tr_b16 v[210:211], v7 offset:18432
v_mfma_f32_16x16x32_bf16 v[116:119], v[220:223], a[124:127], v[116:119]
s_add_u32 m0, s40, 65536
s_xor_b32 s43, s101, 655360
buffer_load_dwordx4 v16, s[20:23], s43 offen lds
v_mfma_f32_16x16x32_bf16 v[84:87], v[220:223], a[108:111], v[84:87]
ds_read_b64_tr_b16 v[212:213], v7 offset:20480
v_cvt_pk_bf16_f32 v184, v184, v185
v_mfma_f32_16x16x32_bf16 v[84:87], v[216:219], a[104:107], v[84:87]
ds_read_b64_tr_b16 v[214:215], v7 offset:22528
s_waitcnt lgkmcnt(8)
v_mfma_f32_16x16x32_bf16 v[88:91], v[192:195], a[96:99], v[88:91]
ds_read_b64_tr_b16 v[216:217], v7 offset:24576
ds_read_b64_tr_b16 v[218:219], v7 offset:26624
v_mfma_f32_16x16x32_bf16 v[88:91], v[196:199], a[100:103], v[88:91]
buffer_load_dwordx4 v17, s[20:23], s43 offen offset:1024 lds
v_mfma_f32_16x16x32_bf16 v[120:123], v[196:199], a[116:119], v[120:123]
ds_read_b64_tr_b16 v[220:221], v7 offset:28672
v_cvt_pk_bf16_f32 v185, v186, v187
v_mfma_f32_16x16x32_bf16 v[120:123], v[192:195], a[112:115], v[120:123]
ds_read_b64_tr_b16 v[222:223], v7 offset:30720
s_waitcnt lgkmcnt(8)
v_mfma_f32_16x16x32_bf16 v[120:123], v[200:203], a[120:123], v[120:123]
ds_read_b64_tr_b16 v[192:193], v10 offset:16384
ds_read_b64_tr_b16 v[194:195], v10 offset:18432
v_mfma_f32_16x16x32_bf16 v[120:123], v[204:207], a[124:127], v[120:123]
buffer_load_dwordx4 v18, s[20:23], s43 offen offset:2048 lds
v_mfma_f32_16x16x32_bf16 v[88:91], v[204:207], a[108:111], v[88:91]
ds_read_b64_tr_b16 v[196:197], v10 offset:20480
v_cvt_pk_bf16_f32 v186, v188, v189
v_mfma_f32_16x16x32_bf16 v[88:91], v[200:203], a[104:107], v[88:91]
ds_read_b64_tr_b16 v[198:199], v10 offset:22528
s_waitcnt lgkmcnt(8)
v_mfma_f32_16x16x32_bf16 v[92:95], v[208:211], a[96:99], v[92:95]
ds_read_b64_tr_b16 v[200:201], v10 offset:24576
ds_read_b64_tr_b16 v[202:203], v10 offset:26624
v_mfma_f32_16x16x32_bf16 v[92:95], v[212:215], a[100:103], v[92:95]
buffer_load_dwordx4 v19, s[20:23], s43 offen offset:3072 lds
v_mfma_f32_16x16x32_bf16 v[124:127], v[212:215], a[116:119], v[124:127]
ds_read_b64_tr_b16 v[204:205], v10 offset:28672
s_xor_b32 s44, s46, 20480
buffer_load_dwordx4 a[160:163], v36, s[28:31], s44 offen offset:1024 sc1
v_mfma_f32_16x16x32_bf16 v[124:127], v[208:211], a[112:115], v[124:127]
ds_read_b64_tr_b16 v[206:207], v10 offset:30720
s_waitcnt lgkmcnt(8)
v_mfma_f32_16x16x32_bf16 v[124:127], v[216:219], a[120:123], v[124:127]
ds_read_b64_tr_b16 v[208:209], v11 offset:16384
ds_read_b64_tr_b16 v[210:211], v11 offset:18432
v_mfma_f32_16x16x32_bf16 v[124:127], v[220:223], a[124:127], v[124:127]
buffer_load_dwordx4 a[164:167], v36, s[28:31], s44 offen sc1
v_mfma_f32_16x16x32_bf16 v[92:95], v[220:223], a[108:111], v[92:95]
ds_read_b64_tr_b16 v[212:213], v11 offset:20480
v_cvt_pk_bf16_f32 v187, v190, v191
v_mfma_f32_16x16x32_bf16 v[92:95], v[216:219], a[104:107], v[92:95]
ds_read_b64_tr_b16 v[214:215], v11 offset:22528
s_waitcnt lgkmcnt(8)
v_mfma_f32_16x16x32_bf16 v[72:75], v[192:195], a[96:99], v[72:75]
ds_read_b64_tr_b16 v[216:217], v11 offset:24576
ds_read_b64_tr_b16 v[218:219], v11 offset:26624
v_mfma_f32_16x16x32_bf16 v[72:75], v[196:199], a[100:103], v[72:75]
buffer_load_dwordx4 a[168:171], v36, s[28:31], s44 offen offset:3072 sc1
v_mfma_f32_16x16x32_bf16 v[104:107], v[196:199], a[116:119], v[104:107]
ds_read_b64_tr_b16 v[220:221], v11 offset:28672
buffer_store_dwordx4 v[184:187], v20, s[52:55], s80 offen offset:1024 sc1
v_mfma_f32_16x16x32_bf16 v[104:107], v[192:195], a[112:115], v[104:107]
ds_read_b64_tr_b16 v[222:223], v11 offset:30720
s_waitcnt lgkmcnt(8)
s_waitcnt vmcnt(22)
s_barrier
v_mfma_f32_16x16x32_bf16 v[104:107], v[200:203], a[120:123], v[104:107]
ds_read_b64_tr_b16 v[192:193], v4 offset:32768
ds_read_b64_tr_b16 v[194:195], v4 offset:34816
v_mfma_f32_16x16x32_bf16 v[104:107], v[204:207], a[124:127], v[104:107]
buffer_load_dwordx4 a[172:175], v36, s[28:31], s44 offen offset:2048 sc1
v_mfma_f32_16x16x32_bf16 v[72:75], v[204:207], a[108:111], v[72:75]
ds_read_b64_tr_b16 v[196:197], v4 offset:36864
v_mfma_f32_16x16x32_bf16 v[72:75], v[200:203], a[104:107], v[72:75]
ds_read_b64_tr_b16 v[198:199], v4 offset:38912
s_waitcnt lgkmcnt(8)
v_mfma_f32_16x16x32_bf16 v[76:79], v[208:211], a[96:99], v[76:79]
ds_read_b64_tr_b16 v[200:201], v4 offset:40960
ds_read_b64_tr_b16 v[202:203], v4 offset:43008
v_mfma_f32_16x16x32_bf16 v[76:79], v[212:215], a[100:103], v[76:79]
buffer_load_dwordx4 a[176:179], v37, s[28:31], s44 offen offset:1024 sc1
v_mfma_f32_16x16x32_bf16 v[108:111], v[212:215], a[116:119], v[108:111]
ds_read_b64_tr_b16 v[204:205], v4 offset:45056
v_mfma_f32_16x16x32_bf16 v[108:111], v[208:211], a[112:115], v[108:111]
ds_read_b64_tr_b16 v[206:207], v4 offset:47104
s_waitcnt lgkmcnt(8)
v_mfma_f32_16x16x32_bf16 v[108:111], v[216:219], a[120:123], v[108:111]
ds_read_b64_tr_b16 v[208:209], v5 offset:32768
ds_read_b64_tr_b16 v[210:211], v5 offset:34816
v_mfma_f32_16x16x32_bf16 v[108:111], v[220:223], a[124:127], v[108:111]
buffer_load_dwordx4 a[180:183], v37, s[28:31], s44 offen sc1
v_mfma_f32_16x16x32_bf16 v[76:79], v[220:223], a[108:111], v[76:79]
ds_read_b64_tr_b16 v[212:213], v5 offset:36864
v_mfma_f32_16x16x32_bf16 v[76:79], v[216:219], a[104:107], v[76:79]
ds_read_b64_tr_b16 v[214:215], v5 offset:38912
s_waitcnt vmcnt(16) lgkmcnt(8)
v_mfma_f32_16x16x32_bf16 v[80:83], v[192:195], a[128:131], v[80:83]
ds_read_b64_tr_b16 v[216:217], v5 offset:40960
ds_read_b64_tr_b16 v[218:219], v5 offset:43008
v_mfma_f32_16x16x32_bf16 v[80:83], v[196:199], a[132:135], v[80:83]
buffer_load_dwordx4 a[184:187], v37, s[28:31], s44 offen offset:3072 sc1
v_mfma_f32_16x16x32_bf16 v[112:115], v[196:199], a[148:151], v[112:115]
ds_read_b64_tr_b16 v[220:221], v5 offset:45056
buffer_load_dwordx4 a[188:191], v37, s[28:31], s44 offen offset:2048 sc1
v_mfma_f32_16x16x32_bf16 v[112:115], v[192:195], a[144:147], v[112:115]
ds_read_b64_tr_b16 v[222:223], v5 offset:47104
s_waitcnt lgkmcnt(8)
v_mfma_f32_16x16x32_bf16 v[112:115], v[200:203], a[152:155], v[112:115]
ds_read_b64_tr_b16 v[192:193], v6 offset:32768
ds_read_b64_tr_b16 v[194:195], v6 offset:34816
v_mfma_f32_16x16x32_bf16 v[112:115], v[204:207], a[156:159], v[112:115]
s_add_u32 m0, s40, 49152
s_xor_b32 s43, s100, 786432
buffer_load_dwordx4 v16, s[20:23], s43 offen lds
v_mfma_f32_16x16x32_bf16 v[80:83], v[204:207], a[140:143], v[80:83]
ds_read_b64_tr_b16 v[196:197], v6 offset:36864
v_mfma_f32_16x16x32_bf16 v[80:83], v[200:203], a[136:139], v[80:83]
ds_read_b64_tr_b16 v[198:199], v6 offset:38912
s_waitcnt lgkmcnt(8)
v_mfma_f32_16x16x32_bf16 v[84:87], v[208:211], a[128:131], v[84:87]
ds_read_b64_tr_b16 v[200:201], v6 offset:40960
ds_read_b64_tr_b16 v[202:203], v6 offset:43008
v_mfma_f32_16x16x32_bf16 v[84:87], v[212:215], a[132:135], v[84:87]
buffer_load_dwordx4 v17, s[20:23], s43 offen offset:1024 lds
v_mfma_f32_16x16x32_bf16 v[116:119], v[212:215], a[148:151], v[116:119]
ds_read_b64_tr_b16 v[204:205], v6 offset:45056
v_mfma_f32_16x16x32_bf16 v[116:119], v[208:211], a[144:147], v[116:119]
ds_read_b64_tr_b16 v[206:207], v6 offset:47104
s_waitcnt lgkmcnt(8)
v_mfma_f32_16x16x32_bf16 v[116:119], v[216:219], a[152:155], v[116:119]
ds_read_b64_tr_b16 v[208:209], v7 offset:32768
ds_read_b64_tr_b16 v[210:211], v7 offset:34816
v_mfma_f32_16x16x32_bf16 v[116:119], v[220:223], a[156:159], v[116:119]
buffer_load_dwordx4 v18, s[20:23], s43 offen offset:2048 lds
v_mfma_f32_16x16x32_bf16 v[84:87], v[220:223], a[140:143], v[84:87]
ds_read_b64_tr_b16 v[212:213], v7 offset:36864
buffer_load_dwordx4 v19, s[20:23], s43 offen offset:3072 lds
v_mfma_f32_16x16x32_bf16 v[84:87], v[216:219], a[136:139], v[84:87]
ds_read_b64_tr_b16 v[214:215], v7 offset:38912
s_waitcnt lgkmcnt(8)
s_waitcnt vmcnt(9)
v_mfma_f32_16x16x32_bf16 v[88:91], v[192:195], a[128:131], v[88:91]
ds_read_b64_tr_b16 v[216:217], v7 offset:40960
ds_read_b64_tr_b16 v[218:219], v7 offset:43008
v_mfma_f32_16x16x32_bf16 v[88:91], v[196:199], a[132:135], v[88:91]
s_add_u32 m0, s40, 131072
s_xor_b32 s43, s101, 786432
buffer_load_dwordx4 v16, s[20:23], s43 offen lds
v_mfma_f32_16x16x32_bf16 v[120:123], v[196:199], a[148:151], v[120:123]
ds_read_b64_tr_b16 v[220:221], v7 offset:45056
s_xor_b32 s81, s83, 1
s_lshl_b32 s81, s81, 12
v_mfma_f32_16x16x32_bf16 v[120:123], v[192:195], a[144:147], v[120:123]
ds_read_b64_tr_b16 v[222:223], v7 offset:47104
s_waitcnt lgkmcnt(8)
v_mfma_f32_16x16x32_bf16 v[120:123], v[200:203], a[152:155], v[120:123]
ds_read_b64_tr_b16 v[192:193], v10 offset:32768
ds_read_b64_tr_b16 v[194:195], v10 offset:34816
v_mfma_f32_16x16x32_bf16 v[120:123], v[204:207], a[156:159], v[120:123]
buffer_load_dwordx4 v17, s[20:23], s43 offen offset:1024 lds
v_mfma_f32_16x16x32_bf16 v[88:91], v[204:207], a[140:143], v[88:91]
ds_read_b64_tr_b16 v[196:197], v10 offset:36864
s_add_u32 s81, s81, s79
v_mov_b32 v60, s87
buffer_store_dword v60, v40, s[88:91], s81 offen offset:128 sc1
v_mfma_f32_16x16x32_bf16 v[88:91], v[200:203], a[136:139], v[88:91]
ds_read_b64_tr_b16 v[198:199], v10 offset:38912
s_waitcnt lgkmcnt(8)
v_mfma_f32_16x16x32_bf16 v[92:95], v[208:211], a[128:131], v[92:95]
ds_read_b64_tr_b16 v[200:201], v10 offset:40960
ds_read_b64_tr_b16 v[202:203], v10 offset:43008
v_mfma_f32_16x16x32_bf16 v[92:95], v[212:215], a[132:135], v[92:95]
buffer_load_dwordx4 v18, s[20:23], s43 offen offset:2048 lds
v_mfma_f32_16x16x32_bf16 v[124:127], v[212:215], a[148:151], v[124:127]
ds_read_b64_tr_b16 v[204:205], v10 offset:45056
s_xor_b32 s81, s83, 2
s_lshl_b32 s81, s81, 12
v_mfma_f32_16x16x32_bf16 v[124:127], v[208:211], a[144:147], v[124:127]
ds_read_b64_tr_b16 v[206:207], v10 offset:47104
s_waitcnt lgkmcnt(8)
v_mfma_f32_16x16x32_bf16 v[124:127], v[216:219], a[152:155], v[124:127]
ds_read_b64_tr_b16 v[208:209], v11 offset:32768
ds_read_b64_tr_b16 v[210:211], v11 offset:34816
v_mfma_f32_16x16x32_bf16 v[124:127], v[220:223], a[156:159], v[124:127]
buffer_load_dwordx4 v19, s[20:23], s43 offen offset:3072 lds
v_mfma_f32_16x16x32_bf16 v[92:95], v[220:223], a[140:143], v[92:95]
ds_read_b64_tr_b16 v[212:213], v11 offset:36864
s_add_u32 s81, s81, s79
v_mov_b32 v60, s87
buffer_store_dword v60, v40, s[88:91], s81 offen offset:256 sc1
v_mfma_f32_16x16x32_bf16 v[92:95], v[216:219], a[136:139], v[92:95]
ds_read_b64_tr_b16 v[214:215], v11 offset:38912
s_waitcnt lgkmcnt(8)
v_mfma_f32_16x16x32_bf16 v[72:75], v[192:195], a[128:131], v[72:75]
ds_read_b64_tr_b16 v[216:217], v11 offset:40960
ds_read_b64_tr_b16 v[218:219], v11 offset:43008
v_mfma_f32_16x16x32_bf16 v[72:75], v[196:199], a[132:135], v[72:75]
s_xor_b32 s81, s83, 3
s_lshl_b32 s81, s81, 12
v_mfma_f32_16x16x32_bf16 v[104:107], v[196:199], a[148:151], v[104:107]
ds_read_b64_tr_b16 v[220:221], v11 offset:45056
v_mfma_f32_16x16x32_bf16 v[104:107], v[192:195], a[144:147], v[104:107]
ds_read_b64_tr_b16 v[222:223], v11 offset:47104
s_waitcnt lgkmcnt(8)
s_waitcnt vmcnt(17)
s_barrier
v_mfma_f32_16x16x32_bf16 v[104:107], v[200:203], a[152:155], v[104:107]
ds_read_b64_tr_b16 v[192:193], v8 offset:49152
ds_read_b64_tr_b16 v[194:195], v8 offset:51200
v_mfma_f32_16x16x32_bf16 v[104:107], v[204:207], a[156:159], v[104:107]
s_xor_b32 s44, s46, 24576
buffer_load_dwordx4 a[192:195], v36, s[28:31], s44 offen offset:2048 sc1
v_mfma_f32_16x16x32_bf16 v[72:75], v[204:207], a[140:143], v[72:75]
ds_read_b64_tr_b16 v[196:197], v8 offset:53248
buffer_load_dwordx4 a[196:199], v36, s[28:31], s44 offen offset:3072 sc1
v_mfma_f32_16x16x32_bf16 v[72:75], v[200:203], a[136:139], v[72:75]
ds_read_b64_tr_b16 v[198:199], v8 offset:55296
s_waitcnt lgkmcnt(8)
v_mfma_f32_16x16x32_bf16 v[76:79], v[208:211], a[128:131], v[76:79]
ds_read_b64_tr_b16 v[200:201], v8 offset:57344
ds_read_b64_tr_b16 v[202:203], v8 offset:59392
v_mfma_f32_16x16x32_bf16 v[76:79], v[212:215], a[132:135], v[76:79]
buffer_load_dwordx4 a[200:203], v36, s[28:31], s44 offen sc1
v_mfma_f32_16x16x32_bf16 v[108:111], v[212:215], a[148:151], v[108:111]
ds_read_b64_tr_b16 v[204:205], v8 offset:61440
s_add_u32 s81, s81, s79
v_mov_b32 v60, s87
buffer_store_dword v60, v40, s[88:91], s81 offen offset:384 sc1
v_mfma_f32_16x16x32_bf16 v[108:111], v[208:211], a[144:147], v[108:111]
ds_read_b64_tr_b16 v[206:207], v8 offset:63488
s_waitcnt lgkmcnt(8)
v_mfma_f32_16x16x32_bf16 v[108:111], v[216:219], a[152:155], v[108:111]
ds_read_b64_tr_b16 v[208:209], v9 offset:49152
ds_read_b64_tr_b16 v[210:211], v9 offset:51200
v_mfma_f32_16x16x32_bf16 v[108:111], v[220:223], a[156:159], v[108:111]
s_lshl_b32 s82, s83, 12
s_add_u32 s82, s82, s79
v_mfma_f32_16x16x32_bf16 v[76:79], v[220:223], a[140:143], v[76:79]
ds_read_b64_tr_b16 v[212:213], v9 offset:53248
v_mfma_f32_16x16x32_bf16 v[76:79], v[216:219], a[136:139], v[76:79]
ds_read_b64_tr_b16 v[214:215], v9 offset:55296
s_waitcnt vmcnt(11) lgkmcnt(8)
v_mfma_f32_16x16x32_bf16 v[80:83], v[192:195], a[160:163], v[80:83]
ds_read_b64_tr_b16 v[216:217], v9 offset:57344
ds_read_b64_tr_b16 v[218:219], v9 offset:59392
v_mfma_f32_16x16x32_bf16 v[80:83], v[196:199], a[164:167], v[80:83]
buffer_load_dwordx4 a[204:207], v36, s[28:31], s44 offen offset:1024 sc1
v_mfma_f32_16x16x32_bf16 v[112:115], v[196:199], a[180:183], v[112:115]
ds_read_b64_tr_b16 v[220:221], v9 offset:61440
buffer_load_dwordx4 a[208:211], v37, s[28:31], s44 offen offset:2048 sc1
v_mfma_f32_16x16x32_bf16 v[112:115], v[192:195], a[176:179], v[112:115]
ds_read_b64_tr_b16 v[222:223], v9 offset:63488
s_waitcnt lgkmcnt(8)
v_mfma_f32_16x16x32_bf16 v[112:115], v[200:203], a[184:187], v[112:115]
ds_read_b64_tr_b16 v[192:193], v10 offset:49152
ds_read_b64_tr_b16 v[194:195], v10 offset:51200
v_mfma_f32_16x16x32_bf16 v[112:115], v[204:207], a[188:191], v[112:115]
buffer_load_dwordx4 a[212:215], v37, s[28:31], s44 offen offset:3072 sc1
v_mfma_f32_16x16x32_bf16 v[80:83], v[204:207], a[172:175], v[80:83]
ds_read_b64_tr_b16 v[196:197], v10 offset:53248
v_and_b32 v224, 384, v41
v_mfma_f32_16x16x32_bf16 v[80:83], v[200:203], a[168:171], v[80:83]
ds_read_b64_tr_b16 v[198:199], v10 offset:55296
s_waitcnt lgkmcnt(8)
v_mfma_f32_16x16x32_bf16 v[84:87], v[208:211], a[160:163], v[84:87]
ds_read_b64_tr_b16 v[200:201], v10 offset:57344
ds_read_b64_tr_b16 v[202:203], v10 offset:59392
v_mfma_f32_16x16x32_bf16 v[84:87], v[212:215], a[164:167], v[84:87]
buffer_load_dwordx4 a[216:219], v37, s[28:31], s44 offen sc1
v_mfma_f32_16x16x32_bf16 v[116:119], v[212:215], a[180:183], v[116:119]
ds_read_b64_tr_b16 v[204:205], v10 offset:61440
v_max_u32 v224, 128, v224
v_mfma_f32_16x16x32_bf16 v[116:119], v[208:211], a[176:179], v[116:119]
ds_read_b64_tr_b16 v[206:207], v10 offset:63488
s_waitcnt lgkmcnt(8)
v_mfma_f32_16x16x32_bf16 v[116:119], v[216:219], a[184:187], v[116:119]
ds_read_b64_tr_b16 v[208:209], v11 offset:49152
ds_read_b64_tr_b16 v[210:211], v11 offset:51200
v_mfma_f32_16x16x32_bf16 v[116:119], v[220:223], a[188:191], v[116:119]
buffer_load_dwordx4 a[220:223], v37, s[28:31], s44 offen offset:1024 sc1
v_mfma_f32_16x16x32_bf16 v[84:87], v[220:223], a[172:175], v[84:87]
ds_read_b64_tr_b16 v[212:213], v11 offset:53248
s_add_u32 m0, s40, 16384
s_xor_b32 s43, s100, 917504
buffer_load_dwordx4 v16, s[20:23], s43 offen lds
v_mfma_f32_16x16x32_bf16 v[84:87], v[216:219], a[168:171], v[84:87]
ds_read_b64_tr_b16 v[214:215], v11 offset:55296
s_waitcnt lgkmcnt(8)
v_mfma_f32_16x16x32_bf16 v[88:91], v[192:195], a[160:163], v[88:91]
ds_read_b64_tr_b16 v[216:217], v11 offset:57344
ds_read_b64_tr_b16 v[218:219], v11 offset:59392
v_mfma_f32_16x16x32_bf16 v[88:91], v[196:199], a[164:167], v[88:91]
buffer_load_dwordx4 v17, s[20:23], s43 offen offset:1024 lds
v_mfma_f32_16x16x32_bf16 v[120:123], v[196:199], a[180:183], v[120:123]
ds_read_b64_tr_b16 v[220:221], v11 offset:61440
buffer_load_dwordx4 v[52:55], v21, s[60:63], 0 offen
v_mfma_f32_16x16x32_bf16 v[120:123], v[192:195], a[176:179], v[120:123]
ds_read_b64_tr_b16 v[222:223], v11 offset:63488
s_waitcnt lgkmcnt(8)
v_mfma_f32_16x16x32_bf16 v[120:123], v[200:203], a[184:187], v[120:123]
ds_read_b64_tr_b16 v[192:193], v10 offset:0
ds_read_b64_tr_b16 v[194:195], v10 offset:2048
v_mfma_f32_16x16x32_bf16 v[120:123], v[204:207], a[188:191], v[120:123]
s_movk_i32 s45, 16384
buffer_load_dwordx4 v[56:59], v21, s[60:63], s45 offen
v_mfma_f32_16x16x32_bf16 v[88:91], v[204:207], a[172:175], v[88:91]
ds_read_b64_tr_b16 v[196:197], v10 offset:4096
v_mfma_f32_16x16x32_bf16 v[88:91], v[200:203], a[168:171], v[88:91]
ds_read_b64_tr_b16 v[198:199], v10 offset:6144
s_waitcnt lgkmcnt(8)
v_mfma_f32_16x16x32_bf16 v[92:95], v[208:211], a[160:163], v[92:95]
ds_read_b64_tr_b16 v[200:201], v10 offset:8192
ds_read_b64_tr_b16 v[202:203], v10 offset:10240
v_mfma_f32_16x16x32_bf16 v[92:95], v[212:215], a[164:167], v[92:95]
buffer_load_dwordx4 v18, s[20:23], s43 offen offset:2048 lds
v_mfma_f32_16x16x32_bf16 v[124:127], v[212:215], a[180:183], v[124:127]
ds_read_b64_tr_b16 v[204:205], v10 offset:12288
v_mfma_f32_16x16x32_bf16 v[124:127], v[208:211], a[176:179], v[124:127]
ds_read_b64_tr_b16 v[206:207], v10 offset:14336
s_waitcnt lgkmcnt(8)
v_mfma_f32_16x16x32_bf16 v[124:127], v[216:219], a[184:187], v[124:127]
ds_read_b64_tr_b16 v[208:209], v11 offset:0
ds_read_b64_tr_b16 v[210:211], v11 offset:2048
v_mfma_f32_16x16x32_bf16 v[124:127], v[220:223], a[188:191], v[124:127]
buffer_load_dwordx4 v19, s[20:23], s43 offen offset:3072 lds
v_mfma_f32_16x16x32_bf16 v[92:95], v[220:223], a[172:175], v[92:95]
ds_read_b64_tr_b16 v[212:213], v11 offset:4096
v_mfma_f32_16x16x32_bf16 v[92:95], v[216:219], a[168:171], v[92:95]
ds_read_b64_tr_b16 v[214:215], v11 offset:6144
s_waitcnt lgkmcnt(8)
v_mfma_f32_16x16x32_bf16 v[72:75], v[192:195], a[160:163], v[72:75]
ds_read_b64_tr_b16 v[216:217], v11 offset:8192
ds_read_b64_tr_b16 v[218:219], v11 offset:10240
v_mfma_f32_16x16x32_bf16 v[72:75], v[196:199], a[164:167], v[72:75]
s_add_u32 m0, s40, 32768
s_xor_b32 s43, s101, 917504
buffer_load_dwordx4 v16, s[20:23], s43 offen lds
v_mfma_f32_16x16x32_bf16 v[104:107], v[196:199], a[180:183], v[104:107]
ds_read_b64_tr_b16 v[220:221], v11 offset:12288
v_mfma_f32_16x16x32_bf16 v[104:107], v[192:195], a[176:179], v[104:107]
ds_read_b64_tr_b16 v[222:223], v11 offset:14336
s_waitcnt lgkmcnt(8)
s_waitcnt vmcnt(15)
s_barrier
v_mfma_f32_16x16x32_bf16 v[104:107], v[200:203], a[184:187], v[104:107]
ds_read_b64_tr_b16 v[192:193], v4 offset:49152
ds_read_b64_tr_b16 v[194:195], v4 offset:51200
v_mfma_f32_16x16x32_bf16 v[104:107], v[204:207], a[188:191], v[104:107]
buffer_load_dwordx4 v17, s[20:23], s43 offen offset:1024 lds
v_mfma_f32_16x16x32_bf16 v[72:75], v[204:207], a[172:175], v[72:75]
ds_read_b64_tr_b16 v[196:197], v4 offset:53248
buffer_load_dwordx4 v18, s[20:23], s43 offen offset:2048 lds
v_mfma_f32_16x16x32_bf16 v[72:75], v[200:203], a[168:171], v[72:75]
ds_read_b64_tr_b16 v[198:199], v4 offset:55296
s_waitcnt lgkmcnt(8)
v_mfma_f32_16x16x32_bf16 v[76:79], v[208:211], a[160:163], v[76:79]
ds_read_b64_tr_b16 v[200:201], v4 offset:57344
ds_read_b64_tr_b16 v[202:203], v4 offset:59392
v_mfma_f32_16x16x32_bf16 v[76:79], v[212:215], a[164:167], v[76:79]
buffer_load_dwordx4 v19, s[20:23], s43 offen offset:3072 lds
v_mfma_f32_16x16x32_bf16 v[108:111], v[212:215], a[180:183], v[108:111]
ds_read_b64_tr_b16 v[204:205], v4 offset:61440
v_mfma_f32_16x16x32_bf16 v[108:111], v[208:211], a[176:179], v[108:111]
ds_read_b64_tr_b16 v[206:207], v4 offset:63488
s_waitcnt lgkmcnt(8)
v_mfma_f32_16x16x32_bf16 v[108:111], v[216:219], a[184:187], v[108:111]
ds_read_b64_tr_b16 v[208:209], v5 offset:49152
ds_read_b64_tr_b16 v[210:211], v5 offset:51200
v_mfma_f32_16x16x32_bf16 v[108:111], v[220:223], a[188:191], v[108:111]
s_xor_b32 s44, s46, 28672
buffer_load_dwordx4 a[224:227], v36, s[28:31], s44 offen offset:3072 sc1
v_mfma_f32_16x16x32_bf16 v[76:79], v[220:223], a[172:175], v[76:79]
ds_read_b64_tr_b16 v[212:213], v5 offset:53248
v_mfma_f32_16x16x32_bf16 v[76:79], v[216:219], a[168:171], v[76:79]
ds_read_b64_tr_b16 v[214:215], v5 offset:55296
s_waitcnt vmcnt(11) lgkmcnt(8)
v_mfma_f32_16x16x32_bf16 v[80:83], v[192:195], a[192:195], v[80:83]
ds_read_b64_tr_b16 v[216:217], v5 offset:57344
ds_read_b64_tr_b16 v[218:219], v5 offset:59392
v_mfma_f32_16x16x32_bf16 v[80:83], v[196:199], a[196:199], v[80:83]
buffer_load_dwordx4 a[228:231], v36, s[28:31], s44 offen offset:2048 sc1
v_mfma_f32_16x16x32_bf16 v[112:115], v[196:199], a[212:215], v[112:115]
ds_read_b64_tr_b16 v[220:221], v5 offset:61440
buffer_load_dwordx4 a[232:235], v36, s[28:31], s44 offen offset:1024 sc1
v_mfma_f32_16x16x32_bf16 v[112:115], v[192:195], a[208:211], v[112:115]
ds_read_b64_tr_b16 v[222:223], v5 offset:63488
s_waitcnt lgkmcnt(8)
v_mfma_f32_16x16x32_bf16 v[112:115], v[200:203], a[216:219], v[112:115]
ds_read_b64_tr_b16 v[192:193], v6 offset:49152
ds_read_b64_tr_b16 v[194:195], v6 offset:51200
v_mfma_f32_16x16x32_bf16 v[112:115], v[204:207], a[220:223], v[112:115]
buffer_load_dwordx4 a[236:239], v36, s[28:31], s44 offen sc1
v_mfma_f32_16x16x32_bf16 v[80:83], v[204:207], a[204:207], v[80:83]
ds_read_b64_tr_b16 v[196:197], v6 offset:53248
v_mfma_f32_16x16x32_bf16 v[80:83], v[200:203], a[200:203], v[80:83]
ds_read_b64_tr_b16 v[198:199], v6 offset:55296
s_waitcnt lgkmcnt(8)
v_mfma_f32_16x16x32_bf16 v[84:87], v[208:211], a[192:195], v[84:87]
ds_read_b64_tr_b16 v[200:201], v6 offset:57344
ds_read_b64_tr_b16 v[202:203], v6 offset:59392
v_mfma_f32_16x16x32_bf16 v[84:87], v[212:215], a[196:199], v[84:87]
buffer_load_dwordx4 a[240:243], v37, s[28:31], s44 offen offset:3072 sc1
v_mfma_f32_16x16x32_bf16 v[116:119], v[212:215], a[212:215], v[116:119]
ds_read_b64_tr_b16 v[204:205], v6 offset:61440
v_mfma_f32_16x16x32_bf16 v[116:119], v[208:211], a[208:211], v[116:119]
ds_read_b64_tr_b16 v[206:207], v6 offset:63488
s_waitcnt lgkmcnt(8)
v_mfma_f32_16x16x32_bf16 v[116:119], v[216:219], a[216:219], v[116:119]
ds_read_b64_tr_b16 v[208:209], v7 offset:49152
ds_read_b64_tr_b16 v[210:211], v7 offset:51200
v_mfma_f32_16x16x32_bf16 v[116:119], v[220:223], a[220:223], v[116:119]
buffer_load_dwordx4 a[244:247], v37, s[28:31], s44 offen offset:2048 sc1
v_mfma_f32_16x16x32_bf16 v[84:87], v[220:223], a[204:207], v[84:87]
ds_read_b64_tr_b16 v[212:213], v7 offset:53248
buffer_load_dwordx4 a[248:251], v37, s[28:31], s44 offen offset:1024 sc1
v_mfma_f32_16x16x32_bf16 v[84:87], v[216:219], a[200:203], v[84:87]
ds_read_b64_tr_b16 v[214:215], v7 offset:55296
s_waitcnt lgkmcnt(8)
v_mfma_f32_16x16x32_bf16 v[88:91], v[192:195], a[192:195], v[88:91]
ds_read_b64_tr_b16 v[216:217], v7 offset:57344
ds_read_b64_tr_b16 v[218:219], v7 offset:59392
v_mfma_f32_16x16x32_bf16 v[88:91], v[196:199], a[196:199], v[88:91]
buffer_load_dwordx4 a[252:255], v37, s[28:31], s44 offen sc1
v_mfma_f32_16x16x32_bf16 v[120:123], v[196:199], a[212:215], v[120:123]
ds_read_b64_tr_b16 v[220:221], v7 offset:61440
buffer_load_dword v60, v224, s[88:91], s82 offen sc1
v_mfma_f32_16x16x32_bf16 v[120:123], v[192:195], a[208:211], v[120:123]
ds_read_b64_tr_b16 v[222:223], v7 offset:63488
s_waitcnt lgkmcnt(8)
v_mfma_f32_16x16x32_bf16 v[120:123], v[200:203], a[216:219], v[120:123]
ds_read_b64_tr_b16 v[192:193], v14 offset:0
ds_read_b64_tr_b16 v[194:195], v14 offset:2048
v_mfma_f32_16x16x32_bf16 v[120:123], v[204:207], a[220:223], v[120:123]
v_mfma_f32_16x16x32_bf16 v[88:91], v[204:207], a[204:207], v[88:91]
ds_read_b64_tr_b16 v[196:197], v14 offset:4096
v_mfma_f32_16x16x32_bf16 v[88:91], v[200:203], a[200:203], v[88:91]
ds_read_b64_tr_b16 v[198:199], v14 offset:6144
s_waitcnt lgkmcnt(8)
v_mfma_f32_16x16x32_bf16 v[92:95], v[208:211], a[192:195], v[92:95]
ds_read_b64_tr_b16 v[200:201], v14 offset:8192
ds_read_b64_tr_b16 v[202:203], v14 offset:10240
v_mfma_f32_16x16x32_bf16 v[92:95], v[212:215], a[196:199], v[92:95]
v_mfma_f32_16x16x32_bf16 v[124:127], v[212:215], a[212:215], v[124:127]
L_pad13:
s_cbranch_execz L_walked
ds_read_b64_tr_b16 v[204:205], v14 offset:12288
v_mfma_f32_16x16x32_bf16 v[124:127], v[208:211], a[208:211], v[124:127]
ds_read_b64_tr_b16 v[206:207], v14 offset:14336
s_waitcnt lgkmcnt(8)
v_mfma_f32_16x16x32_bf16 v[124:127], v[216:219], a[216:219], v[124:127]
ds_read_b64_tr_b16 v[208:209], v15 offset:0
ds_read_b64_tr_b16 v[210:211], v15 offset:2048
v_mfma_f32_16x16x32_bf16 v[124:127], v[220:223], a[220:223], v[124:127]
v_mfma_f32_16x16x32_bf16 v[92:95], v[220:223], a[204:207], v[92:95]
ds_read_b64_tr_b16 v[212:213], v15 offset:4096
v_mfma_f32_16x16x32_bf16 v[92:95], v[216:219], a[200:203], v[92:95]
ds_read_b64_tr_b16 v[214:215], v15 offset:6144
s_waitcnt lgkmcnt(8)
v_mfma_f32_16x16x32_bf16 v[72:75], v[192:195], a[192:195], v[72:75]
ds_read_b64_tr_b16 v[216:217], v15 offset:8192
ds_read_b64_tr_b16 v[218:219], v15 offset:10240
v_mfma_f32_16x16x32_bf16 v[72:75], v[196:199], a[196:199], v[72:75]
v_mfma_f32_16x16x32_bf16 v[104:107], v[196:199], a[212:215], v[104:107]
ds_read_b64_tr_b16 v[220:221], v15 offset:12288
v_mfma_f32_16x16x32_bf16 v[104:107], v[192:195], a[208:211], v[104:107]
ds_read_b64_tr_b16 v[222:223], v15 offset:14336
s_waitcnt lgkmcnt(8)
s_waitcnt vmcnt(9)
s_barrier
v_mfma_f32_16x16x32_bf16 v[104:107], v[200:203], a[216:219], v[104:107]
ds_read_b64_tr_b16 v[192:193], v4 offset:16384
ds_read_b64_tr_b16 v[194:195], v4 offset:18432
v_mfma_f32_16x16x32_bf16 v[104:107], v[204:207], a[220:223], v[104:107]
v_mfma_f32_16x16x32_bf16 v[72:75], v[204:207], a[204:207], v[72:75]
ds_read_b64_tr_b16 v[196:197], v4 offset:20480
v_mfma_f32_16x16x32_bf16 v[72:75], v[200:203], a[200:203], v[72:75]
ds_read_b64_tr_b16 v[198:199], v4 offset:22528
s_waitcnt lgkmcnt(8)
v_mfma_f32_16x16x32_bf16 v[76:79], v[208:211], a[192:195], v[76:79]
ds_read_b64_tr_b16 v[200:201], v4 offset:24576
ds_read_b64_tr_b16 v[202:203], v4 offset:26624
v_mfma_f32_16x16x32_bf16 v[76:79], v[212:215], a[196:199], v[76:79]
v_mfma_f32_16x16x32_bf16 v[108:111], v[212:215], a[212:215], v[108:111]
ds_read_b64_tr_b16 v[204:205], v4 offset:28672
v_mfma_f32_16x16x32_bf16 v[108:111], v[208:211], a[208:211], v[108:111]
ds_read_b64_tr_b16 v[206:207], v4 offset:30720
s_waitcnt lgkmcnt(8)
v_mfma_f32_16x16x32_bf16 v[108:111], v[216:219], a[216:219], v[108:111]
ds_read_b64_tr_b16 v[208:209], v5 offset:16384
ds_read_b64_tr_b16 v[210:211], v5 offset:18432
v_mfma_f32_16x16x32_bf16 v[108:111], v[220:223], a[220:223], v[108:111]
v_mfma_f32_16x16x32_bf16 v[76:79], v[220:223], a[204:207], v[76:79]
ds_read_b64_tr_b16 v[212:213], v5 offset:20480
v_mfma_f32_16x16x32_bf16 v[76:79], v[216:219], a[200:203], v[76:79]
ds_read_b64_tr_b16 v[214:215], v5 offset:22528
s_waitcnt vmcnt(1) lgkmcnt(8)
s_waitcnt vmcnt(0)
v_cmp_ne_u32 vcc, s87, v60
s_cbranch_vccnz L_fwait
L_fok:
v_mfma_f32_16x16x32_bf16 v[80:83], v[192:195], a[224:227], v[80:83]
ds_read_b64_tr_b16 v[216:217], v5 offset:24576
ds_read_b64_tr_b16 v[218:219], v5 offset:26624
v_mfma_f32_16x16x32_bf16 v[80:83], v[196:199], a[228:231], v[80:83]
s_mul_i32 s80, s83, 49152
s_add_u32 s80, s80, 0
v_mfma_f32_16x16x32_bf16 v[112:115], v[196:199], a[244:247], v[112:115]
ds_read_b64_tr_b16 v[220:221], v5 offset:28672
buffer_load_dwordx4 v[140:143], v20, s[52:55], s80 offen sc1
v_mfma_f32_16x16x32_bf16 v[112:115], v[192:195], a[240:243], v[112:115]
ds_read_b64_tr_b16 v[222:223], v5 offset:30720
s_waitcnt lgkmcnt(8)
v_mfma_f32_16x16x32_bf16 v[112:115], v[200:203], a[248:251], v[112:115]
ds_read_b64_tr_b16 v[192:193], v6 offset:16384
ds_read_b64_tr_b16 v[194:195], v6 offset:18432
v_mfma_f32_16x16x32_bf16 v[112:115], v[204:207], a[252:255], v[112:115]
buffer_load_dwordx4 v[172:175], v20, s[52:55], s80 offen offset:1024 sc1
v_mfma_f32_16x16x32_bf16 v[80:83], v[204:207], a[236:239], v[80:83]
ds_read_b64_tr_b16 v[196:197], v6 offset:20480
s_mul_i32 s80, s83, 49152
s_add_u32 s80, s80, 16384
v_mfma_f32_16x16x32_bf16 v[80:83], v[200:203], a[232:235], v[80:83]
ds_read_b64_tr_b16 v[198:199], v6 offset:22528
s_waitcnt lgkmcnt(8)
v_mfma_f32_16x16x32_bf16 v[84:87], v[208:211], a[224:227], v[84:87]
ds_read_b64_tr_b16 v[200:201], v6 offset:24576
ds_read_b64_tr_b16 v[202:203], v6 offset:26624
v_mfma_f32_16x16x32_bf16 v[84:87], v[212:215], a[228:231], v[84:87]
buffer_load_dwordx4 v[148:151], v20, s[52:55], s80 offen sc1
v_mfma_f32_16x16x32_bf16 v[116:119], v[212:215], a[244:247], v[116:119]
ds_read_b64_tr_b16 v[204:205], v6 offset:28672
buffer_load_dwordx4 v[180:183], v20, s[52:55], s80 offen offset:1024 sc1
v_mfma_f32_16x16x32_bf16 v[116:119], v[208:211], a[240:243], v[116:119]
ds_read_b64_tr_b16 v[206:207], v6 offset:30720
s_waitcnt lgkmcnt(8)
v_mfma_f32_16x16x32_bf16 v[116:119], v[216:219], a[248:251], v[116:119]
ds_read_b64_tr_b16 v[208:209], v7 offset:16384
ds_read_b64_tr_b16 v[210:211], v7 offset:18432
v_mfma_f32_16x16x32_bf16 v[116:119], v[220:223], a[252:255], v[116:119]
s_mul_i32 s80, s83, 49152
s_add_u32 s80, s80, 32768
v_mfma_f32_16x16x32_bf16 v[84:87], v[220:223], a[236:239], v[84:87]
ds_read_b64_tr_b16 v[212:213], v7 offset:20480
buffer_load_dwordx4 v[156:159], v20, s[52:55], s80 offen sc1
v_mfma_f32_16x16x32_bf16 v[84:87], v[216:219], a[232:235], v[84:87]
ds_read_b64_tr_b16 v[214:215], v7 offset:22528
s_waitcnt lgkmcnt(8)
v_mfma_f32_16x16x32_bf16 v[88:91], v[192:195], a[224:227], v[88:91]
ds_read_b64_tr_b16 v[216:217], v7 offset:24576
ds_read_b64_tr_b16 v[218:219], v7 offset:26624
v_mfma_f32_16x16x32_bf16 v[88:91], v[196:199], a[228:231], v[88:91]
buffer_load_dwordx4 v[188:191], v20, s[52:55], s80 offen offset:1024 sc1
v_mfma_f32_16x16x32_bf16 v[120:123], v[196:199], a[244:247], v[120:123]
ds_read_b64_tr_b16 v[220:221], v7 offset:28672
v_mfma_f32_16x16x32_bf16 v[120:123], v[192:195], a[240:243], v[120:123]
ds_read_b64_tr_b16 v[222:223], v7 offset:30720
s_waitcnt lgkmcnt(8)
v_mfma_f32_16x16x32_bf16 v[120:123], v[200:203], a[248:251], v[120:123]
ds_read_b64_tr_b16 v[192:193], v6 offset:32768
ds_read_b64_tr_b16 v[194:195], v6 offset:34816
v_mfma_f32_16x16x32_bf16 v[120:123], v[204:207], a[252:255], v[120:123]
s_xor_b32 s80, s83, 2
s_mul_i32 s80, s80, 49152
s_add_u32 s80, s80, 24576
v_mfma_f32_16x16x32_bf16 v[88:91], v[204:207], a[236:239], v[88:91]
ds_read_b64_tr_b16 v[196:197], v6 offset:36864
v_cvt_pk_bf16_f32 v80, v80, v81
v_mfma_f32_16x16x32_bf16 v[88:91], v[200:203], a[232:235], v[88:91]
ds_read_b64_tr_b16 v[198:199], v6 offset:38912
s_waitcnt lgkmcnt(8)
v_mfma_f32_16x16x32_bf16 v[92:95], v[208:211], a[224:227], v[92:95]
ds_read_b64_tr_b16 v[200:201], v6 offset:40960
ds_read_b64_tr_b16 v[202:203], v6 offset:43008
v_mfma_f32_16x16x32_bf16 v[92:95], v[212:215], a[228:231], v[92:95]
v_cvt_pk_bf16_f32 v81, v82, v83
v_cvt_pk_bf16_f32 v82, v84, v85
v_mfma_f32_16x16x32_bf16 v[124:127], v[212:215], a[244:247], v[124:127]
ds_read_b64_tr_b16 v[204:205], v6 offset:45056
v_cvt_pk_bf16_f32 v83, v86, v87
v_mfma_f32_16x16x32_bf16 v[124:127], v[208:211], a[240:243], v[124:127]
ds_read_b64_tr_b16 v[206:207], v6 offset:47104
s_waitcnt lgkmcnt(8)
v_mfma_f32_16x16x32_bf16 v[124:127], v[216:219], a[248:251], v[124:127]
ds_read_b64_tr_b16 v[208:209], v7 offset:32768
ds_read_b64_tr_b16 v[210:211], v7 offset:34816
v_mfma_f32_16x16x32_bf16 v[124:127], v[220:223], a[252:255], v[124:127]
buffer_store_dwordx4 v[80:83], v20, s[52:55], s80 offen sc1
v_mfma_f32_16x16x32_bf16 v[92:95], v[220:223], a[236:239], v[92:95]
ds_read_b64_tr_b16 v[212:213], v7 offset:36864
v_cvt_pk_bf16_f32 v112, v112, v113
v_mfma_f32_16x16x32_bf16 v[92:95], v[216:219], a[232:235], v[92:95]
ds_read_b64_tr_b16 v[214:215], v7 offset:38912
s_waitcnt lgkmcnt(8)
v_mfma_f32_16x16x32_bf16 v[72:75], v[192:195], a[224:227], v[72:75]
ds_read_b64_tr_b16 v[216:217], v7 offset:40960
ds_read_b64_tr_b16 v[218:219], v7 offset:43008
v_mfma_f32_16x16x32_bf16 v[72:75], v[196:199], a[228:231], v[72:75]
v_cvt_pk_bf16_f32 v113, v114, v115
v_cvt_pk_bf16_f32 v114, v116, v117
v_mfma_f32_16x16x32_bf16 v[104:107], v[196:199], a[244:247], v[104:107]
ds_read_b64_tr_b16 v[220:221], v7 offset:45056
v_cvt_pk_bf16_f32 v115, v118, v119
v_mfma_f32_16x16x32_bf16 v[104:107], v[192:195], a[240:243], v[104:107]
ds_read_b64_tr_b16 v[222:223], v7 offset:47104
s_waitcnt lgkmcnt(8)
v_mfma_f32_16x16x32_bf16 v[104:107], v[200:203], a[248:251], v[104:107]
ds_read_b64_tr_b16 v[192:193], v4 offset:0
ds_read_b64_tr_b16 v[194:195], v4 offset:2048
v_mfma_f32_16x16x32_bf16 v[104:107], v[204:207], a[252:255], v[104:107]
buffer_store_dwordx4 v[112:115], v20, s[52:55], s80 offen offset:1024 sc1
v_mfma_f32_16x16x32_bf16 v[72:75], v[204:207], a[236:239], v[72:75]
ds_read_b64_tr_b16 v[196:197], v4 offset:4096
s_xor_b32 s80, s83, 3
s_mul_i32 s80, s80, 49152
v_mfma_f32_16x16x32_bf16 v[72:75], v[200:203], a[232:235], v[72:75]
ds_read_b64_tr_b16 v[198:199], v4 offset:6144
s_waitcnt lgkmcnt(8)
v_mfma_f32_16x16x32_bf16 v[76:79], v[208:211], a[224:227], v[76:79]
ds_read_b64_tr_b16 v[200:201], v4 offset:8192
ds_read_b64_tr_b16 v[202:203], v4 offset:10240
v_mfma_f32_16x16x32_bf16 v[76:79], v[212:215], a[228:231], v[76:79]
s_add_u32 s80, s80, 40960
v_cvt_pk_bf16_f32 v88, v88, v89
v_mfma_f32_16x16x32_bf16 v[108:111], v[212:215], a[244:247], v[108:111]
ds_read_b64_tr_b16 v[204:205], v4 offset:12288
v_cvt_pk_bf16_f32 v89, v90, v91
v_mfma_f32_16x16x32_bf16 v[108:111], v[208:211], a[240:243], v[108:111]
ds_read_b64_tr_b16 v[206:207], v4 offset:14336
s_waitcnt lgkmcnt(8)
v_mfma_f32_16x16x32_bf16 v[108:111], v[216:219], a[248:251], v[108:111]
ds_read_b64_tr_b16 v[208:209], v12 offset:16384
ds_read_b64_tr_b16 v[210:211], v12 offset:18432
v_mfma_f32_16x16x32_bf16 v[108:111], v[220:223], a[252:255], v[108:111]
v_cvt_pk_bf16_f32 v90, v92, v93
v_cvt_pk_bf16_f32 v91, v94, v95
v_mfma_f32_16x16x32_bf16 v[76:79], v[220:223], a[236:239], v[76:79]
ds_read_b64_tr_b16 v[212:213], v12 offset:20480
buffer_store_dwordx4 v[88:91], v20, s[52:55], s80 offen sc1
v_mfma_f32_16x16x32_bf16 v[76:79], v[216:219], a[232:235], v[76:79]
ds_read_b64_tr_b16 v[214:215], v12 offset:22528
s_waitcnt lgkmcnt(8)
v_mfma_f32_16x16x32_bf16 v[64:67], v[192:195], a[32:35], v[64:67]
ds_read_b64_tr_b16 v[216:217], v12 offset:24576
ds_read_b64_tr_b16 v[218:219], v12 offset:26624
v_mfma_f32_16x16x32_bf16 v[64:67], v[196:199], a[36:39], v[64:67]
v_cvt_pk_bf16_f32 v120, v120, v121
v_cvt_pk_bf16_f32 v121, v122, v123
v_mfma_f32_16x16x32_bf16 v[96:99], v[196:199], a[52:55], v[96:99]
ds_read_b64_tr_b16 v[220:221], v12 offset:28672
v_cvt_pk_bf16_f32 v122, v124, v125
v_mfma_f32_16x16x32_bf16 v[96:99], v[192:195], a[48:51], v[96:99]
ds_read_b64_tr_b16 v[222:223], v12 offset:30720
s_waitcnt lgkmcnt(8)
v_mfma_f32_16x16x32_bf16 v[96:99], v[200:203], a[56:59], v[96:99]
ds_read_b64_tr_b16 v[192:193], v8 offset:16384
ds_read_b64_tr_b16 v[194:195], v8 offset:18432
v_mfma_f32_16x16x32_bf16 v[96:99], v[204:207], a[60:63], v[96:99]
v_cvt_pk_bf16_f32 v123, v126, v127
v_mfma_f32_16x16x32_bf16 v[64:67], v[204:207], a[44:47], v[64:67]
ds_read_b64_tr_b16 v[196:197], v8 offset:20480
buffer_store_dwordx4 v[120:123], v20, s[52:55], s80 offen offset:1024 sc1
v_mfma_f32_16x16x32_bf16 v[64:67], v[200:203], a[40:43], v[64:67]
ds_read_b64_tr_b16 v[198:199], v8 offset:22528
s_waitcnt lgkmcnt(8)
v_mfma_f32_16x16x32_bf16 v[64:67], v[208:211], a[64:67], v[64:67]
ds_read_b64_tr_b16 v[200:201], v8 offset:24576
ds_read_b64_tr_b16 v[202:203], v8 offset:26624
v_mfma_f32_16x16x32_bf16 v[64:67], v[212:215], a[68:71], v[64:67]
s_xor_b32 s80, s83, 1
s_mul_i32 s80, s80, 49152
s_add_u32 s80, s80, 8192
v_mfma_f32_16x16x32_bf16 v[96:99], v[212:215], a[84:87], v[96:99]
ds_read_b64_tr_b16 v[204:205], v8 offset:28672
v_cvt_pk_bf16_f32 v72, v72, v73
v_mfma_f32_16x16x32_bf16 v[96:99], v[208:211], a[80:83], v[96:99]
ds_read_b64_tr_b16 v[206:207], v8 offset:30720
s_waitcnt lgkmcnt(8)
v_mfma_f32_16x16x32_bf16 v[96:99], v[216:219], a[88:91], v[96:99]
ds_read_b64_tr_b16 v[208:209], v8 offset:32768
ds_read_b64_tr_b16 v[210:211], v8 offset:34816
v_mfma_f32_16x16x32_bf16 v[96:99], v[220:223], a[92:95], v[96:99]
v_cvt_pk_bf16_f32 v73, v74, v75
v_cvt_pk_bf16_f32 v74, v76, v77
v_mfma_f32_16x16x32_bf16 v[64:67], v[220:223], a[76:79], v[64:67]
ds_read_b64_tr_b16 v[212:213], v8 offset:36864
v_cvt_pk_bf16_f32 v75, v78, v79
v_mfma_f32_16x16x32_bf16 v[64:67], v[216:219], a[72:75], v[64:67]
ds_read_b64_tr_b16 v[214:215], v8 offset:38912
s_waitcnt lgkmcnt(8)
v_mfma_f32_16x16x32_bf16 v[64:67], v[192:195], a[96:99], v[64:67]
ds_read_b64_tr_b16 v[216:217], v8 offset:40960
ds_read_b64_tr_b16 v[218:219], v8 offset:43008
v_mfma_f32_16x16x32_bf16 v[64:67], v[196:199], a[100:103], v[64:67]
buffer_store_dwordx4 v[72:75], v20, s[52:55], s80 offen sc1
v_mfma_f32_16x16x32_bf16 v[96:99], v[196:199], a[116:119], v[96:99]
ds_read_b64_tr_b16 v[220:221], v8 offset:45056
v_cvt_pk_bf16_f32 v104, v104, v105
v_mfma_f32_16x16x32_bf16 v[96:99], v[192:195], a[112:115], v[96:99]
ds_read_b64_tr_b16 v[222:223], v8 offset:47104
s_waitcnt lgkmcnt(8)
v_mfma_f32_16x16x32_bf16 v[96:99], v[200:203], a[120:123], v[96:99]
ds_read_b64_tr_b16 v[192:193], v8 offset:0
ds_read_b64_tr_b16 v[194:195], v8 offset:2048
v_mfma_f32_16x16x32_bf16 v[96:99], v[204:207], a[124:127], v[96:99]
v_cvt_pk_bf16_f32 v105, v106, v107
v_cvt_pk_bf16_f32 v106, v108, v109
v_mfma_f32_16x16x32_bf16 v[64:67], v[204:207], a[108:111], v[64:67]
ds_read_b64_tr_b16 v[196:197], v8 offset:4096
v_cvt_pk_bf16_f32 v107, v110, v111
v_mfma_f32_16x16x32_bf16 v[64:67], v[200:203], a[104:107], v[64:67]
ds_read_b64_tr_b16 v[198:199], v8 offset:6144
s_waitcnt lgkmcnt(8)
v_mfma_f32_16x16x32_bf16 v[64:67], v[208:211], a[128:131], v[64:67]
ds_read_b64_tr_b16 v[200:201], v8 offset:8192
ds_read_b64_tr_b16 v[202:203], v8 offset:10240
v_mfma_f32_16x16x32_bf16 v[64:67], v[212:215], a[132:135], v[64:67]
buffer_store_dwordx4 v[104:107], v20, s[52:55], s80 offen offset:1024 sc1
v_mfma_f32_16x16x32_bf16 v[96:99], v[212:215], a[148:151], v[96:99]
ds_read_b64_tr_b16 v[204:205], v8 offset:12288
v_mfma_f32_16x16x32_bf16 v[96:99], v[208:211], a[144:147], v[96:99]
ds_read_b64_tr_b16 v[206:207], v8 offset:14336
s_waitcnt lgkmcnt(8)
v_mfma_f32_16x16x32_bf16 v[96:99], v[216:219], a[152:155], v[96:99]
ds_read_b64_tr_b16 v[208:209], v12 offset:0
ds_read_b64_tr_b16 v[210:211], v12 offset:2048
v_mfma_f32_16x16x32_bf16 v[96:99], v[220:223], a[156:159], v[96:99]
v_mfma_f32_16x16x32_bf16 v[64:67], v[220:223], a[140:143], v[64:67]
ds_read_b64_tr_b16 v[212:213], v12 offset:4096
v_mfma_f32_16x16x32_bf16 v[64:67], v[216:219], a[136:139], v[64:67]
ds_read_b64_tr_b16 v[214:215], v12 offset:6144
s_waitcnt lgkmcnt(8)
v_mfma_f32_16x16x32_bf16 v[64:67], v[192:195], a[160:163], v[64:67]
ds_read_b64_tr_b16 v[216:217], v12 offset:8192
ds_read_b64_tr_b16 v[218:219], v12 offset:10240
v_mfma_f32_16x16x32_bf16 v[64:67], v[196:199], a[164:167], v[64:67]
v_mfma_f32_16x16x32_bf16 v[96:99], v[196:199], a[180:183], v[96:99]
ds_read_b64_tr_b16 v[220:221], v12 offset:12288
v_mfma_f32_16x16x32_bf16 v[96:99], v[192:195], a[176:179], v[96:99]
ds_read_b64_tr_b16 v[222:223], v12 offset:14336
s_waitcnt lgkmcnt(8)
s_waitcnt vmcnt(2)
v_mfma_f32_16x16x32_bf16 v[96:99], v[200:203], a[184:187], v[96:99]
ds_read_b64_tr_b16 v[192:193], v4 offset:32768
ds_read_b64_tr_b16 v[194:195], v4 offset:34816
v_mfma_f32_16x16x32_bf16 v[96:99], v[204:207], a[188:191], v[96:99]
s_xor_b32 s81, s83, 2
s_lshl_b32 s81, s81, 12
v_mfma_f32_16x16x32_bf16 v[64:67], v[204:207], a[172:175], v[64:67]
ds_read_b64_tr_b16 v[196:197], v4 offset:36864
s_add_u32 s81, s81, s79
v_mov_b32 v60, s87
buffer_store_dword v60, v40, s[88:91], s81 offen offset:768 sc1
v_mfma_f32_16x16x32_bf16 v[64:67], v[200:203], a[168:171], v[64:67]
ds_read_b64_tr_b16 v[198:199], v4 offset:38912
s_waitcnt lgkmcnt(8)
v_mfma_f32_16x16x32_bf16 v[64:67], v[208:211], a[192:195], v[64:67]
ds_read_b64_tr_b16 v[200:201], v4 offset:40960
ds_read_b64_tr_b16 v[202:203], v4 offset:43008
v_mfma_f32_16x16x32_bf16 v[64:67], v[212:215], a[196:199], v[64:67]
s_xor_b32 s81, s83, 3
s_lshl_b32 s81, s81, 12
v_mfma_f32_16x16x32_bf16 v[96:99], v[212:215], a[212:215], v[96:99]
ds_read_b64_tr_b16 v[204:205], v4 offset:45056
s_add_u32 s81, s81, s79
v_mov_b32 v60, s87
buffer_store_dword v60, v40, s[88:91], s81 offen offset:896 sc1
v_mfma_f32_16x16x32_bf16 v[96:99], v[208:211], a[208:211], v[96:99]
ds_read_b64_tr_b16 v[206:207], v4 offset:47104
s_waitcnt lgkmcnt(8)
v_mfma_f32_16x16x32_bf16 v[96:99], v[216:219], a[216:219], v[96:99]
ds_read_b64_tr_b16 v[208:209], v5 offset:0
ds_read_b64_tr_b16 v[210:211], v5 offset:2048
v_mfma_f32_16x16x32_bf16 v[96:99], v[220:223], a[220:223], v[96:99]
v_mfma_f32_16x16x32_bf16 v[64:67], v[220:223], a[204:207], v[64:67]
ds_read_b64_tr_b16 v[212:213], v5 offset:4096
v_mfma_f32_16x16x32_bf16 v[64:67], v[216:219], a[200:203], v[64:67]
ds_read_b64_tr_b16 v[214:215], v5 offset:6144
s_waitcnt lgkmcnt(8)
v_mfma_f32_16x16x32_bf16 v[64:67], v[192:195], a[224:227], v[64:67]
ds_read_b64_tr_b16 v[216:217], v5 offset:8192
ds_read_b64_tr_b16 v[218:219], v5 offset:10240
v_mfma_f32_16x16x32_bf16 v[64:67], v[196:199], a[228:231], v[64:67]
v_mfma_f32_16x16x32_bf16 v[96:99], v[196:199], a[244:247], v[96:99]
ds_read_b64_tr_b16 v[220:221], v5 offset:12288
v_mfma_f32_16x16x32_bf16 v[96:99], v[192:195], a[240:243], v[96:99]
ds_read_b64_tr_b16 v[222:223], v5 offset:14336
s_waitcnt lgkmcnt(8)
s_waitcnt vmcnt(2)
v_mfma_f32_16x16x32_bf16 v[96:99], v[200:203], a[248:251], v[96:99]
ds_read_b64_tr_b16 v[192:193], v13 offset:16384
ds_read_b64_tr_b16 v[194:195], v13 offset:18432
v_mfma_f32_16x16x32_bf16 v[96:99], v[204:207], a[252:255], v[96:99]
s_xor_b32 s81, s83, 1
s_lshl_b32 s81, s81, 12
v_mfma_f32_16x16x32_bf16 v[64:67], v[204:207], a[236:239], v[64:67]
ds_read_b64_tr_b16 v[196:197], v13 offset:20480
s_add_u32 s81, s81, s79
v_mov_b32 v60, s87
buffer_store_dword v60, v40, s[88:91], s81 offen offset:640 sc1
v_mfma_f32_16x16x32_bf16 v[64:67], v[200:203], a[232:235], v[64:67]
ds_read_b64_tr_b16 v[198:199], v13 offset:22528
s_waitcnt lgkmcnt(8)
v_mfma_f32_16x16x32_bf16 v[68:71], v[208:211], a[32:35], v[68:71]
ds_read_b64_tr_b16 v[200:201], v13 offset:24576
ds_read_b64_tr_b16 v[202:203], v13 offset:26624
v_mfma_f32_16x16x32_bf16 v[68:71], v[212:215], a[36:39], v[68:71]
v_mfma_f32_16x16x32_bf16 v[100:103], v[212:215], a[52:55], v[100:103]
ds_read_b64_tr_b16 v[204:205], v13 offset:28672
v_mfma_f32_16x16x32_bf16 v[100:103], v[208:211], a[48:51], v[100:103]
ds_read_b64_tr_b16 v[206:207], v13 offset:30720
s_waitcnt lgkmcnt(8)
v_mfma_f32_16x16x32_bf16 v[100:103], v[216:219], a[56:59], v[100:103]
ds_read_b64_tr_b16 v[208:209], v9 offset:16384
ds_read_b64_tr_b16 v[210:211], v9 offset:18432
v_mfma_f32_16x16x32_bf16 v[100:103], v[220:223], a[60:63], v[100:103]
v_mfma_f32_16x16x32_bf16 v[68:71], v[220:223], a[44:47], v[68:71]
ds_read_b64_tr_b16 v[212:213], v9 offset:20480
v_mfma_f32_16x16x32_bf16 v[68:71], v[216:219], a[40:43], v[68:71]
ds_read_b64_tr_b16 v[214:215], v9 offset:22528
s_waitcnt lgkmcnt(8)
v_mfma_f32_16x16x32_bf16 v[68:71], v[192:195], a[64:67], v[68:71]
ds_read_b64_tr_b16 v[216:217], v9 offset:24576
ds_read_b64_tr_b16 v[218:219], v9 offset:26624
v_mfma_f32_16x16x32_bf16 v[68:71], v[196:199], a[68:71], v[68:71]
v_mfma_f32_16x16x32_bf16 v[100:103], v[196:199], a[84:87], v[100:103]
ds_read_b64_tr_b16 v[220:221], v9 offset:28672
v_mfma_f32_16x16x32_bf16 v[100:103], v[192:195], a[80:83], v[100:103]
ds_read_b64_tr_b16 v[222:223], v9 offset:30720
s_waitcnt lgkmcnt(8)
v_mfma_f32_16x16x32_bf16 v[100:103], v[200:203], a[88:91], v[100:103]
ds_read_b64_tr_b16 v[192:193], v9 offset:32768
ds_read_b64_tr_b16 v[194:195], v9 offset:34816
v_mfma_f32_16x16x32_bf16 v[100:103], v[204:207], a[92:95], v[100:103]
v_mfma_f32_16x16x32_bf16 v[68:71], v[204:207], a[76:79], v[68:71]
ds_read_b64_tr_b16 v[196:197], v9 offset:36864
v_mfma_f32_16x16x32_bf16 v[68:71], v[200:203], a[72:75], v[68:71]
ds_read_b64_tr_b16 v[198:199], v9 offset:38912
s_waitcnt lgkmcnt(8)
v_mfma_f32_16x16x32_bf16 v[68:71], v[208:211], a[96:99], v[68:71]
ds_read_b64_tr_b16 v[200:201], v9 offset:40960
ds_read_b64_tr_b16 v[202:203], v9 offset:43008
v_mfma_f32_16x16x32_bf16 v[68:71], v[212:215], a[100:103], v[68:71]
v_mfma_f32_16x16x32_bf16 v[100:103], v[212:215], a[116:119], v[100:103]
ds_read_b64_tr_b16 v[204:205], v9 offset:45056
v_mfma_f32_16x16x32_bf16 v[100:103], v[208:211], a[112:115], v[100:103]
ds_read_b64_tr_b16 v[206:207], v9 offset:47104
s_waitcnt lgkmcnt(8)
v_mfma_f32_16x16x32_bf16 v[100:103], v[216:219], a[120:123], v[100:103]
ds_read_b64_tr_b16 v[208:209], v9 offset:0
ds_read_b64_tr_b16 v[210:211], v9 offset:2048
v_mfma_f32_16x16x32_bf16 v[100:103], v[220:223], a[124:127], v[100:103]
v_mfma_f32_16x16x32_bf16 v[68:71], v[220:223], a[108:111], v[68:71]
ds_read_b64_tr_b16 v[212:213], v9 offset:4096
v_mfma_f32_16x16x32_bf16 v[68:71], v[216:219], a[104:107], v[68:71]
ds_read_b64_tr_b16 v[214:215], v9 offset:6144
s_waitcnt lgkmcnt(8)
v_mfma_f32_16x16x32_bf16 v[68:71], v[192:195], a[128:131], v[68:71]
ds_read_b64_tr_b16 v[216:217], v9 offset:8192
ds_read_b64_tr_b16 v[218:219], v9 offset:10240
v_mfma_f32_16x16x32_bf16 v[68:71], v[196:199], a[132:135], v[68:71]
v_mfma_f32_16x16x32_bf16 v[100:103], v[196:199], a[148:151], v[100:103]
ds_read_b64_tr_b16 v[220:221], v9 offset:12288
v_mfma_f32_16x16x32_bf16 v[100:103], v[192:195], a[144:147], v[100:103]
ds_read_b64_tr_b16 v[222:223], v9 offset:14336
s_waitcnt lgkmcnt(8)
v_mfma_f32_16x16x32_bf16 v[100:103], v[200:203], a[152:155], v[100:103]
ds_read_b64_tr_b16 v[192:193], v13 offset:0
ds_read_b64_tr_b16 v[194:195], v13 offset:2048
v_mfma_f32_16x16x32_bf16 v[100:103], v[204:207], a[156:159], v[100:103]
buffer_load_dword v60, v224, s[88:91], s82 offen offset:512 sc1
v_mfma_f32_16x16x32_bf16 v[68:71], v[204:207], a[140:143], v[68:71]
ds_read_b64_tr_b16 v[196:197], v13 offset:4096
v_mfma_f32_16x16x32_bf16 v[68:71], v[200:203], a[136:139], v[68:71]
ds_read_b64_tr_b16 v[198:199], v13 offset:6144
s_waitcnt lgkmcnt(8)
v_mfma_f32_16x16x32_bf16 v[68:71], v[208:211], a[160:163], v[68:71]
ds_read_b64_tr_b16 v[200:201], v13 offset:8192
ds_read_b64_tr_b16 v[202:203], v13 offset:10240
v_mfma_f32_16x16x32_bf16 v[68:71], v[212:215], a[164:167], v[68:71]
v_mfma_f32_16x16x32_bf16 v[100:103], v[212:215], a[180:183], v[100:103]
ds_read_b64_tr_b16 v[204:205], v13 offset:12288
v_mfma_f32_16x16x32_bf16 v[100:103], v[208:211], a[176:179], v[100:103]
ds_read_b64_tr_b16 v[206:207], v13 offset:14336
s_waitcnt lgkmcnt(8)
v_mfma_f32_16x16x32_bf16 v[100:103], v[216:219], a[184:187], v[100:103]
ds_read_b64_tr_b16 v[208:209], v5 offset:32768
ds_read_b64_tr_b16 v[210:211], v5 offset:34816
v_mfma_f32_16x16x32_bf16 v[100:103], v[220:223], a[188:191], v[100:103]
v_mfma_f32_16x16x32_bf16 v[68:71], v[220:223], a[172:175], v[68:71]
ds_read_b64_tr_b16 v[212:213], v5 offset:36864
v_mfma_f32_16x16x32_bf16 v[68:71], v[216:219], a[168:171], v[68:71]
ds_read_b64_tr_b16 v[214:215], v5 offset:38912
s_waitcnt lgkmcnt(8)
v_mfma_f32_16x16x32_bf16 v[68:71], v[192:195], a[192:195], v[68:71]
ds_read_b64_tr_b16 v[216:217], v5 offset:40960
ds_read_b64_tr_b16 v[218:219], v5 offset:43008
v_mfma_f32_16x16x32_bf16 v[68:71], v[196:199], a[196:199], v[68:71]
v_mfma_f32_16x16x32_bf16 v[100:103], v[196:199], a[212:215], v[100:103]
ds_read_b64_tr_b16 v[220:221], v5 offset:45056
v_mfma_f32_16x16x32_bf16 v[100:103], v[192:195], a[208:211], v[100:103]
ds_read_b64_tr_b16 v[222:223], v5 offset:47104
s_waitcnt lgkmcnt(8)
v_mfma_f32_16x16x32_bf16 v[100:103], v[200:203], a[216:219], v[100:103]
v_mfma_f32_16x16x32_bf16 v[100:103], v[204:207], a[220:223], v[100:103]
v_mfma_f32_16x16x32_bf16 v[68:71], v[204:207], a[204:207], v[68:71]
v_mfma_f32_16x16x32_bf16 v[68:71], v[200:203], a[200:203], v[68:71]
s_waitcnt lgkmcnt(4)
v_mfma_f32_16x16x32_bf16 v[68:71], v[208:211], a[224:227], v[68:71]
v_mfma_f32_16x16x32_bf16 v[68:71], v[212:215], a[228:231], v[68:71]
v_mfma_f32_16x16x32_bf16 v[100:103], v[212:215], a[244:247], v[100:103]
v_mfma_f32_16x16x32_bf16 v[100:103], v[208:211], a[240:243], v[100:103]
s_waitcnt lgkmcnt(0)
v_mfma_f32_16x16x32_bf16 v[100:103], v[216:219], a[248:251], v[100:103]
v_mfma_f32_16x16x32_bf16 v[100:103], v[220:223], a[252:255], v[100:103]
v_mfma_f32_16x16x32_bf16 v[68:71], v[220:223], a[236:239], v[68:71]
v_mfma_f32_16x16x32_bf16 v[68:71], v[216:219], a[232:235], v[68:71]
s_waitcnt vmcnt(0)
v_cmp_ne_u32 vcc, s87, v60
s_cbranch_vccnz L_notyet
s_mul_i32 s80, s83, 49152
s_add_u32 s80, s80, 8192
buffer_load_dwordx4 v[76:79], v20, s[52:55], s80 offen sc1
buffer_load_dwordx4 v[108:111], v20, s[52:55], s80 offen offset:1024 sc1
s_mul_i32 s80, s83, 49152
s_add_u32 s80, s80, 24576
buffer_load_dwordx4 v[84:87], v20, s[52:55], s80 offen sc1
buffer_load_dwordx4 v[116:119], v20, s[52:55], s80 offen offset:1024 sc1
s_mul_i32 s80, s83, 49152
s_add_u32 s80, s80, 40960
buffer_load_dwordx4 v[92:95], v20, s[52:55], s80 offen sc1
buffer_load_dwordx4 v[124:127], v20, s[52:55], s80 offen offset:1024 sc1
L_notyet:
s_mov_b32 s46, 0xbfb8aa3b
s_mov_b32 s47, 0xbfb8aa3b
s_mov_b32 s81, 0xffff0000
v_lshlrev_b32 v240, 16, v140
v_and_b32 v241, s81, v140
v_lshlrev_b32 v242, 16, v141
v_and_b32 v243, s81, v141
v_lshlrev_b32 v244, 16, v142
v_and_b32 v245, s81, v142
v_lshlrev_b32 v246, 16, v143
v_and_b32 v247, s81, v143
v_pk_add_f32 v[128:129], v[128:129], v[240:241]
v_pk_add_f32 v[130:131], v[130:131], v[242:243]
v_pk_add_f32 v[132:133], v[132:133], v[244:245]
v_pk_add_f32 v[134:135], v[134:135], v[246:247]
v_lshlrev_b32 v248, 16, v172
v_and_b32 v249, s81, v172
v_lshlrev_b32 v250, 16, v173
v_and_b32 v251, s81, v173
v_lshlrev_b32 v252, 16, v174
v_and_b32 v253, s81, v174
v_lshlrev_b32 v254, 16, v175
v_and_b32 v255, s81, v175
v_pk_add_f32 v[160:161], v[160:161], v[248:249]
v_pk_add_f32 v[162:163], v[162:163], v[250:251]
v_pk_add_f32 v[164:165], v[164:165], v[252:253]
v_pk_add_f32 v[166:167], v[166:167], v[254:255]
v_lshlrev_b32 v240, 16, v148
v_and_b32 v241, s81, v148
v_lshlrev_b32 v242, 16, v149
v_and_b32 v243, s81, v149
v_lshlrev_b32 v244, 16, v150
v_and_b32 v245, s81, v150
v_lshlrev_b32 v246, 16, v151
v_and_b32 v247, s81, v151
v_pk_add_f32 v[128:129], v[128:129], v[240:241]
v_pk_add_f32 v[130:131], v[130:131], v[242:243]
v_pk_add_f32 v[132:133], v[132:133], v[244:245]
v_pk_add_f32 v[134:135], v[134:135], v[246:247]
v_lshlrev_b32 v248, 16, v180
v_and_b32 v249, s81, v180
v_lshlrev_b32 v250, 16, v181
v_and_b32 v251, s81, v181
v_lshlrev_b32 v252, 16, v182
v_and_b32 v253, s81, v182
v_lshlrev_b32 v254, 16, v183
v_and_b32 v255, s81, v183
v_pk_add_f32 v[160:161], v[160:161], v[248:249]
v_pk_add_f32 v[162:163], v[162:163], v[250:251]
v_pk_add_f32 v[164:165], v[164:165], v[252:253]
v_pk_add_f32 v[166:167], v[166:167], v[254:255]
v_lshlrev_b32 v240, 16, v156
v_and_b32 v241, s81, v156
v_lshlrev_b32 v242, 16, v157
v_and_b32 v243, s81, v157
v_lshlrev_b32 v244, 16, v158
v_and_b32 v245, s81, v158
v_lshlrev_b32 v246, 16, v159
v_and_b32 v247, s81, v159
v_pk_add_f32 v[128:129], v[128:129], v[240:241]
v_pk_add_f32 v[130:131], v[130:131], v[242:243]
v_pk_add_f32 v[132:133], v[132:133], v[244:245]
v_pk_add_f32 v[134:135], v[134:135], v[246:247]
v_lshlrev_b32 v248, 16, v188
v_and_b32 v249, s81, v188
v_lshlrev_b32 v250, 16, v189
v_and_b32 v251, s81, v189
v_lshlrev_b32 v252, 16, v190
v_and_b32 v253, s81, v190
v_lshlrev_b32 v254, 16, v191
v_and_b32 v255, s81, v191
v_pk_add_f32 v[160:161], v[160:161], v[248:249]
v_pk_add_f32 v[162:163], v[162:163], v[250:251]
v_pk_add_f32 v[164:165], v[164:165], v[252:253]
v_pk_add_f32 v[166:167], v[166:167], v[254:255]
v_pk_mul_f32 v[192:193], v[128:129], s[46:47]
v_pk_mul_f32 v[194:195], v[130:131], s[46:47]
v_pk_mul_f32 v[196:197], v[132:133], s[46:47]
v_pk_mul_f32 v[198:199], v[134:135], s[46:47]
v_pk_mul_f32 v[200:201], v[160:161], s[46:47]
v_pk_mul_f32 v[202:203], v[162:163], s[46:47]
v_pk_mul_f32 v[204:205], v[164:165], s[46:47]
v_pk_mul_f32 v[206:207], v[166:167], s[46:47]
v_exp_f32 v192, v192
v_exp_f32 v193, v193
v_exp_f32 v194, v194
v_exp_f32 v195, v195
v_exp_f32 v196, v196
L_pad14:
s_cbranch_execz L_walked
v_exp_f32 v197, v197
v_exp_f32 v198, v198
v_exp_f32 v199, v199
v_exp_f32 v200, v200
v_exp_f32 v201, v201
v_exp_f32 v202, v202
v_exp_f32 v203, v203
v_exp_f32 v204, v204
v_exp_f32 v205, v205
v_exp_f32 v206, v206
v_exp_f32 v207, v207
v_pk_add_f32 v[192:193], v[192:193], 1.0 op_sel_hi:[1,0]
v_pk_add_f32 v[194:195], v[194:195], 1.0 op_sel_hi:[1,0]
v_pk_add_f32 v[196:197], v[196:197], 1.0 op_sel_hi:[1,0]
v_pk_add_f32 v[198:199], v[198:199], 1.0 op_sel_hi:[1,0]
v_pk_add_f32 v[200:201], v[200:201], 1.0 op_sel_hi:[1,0]
v_pk_add_f32 v[202:203], v[202:203], 1.0 op_sel_hi:[1,0]
v_pk_add_f32 v[204:205], v[204:205], 1.0 op_sel_hi:[1,0]
v_pk_add_f32 v[206:207], v[206:207], 1.0 op_sel_hi:[1,0]
s_cbranch_vccz L_fetched
s_mov_b32 s45, 0x40000
L_spin2:
buffer_load_dword v60, v224, s[88:91], s82 offen offset:512 sc1
s_sub_u32 s45, s45, 1
s_waitcnt vmcnt(0)
s_cbranch_scc1 L_spin_done2
v_cmp_ne_u32 vcc, s87, v60
s_cbranch_vccnz L_spin2
L_spin_done2:
s_mul_i32 s80, s83, 49152
s_add_u32 s80, s80, 8192
buffer_load_dwordx4 v[76:79], v20, s[52:55], s80 offen sc1
buffer_load_dwordx4 v[108:111], v20, s[52:55], s80 offen offset:1024 sc1
s_mul_i32 s80, s83, 49152
s_add_u32 s80, s80, 24576
buffer_load_dwordx4 v[84:87], v20, s[52:55], s80 offen sc1
buffer_load_dwordx4 v[116:119], v20, s[52:55], s80 offen offset:1024 sc1
s_mul_i32 s80, s83, 49152
s_add_u32 s80, s80, 40960
buffer_load_dwordx4 v[92:95], v20, s[52:55], s80 offen sc1
buffer_load_dwordx4 v[124:127], v20, s[52:55], s80 offen offset:1024 sc1
L_fetched:
v_rcp_f32 v192, v192
v_rcp_f32 v193, v193
v_rcp_f32 v194, v194
v_rcp_f32 v195, v195
v_rcp_f32 v196, v196
v_rcp_f32 v197, v197
v_rcp_f32 v198, v198
v_rcp_f32 v199, v199
v_rcp_f32 v200, v200
v_rcp_f32 v201, v201
v_rcp_f32 v202, v202
v_rcp_f32 v203, v203
v_rcp_f32 v204, v204
v_rcp_f32 v205, v205
v_rcp_f32 v206, v206
v_rcp_f32 v207, v207
v_permlane16_swap_b32 v52, v54
v_permlane16_swap_b32 v53, v55
v_permlane16_swap_b32 v56, v58
v_permlane16_swap_b32 v57, v59
v_permlane32_swap_b32 v52, v54
v_permlane32_swap_b32 v53, v55
v_permlane32_swap_b32 v56, v58
v_permlane32_swap_b32 v57, v59
v_lshlrev_b32 v208, 16, v52
v_and_b32 v209, s81, v52
v_lshlrev_b32 v210, 16, v53
v_and_b32 v211, s81, v53
v_lshlrev_b32 v212, 16, v54
v_and_b32 v213, s81, v54
v_lshlrev_b32 v214, 16, v55
v_and_b32 v215, s81, v55
v_lshlrev_b32 v216, 16, v56
v_and_b32 v217, s81, v56
v_lshlrev_b32 v218, 16, v57
v_and_b32 v219, s81, v57
v_lshlrev_b32 v220, 16, v58
v_and_b32 v221, s81, v58
v_lshlrev_b32 v222, 16, v59
v_and_b32 v223, s81, v59
v_pk_mul_f32 v[192:193], v[128:129], v[192:193]
v_pk_mul_f32 v[194:195], v[130:131], v[194:195]
v_pk_mul_f32 v[196:197], v[132:133], v[196:197]
v_pk_mul_f32 v[198:199], v[134:135], v[198:199]
v_pk_mul_f32 v[200:201], v[160:161], v[200:201]
v_pk_mul_f32 v[202:203], v[162:163], v[202:203]
v_pk_mul_f32 v[204:205], v[164:165], v[204:205]
v_pk_mul_f32 v[206:207], v[166:167], v[206:207]
s_movk_i32 s45, 16384
s_waitcnt vmcnt(0)
v_lshlrev_b32 v240, 16, v76
v_and_b32 v241, s81, v76
v_lshlrev_b32 v242, 16, v77
v_and_b32 v243, s81, v77
v_lshlrev_b32 v244, 16, v78
v_and_b32 v245, s81, v78
v_lshlrev_b32 v246, 16, v79
v_and_b32 v247, s81, v79
v_pk_add_f32 v[64:65], v[64:65], v[240:241]
v_pk_add_f32 v[66:67], v[66:67], v[242:243]
v_pk_add_f32 v[68:69], v[68:69], v[244:245]
v_pk_add_f32 v[70:71], v[70:71], v[246:247]
v_lshlrev_b32 v248, 16, v108
v_and_b32 v249, s81, v108
v_lshlrev_b32 v250, 16, v109
v_and_b32 v251, s81, v109
v_lshlrev_b32 v252, 16, v110
v_and_b32 v253, s81, v110
v_lshlrev_b32 v254, 16, v111
v_and_b32 v255, s81, v111
v_pk_add_f32 v[96:97], v[96:97], v[248:249]
v_pk_add_f32 v[98:99], v[98:99], v[250:251]
v_pk_add_f32 v[100:101], v[100:101], v[252:253]
v_pk_add_f32 v[102:103], v[102:103], v[254:255]
v_lshlrev_b32 v240, 16, v84
v_and_b32 v241, s81, v84
v_lshlrev_b32 v242, 16, v85
v_and_b32 v243, s81, v85
v_lshlrev_b32 v244, 16, v86
v_and_b32 v245, s81, v86
v_lshlrev_b32 v246, 16, v87
v_and_b32 v247, s81, v87
v_pk_add_f32 v[64:65], v[64:65], v[240:241]
v_pk_add_f32 v[66:67], v[66:67], v[242:243]
v_pk_add_f32 v[68:69], v[68:69], v[244:245]
v_pk_add_f32 v[70:71], v[70:71], v[246:247]
v_lshlrev_b32 v248, 16, v116
v_and_b32 v249, s81, v116
v_lshlrev_b32 v250, 16, v117
v_and_b32 v251, s81, v117
v_lshlrev_b32 v252, 16, v118
v_and_b32 v253, s81, v118
v_lshlrev_b32 v254, 16, v119
v_and_b32 v255, s81, v119
v_pk_add_f32 v[96:97], v[96:97], v[248:249]
v_pk_add_f32 v[98:99], v[98:99], v[250:251]
v_pk_add_f32 v[100:101], v[100:101], v[252:253]
v_pk_add_f32 v[102:103], v[102:103], v[254:255]
v_lshlrev_b32 v240, 16, v92
v_and_b32 v241, s81, v92
v_lshlrev_b32 v242, 16, v93
v_and_b32 v243, s81, v93
v_lshlrev_b32 v244, 16, v94
v_and_b32 v245, s81, v94
v_lshlrev_b32 v246, 16, v95
v_and_b32 v247, s81, v95
v_pk_add_f32 v[64:65], v[64:65], v[240:241]
v_pk_add_f32 v[66:67], v[66:67], v[242:243]
v_pk_add_f32 v[68:69], v[68:69], v[244:245]
v_pk_add_f32 v[70:71], v[70:71], v[246:247]
v_lshlrev_b32 v248, 16, v124
v_and_b32 v249, s81, v124
v_lshlrev_b32 v250, 16, v125
v_and_b32 v251, s81, v125
v_lshlrev_b32 v252, 16, v126
v_and_b32 v253, s81, v126
v_lshlrev_b32 v254, 16, v127
v_and_b32 v255, s81, v127
v_pk_add_f32 v[96:97], v[96:97], v[248:249]
v_pk_add_f32 v[98:99], v[98:99], v[250:251]
v_pk_add_f32 v[100:101], v[100:101], v[252:253]
v_pk_add_f32 v[102:103], v[102:103], v[254:255]
v_pk_fma_f32 v[208:209], v[192:193], v[64:65], v[208:209]
v_pk_fma_f32 v[210:211], v[194:195], v[66:67], v[210:211]
v_pk_fma_f32 v[212:213], v[196:197], v[68:69], v[212:213]
v_pk_fma_f32 v[214:215], v[198:199], v[70:71], v[214:215]
v_pk_fma_f32 v[216:217], v[200:201], v[96:97], v[216:217]
v_pk_fma_f32 v[218:219], v[202:203], v[98:99], v[218:219]
v_pk_fma_f32 v[220:221], v[204:205], v[100:101], v[220:221]
v_pk_fma_f32 v[222:223], v[206:207], v[102:103], v[222:223]
v_cvt_pk_bf16_f32 v52, v208, v209
v_cvt_pk_bf16_f32 v53, v210, v211
v_cvt_pk_bf16_f32 v54, v212, v213
v_cvt_pk_bf16_f32 v55, v214, v215
v_cvt_pk_bf16_f32 v56, v216, v217
v_cvt_pk_bf16_f32 v57, v218, v219
v_cvt_pk_bf16_f32 v58, v220, v221
v_cvt_pk_bf16_f32 v59, v222, v223
s_nop 0
s_nop 0
v_permlane32_swap_b32 v52, v54
v_permlane32_swap_b32 v53, v55
v_permlane32_swap_b32 v56, v58
v_permlane32_swap_b32 v57, v59
s_nop 0
v_permlane16_swap_b32 v52, v54
v_permlane16_swap_b32 v53, v55
v_permlane16_swap_b32 v56, v58
v_permlane16_swap_b32 v57, v59
buffer_store_dwordx4 v[52:55], v21, s[56:59], 0 offen nt
buffer_store_dwordx4 v[56:59], v21, s[56:59], s45 offen nt
s_endpgm
L_even:
L_pad15:
s_cbranch_execz L_pad16
s_waitcnt vmcnt(0) lgkmcnt(4)
v_mfma_f32_16x16x32_bf16 v[128:131], a[224:227], a[128:131], 0
ds_read_b64_tr_b16 a[240:241], v25 offset:0
ds_read_b64_tr_b16 a[242:243], v25 offset:1024
v_mfma_f32_16x16x32_bf16 v[128:131], a[228:231], a[132:135], v[128:131]
ds_read_b64_tr_b16 a[244:245], v25 offset:8192
ds_read_b64_tr_b16 a[246:247], v25 offset:9216
v_mfma_f32_16x16x32_bf16 v[144:147], a[228:231], a[140:143], 0
s_xor_b32 s44, s79, 2048
v_mfma_f32_16x16x32_bf16 v[144:147], a[224:227], a[136:139], v[144:147]
buffer_load_dwordx4 a[160:163], v40, s[28:31], s44 offen sc1
v_mfma_f32_16x16x32_bf16 v[160:163], a[224:227], a[144:147], 0
v_lshl_add_u32 v8, v57, 5, v56
v_xor_b32 v57, 1, v55
v_mfma_f32_16x16x32_bf16 v[160:163], a[228:231], a[148:151], v[160:163]
buffer_load_dwordx4 a[164:167], v40, s[28:31], s44 offen offset:1024 sc1
v_mfma_f32_16x16x32_bf16 v[176:179], a[228:231], a[156:159], 0
v_lshl_add_u32 v9, v57, 5, v56
v_xor_b32 v57, 2, v55
v_mfma_f32_16x16x32_bf16 v[176:179], a[224:227], a[152:155], v[176:179]
s_waitcnt lgkmcnt(4)
v_mfma_f32_16x16x32_bf16 v[240:243], a[232:235], a[152:155], 0
ds_read_b64_tr_b16 a[224:225], v25 offset:8
ds_read_b64_tr_b16 a[226:227], v25 offset:1032
v_mfma_f32_16x16x32_bf16 v[240:243], a[236:239], a[156:159], v[240:243]
ds_read_b64_tr_b16 a[228:229], v25 offset:8200
ds_read_b64_tr_b16 a[230:231], v25 offset:9224
v_mfma_f32_16x16x32_bf16 v[224:227], a[236:239], a[148:151], 0
v_mfma_f32_16x16x32_bf16 v[224:227], a[232:235], a[144:147], v[224:227]
buffer_load_dwordx4 a[168:171], v41, s[28:31], s44 offen sc1
v_mfma_f32_16x16x32_bf16 v[208:211], a[232:235], a[136:139], 0
v_lshl_add_u32 v10, v57, 5, v56
v_xor_b32 v57, 3, v55
v_mfma_f32_16x16x32_bf16 v[208:211], a[236:239], a[140:143], v[208:211]
buffer_load_dwordx4 a[172:175], v41, s[28:31], s44 offen offset:1024 sc1
v_mfma_f32_16x16x32_bf16 v[192:195], a[236:239], a[132:135], 0
v_lshl_add_u32 v11, v57, 5, v56
v_xor_b32 v57, 4, v55
v_mfma_f32_16x16x32_bf16 v[192:195], a[232:235], a[128:131], v[192:195]
s_waitcnt lgkmcnt(4)
v_mfma_f32_16x16x32_bf16 v[132:135], a[240:243], a[128:131], 0
ds_read_b64_tr_b16 a[232:233], v26 offset:0
ds_read_b64_tr_b16 a[234:235], v26 offset:1024
v_mfma_f32_16x16x32_bf16 v[132:135], a[244:247], a[132:135], v[132:135]
ds_read_b64_tr_b16 a[236:237], v26 offset:8192
ds_read_b64_tr_b16 a[238:239], v26 offset:9216
v_mfma_f32_16x16x32_bf16 v[148:151], a[244:247], a[140:143], 0
v_mfma_f32_16x16x32_bf16 v[148:151], a[240:243], a[136:139], v[148:151]
buffer_load_dwordx4 a[176:179], v42, s[28:31], s44 offen sc1
v_mfma_f32_16x16x32_bf16 v[164:167], a[240:243], a[144:147], 0
v_lshl_add_u32 v12, v57, 5, v56
v_xor_b32 v57, 5, v55
v_mfma_f32_16x16x32_bf16 v[164:167], a[244:247], a[148:151], v[164:167]
buffer_load_dwordx4 a[180:183], v42, s[28:31], s44 offen offset:1024 sc1
v_mfma_f32_16x16x32_bf16 v[180:183], a[244:247], a[156:159], 0
v_lshl_add_u32 v13, v57, 5, v56
v_xor_b32 v57, 6, v55
v_mfma_f32_16x16x32_bf16 v[180:183], a[240:243], a[152:155], v[180:183]
s_waitcnt lgkmcnt(4)
v_mfma_f32_16x16x32_bf16 v[244:247], a[224:227], a[152:155], 0
ds_read_b64_tr_b16 a[240:241], v26 offset:8
ds_read_b64_tr_b16 a[242:243], v26 offset:1032
v_mfma_f32_16x16x32_bf16 v[244:247], a[228:231], a[156:159], v[244:247]
ds_read_b64_tr_b16 a[244:245], v26 offset:8200
ds_read_b64_tr_b16 a[246:247], v26 offset:9224
v_mfma_f32_16x16x32_bf16 v[228:231], a[228:231], a[148:151], 0
v_mfma_f32_16x16x32_bf16 v[228:231], a[224:227], a[144:147], v[228:231]
buffer_load_dwordx4 a[184:187], v43, s[28:31], s44 offen sc1
v_mfma_f32_16x16x32_bf16 v[212:215], a[224:227], a[136:139], 0
v_lshl_add_u32 v14, v57, 5, v56
v_xor_b32 v57, 7, v55
v_mfma_f32_16x16x32_bf16 v[212:215], a[228:231], a[140:143], v[212:215]
buffer_load_dwordx4 a[188:191], v43, s[28:31], s44 offen offset:1024 sc1
v_mfma_f32_16x16x32_bf16 v[196:199], a[228:231], a[132:135], 0
v_lshl_add_u32 v15, v57, 5, v56
v_lshlrev_b32 v55, 12, v1
v_mfma_f32_16x16x32_bf16 v[196:199], a[224:227], a[128:131], v[196:199]
s_waitcnt lgkmcnt(4)
v_mfma_f32_16x16x32_bf16 v[136:139], a[232:235], a[128:131], 0
ds_read_b64_tr_b16 a[224:225], v27 offset:0
ds_read_b64_tr_b16 a[226:227], v27 offset:1024
v_mfma_f32_16x16x32_bf16 v[136:139], a[236:239], a[132:135], v[136:139]
ds_read_b64_tr_b16 a[228:229], v27 offset:8192
ds_read_b64_tr_b16 a[230:231], v27 offset:9216
v_mfma_f32_16x16x32_bf16 v[152:155], a[236:239], a[140:143], 0
s_add_u32 m0, s40, 32768
s_xor_b32 s43, s101, 1048576
v_mfma_f32_16x16x32_bf16 v[152:155], a[232:235], a[136:139], v[152:155]
buffer_load_dwordx4 v32, s[16:19], s43 offen lds
v_mfma_f32_16x16x32_bf16 v[168:171], a[232:235], a[144:147], 0
v_lshl_add_u32 v55, v3, 8, v55
v_xor_b32 v56, v2, v3
v_mfma_f32_16x16x32_bf16 v[168:171], a[236:239], a[148:151], v[168:171]
buffer_load_dwordx4 v33, s[16:19], s43 offen offset:1024 lds
v_mfma_f32_16x16x32_bf16 v[184:187], a[236:239], a[156:159], 0
v_xor_b32 v57, 0, v56
v_lshl_add_u32 v16, v57, 4, v55
v_mfma_f32_16x16x32_bf16 v[184:187], a[232:235], a[152:155], v[184:187]
s_waitcnt lgkmcnt(4)
v_mfma_f32_16x16x32_bf16 v[248:251], a[240:243], a[152:155], 0
ds_read_b64_tr_b16 a[232:233], v27 offset:8
ds_read_b64_tr_b16 a[234:235], v27 offset:1032
v_mfma_f32_16x16x32_bf16 v[248:251], a[244:247], a[156:159], v[248:251]
ds_read_b64_tr_b16 a[236:237], v27 offset:8200
ds_read_b64_tr_b16 a[238:239], v27 offset:9224
v_mfma_f32_16x16x32_bf16 v[232:235], a[244:247], a[148:151], 0
v_mfma_f32_16x16x32_bf16 v[232:235], a[240:243], a[144:147], v[232:235]
buffer_load_dwordx4 v34, s[16:19], s43 offen offset:2048 lds
v_mfma_f32_16x16x32_bf16 v[216:219], a[240:243], a[136:139], 0
s_xor_b32 s86, s100, 2
v_mfma_f32_16x16x32_bf16 v[216:219], a[244:247], a[140:143], v[216:219]
buffer_load_dwordx4 v35, s[16:19], s43 offen offset:3072 lds
v_mfma_f32_16x16x32_bf16 v[200:203], a[244:247], a[132:135], 0
v_xor_b32 v57, 4, v56
v_lshl_add_u32 v17, v57, 4, v55
v_mfma_f32_16x16x32_bf16 v[200:203], a[240:243], a[128:131], v[200:203]
s_waitcnt lgkmcnt(4)
v_mfma_f32_16x16x32_bf16 v[140:143], a[224:227], a[128:131], 0
ds_read_b64_tr_b16 a[240:241], v28 offset:0
ds_read_b64_tr_b16 a[242:243], v28 offset:512
v_mfma_f32_16x16x32_bf16 v[140:143], a[228:231], a[132:135], v[140:143]
ds_read_b64_tr_b16 a[244:245], v28 offset:4096
ds_read_b64_tr_b16 a[246:247], v28 offset:4608
v_mfma_f32_16x16x32_bf16 v[156:159], a[228:231], a[140:143], 0
s_add_u32 m0, s41, 32768
s_mul_i32 s43, s86, 229376
v_mfma_f32_16x16x32_bf16 v[156:159], a[224:227], a[136:139], v[156:159]
buffer_load_dwordx4 v36, s[20:23], s43 offen lds
v_mfma_f32_16x16x32_bf16 v[172:175], a[224:227], a[144:147], 0
v_xor_b32 v57, 8, v56
v_lshl_add_u32 v18, v57, 4, v55
v_mfma_f32_16x16x32_bf16 v[172:175], a[228:231], a[148:151], v[172:175]
buffer_load_dwordx4 v37, s[20:23], s43 offen offset:1024 lds
v_mfma_f32_16x16x32_bf16 v[188:191], a[228:231], a[156:159], 0
v_xor_b32 v57, 12, v56
v_lshl_add_u32 v19, v57, 4, v55
v_mfma_f32_16x16x32_bf16 v[188:191], a[224:227], a[152:155], v[188:191]
s_waitcnt lgkmcnt(4)
v_mfma_f32_16x16x32_bf16 v[252:255], a[232:235], a[152:155], 0
ds_read_b64_tr_b16 a[224:225], v29 offset:0
ds_read_b64_tr_b16 a[226:227], v29 offset:512
v_mfma_f32_16x16x32_bf16 v[252:255], a[236:239], a[156:159], v[252:255]
ds_read_b64_tr_b16 a[228:229], v29 offset:4096
ds_read_b64_tr_b16 a[230:231], v29 offset:4608
v_mfma_f32_16x16x32_bf16 v[236:239], a[236:239], a[148:151], 0
s_add_u32 m0, s41, 40960
v_mfma_f32_16x16x32_bf16 v[236:239], a[232:235], a[144:147], v[236:239]
buffer_load_dwordx4 v36, s[24:27], s43 offen lds
v_mfma_f32_16x16x32_bf16 v[220:223], a[232:235], a[136:139], 0
v_lshlrev_b32 v56, 1, v3
v_xor_b32 v56, v2, v56
v_mfma_f32_16x16x32_bf16 v[220:223], a[236:239], a[140:143], v[220:223]
buffer_load_dwordx4 v37, s[24:27], s43 offen offset:1024 lds
v_mfma_f32_16x16x32_bf16 v[204:207], a[236:239], a[132:135], 0
v_xor_b32 v57, 0, v56
v_lshl_add_u32 v20, v57, 4, v55
v_mfma_f32_16x16x32_bf16 v[204:207], a[232:235], a[128:131], v[204:207]
s_waitcnt lgkmcnt(4)
v_mfma_f32_16x16x32_bf16 v[64:67], a[240:243], a[128:131], 0
ds_read_b64_tr_b16 a[232:233], v30 offset:0
ds_read_b64_tr_b16 a[234:235], v30 offset:512
v_mfma_f32_16x16x32_bf16 v[64:67], a[244:247], a[132:135], v[64:67]
ds_read_b64_tr_b16 a[236:237], v30 offset:4096
ds_read_b64_tr_b16 a[238:239], v30 offset:4608
v_mfma_f32_16x16x32_bf16 v[80:83], a[244:247], a[140:143], 0
s_xor_b32 s44, s79, 4096
v_mfma_f32_16x16x32_bf16 v[80:83], a[240:243], a[136:139], v[80:83]
buffer_load_dwordx4 a[192:195], v40, s[28:31], s44 offen sc1
v_mfma_f32_16x16x32_bf16 v[96:99], a[240:243], a[144:147], 0
v_xor_b32 v57, 8, v56
v_lshl_add_u32 v21, v57, 4, v55
v_mfma_f32_16x16x32_bf16 v[96:99], a[244:247], a[148:151], v[96:99]
buffer_load_dwordx4 a[196:199], v40, s[28:31], s44 offen offset:1024 sc1
v_mfma_f32_16x16x32_bf16 v[112:115], a[244:247], a[156:159], 0
s_mul_i32 s80, s50, 233472
v_lshlrev_b32 v55, 4, v0
v_mfma_f32_16x16x32_bf16 v[112:115], a[240:243], a[152:155], v[112:115]
s_waitcnt lgkmcnt(4)
v_mfma_f32_16x16x32_bf16 v[116:119], a[224:227], a[152:155], 0
ds_read_b64_tr_b16 a[240:241], v31 offset:0
ds_read_b64_tr_b16 a[242:243], v31 offset:512
v_mfma_f32_16x16x32_bf16 v[116:119], a[228:231], a[156:159], v[116:119]
ds_read_b64_tr_b16 a[244:245], v31 offset:4096
ds_read_b64_tr_b16 a[246:247], v31 offset:4608
v_mfma_f32_16x16x32_bf16 v[100:103], a[228:231], a[148:151], 0
v_mfma_f32_16x16x32_bf16 v[100:103], a[224:227], a[144:147], v[100:103]
buffer_load_dwordx4 a[200:203], v41, s[28:31], s44 offen sc1
v_mfma_f32_16x16x32_bf16 v[84:87], a[224:227], a[136:139], 0
v_add_u32 v44, s80, v55
s_mul_i32 s80, s50, 524288
v_mfma_f32_16x16x32_bf16 v[84:87], a[228:231], a[140:143], v[84:87]
buffer_load_dwordx4 a[204:207], v41, s[28:31], s44 offen offset:1024 sc1
v_mfma_f32_16x16x32_bf16 v[68:71], a[228:231], a[132:135], 0
v_add_u32 v48, s80, v55
v_add_u32 v45, 58368, v44
v_mfma_f32_16x16x32_bf16 v[68:71], a[224:227], a[128:131], v[68:71]
s_waitcnt lgkmcnt(4)
v_mfma_f32_16x16x32_bf16 v[72:75], a[232:235], a[128:131], 0
ds_read_b64_tr_b16 a[224:225], v28 offset:8192
ds_read_b64_tr_b16 a[226:227], v28 offset:8704
v_mfma_f32_16x16x32_bf16 v[72:75], a[236:239], a[132:135], v[72:75]
ds_read_b64_tr_b16 a[228:229], v28 offset:12288
ds_read_b64_tr_b16 a[230:231], v28 offset:12800
v_mfma_f32_16x16x32_bf16 v[88:91], a[236:239], a[140:143], 0
v_mfma_f32_16x16x32_bf16 v[88:91], a[232:235], a[136:139], v[88:91]
buffer_load_dwordx4 a[208:211], v42, s[28:31], s44 offen sc1
v_mfma_f32_16x16x32_bf16 v[104:107], a[232:235], a[144:147], 0
v_add_u32 v49, 131072, v48
v_add_u32 v46, 116736, v44
v_mfma_f32_16x16x32_bf16 v[104:107], a[236:239], a[148:151], v[104:107]
buffer_load_dwordx4 a[212:215], v42, s[28:31], s44 offen offset:1024 sc1
v_mfma_f32_16x16x32_bf16 v[120:123], a[236:239], a[156:159], 0
v_add_u32 v50, 262144, v48
v_add_u32 v47, 175104, v44
v_mfma_f32_16x16x32_bf16 v[120:123], a[232:235], a[152:155], v[120:123]
s_waitcnt lgkmcnt(4)
v_mfma_f32_16x16x32_bf16 v[124:127], a[240:243], a[152:155], 0
ds_read_b64_tr_b16 a[232:233], v29 offset:8192
ds_read_b64_tr_b16 a[234:235], v29 offset:8704
v_mfma_f32_16x16x32_bf16 v[124:127], a[244:247], a[156:159], v[124:127]
ds_read_b64_tr_b16 a[236:237], v29 offset:12288
ds_read_b64_tr_b16 a[238:239], v29 offset:12800
v_mfma_f32_16x16x32_bf16 v[108:111], a[244:247], a[148:151], 0
v_mfma_f32_16x16x32_bf16 v[108:111], a[240:243], a[144:147], v[108:111]
v_mfma_f32_16x16x32_bf16 v[92:95], a[240:243], a[136:139], 0
v_add_u32 v51, 393216, v48
s_mul_i32 s80, s50, 116736
v_mfma_f32_16x16x32_bf16 v[92:95], a[244:247], a[140:143], v[92:95]
buffer_load_dwordx4 a[216:219], v43, s[28:31], s44 offen sc1
v_mfma_f32_16x16x32_bf16 v[76:79], a[244:247], a[132:135], 0
v_add_u32 v22, s80, v55
v_add_u32 v23, 58368, v22
v_mfma_f32_16x16x32_bf16 v[76:79], a[240:243], a[128:131], v[76:79]
s_waitcnt lgkmcnt(4)
v_mfma_f32_16x16x32_bf16 a[0:3], a[224:227], a[128:131], 0
ds_read_b64_tr_b16 a[240:241], v30 offset:8192
ds_read_b64_tr_b16 a[242:243], v30 offset:8704
v_mfma_f32_16x16x32_bf16 a[0:3], a[228:231], a[132:135], a[0:3]
ds_read_b64_tr_b16 a[244:245], v30 offset:12288
ds_read_b64_tr_b16 a[246:247], v30 offset:12800
v_mfma_f32_16x16x32_bf16 a[16:19], a[228:231], a[140:143], 0
v_mfma_f32_16x16x32_bf16 a[16:19], a[224:227], a[136:139], a[16:19]
v_mfma_f32_16x16x32_bf16 a[32:35], a[224:227], a[144:147], 0
s_mov_b32 s46, 0x3e0293ee
s_mov_b32 s47, 0x3e0293ee
v_mfma_f32_16x16x32_bf16 a[32:35], a[228:231], a[148:151], a[32:35]
buffer_load_dwordx4 a[220:223], v43, s[28:31], s44 offen offset:1024 sc1
v_mfma_f32_16x16x32_bf16 a[48:51], a[228:231], a[156:159], 0
v_mfma_f32_16x16x32_bf16 a[48:51], a[224:227], a[152:155], a[48:51]
s_waitcnt lgkmcnt(4)
v_mfma_f32_16x16x32_bf16 a[52:55], a[232:235], a[152:155], 0
ds_read_b64_tr_b16 a[224:225], v31 offset:8192
ds_read_b64_tr_b16 a[226:227], v31 offset:8704
v_mfma_f32_16x16x32_bf16 a[52:55], a[236:239], a[156:159], a[52:55]
ds_read_b64_tr_b16 a[228:229], v31 offset:12288
ds_read_b64_tr_b16 a[230:231], v31 offset:12800
v_mfma_f32_16x16x32_bf16 a[36:39], a[236:239], a[148:151], 0
v_mfma_f32_16x16x32_bf16 a[36:39], a[232:235], a[144:147], a[36:39]
v_mfma_f32_16x16x32_bf16 a[20:23], a[232:235], a[136:139], 0
s_xor_b32 s45, s101, 2097152
s_and_b32 s45, s45, 2097152
v_mfma_f32_16x16x32_bf16 a[20:23], a[236:239], a[140:143], a[20:23]
buffer_load_dword v58, v38, s[16:19], s45 offen
v_mfma_f32_16x16x32_bf16 a[4:7], a[236:239], a[132:135], 0
v_mfma_f32_16x16x32_bf16 a[4:7], a[232:235], a[128:131], a[4:7]
s_waitcnt vmcnt(17) lgkmcnt(4)
s_barrier
v_mfma_f32_16x16x32_bf16 a[8:11], a[240:243], a[128:131], 0
ds_read_b64_tr_b16 a[232:233], v24 offset:16384
ds_read_b64_tr_b16 a[234:235], v24 offset:17408
v_mfma_f32_16x16x32_bf16 a[8:11], a[244:247], a[132:135], a[8:11]
ds_read_b64_tr_b16 a[236:237], v24 offset:24576
ds_read_b64_tr_b16 a[238:239], v24 offset:25600
v_mfma_f32_16x16x32_bf16 a[24:27], a[244:247], a[140:143], 0
v_mfma_f32_16x16x32_bf16 a[24:27], a[240:243], a[136:139], a[24:27]
v_mfma_f32_16x16x32_bf16 a[40:43], a[240:243], a[144:147], 0
s_lshr_b32 s45, s45, 13
s_mul_i32 s45, s45, 3584
v_mfma_f32_16x16x32_bf16 a[40:43], a[244:247], a[148:151], a[40:43]
buffer_load_dword v59, v39, s[20:23], s45 offen offset:64
v_mfma_f32_16x16x32_bf16 a[56:59], a[244:247], a[156:159], 0
v_mfma_f32_16x16x32_bf16 a[56:59], a[240:243], a[152:155], a[56:59]
s_waitcnt lgkmcnt(4)
v_mfma_f32_16x16x32_bf16 a[60:63], a[224:227], a[152:155], 0
ds_read_b64_tr_b16 a[240:241], v24 offset:16392
ds_read_b64_tr_b16 a[242:243], v24 offset:17416
v_mfma_f32_16x16x32_bf16 a[60:63], a[228:231], a[156:159], a[60:63]
ds_read_b64_tr_b16 a[244:245], v24 offset:24584
ds_read_b64_tr_b16 a[246:247], v24 offset:25608
v_mfma_f32_16x16x32_bf16 a[44:47], a[228:231], a[148:151], 0
v_mfma_f32_16x16x32_bf16 a[44:47], a[224:227], a[144:147], a[44:47]
v_mfma_f32_16x16x32_bf16 a[28:31], a[224:227], a[136:139], 0
v_mfma_f32_16x16x32_bf16 a[28:31], a[228:231], a[140:143], a[28:31]
buffer_load_dword v60, v39, s[24:27], s45 offen offset:64
v_mfma_f32_16x16x32_bf16 a[12:15], a[228:231], a[132:135], 0
v_mfma_f32_16x16x32_bf16 a[12:15], a[224:227], a[128:131], a[12:15]
s_waitcnt lgkmcnt(4)
v_mfma_f32_16x16x32_bf16 v[128:131], a[232:235], a[160:163], v[128:131]
ds_read_b64_tr_b16 a[224:225], v25 offset:16384
ds_read_b64_tr_b16 a[226:227], v25 offset:17408
v_mfma_f32_16x16x32_bf16 v[128:131], a[236:239], a[164:167], v[128:131]
ds_read_b64_tr_b16 a[228:229], v25 offset:24576
ds_read_b64_tr_b16 a[230:231], v25 offset:25600
v_mfma_f32_16x16x32_bf16 v[144:147], a[236:239], a[172:175], v[144:147]
v_mfma_f32_16x16x32_bf16 v[144:147], a[232:235], a[168:171], v[144:147]
v_mfma_f32_16x16x32_bf16 v[160:163], a[232:235], a[176:179], v[160:163]
s_add_u32 m0, s40, 49152
s_xor_b32 s43, s101, 1572864
v_mfma_f32_16x16x32_bf16 v[160:163], a[236:239], a[180:183], v[160:163]
buffer_load_dwordx4 v32, s[16:19], s43 offen lds
v_mfma_f32_16x16x32_bf16 v[176:179], a[236:239], a[188:191], v[176:179]
v_mfma_f32_16x16x32_bf16 v[176:179], a[232:235], a[184:187], v[176:179]
s_waitcnt lgkmcnt(4)
v_mfma_f32_16x16x32_bf16 v[240:243], a[240:243], a[184:187], v[240:243]
ds_read_b64_tr_b16 a[232:233], v25 offset:16392
ds_read_b64_tr_b16 a[234:235], v25 offset:17416
v_mfma_f32_16x16x32_bf16 v[240:243], a[244:247], a[188:191], v[240:243]
ds_read_b64_tr_b16 a[236:237], v25 offset:24584
ds_read_b64_tr_b16 a[238:239], v25 offset:25608
v_mfma_f32_16x16x32_bf16 v[224:227], a[244:247], a[180:183], v[224:227]
v_mfma_f32_16x16x32_bf16 v[224:227], a[240:243], a[176:179], v[224:227]
v_mfma_f32_16x16x32_bf16 v[208:211], a[240:243], a[168:171], v[208:211]
v_mfma_f32_16x16x32_bf16 v[208:211], a[244:247], a[172:175], v[208:211]
buffer_load_dwordx4 v33, s[16:19], s43 offen offset:1024 lds
v_mfma_f32_16x16x32_bf16 v[192:195], a[244:247], a[164:167], v[192:195]
v_mfma_f32_16x16x32_bf16 v[192:195], a[240:243], a[160:163], v[192:195]
s_waitcnt lgkmcnt(4)
v_mfma_f32_16x16x32_bf16 v[132:135], a[224:227], a[160:163], v[132:135]
ds_read_b64_tr_b16 a[240:241], v26 offset:16384
ds_read_b64_tr_b16 a[242:243], v26 offset:17408
v_mfma_f32_16x16x32_bf16 v[132:135], a[228:231], a[164:167], v[132:135]
ds_read_b64_tr_b16 a[244:245], v26 offset:24576
ds_read_b64_tr_b16 a[246:247], v26 offset:25600
v_mfma_f32_16x16x32_bf16 v[148:151], a[228:231], a[172:175], v[148:151]
v_mfma_f32_16x16x32_bf16 v[148:151], a[224:227], a[168:171], v[148:151]
v_mfma_f32_16x16x32_bf16 v[164:167], a[224:227], a[176:179], v[164:167]
v_mfma_f32_16x16x32_bf16 v[164:167], a[228:231], a[180:183], v[164:167]
buffer_load_dwordx4 v34, s[16:19], s43 offen offset:2048 lds
v_mfma_f32_16x16x32_bf16 v[180:183], a[228:231], a[188:191], v[180:183]
v_mfma_f32_16x16x32_bf16 v[180:183], a[224:227], a[184:187], v[180:183]
s_waitcnt lgkmcnt(4)
v_mfma_f32_16x16x32_bf16 v[244:247], a[232:235], a[184:187], v[244:247]
ds_read_b64_tr_b16 a[224:225], v26 offset:16392
ds_read_b64_tr_b16 a[226:227], v26 offset:17416
v_mfma_f32_16x16x32_bf16 v[244:247], a[236:239], a[188:191], v[244:247]
ds_read_b64_tr_b16 a[228:229], v26 offset:24584
ds_read_b64_tr_b16 a[230:231], v26 offset:25608
v_mfma_f32_16x16x32_bf16 v[228:231], a[236:239], a[180:183], v[228:231]
v_mfma_f32_16x16x32_bf16 v[228:231], a[232:235], a[176:179], v[228:231]
v_mfma_f32_16x16x32_bf16 v[212:215], a[232:235], a[168:171], v[212:215]
s_xor_b32 s86, s100, 3
v_mfma_f32_16x16x32_bf16 v[212:215], a[236:239], a[172:175], v[212:215]
buffer_load_dwordx4 v35, s[16:19], s43 offen offset:3072 lds
v_mfma_f32_16x16x32_bf16 v[196:199], a[236:239], a[164:167], v[196:199]
v_mfma_f32_16x16x32_bf16 v[196:199], a[232:235], a[160:163], v[196:199]
s_waitcnt lgkmcnt(4)
v_mfma_f32_16x16x32_bf16 v[136:139], a[240:243], a[160:163], v[136:139]
ds_read_b64_tr_b16 a[232:233], v27 offset:16384
ds_read_b64_tr_b16 a[234:235], v27 offset:17408
v_mfma_f32_16x16x32_bf16 v[136:139], a[244:247], a[164:167], v[136:139]
ds_read_b64_tr_b16 a[236:237], v27 offset:24576
ds_read_b64_tr_b16 a[238:239], v27 offset:25600
v_mfma_f32_16x16x32_bf16 v[152:155], a[244:247], a[172:175], v[152:155]
v_mfma_f32_16x16x32_bf16 v[152:155], a[240:243], a[168:171], v[152:155]
v_mfma_f32_16x16x32_bf16 v[168:171], a[240:243], a[176:179], v[168:171]
s_add_u32 m0, s41, 49152
s_mul_i32 s43, s86, 229376
v_mfma_f32_16x16x32_bf16 v[168:171], a[244:247], a[180:183], v[168:171]
buffer_load_dwordx4 v36, s[20:23], s43 offen lds
v_mfma_f32_16x16x32_bf16 v[184:187], a[244:247], a[188:191], v[184:187]
v_mfma_f32_16x16x32_bf16 v[184:187], a[240:243], a[184:187], v[184:187]
s_waitcnt lgkmcnt(4)
v_mfma_f32_16x16x32_bf16 v[248:251], a[224:227], a[184:187], v[248:251]
ds_read_b64_tr_b16 a[240:241], v27 offset:16392
ds_read_b64_tr_b16 a[242:243], v27 offset:17416
v_mfma_f32_16x16x32_bf16 v[248:251], a[228:231], a[188:191], v[248:251]
ds_read_b64_tr_b16 a[244:245], v27 offset:24584
ds_read_b64_tr_b16 a[246:247], v27 offset:25608
v_mfma_f32_16x16x32_bf16 v[232:235], a[228:231], a[180:183], v[232:235]
v_mfma_f32_16x16x32_bf16 v[232:235], a[224:227], a[176:179], v[232:235]
v_mfma_f32_16x16x32_bf16 v[216:219], a[224:227], a[168:171], v[216:219]
v_mfma_f32_16x16x32_bf16 v[216:219], a[228:231], a[172:175], v[216:219]
buffer_load_dwordx4 v37, s[20:23], s43 offen offset:1024 lds
v_mfma_f32_16x16x32_bf16 v[200:203], a[228:231], a[164:167], v[200:203]
v_mfma_f32_16x16x32_bf16 v[200:203], a[224:227], a[160:163], v[200:203]
s_waitcnt lgkmcnt(4)
v_mfma_f32_16x16x32_bf16 v[140:143], a[232:235], a[160:163], v[140:143]
ds_read_b64_tr_b16 a[224:225], v28 offset:16384
ds_read_b64_tr_b16 a[226:227], v28 offset:16896
v_mfma_f32_16x16x32_bf16 v[140:143], a[236:239], a[164:167], v[140:143]
ds_read_b64_tr_b16 a[228:229], v28 offset:20480
ds_read_b64_tr_b16 a[230:231], v28 offset:20992
v_mfma_f32_16x16x32_bf16 v[156:159], a[236:239], a[172:175], v[156:159]
v_mfma_f32_16x16x32_bf16 v[156:159], a[232:235], a[168:171], v[156:159]
v_mfma_f32_16x16x32_bf16 v[172:175], a[232:235], a[176:179], v[172:175]
s_add_u32 m0, s41, 57344
v_mfma_f32_16x16x32_bf16 v[172:175], a[236:239], a[180:183], v[172:175]
buffer_load_dwordx4 v36, s[24:27], s43 offen lds
v_mfma_f32_16x16x32_bf16 v[188:191], a[236:239], a[188:191], v[188:191]
v_mfma_f32_16x16x32_bf16 v[188:191], a[232:235], a[184:187], v[188:191]
s_waitcnt lgkmcnt(4)
v_mfma_f32_16x16x32_bf16 v[252:255], a[240:243], a[184:187], v[252:255]
ds_read_b64_tr_b16 a[232:233], v29 offset:16384
ds_read_b64_tr_b16 a[234:235], v29 offset:16896
L_pad16:
s_cbranch_execz L_walked0
v_mfma_f32_16x16x32_bf16 v[252:255], a[244:247], a[188:191], v[252:255]
ds_read_b64_tr_b16 a[236:237], v29 offset:20480
ds_read_b64_tr_b16 a[238:239], v29 offset:20992
v_mfma_f32_16x16x32_bf16 v[236:239], a[244:247], a[180:183], v[236:239]
v_mfma_f32_16x16x32_bf16 v[236:239], a[240:243], a[176:179], v[236:239]
v_mfma_f32_16x16x32_bf16 v[220:223], a[240:243], a[168:171], v[220:223]
v_mfma_f32_16x16x32_bf16 v[220:223], a[244:247], a[172:175], v[220:223]
buffer_load_dwordx4 v37, s[24:27], s43 offen offset:1024 lds
v_mfma_f32_16x16x32_bf16 v[204:207], a[244:247], a[164:167], v[204:207]
v_mfma_f32_16x16x32_bf16 v[204:207], a[240:243], a[160:163], v[204:207]
s_waitcnt lgkmcnt(4)
v_mfma_f32_16x16x32_bf16 v[64:67], a[224:227], a[160:163], v[64:67]
ds_read_b64_tr_b16 a[240:241], v30 offset:16384
ds_read_b64_tr_b16 a[242:243], v30 offset:16896
v_mfma_f32_16x16x32_bf16 v[64:67], a[228:231], a[164:167], v[64:67]
ds_read_b64_tr_b16 a[244:245], v30 offset:20480
ds_read_b64_tr_b16 a[246:247], v30 offset:20992
v_mfma_f32_16x16x32_bf16 v[80:83], a[228:231], a[172:175], v[80:83]
v_mfma_f32_16x16x32_bf16 v[80:83], a[224:227], a[168:171], v[80:83]
v_mfma_f32_16x16x32_bf16 v[96:99], a[224:227], a[176:179], v[96:99]
s_xor_b32 s44, s79, 6144
v_mfma_f32_16x16x32_bf16 v[96:99], a[228:231], a[180:183], v[96:99]
buffer_load_dwordx4 a[128:131], v40, s[28:31], s44 offen sc1
v_mfma_f32_16x16x32_bf16 v[112:115], a[228:231], a[188:191], v[112:115]
v_mfma_f32_16x16x32_bf16 v[112:115], a[224:227], a[184:187], v[112:115]
s_waitcnt lgkmcnt(4)
v_mfma_f32_16x16x32_bf16 v[116:119], a[232:235], a[184:187], v[116:119]
ds_read_b64_tr_b16 a[224:225], v31 offset:16384
ds_read_b64_tr_b16 a[226:227], v31 offset:16896
v_mfma_f32_16x16x32_bf16 v[116:119], a[236:239], a[188:191], v[116:119]
ds_read_b64_tr_b16 a[228:229], v31 offset:20480
ds_read_b64_tr_b16 a[230:231], v31 offset:20992
v_mfma_f32_16x16x32_bf16 v[100:103], a[236:239], a[180:183], v[100:103]
v_mfma_f32_16x16x32_bf16 v[100:103], a[232:235], a[176:179], v[100:103]
v_mfma_f32_16x16x32_bf16 v[84:87], a[232:235], a[168:171], v[84:87]
v_mfma_f32_16x16x32_bf16 v[84:87], a[236:239], a[172:175], v[84:87]
buffer_load_dwordx4 a[132:135], v40, s[28:31], s44 offen offset:1024 sc1
v_mfma_f32_16x16x32_bf16 v[68:71], a[236:239], a[164:167], v[68:71]
v_mfma_f32_16x16x32_bf16 v[68:71], a[232:235], a[160:163], v[68:71]
s_waitcnt lgkmcnt(4)
v_mfma_f32_16x16x32_bf16 v[72:75], a[240:243], a[160:163], v[72:75]
ds_read_b64_tr_b16 a[232:233], v28 offset:24576
ds_read_b64_tr_b16 a[234:235], v28 offset:25088
v_mfma_f32_16x16x32_bf16 v[72:75], a[244:247], a[164:167], v[72:75]
ds_read_b64_tr_b16 a[236:237], v28 offset:28672
ds_read_b64_tr_b16 a[238:239], v28 offset:29184
v_mfma_f32_16x16x32_bf16 v[88:91], a[244:247], a[172:175], v[88:91]
v_mfma_f32_16x16x32_bf16 v[88:91], a[240:243], a[168:171], v[88:91]
v_mfma_f32_16x16x32_bf16 v[104:107], a[240:243], a[176:179], v[104:107]
v_mfma_f32_16x16x32_bf16 v[104:107], a[244:247], a[180:183], v[104:107]
buffer_load_dwordx4 a[136:139], v41, s[28:31], s44 offen sc1
v_mfma_f32_16x16x32_bf16 v[120:123], a[244:247], a[188:191], v[120:123]
v_mfma_f32_16x16x32_bf16 v[120:123], a[240:243], a[184:187], v[120:123]
s_waitcnt lgkmcnt(4)
v_mfma_f32_16x16x32_bf16 v[124:127], a[224:227], a[184:187], v[124:127]
ds_read_b64_tr_b16 a[240:241], v29 offset:24576
ds_read_b64_tr_b16 a[242:243], v29 offset:25088
v_mfma_f32_16x16x32_bf16 v[124:127], a[228:231], a[188:191], v[124:127]
ds_read_b64_tr_b16 a[244:245], v29 offset:28672
ds_read_b64_tr_b16 a[246:247], v29 offset:29184
v_mfma_f32_16x16x32_bf16 v[108:111], a[228:231], a[180:183], v[108:111]
v_mfma_f32_16x16x32_bf16 v[108:111], a[224:227], a[176:179], v[108:111]
v_mfma_f32_16x16x32_bf16 v[92:95], a[224:227], a[168:171], v[92:95]
v_mfma_f32_16x16x32_bf16 v[92:95], a[228:231], a[172:175], v[92:95]
buffer_load_dwordx4 a[140:143], v41, s[28:31], s44 offen offset:1024 sc1
v_mfma_f32_16x16x32_bf16 v[76:79], a[228:231], a[164:167], v[76:79]
v_mfma_f32_16x16x32_bf16 v[76:79], a[224:227], a[160:163], v[76:79]
s_waitcnt lgkmcnt(4)
v_mfma_f32_16x16x32_bf16 a[0:3], a[232:235], a[160:163], a[0:3]
ds_read_b64_tr_b16 a[224:225], v30 offset:24576
ds_read_b64_tr_b16 a[226:227], v30 offset:25088
v_mfma_f32_16x16x32_bf16 a[0:3], a[236:239], a[164:167], a[0:3]
ds_read_b64_tr_b16 a[228:229], v30 offset:28672
ds_read_b64_tr_b16 a[230:231], v30 offset:29184
v_mfma_f32_16x16x32_bf16 a[16:19], a[236:239], a[172:175], a[16:19]
v_mfma_f32_16x16x32_bf16 a[16:19], a[232:235], a[168:171], a[16:19]
v_mfma_f32_16x16x32_bf16 a[32:35], a[232:235], a[176:179], a[32:35]
v_mfma_f32_16x16x32_bf16 a[32:35], a[236:239], a[180:183], a[32:35]
buffer_load_dwordx4 a[144:147], v42, s[28:31], s44 offen sc1
v_mfma_f32_16x16x32_bf16 a[48:51], a[236:239], a[188:191], a[48:51]
v_mfma_f32_16x16x32_bf16 a[48:51], a[232:235], a[184:187], a[48:51]
s_waitcnt lgkmcnt(4)
v_mfma_f32_16x16x32_bf16 a[52:55], a[240:243], a[184:187], a[52:55]
ds_read_b64_tr_b16 a[232:233], v31 offset:24576
ds_read_b64_tr_b16 a[234:235], v31 offset:25088
v_mfma_f32_16x16x32_bf16 a[52:55], a[244:247], a[188:191], a[52:55]
ds_read_b64_tr_b16 a[236:237], v31 offset:28672
ds_read_b64_tr_b16 a[238:239], v31 offset:29184
v_mfma_f32_16x16x32_bf16 a[36:39], a[244:247], a[180:183], a[36:39]
v_mfma_f32_16x16x32_bf16 a[36:39], a[240:243], a[176:179], a[36:39]
v_mfma_f32_16x16x32_bf16 a[20:23], a[240:243], a[168:171], a[20:23]
v_mfma_f32_16x16x32_bf16 a[20:23], a[244:247], a[172:175], a[20:23]
buffer_load_dwordx4 a[148:151], v42, s[28:31], s44 offen offset:1024 sc1
v_mfma_f32_16x16x32_bf16 a[4:7], a[244:247], a[164:167], a[4:7]
v_mfma_f32_16x16x32_bf16 a[4:7], a[240:243], a[160:163], a[4:7]
s_waitcnt vmcnt(17) lgkmcnt(4)
s_barrier
v_mfma_f32_16x16x32_bf16 a[8:11], a[224:227], a[160:163], a[8:11]
ds_read_b64_tr_b16 a[240:241], v24 offset:32768
ds_read_b64_tr_b16 a[242:243], v24 offset:33792
v_mfma_f32_16x16x32_bf16 a[8:11], a[228:231], a[164:167], a[8:11]
ds_read_b64_tr_b16 a[244:245], v24 offset:40960
ds_read_b64_tr_b16 a[246:247], v24 offset:41984
v_mfma_f32_16x16x32_bf16 a[24:27], a[228:231], a[172:175], a[24:27]
v_mfma_f32_16x16x32_bf16 a[24:27], a[224:227], a[168:171], a[24:27]
v_mfma_f32_16x16x32_bf16 a[40:43], a[224:227], a[176:179], a[40:43]
v_mfma_f32_16x16x32_bf16 a[40:43], a[228:231], a[180:183], a[40:43]
buffer_load_dwordx4 a[152:155], v43, s[28:31], s44 offen sc1
v_mfma_f32_16x16x32_bf16 a[56:59], a[228:231], a[188:191], a[56:59]
v_mfma_f32_16x16x32_bf16 a[56:59], a[224:227], a[184:187], a[56:59]
s_waitcnt lgkmcnt(4)
v_mfma_f32_16x16x32_bf16 a[60:63], a[232:235], a[184:187], a[60:63]
ds_read_b64_tr_b16 a[224:225], v24 offset:32776
ds_read_b64_tr_b16 a[226:227], v24 offset:33800
v_mfma_f32_16x16x32_bf16 a[60:63], a[236:239], a[188:191], a[60:63]
ds_read_b64_tr_b16 a[228:229], v24 offset:40968
ds_read_b64_tr_b16 a[230:231], v24 offset:41992
v_mfma_f32_16x16x32_bf16 a[44:47], a[236:239], a[180:183], a[44:47]
v_mfma_f32_16x16x32_bf16 a[44:47], a[232:235], a[176:179], a[44:47]
v_mfma_f32_16x16x32_bf16 a[28:31], a[232:235], a[168:171], a[28:31]
v_mfma_f32_16x16x32_bf16 a[28:31], a[236:239], a[172:175], a[28:31]
buffer_load_dwordx4 a[156:159], v43, s[28:31], s44 offen offset:1024 sc1
v_mfma_f32_16x16x32_bf16 a[12:15], a[236:239], a[164:167], a[12:15]
v_mfma_f32_16x16x32_bf16 a[12:15], a[232:235], a[160:163], a[12:15]
s_waitcnt lgkmcnt(4)
v_mfma_f32_16x16x32_bf16 v[128:131], a[240:243], a[192:195], v[128:131]
ds_read_b64_tr_b16 a[232:233], v25 offset:32768
ds_read_b64_tr_b16 a[234:235], v25 offset:33792
v_mfma_f32_16x16x32_bf16 v[128:131], a[244:247], a[196:199], v[128:131]
ds_read_b64_tr_b16 a[236:237], v25 offset:40960
ds_read_b64_tr_b16 a[238:239], v25 offset:41984
v_mfma_f32_16x16x32_bf16 v[144:147], a[244:247], a[204:207], v[144:147]
v_mfma_f32_16x16x32_bf16 v[144:147], a[240:243], a[200:203], v[144:147]
v_mfma_f32_16x16x32_bf16 v[160:163], a[240:243], a[208:211], v[160:163]
s_add_u32 m0, s40, 0
s_xor_b32 s43, s101, 2097152
v_mfma_f32_16x16x32_bf16 v[160:163], a[244:247], a[212:215], v[160:163]
buffer_load_dwordx4 v32, s[16:19], s43 offen lds
v_mfma_f32_16x16x32_bf16 v[176:179], a[244:247], a[220:223], v[176:179]
v_mfma_f32_16x16x32_bf16 v[176:179], a[240:243], a[216:219], v[176:179]
s_waitcnt lgkmcnt(4)
v_mfma_f32_16x16x32_bf16 v[240:243], a[224:227], a[216:219], v[240:243]
ds_read_b64_tr_b16 a[240:241], v25 offset:32776
ds_read_b64_tr_b16 a[242:243], v25 offset:33800
v_mfma_f32_16x16x32_bf16 v[240:243], a[228:231], a[220:223], v[240:243]
ds_read_b64_tr_b16 a[244:245], v25 offset:40968
ds_read_b64_tr_b16 a[246:247], v25 offset:41992
v_mfma_f32_16x16x32_bf16 v[224:227], a[228:231], a[212:215], v[224:227]
v_mfma_f32_16x16x32_bf16 v[224:227], a[224:227], a[208:211], v[224:227]
v_mfma_f32_16x16x32_bf16 v[208:211], a[224:227], a[200:203], v[208:211]
v_mfma_f32_16x16x32_bf16 v[208:211], a[228:231], a[204:207], v[208:211]
buffer_load_dwordx4 v33, s[16:19], s43 offen offset:1024 lds
v_mfma_f32_16x16x32_bf16 v[192:195], a[228:231], a[196:199], v[192:195]
v_mfma_f32_16x16x32_bf16 v[192:195], a[224:227], a[192:195], v[192:195]
s_waitcnt lgkmcnt(4)
v_mfma_f32_16x16x32_bf16 v[132:135], a[232:235], a[192:195], v[132:135]
ds_read_b64_tr_b16 a[224:225], v26 offset:32768
ds_read_b64_tr_b16 a[226:227], v26 offset:33792
v_mfma_f32_16x16x32_bf16 v[132:135], a[236:239], a[196:199], v[132:135]
ds_read_b64_tr_b16 a[228:229], v26 offset:40960
ds_read_b64_tr_b16 a[230:231], v26 offset:41984
v_mfma_f32_16x16x32_bf16 v[148:151], a[236:239], a[204:207], v[148:151]
v_mfma_f32_16x16x32_bf16 v[148:151], a[232:235], a[200:203], v[148:151]
v_mfma_f32_16x16x32_bf16 v[164:167], a[232:235], a[208:211], v[164:167]
v_mfma_f32_16x16x32_bf16 v[164:167], a[236:239], a[212:215], v[164:167]
buffer_load_dwordx4 v34, s[16:19], s43 offen offset:2048 lds
v_mfma_f32_16x16x32_bf16 v[180:183], a[236:239], a[220:223], v[180:183]
v_mfma_f32_16x16x32_bf16 v[180:183], a[232:235], a[216:219], v[180:183]
s_waitcnt lgkmcnt(4)
v_mfma_f32_16x16x32_bf16 v[244:247], a[240:243], a[216:219], v[244:247]
ds_read_b64_tr_b16 a[232:233], v26 offset:32776
ds_read_b64_tr_b16 a[234:235], v26 offset:33800
v_mfma_f32_16x16x32_bf16 v[244:247], a[244:247], a[220:223], v[244:247]
ds_read_b64_tr_b16 a[236:237], v26 offset:40968
ds_read_b64_tr_b16 a[238:239], v26 offset:41992
v_mfma_f32_16x16x32_bf16 v[228:231], a[244:247], a[212:215], v[228:231]
v_mfma_f32_16x16x32_bf16 v[228:231], a[240:243], a[208:211], v[228:231]
v_mfma_f32_16x16x32_bf16 v[212:215], a[240:243], a[200:203], v[212:215]
s_xor_b32 s86, s100, 4
v_mfma_f32_16x16x32_bf16 v[212:215], a[244:247], a[204:207], v[212:215]
buffer_load_dwordx4 v35, s[16:19], s43 offen offset:3072 lds
v_mfma_f32_16x16x32_bf16 v[196:199], a[244:247], a[196:199], v[196:199]
v_mfma_f32_16x16x32_bf16 v[196:199], a[240:243], a[192:195], v[196:199]
s_waitcnt lgkmcnt(4)
v_mfma_f32_16x16x32_bf16 v[136:139], a[224:227], a[192:195], v[136:139]
ds_read_b64_tr_b16 a[240:241], v27 offset:32768
ds_read_b64_tr_b16 a[242:243], v27 offset:33792
v_mfma_f32_16x16x32_bf16 v[136:139], a[228:231], a[196:199], v[136:139]
ds_read_b64_tr_b16 a[244:245], v27 offset:40960
ds_read_b64_tr_b16 a[246:247], v27 offset:41984
v_mfma_f32_16x16x32_bf16 v[152:155], a[228:231], a[204:207], v[152:155]
v_mfma_f32_16x16x32_bf16 v[152:155], a[224:227], a[200:203], v[152:155]
v_mfma_f32_16x16x32_bf16 v[168:171], a[224:227], a[208:211], v[168:171]
s_add_u32 m0, s41, 0
s_mul_i32 s43, s86, 229376
v_mfma_f32_16x16x32_bf16 v[168:171], a[228:231], a[212:215], v[168:171]
buffer_load_dwordx4 v36, s[20:23], s43 offen lds
v_mfma_f32_16x16x32_bf16 v[184:187], a[228:231], a[220:223], v[184:187]
v_mfma_f32_16x16x32_bf16 v[184:187], a[224:227], a[216:219], v[184:187]
s_waitcnt lgkmcnt(4)
v_mfma_f32_16x16x32_bf16 v[248:251], a[232:235], a[216:219], v[248:251]
ds_read_b64_tr_b16 a[224:225], v27 offset:32776
ds_read_b64_tr_b16 a[226:227], v27 offset:33800
v_mfma_f32_16x16x32_bf16 v[248:251], a[236:239], a[220:223], v[248:251]
ds_read_b64_tr_b16 a[228:229], v27 offset:40968
ds_read_b64_tr_b16 a[230:231], v27 offset:41992
v_mfma_f32_16x16x32_bf16 v[232:235], a[236:239], a[212:215], v[232:235]
v_mfma_f32_16x16x32_bf16 v[232:235], a[232:235], a[208:211], v[232:235]
v_mfma_f32_16x16x32_bf16 v[216:219], a[232:235], a[200:203], v[216:219]
v_mfma_f32_16x16x32_bf16 v[216:219], a[236:239], a[204:207], v[216:219]
buffer_load_dwordx4 v37, s[20:23], s43 offen offset:1024 lds
v_mfma_f32_16x16x32_bf16 v[200:203], a[236:239], a[196:199], v[200:203]
v_mfma_f32_16x16x32_bf16 v[200:203], a[232:235], a[192:195], v[200:203]
s_waitcnt lgkmcnt(4)
v_mfma_f32_16x16x32_bf16 v[140:143], a[240:243], a[192:195], v[140:143]
ds_read_b64_tr_b16 a[232:233], v28 offset:32768
ds_read_b64_tr_b16 a[234:235], v28 offset:33280
v_mfma_f32_16x16x32_bf16 v[140:143], a[244:247], a[196:199], v[140:143]
ds_read_b64_tr_b16 a[236:237], v28 offset:36864
ds_read_b64_tr_b16 a[238:239], v28 offset:37376
v_mfma_f32_16x16x32_bf16 v[156:159], a[244:247], a[204:207], v[156:159]
v_mfma_f32_16x16x32_bf16 v[156:159], a[240:243], a[200:203], v[156:159]
v_mfma_f32_16x16x32_bf16 v[172:175], a[240:243], a[208:211], v[172:175]
s_add_u32 m0, s41, 8192
v_mfma_f32_16x16x32_bf16 v[172:175], a[244:247], a[212:215], v[172:175]
buffer_load_dwordx4 v36, s[24:27], s43 offen lds
v_mfma_f32_16x16x32_bf16 v[188:191], a[244:247], a[220:223], v[188:191]
v_mfma_f32_16x16x32_bf16 v[188:191], a[240:243], a[216:219], v[188:191]
s_waitcnt lgkmcnt(4)
v_mfma_f32_16x16x32_bf16 v[252:255], a[224:227], a[216:219], v[252:255]
ds_read_b64_tr_b16 a[240:241], v29 offset:32768
ds_read_b64_tr_b16 a[242:243], v29 offset:33280
v_mfma_f32_16x16x32_bf16 v[252:255], a[228:231], a[220:223], v[252:255]
ds_read_b64_tr_b16 a[244:245], v29 offset:36864
ds_read_b64_tr_b16 a[246:247], v29 offset:37376
v_mfma_f32_16x16x32_bf16 v[236:239], a[228:231], a[212:215], v[236:239]
v_mfma_f32_16x16x32_bf16 v[236:239], a[224:227], a[208:211], v[236:239]
v_mfma_f32_16x16x32_bf16 v[220:223], a[224:227], a[200:203], v[220:223]
v_mfma_f32_16x16x32_bf16 v[220:223], a[228:231], a[204:207], v[220:223]
buffer_load_dwordx4 v37, s[24:27], s43 offen offset:1024 lds
v_mfma_f32_16x16x32_bf16 v[204:207], a[228:231], a[196:199], v[204:207]
v_mfma_f32_16x16x32_bf16 v[204:207], a[224:227], a[192:195], v[204:207]
s_waitcnt lgkmcnt(4)
v_mfma_f32_16x16x32_bf16 v[64:67], a[232:235], a[192:195], v[64:67]
ds_read_b64_tr_b16 a[224:225], v30 offset:32768
ds_read_b64_tr_b16 a[226:227], v30 offset:33280
v_mfma_f32_16x16x32_bf16 v[64:67], a[236:239], a[196:199], v[64:67]
ds_read_b64_tr_b16 a[228:229], v30 offset:36864
ds_read_b64_tr_b16 a[230:231], v30 offset:37376
v_mfma_f32_16x16x32_bf16 v[80:83], a[236:239], a[204:207], v[80:83]
v_mfma_f32_16x16x32_bf16 v[80:83], a[232:235], a[200:203], v[80:83]
v_mfma_f32_16x16x32_bf16 v[96:99], a[232:235], a[208:211], v[96:99]
s_xor_b32 s44, s79, 8192
v_mfma_f32_16x16x32_bf16 v[96:99], a[236:239], a[212:215], v[96:99]
buffer_load_dwordx4 a[160:163], v40, s[28:31], s44 offen sc1
v_mfma_f32_16x16x32_bf16 v[112:115], a[236:239], a[220:223], v[112:115]
v_mfma_f32_16x16x32_bf16 v[112:115], a[232:235], a[216:219], v[112:115]
s_waitcnt lgkmcnt(4)
v_mfma_f32_16x16x32_bf16 v[116:119], a[240:243], a[216:219], v[116:119]
ds_read_b64_tr_b16 a[232:233], v31 offset:32768
ds_read_b64_tr_b16 a[234:235], v31 offset:33280
v_mfma_f32_16x16x32_bf16 v[116:119], a[244:247], a[220:223], v[116:119]
ds_read_b64_tr_b16 a[236:237], v31 offset:36864
ds_read_b64_tr_b16 a[238:239], v31 offset:37376
v_mfma_f32_16x16x32_bf16 v[100:103], a[244:247], a[212:215], v[100:103]
v_mfma_f32_16x16x32_bf16 v[100:103], a[240:243], a[208:211], v[100:103]
v_mfma_f32_16x16x32_bf16 v[84:87], a[240:243], a[200:203], v[84:87]
v_mfma_f32_16x16x32_bf16 v[84:87], a[244:247], a[204:207], v[84:87]
buffer_load_dwordx4 a[164:167], v40, s[28:31], s44 offen offset:1024 sc1
v_mfma_f32_16x16x32_bf16 v[68:71], a[244:247], a[196:199], v[68:71]
v_mfma_f32_16x16x32_bf16 v[68:71], a[240:243], a[192:195], v[68:71]
s_waitcnt lgkmcnt(4)
v_mfma_f32_16x16x32_bf16 v[72:75], a[224:227], a[192:195], v[72:75]
ds_read_b64_tr_b16 a[240:241], v28 offset:40960
ds_read_b64_tr_b16 a[242:243], v28 offset:41472
v_mfma_f32_16x16x32_bf16 v[72:75], a[228:231], a[196:199], v[72:75]
ds_read_b64_tr_b16 a[244:245], v28 offset:45056
ds_read_b64_tr_b16 a[246:247], v28 offset:45568
v_mfma_f32_16x16x32_bf16 v[88:91], a[228:231], a[204:207], v[88:91]
v_mfma_f32_16x16x32_bf16 v[88:91], a[224:227], a[200:203], v[88:91]
v_mfma_f32_16x16x32_bf16 v[104:107], a[224:227], a[208:211], v[104:107]
v_mfma_f32_16x16x32_bf16 v[104:107], a[228:231], a[212:215], v[104:107]
buffer_load_dwordx4 a[168:171], v41, s[28:31], s44 offen sc1
v_mfma_f32_16x16x32_bf16 v[120:123], a[228:231], a[220:223], v[120:123]
v_mfma_f32_16x16x32_bf16 v[120:123], a[224:227], a[216:219], v[120:123]
s_waitcnt lgkmcnt(4)
v_mfma_f32_16x16x32_bf16 v[124:127], a[232:235], a[216:219], v[124:127]
ds_read_b64_tr_b16 a[224:225], v29 offset:40960
ds_read_b64_tr_b16 a[226:227], v29 offset:41472
v_mfma_f32_16x16x32_bf16 v[124:127], a[236:239], a[220:223], v[124:127]
ds_read_b64_tr_b16 a[228:229], v29 offset:45056
ds_read_b64_tr_b16 a[230:231], v29 offset:45568
v_mfma_f32_16x16x32_bf16 v[108:111], a[236:239], a[212:215], v[108:111]
v_mfma_f32_16x16x32_bf16 v[108:111], a[232:235], a[208:211], v[108:111]
v_mfma_f32_16x16x32_bf16 v[92:95], a[232:235], a[200:203], v[92:95]
v_mfma_f32_16x16x32_bf16 v[92:95], a[236:239], a[204:207], v[92:95]
buffer_load_dwordx4 a[172:175], v41, s[28:31], s44 offen offset:1024 sc1
v_mfma_f32_16x16x32_bf16 v[76:79], a[236:239], a[196:199], v[76:79]
v_mfma_f32_16x16x32_bf16 v[76:79], a[232:235], a[192:195], v[76:79]
s_waitcnt lgkmcnt(4)
v_mfma_f32_16x16x32_bf16 a[0:3], a[240:243], a[192:195], a[0:3]
ds_read_b64_tr_b16 a[232:233], v30 offset:40960
ds_read_b64_tr_b16 a[234:235], v30 offset:41472
v_mfma_f32_16x16x32_bf16 a[0:3], a[244:247], a[196:199], a[0:3]
ds_read_b64_tr_b16 a[236:237], v30 offset:45056
ds_read_b64_tr_b16 a[238:239], v30 offset:45568
v_mfma_f32_16x16x32_bf16 a[16:19], a[244:247], a[204:207], a[16:19]
v_mfma_f32_16x16x32_bf16 a[16:19], a[240:243], a[200:203], a[16:19]
v_mfma_f32_16x16x32_bf16 a[32:35], a[240:243], a[208:211], a[32:35]
v_mfma_f32_16x16x32_bf16 a[32:35], a[244:247], a[212:215], a[32:35]
buffer_load_dwordx4 a[176:179], v42, s[28:31], s44 offen sc1
v_mfma_f32_16x16x32_bf16 a[48:51], a[244:247], a[220:223], a[48:51]
v_mfma_f32_16x16x32_bf16 a[48:51], a[240:243], a[216:219], a[48:51]
s_waitcnt lgkmcnt(4)
v_mfma_f32_16x16x32_bf16 a[52:55], a[224:227], a[216:219], a[52:55]
ds_read_b64_tr_b16 a[240:241], v31 offset:40960
ds_read_b64_tr_b16 a[242:243], v31 offset:41472
v_mfma_f32_16x16x32_bf16 a[52:55], a[228:231], a[220:223], a[52:55]
ds_read_b64_tr_b16 a[244:245], v31 offset:45056
ds_read_b64_tr_b16 a[246:247], v31 offset:45568
v_mfma_f32_16x16x32_bf16 a[36:39], a[228:231], a[212:215], a[36:39]
v_mfma_f32_16x16x32_bf16 a[36:39], a[224:227], a[208:211], a[36:39]
v_mfma_f32_16x16x32_bf16 a[20:23], a[224:227], a[200:203], a[20:23]
v_mfma_f32_16x16x32_bf16 a[20:23], a[228:231], a[204:207], a[20:23]
buffer_load_dwordx4 a[180:183], v42, s[28:31], s44 offen offset:1024 sc1
v_mfma_f32_16x16x32_bf16 a[4:7], a[228:231], a[196:199], a[4:7]
v_mfma_f32_16x16x32_bf16 a[4:7], a[224:227], a[192:195], a[4:7]
s_waitcnt vmcnt(14) lgkmcnt(4)
s_barrier
v_mfma_f32_16x16x32_bf16 a[8:11], a[232:235], a[192:195], a[8:11]
ds_read_b64_tr_b16 a[224:225], v24 offset:49152
ds_read_b64_tr_b16 a[226:227], v24 offset:50176
v_mfma_f32_16x16x32_bf16 a[8:11], a[236:239], a[196:199], a[8:11]
ds_read_b64_tr_b16 a[228:229], v24 offset:57344
ds_read_b64_tr_b16 a[230:231], v24 offset:58368
v_mfma_f32_16x16x32_bf16 a[24:27], a[236:239], a[204:207], a[24:27]
v_mfma_f32_16x16x32_bf16 a[24:27], a[232:235], a[200:203], a[24:27]
v_mfma_f32_16x16x32_bf16 a[40:43], a[232:235], a[208:211], a[40:43]
v_mfma_f32_16x16x32_bf16 a[40:43], a[236:239], a[212:215], a[40:43]
buffer_load_dwordx4 a[184:187], v43, s[28:31], s44 offen sc1
v_mfma_f32_16x16x32_bf16 a[56:59], a[236:239], a[220:223], a[56:59]
v_mfma_f32_16x16x32_bf16 a[56:59], a[232:235], a[216:219], a[56:59]
s_waitcnt lgkmcnt(4)
v_mfma_f32_16x16x32_bf16 a[60:63], a[240:243], a[216:219], a[60:63]
ds_read_b64_tr_b16 a[232:233], v24 offset:49160
ds_read_b64_tr_b16 a[234:235], v24 offset:50184
v_mfma_f32_16x16x32_bf16 a[60:63], a[244:247], a[220:223], a[60:63]
ds_read_b64_tr_b16 a[236:237], v24 offset:57352
ds_read_b64_tr_b16 a[238:239], v24 offset:58376
v_mfma_f32_16x16x32_bf16 a[44:47], a[244:247], a[212:215], a[44:47]
v_mfma_f32_16x16x32_bf16 a[44:47], a[240:243], a[208:211], a[44:47]
v_mfma_f32_16x16x32_bf16 a[28:31], a[240:243], a[200:203], a[28:31]
v_mfma_f32_16x16x32_bf16 a[28:31], a[244:247], a[204:207], a[28:31]
buffer_load_dwordx4 a[188:191], v43, s[28:31], s44 offen offset:1024 sc1
v_mfma_f32_16x16x32_bf16 a[12:15], a[244:247], a[196:199], a[12:15]
v_mfma_f32_16x16x32_bf16 a[12:15], a[240:243], a[192:195], a[12:15]
s_waitcnt lgkmcnt(4)
v_mfma_f32_16x16x32_bf16 v[128:131], a[224:227], a[128:131], v[128:131]
ds_read_b64_tr_b16 a[240:241], v25 offset:49152
ds_read_b64_tr_b16 a[242:243], v25 offset:50176
v_mfma_f32_16x16x32_bf16 v[128:131], a[228:231], a[132:135], v[128:131]
ds_read_b64_tr_b16 a[244:245], v25 offset:57344
ds_read_b64_tr_b16 a[246:247], v25 offset:58368
v_mfma_f32_16x16x32_bf16 v[144:147], a[228:231], a[140:143], v[144:147]
v_mfma_f32_16x16x32_bf16 v[144:147], a[224:227], a[136:139], v[144:147]
v_mfma_f32_16x16x32_bf16 v[160:163], a[224:227], a[144:147], v[160:163]
s_add_u32 m0, s40, 16384
s_xor_b32 s43, s101, 2621440
v_mfma_f32_16x16x32_bf16 v[160:163], a[228:231], a[148:151], v[160:163]
buffer_load_dwordx4 v32, s[16:19], s43 offen lds
v_mfma_f32_16x16x32_bf16 v[176:179], a[228:231], a[156:159], v[176:179]
v_mfma_f32_16x16x32_bf16 v[176:179], a[224:227], a[152:155], v[176:179]
s_waitcnt lgkmcnt(4)
v_mfma_f32_16x16x32_bf16 v[240:243], a[232:235], a[152:155], v[240:243]
ds_read_b64_tr_b16 a[224:225], v25 offset:49160
ds_read_b64_tr_b16 a[226:227], v25 offset:50184
v_mfma_f32_16x16x32_bf16 v[240:243], a[236:239], a[156:159], v[240:243]
ds_read_b64_tr_b16 a[228:229], v25 offset:57352
ds_read_b64_tr_b16 a[230:231], v25 offset:58376
v_mfma_f32_16x16x32_bf16 v[224:227], a[236:239], a[148:151], v[224:227]
v_mfma_f32_16x16x32_bf16 v[224:227], a[232:235], a[144:147], v[224:227]
v_mfma_f32_16x16x32_bf16 v[208:211], a[232:235], a[136:139], v[208:211]
v_mfma_f32_16x16x32_bf16 v[208:211], a[236:239], a[140:143], v[208:211]
buffer_load_dwordx4 v33, s[16:19], s43 offen offset:1024 lds
v_mfma_f32_16x16x32_bf16 v[192:195], a[236:239], a[132:135], v[192:195]
v_mfma_f32_16x16x32_bf16 v[192:195], a[232:235], a[128:131], v[192:195]
s_waitcnt lgkmcnt(4)
v_mfma_f32_16x16x32_bf16 v[132:135], a[240:243], a[128:131], v[132:135]
ds_read_b64_tr_b16 a[232:233], v26 offset:49152
ds_read_b64_tr_b16 a[234:235], v26 offset:50176
v_mfma_f32_16x16x32_bf16 v[132:135], a[244:247], a[132:135], v[132:135]
ds_read_b64_tr_b16 a[236:237], v26 offset:57344
ds_read_b64_tr_b16 a[238:239], v26 offset:58368
v_mfma_f32_16x16x32_bf16 v[148:151], a[244:247], a[140:143], v[148:151]
v_mfma_f32_16x16x32_bf16 v[148:151], a[240:243], a[136:139], v[148:151]
v_mfma_f32_16x16x32_bf16 v[164:167], a[240:243], a[144:147], v[164:167]
v_mfma_f32_16x16x32_bf16 v[164:167], a[244:247], a[148:151], v[164:167]
buffer_load_dwordx4 v34, s[16:19], s43 offen offset:2048 lds
v_mfma_f32_16x16x32_bf16 v[180:183], a[244:247], a[156:159], v[180:183]
v_mfma_f32_16x16x32_bf16 v[180:183], a[240:243], a[152:155], v[180:183]
s_waitcnt lgkmcnt(4)
v_mfma_f32_16x16x32_bf16 v[244:247], a[224:227], a[152:155], v[244:247]
ds_read_b64_tr_b16 a[240:241], v26 offset:49160
ds_read_b64_tr_b16 a[242:243], v26 offset:50184
v_mfma_f32_16x16x32_bf16 v[244:247], a[228:231], a[156:159], v[244:247]
ds_read_b64_tr_b16 a[244:245], v26 offset:57352
ds_read_b64_tr_b16 a[246:247], v26 offset:58376
v_mfma_f32_16x16x32_bf16 v[228:231], a[228:231], a[148:151], v[228:231]
v_mfma_f32_16x16x32_bf16 v[228:231], a[224:227], a[144:147], v[228:231]
v_mfma_f32_16x16x32_bf16 v[212:215], a[224:227], a[136:139], v[212:215]
s_xor_b32 s86, s100, 5
v_mfma_f32_16x16x32_bf16 v[212:215], a[228:231], a[140:143], v[212:215]
buffer_load_dwordx4 v35, s[16:19], s43 offen offset:3072 lds
v_mfma_f32_16x16x32_bf16 v[196:199], a[228:231], a[132:135], v[196:199]
v_mfma_f32_16x16x32_bf16 v[196:199], a[224:227], a[128:131], v[196:199]
s_waitcnt lgkmcnt(4)
v_mfma_f32_16x16x32_bf16 v[136:139], a[232:235], a[128:131], v[136:139]
ds_read_b64_tr_b16 a[224:225], v27 offset:49152
ds_read_b64_tr_b16 a[226:227], v27 offset:50176
v_mfma_f32_16x16x32_bf16 v[136:139], a[236:239], a[132:135], v[136:139]
ds_read_b64_tr_b16 a[228:229], v27 offset:57344
ds_read_b64_tr_b16 a[230:231], v27 offset:58368
v_mfma_f32_16x16x32_bf16 v[152:155], a[236:239], a[140:143], v[152:155]
v_mfma_f32_16x16x32_bf16 v[152:155], a[232:235], a[136:139], v[152:155]
v_mfma_f32_16x16x32_bf16 v[168:171], a[232:235], a[144:147], v[168:171]
s_add_u32 m0, s41, 16384
s_mul_i32 s43, s86, 229376
v_mfma_f32_16x16x32_bf16 v[168:171], a[236:239], a[148:151], v[168:171]
buffer_load_dwordx4 v36, s[20:23], s43 offen lds
v_mfma_f32_16x16x32_bf16 v[184:187], a[236:239], a[156:159], v[184:187]
v_mfma_f32_16x16x32_bf16 v[184:187], a[232:235], a[152:155], v[184:187]
s_waitcnt lgkmcnt(4)
v_mfma_f32_16x16x32_bf16 v[248:251], a[240:243], a[152:155], v[248:251]
ds_read_b64_tr_b16 a[232:233], v27 offset:49160
ds_read_b64_tr_b16 a[234:235], v27 offset:50184
v_mfma_f32_16x16x32_bf16 v[248:251], a[244:247], a[156:159], v[248:251]
ds_read_b64_tr_b16 a[236:237], v27 offset:57352
ds_read_b64_tr_b16 a[238:239], v27 offset:58376
v_mfma_f32_16x16x32_bf16 v[232:235], a[244:247], a[148:151], v[232:235]
v_mfma_f32_16x16x32_bf16 v[232:235], a[240:243], a[144:147], v[232:235]
v_mfma_f32_16x16x32_bf16 v[216:219], a[240:243], a[136:139], v[216:219]
v_mfma_f32_16x16x32_bf16 v[216:219], a[244:247], a[140:143], v[216:219]
buffer_load_dwordx4 v37, s[20:23], s43 offen offset:1024 lds
v_mfma_f32_16x16x32_bf16 v[200:203], a[244:247], a[132:135], v[200:203]
v_mfma_f32_16x16x32_bf16 v[200:203], a[240:243], a[128:131], v[200:203]
s_waitcnt lgkmcnt(4)
v_mfma_f32_16x16x32_bf16 v[140:143], a[224:227], a[128:131], v[140:143]
ds_read_b64_tr_b16 a[240:241], v28 offset:49152
ds_read_b64_tr_b16 a[242:243], v28 offset:49664
v_mfma_f32_16x16x32_bf16 v[140:143], a[228:231], a[132:135], v[140:143]
ds_read_b64_tr_b16 a[244:245], v28 offset:53248
ds_read_b64_tr_b16 a[246:247], v28 offset:53760
v_mfma_f32_16x16x32_bf16 v[156:159], a[228:231], a[140:143], v[156:159]
v_mfma_f32_16x16x32_bf16 v[156:159], a[224:227], a[136:139], v[156:159]
v_mfma_f32_16x16x32_bf16 v[172:175], a[224:227], a[144:147], v[172:175]
s_add_u32 m0, s41, 24576
v_mfma_f32_16x16x32_bf16 v[172:175], a[228:231], a[148:151], v[172:175]
buffer_load_dwordx4 v36, s[24:27], s43 offen lds
v_mfma_f32_16x16x32_bf16 v[188:191], a[228:231], a[156:159], v[188:191]
v_mfma_f32_16x16x32_bf16 v[188:191], a[224:227], a[152:155], v[188:191]
s_waitcnt lgkmcnt(4)
v_mfma_f32_16x16x32_bf16 v[252:255], a[232:235], a[152:155], v[252:255]
ds_read_b64_tr_b16 a[224:225], v29 offset:49152
ds_read_b64_tr_b16 a[226:227], v29 offset:49664
v_mfma_f32_16x16x32_bf16 v[252:255], a[236:239], a[156:159], v[252:255]
ds_read_b64_tr_b16 a[228:229], v29 offset:53248
ds_read_b64_tr_b16 a[230:231], v29 offset:53760
v_mfma_f32_16x16x32_bf16 v[236:239], a[236:239], a[148:151], v[236:239]
v_mfma_f32_16x16x32_bf16 v[236:239], a[232:235], a[144:147], v[236:239]
v_mfma_f32_16x16x32_bf16 v[220:223], a[232:235], a[136:139], v[220:223]
v_mfma_f32_16x16x32_bf16 v[220:223], a[236:239], a[140:143], v[220:223]
buffer_load_dwordx4 v37, s[24:27], s43 offen offset:1024 lds
v_mfma_f32_16x16x32_bf16 v[204:207], a[236:239], a[132:135], v[204:207]
v_mfma_f32_16x16x32_bf16 v[204:207], a[232:235], a[128:131], v[204:207]
s_waitcnt lgkmcnt(4)
v_mfma_f32_16x16x32_bf16 v[64:67], a[240:243], a[128:131], v[64:67]
ds_read_b64_tr_b16 a[232:233], v30 offset:49152
ds_read_b64_tr_b16 a[234:235], v30 offset:49664
v_mfma_f32_16x16x32_bf16 v[64:67], a[244:247], a[132:135], v[64:67]
ds_read_b64_tr_b16 a[236:237], v30 offset:53248
ds_read_b64_tr_b16 a[238:239], v30 offset:53760
v_mfma_f32_16x16x32_bf16 v[80:83], a[244:247], a[140:143], v[80:83]
v_mfma_f32_16x16x32_bf16 v[80:83], a[240:243], a[136:139], v[80:83]
v_mfma_f32_16x16x32_bf16 v[96:99], a[240:243], a[144:147], v[96:99]
s_xor_b32 s44, s79, 10240
v_mfma_f32_16x16x32_bf16 v[96:99], a[244:247], a[148:151], v[96:99]
buffer_load_dwordx4 a[192:195], v40, s[28:31], s44 offen sc1
v_mfma_f32_16x16x32_bf16 v[112:115], a[244:247], a[156:159], v[112:115]
v_mfma_f32_16x16x32_bf16 v[112:115], a[240:243], a[152:155], v[112:115]
s_waitcnt lgkmcnt(4)
v_mfma_f32_16x16x32_bf16 v[116:119], a[224:227], a[152:155], v[116:119]
ds_read_b64_tr_b16 a[240:241], v31 offset:49152
ds_read_b64_tr_b16 a[242:243], v31 offset:49664
v_mfma_f32_16x16x32_bf16 v[116:119], a[228:231], a[156:159], v[116:119]
ds_read_b64_tr_b16 a[244:245], v31 offset:53248
ds_read_b64_tr_b16 a[246:247], v31 offset:53760
v_mfma_f32_16x16x32_bf16 v[100:103], a[228:231], a[148:151], v[100:103]
v_mfma_f32_16x16x32_bf16 v[100:103], a[224:227], a[144:147], v[100:103]
v_mfma_f32_16x16x32_bf16 v[84:87], a[224:227], a[136:139], v[84:87]
v_mfma_f32_16x16x32_bf16 v[84:87], a[228:231], a[140:143], v[84:87]
buffer_load_dwordx4 a[196:199], v40, s[28:31], s44 offen offset:1024 sc1
v_mfma_f32_16x16x32_bf16 v[68:71], a[228:231], a[132:135], v[68:71]
v_mfma_f32_16x16x32_bf16 v[68:71], a[224:227], a[128:131], v[68:71]
s_waitcnt lgkmcnt(4)
v_mfma_f32_16x16x32_bf16 v[72:75], a[232:235], a[128:131], v[72:75]
ds_read_b64_tr_b16 a[224:225], v28 offset:57344
ds_read_b64_tr_b16 a[226:227], v28 offset:57856
v_mfma_f32_16x16x32_bf16 v[72:75], a[236:239], a[132:135], v[72:75]
ds_read_b64_tr_b16 a[228:229], v28 offset:61440
ds_read_b64_tr_b16 a[230:231], v28 offset:61952
v_mfma_f32_16x16x32_bf16 v[88:91], a[236:239], a[140:143], v[88:91]
v_mfma_f32_16x16x32_bf16 v[88:91], a[232:235], a[136:139], v[88:91]
v_mfma_f32_16x16x32_bf16 v[104:107], a[232:235], a[144:147], v[104:107]
v_mfma_f32_16x16x32_bf16 v[104:107], a[236:239], a[148:151], v[104:107]
buffer_load_dwordx4 a[200:203], v41, s[28:31], s44 offen sc1
v_mfma_f32_16x16x32_bf16 v[120:123], a[236:239], a[156:159], v[120:123]
v_mfma_f32_16x16x32_bf16 v[120:123], a[232:235], a[152:155], v[120:123]
s_waitcnt lgkmcnt(4)
v_mfma_f32_16x16x32_bf16 v[124:127], a[240:243], a[152:155], v[124:127]
ds_read_b64_tr_b16 a[232:233], v29 offset:57344
ds_read_b64_tr_b16 a[234:235], v29 offset:57856
v_mfma_f32_16x16x32_bf16 v[124:127], a[244:247], a[156:159], v[124:127]
ds_read_b64_tr_b16 a[236:237], v29 offset:61440
ds_read_b64_tr_b16 a[238:239], v29 offset:61952
v_mfma_f32_16x16x32_bf16 v[108:111], a[244:247], a[148:151], v[108:111]
v_mfma_f32_16x16x32_bf16 v[108:111], a[240:243], a[144:147], v[108:111]
v_mfma_f32_16x16x32_bf16 v[92:95], a[240:243], a[136:139], v[92:95]
v_mfma_f32_16x16x32_bf16 v[92:95], a[244:247], a[140:143], v[92:95]
buffer_load_dwordx4 a[204:207], v41, s[28:31], s44 offen offset:1024 sc1
v_mfma_f32_16x16x32_bf16 v[76:79], a[244:247], a[132:135], v[76:79]
v_mfma_f32_16x16x32_bf16 v[76:79], a[240:243], a[128:131], v[76:79]
s_waitcnt lgkmcnt(4)
v_mfma_f32_16x16x32_bf16 a[0:3], a[224:227], a[128:131], a[0:3]
L_pad17:
s_cbranch_execz L_pad18
ds_read_b64_tr_b16 a[240:241], v30 offset:57344
ds_read_b64_tr_b16 a[242:243], v30 offset:57856
v_mfma_f32_16x16x32_bf16 a[0:3], a[228:231], a[132:135], a[0:3]
ds_read_b64_tr_b16 a[244:245], v30 offset:61440
ds_read_b64_tr_b16 a[246:247], v30 offset:61952
v_mfma_f32_16x16x32_bf16 a[16:19], a[228:231], a[140:143], a[16:19]
v_mfma_f32_16x16x32_bf16 a[16:19], a[224:227], a[136:139], a[16:19]
v_mfma_f32_16x16x32_bf16 a[32:35], a[224:227], a[144:147], a[32:35]
v_mfma_f32_16x16x32_bf16 a[32:35], a[228:231], a[148:151], a[32:35]
buffer_load_dwordx4 a[208:211], v42, s[28:31], s44 offen sc1
v_mfma_f32_16x16x32_bf16 a[48:51], a[228:231], a[156:159], a[48:51]
v_mfma_f32_16x16x32_bf16 a[48:51], a[224:227], a[152:155], a[48:51]
s_waitcnt lgkmcnt(4)
v_mfma_f32_16x16x32_bf16 a[52:55], a[232:235], a[152:155], a[52:55]
ds_read_b64_tr_b16 a[224:225], v31 offset:57344
ds_read_b64_tr_b16 a[226:227], v31 offset:57856
v_mfma_f32_16x16x32_bf16 a[52:55], a[236:239], a[156:159], a[52:55]
ds_read_b64_tr_b16 a[228:229], v31 offset:61440
ds_read_b64_tr_b16 a[230:231], v31 offset:61952
v_mfma_f32_16x16x32_bf16 a[36:39], a[236:239], a[148:151], a[36:39]
v_mfma_f32_16x16x32_bf16 a[36:39], a[232:235], a[144:147], a[36:39]
v_mfma_f32_16x16x32_bf16 a[20:23], a[232:235], a[136:139], a[20:23]
v_mfma_f32_16x16x32_bf16 a[20:23], a[236:239], a[140:143], a[20:23]
buffer_load_dwordx4 a[212:215], v42, s[28:31], s44 offen offset:1024 sc1
v_mfma_f32_16x16x32_bf16 a[4:7], a[236:239], a[132:135], a[4:7]
v_mfma_f32_16x16x32_bf16 a[4:7], a[232:235], a[128:131], a[4:7]
s_waitcnt vmcnt(14) lgkmcnt(4)
s_barrier
v_mfma_f32_16x16x32_bf16 a[8:11], a[240:243], a[128:131], a[8:11]
ds_read_b64_tr_b16 a[232:233], v24 offset:0
ds_read_b64_tr_b16 a[234:235], v24 offset:1024
v_mfma_f32_16x16x32_bf16 a[8:11], a[244:247], a[132:135], a[8:11]
ds_read_b64_tr_b16 a[236:237], v24 offset:8192
ds_read_b64_tr_b16 a[238:239], v24 offset:9216
v_mfma_f32_16x16x32_bf16 a[24:27], a[244:247], a[140:143], a[24:27]
v_mfma_f32_16x16x32_bf16 a[24:27], a[240:243], a[136:139], a[24:27]
v_mfma_f32_16x16x32_bf16 a[40:43], a[240:243], a[144:147], a[40:43]
v_mfma_f32_16x16x32_bf16 a[40:43], a[244:247], a[148:151], a[40:43]
buffer_load_dwordx4 a[216:219], v43, s[28:31], s44 offen sc1
v_mfma_f32_16x16x32_bf16 a[56:59], a[244:247], a[156:159], a[56:59]
v_mfma_f32_16x16x32_bf16 a[56:59], a[240:243], a[152:155], a[56:59]
s_waitcnt lgkmcnt(4)
v_mfma_f32_16x16x32_bf16 a[60:63], a[224:227], a[152:155], a[60:63]
ds_read_b64_tr_b16 a[240:241], v24 offset:8
ds_read_b64_tr_b16 a[242:243], v24 offset:1032
v_mfma_f32_16x16x32_bf16 a[60:63], a[228:231], a[156:159], a[60:63]
ds_read_b64_tr_b16 a[244:245], v24 offset:8200
ds_read_b64_tr_b16 a[246:247], v24 offset:9224
v_mfma_f32_16x16x32_bf16 a[44:47], a[228:231], a[148:151], a[44:47]
v_mfma_f32_16x16x32_bf16 a[44:47], a[224:227], a[144:147], a[44:47]
v_mfma_f32_16x16x32_bf16 a[28:31], a[224:227], a[136:139], a[28:31]
v_mfma_f32_16x16x32_bf16 a[28:31], a[228:231], a[140:143], a[28:31]
buffer_load_dwordx4 a[220:223], v43, s[28:31], s44 offen offset:1024 sc1
v_mfma_f32_16x16x32_bf16 a[12:15], a[228:231], a[132:135], a[12:15]
v_mfma_f32_16x16x32_bf16 a[12:15], a[224:227], a[128:131], a[12:15]
s_waitcnt lgkmcnt(4)
v_mfma_f32_16x16x32_bf16 v[128:131], a[232:235], a[160:163], v[128:131]
ds_read_b64_tr_b16 a[224:225], v25 offset:0
ds_read_b64_tr_b16 a[226:227], v25 offset:1024
v_mfma_f32_16x16x32_bf16 v[128:131], a[236:239], a[164:167], v[128:131]
ds_read_b64_tr_b16 a[228:229], v25 offset:8192
ds_read_b64_tr_b16 a[230:231], v25 offset:9216
v_mfma_f32_16x16x32_bf16 v[144:147], a[236:239], a[172:175], v[144:147]
v_mfma_f32_16x16x32_bf16 v[144:147], a[232:235], a[168:171], v[144:147]
v_mfma_f32_16x16x32_bf16 v[160:163], a[232:235], a[176:179], v[160:163]
s_add_u32 m0, s40, 32768
s_xor_b32 s43, s101, 3145728
v_mfma_f32_16x16x32_bf16 v[160:163], a[236:239], a[180:183], v[160:163]
buffer_load_dwordx4 v32, s[16:19], s43 offen lds
v_mfma_f32_16x16x32_bf16 v[176:179], a[236:239], a[188:191], v[176:179]
v_mfma_f32_16x16x32_bf16 v[176:179], a[232:235], a[184:187], v[176:179]
s_waitcnt lgkmcnt(4)
v_mfma_f32_16x16x32_bf16 v[240:243], a[240:243], a[184:187], v[240:243]
ds_read_b64_tr_b16 a[232:233], v25 offset:8
ds_read_b64_tr_b16 a[234:235], v25 offset:1032
v_mfma_f32_16x16x32_bf16 v[240:243], a[244:247], a[188:191], v[240:243]
ds_read_b64_tr_b16 a[236:237], v25 offset:8200
ds_read_b64_tr_b16 a[238:239], v25 offset:9224
v_mfma_f32_16x16x32_bf16 v[224:227], a[244:247], a[180:183], v[224:227]
v_mfma_f32_16x16x32_bf16 v[224:227], a[240:243], a[176:179], v[224:227]
v_mfma_f32_16x16x32_bf16 v[208:211], a[240:243], a[168:171], v[208:211]
v_mfma_f32_16x16x32_bf16 v[208:211], a[244:247], a[172:175], v[208:211]
buffer_load_dwordx4 v33, s[16:19], s43 offen offset:1024 lds
v_mfma_f32_16x16x32_bf16 v[192:195], a[244:247], a[164:167], v[192:195]
v_mfma_f32_16x16x32_bf16 v[192:195], a[240:243], a[160:163], v[192:195]
s_waitcnt lgkmcnt(4)
v_mfma_f32_16x16x32_bf16 v[132:135], a[224:227], a[160:163], v[132:135]
ds_read_b64_tr_b16 a[240:241], v26 offset:0
ds_read_b64_tr_b16 a[242:243], v26 offset:1024
v_mfma_f32_16x16x32_bf16 v[132:135], a[228:231], a[164:167], v[132:135]
ds_read_b64_tr_b16 a[244:245], v26 offset:8192
ds_read_b64_tr_b16 a[246:247], v26 offset:9216
v_mfma_f32_16x16x32_bf16 v[148:151], a[228:231], a[172:175], v[148:151]
v_mfma_f32_16x16x32_bf16 v[148:151], a[224:227], a[168:171], v[148:151]
v_mfma_f32_16x16x32_bf16 v[164:167], a[224:227], a[176:179], v[164:167]
v_mfma_f32_16x16x32_bf16 v[164:167], a[228:231], a[180:183], v[164:167]
buffer_load_dwordx4 v34, s[16:19], s43 offen offset:2048 lds
v_mfma_f32_16x16x32_bf16 v[180:183], a[228:231], a[188:191], v[180:183]
v_mfma_f32_16x16x32_bf16 v[180:183], a[224:227], a[184:187], v[180:183]
s_waitcnt lgkmcnt(4)
v_mfma_f32_16x16x32_bf16 v[244:247], a[232:235], a[184:187], v[244:247]
ds_read_b64_tr_b16 a[224:225], v26 offset:8
ds_read_b64_tr_b16 a[226:227], v26 offset:1032
v_mfma_f32_16x16x32_bf16 v[244:247], a[236:239], a[188:191], v[244:247]
ds_read_b64_tr_b16 a[228:229], v26 offset:8200
ds_read_b64_tr_b16 a[230:231], v26 offset:9224
v_mfma_f32_16x16x32_bf16 v[228:231], a[236:239], a[180:183], v[228:231]
v_mfma_f32_16x16x32_bf16 v[228:231], a[232:235], a[176:179], v[228:231]
v_mfma_f32_16x16x32_bf16 v[212:215], a[232:235], a[168:171], v[212:215]
s_xor_b32 s86, s100, 6
v_mfma_f32_16x16x32_bf16 v[212:215], a[236:239], a[172:175], v[212:215]
buffer_load_dwordx4 v35, s[16:19], s43 offen offset:3072 lds
v_mfma_f32_16x16x32_bf16 v[196:199], a[236:239], a[164:167], v[196:199]
v_mfma_f32_16x16x32_bf16 v[196:199], a[232:235], a[160:163], v[196:199]
s_waitcnt lgkmcnt(4)
v_mfma_f32_16x16x32_bf16 v[136:139], a[240:243], a[160:163], v[136:139]
ds_read_b64_tr_b16 a[232:233], v27 offset:0
ds_read_b64_tr_b16 a[234:235], v27 offset:1024
v_mfma_f32_16x16x32_bf16 v[136:139], a[244:247], a[164:167], v[136:139]
ds_read_b64_tr_b16 a[236:237], v27 offset:8192
ds_read_b64_tr_b16 a[238:239], v27 offset:9216
v_mfma_f32_16x16x32_bf16 v[152:155], a[244:247], a[172:175], v[152:155]
v_mfma_f32_16x16x32_bf16 v[152:155], a[240:243], a[168:171], v[152:155]
v_mfma_f32_16x16x32_bf16 v[168:171], a[240:243], a[176:179], v[168:171]
s_add_u32 m0, s41, 32768
s_mul_i32 s43, s86, 229376
v_mfma_f32_16x16x32_bf16 v[168:171], a[244:247], a[180:183], v[168:171]
buffer_load_dwordx4 v36, s[20:23], s43 offen lds
v_mfma_f32_16x16x32_bf16 v[184:187], a[244:247], a[188:191], v[184:187]
v_mfma_f32_16x16x32_bf16 v[184:187], a[240:243], a[184:187], v[184:187]
s_waitcnt lgkmcnt(4)
v_mfma_f32_16x16x32_bf16 v[248:251], a[224:227], a[184:187], v[248:251]
ds_read_b64_tr_b16 a[240:241], v27 offset:8
ds_read_b64_tr_b16 a[242:243], v27 offset:1032
v_mfma_f32_16x16x32_bf16 v[248:251], a[228:231], a[188:191], v[248:251]
ds_read_b64_tr_b16 a[244:245], v27 offset:8200
ds_read_b64_tr_b16 a[246:247], v27 offset:9224
v_mfma_f32_16x16x32_bf16 v[232:235], a[228:231], a[180:183], v[232:235]
v_mfma_f32_16x16x32_bf16 v[232:235], a[224:227], a[176:179], v[232:235]
v_mfma_f32_16x16x32_bf16 v[216:219], a[224:227], a[168:171], v[216:219]
v_mfma_f32_16x16x32_bf16 v[216:219], a[228:231], a[172:175], v[216:219]
buffer_load_dwordx4 v37, s[20:23], s43 offen offset:1024 lds
v_mfma_f32_16x16x32_bf16 v[200:203], a[228:231], a[164:167], v[200:203]
v_mfma_f32_16x16x32_bf16 v[200:203], a[224:227], a[160:163], v[200:203]
s_waitcnt lgkmcnt(4)
v_mfma_f32_16x16x32_bf16 v[140:143], a[232:235], a[160:163], v[140:143]
ds_read_b64_tr_b16 a[224:225], v28 offset:0
ds_read_b64_tr_b16 a[226:227], v28 offset:512
v_mfma_f32_16x16x32_bf16 v[140:143], a[236:239], a[164:167], v[140:143]
ds_read_b64_tr_b16 a[228:229], v28 offset:4096
ds_read_b64_tr_b16 a[230:231], v28 offset:4608
v_mfma_f32_16x16x32_bf16 v[156:159], a[236:239], a[172:175], v[156:159]
v_mfma_f32_16x16x32_bf16 v[156:159], a[232:235], a[168:171], v[156:159]
v_mfma_f32_16x16x32_bf16 v[172:175], a[232:235], a[176:179], v[172:175]
s_add_u32 m0, s41, 40960
v_mfma_f32_16x16x32_bf16 v[172:175], a[236:239], a[180:183], v[172:175]
buffer_load_dwordx4 v36, s[24:27], s43 offen lds
v_mfma_f32_16x16x32_bf16 v[188:191], a[236:239], a[188:191], v[188:191]
v_mfma_f32_16x16x32_bf16 v[188:191], a[232:235], a[184:187], v[188:191]
s_waitcnt lgkmcnt(4)
v_mfma_f32_16x16x32_bf16 v[252:255], a[240:243], a[184:187], v[252:255]
ds_read_b64_tr_b16 a[232:233], v29 offset:0
ds_read_b64_tr_b16 a[234:235], v29 offset:512
v_mfma_f32_16x16x32_bf16 v[252:255], a[244:247], a[188:191], v[252:255]
ds_read_b64_tr_b16 a[236:237], v29 offset:4096
ds_read_b64_tr_b16 a[238:239], v29 offset:4608
v_mfma_f32_16x16x32_bf16 v[236:239], a[244:247], a[180:183], v[236:239]
v_mfma_f32_16x16x32_bf16 v[236:239], a[240:243], a[176:179], v[236:239]
v_mfma_f32_16x16x32_bf16 v[220:223], a[240:243], a[168:171], v[220:223]
v_mfma_f32_16x16x32_bf16 v[220:223], a[244:247], a[172:175], v[220:223]
buffer_load_dwordx4 v37, s[24:27], s43 offen offset:1024 lds
v_mfma_f32_16x16x32_bf16 v[204:207], a[244:247], a[164:167], v[204:207]
v_mfma_f32_16x16x32_bf16 v[204:207], a[240:243], a[160:163], v[204:207]
s_waitcnt lgkmcnt(4)
v_mfma_f32_16x16x32_bf16 v[64:67], a[224:227], a[160:163], v[64:67]
ds_read_b64_tr_b16 a[240:241], v30 offset:0
ds_read_b64_tr_b16 a[242:243], v30 offset:512
v_mfma_f32_16x16x32_bf16 v[64:67], a[228:231], a[164:167], v[64:67]
ds_read_b64_tr_b16 a[244:245], v30 offset:4096
ds_read_b64_tr_b16 a[246:247], v30 offset:4608
v_mfma_f32_16x16x32_bf16 v[80:83], a[228:231], a[172:175], v[80:83]
v_mfma_f32_16x16x32_bf16 v[80:83], a[224:227], a[168:171], v[80:83]
v_mfma_f32_16x16x32_bf16 v[96:99], a[224:227], a[176:179], v[96:99]
s_xor_b32 s44, s79, 12288
v_mfma_f32_16x16x32_bf16 v[96:99], a[228:231], a[180:183], v[96:99]
buffer_load_dwordx4 a[128:131], v40, s[28:31], s44 offen sc1
v_mfma_f32_16x16x32_bf16 v[112:115], a[228:231], a[188:191], v[112:115]
v_mfma_f32_16x16x32_bf16 v[112:115], a[224:227], a[184:187], v[112:115]
s_waitcnt lgkmcnt(4)
v_mfma_f32_16x16x32_bf16 v[116:119], a[232:235], a[184:187], v[116:119]
ds_read_b64_tr_b16 a[224:225], v31 offset:0
ds_read_b64_tr_b16 a[226:227], v31 offset:512
v_mfma_f32_16x16x32_bf16 v[116:119], a[236:239], a[188:191], v[116:119]
ds_read_b64_tr_b16 a[228:229], v31 offset:4096
ds_read_b64_tr_b16 a[230:231], v31 offset:4608
v_mfma_f32_16x16x32_bf16 v[100:103], a[236:239], a[180:183], v[100:103]
v_mfma_f32_16x16x32_bf16 v[100:103], a[232:235], a[176:179], v[100:103]
v_mfma_f32_16x16x32_bf16 v[84:87], a[232:235], a[168:171], v[84:87]
v_mfma_f32_16x16x32_bf16 v[84:87], a[236:239], a[172:175], v[84:87]
buffer_load_dwordx4 a[132:135], v40, s[28:31], s44 offen offset:1024 sc1
v_mfma_f32_16x16x32_bf16 v[68:71], a[236:239], a[164:167], v[68:71]
v_mfma_f32_16x16x32_bf16 v[68:71], a[232:235], a[160:163], v[68:71]
s_waitcnt lgkmcnt(4)
v_mfma_f32_16x16x32_bf16 v[72:75], a[240:243], a[160:163], v[72:75]
ds_read_b64_tr_b16 a[232:233], v28 offset:8192
ds_read_b64_tr_b16 a[234:235], v28 offset:8704
v_mfma_f32_16x16x32_bf16 v[72:75], a[244:247], a[164:167], v[72:75]
ds_read_b64_tr_b16 a[236:237], v28 offset:12288
ds_read_b64_tr_b16 a[238:239], v28 offset:12800
v_mfma_f32_16x16x32_bf16 v[88:91], a[244:247], a[172:175], v[88:91]
v_mfma_f32_16x16x32_bf16 v[88:91], a[240:243], a[168:171], v[88:91]
v_mfma_f32_16x16x32_bf16 v[104:107], a[240:243], a[176:179], v[104:107]
v_mfma_f32_16x16x32_bf16 v[104:107], a[244:247], a[180:183], v[104:107]
buffer_load_dwordx4 a[136:139], v41, s[28:31], s44 offen sc1
v_mfma_f32_16x16x32_bf16 v[120:123], a[244:247], a[188:191], v[120:123]
v_mfma_f32_16x16x32_bf16 v[120:123], a[240:243], a[184:187], v[120:123]
s_waitcnt lgkmcnt(4)
v_mfma_f32_16x16x32_bf16 v[124:127], a[224:227], a[184:187], v[124:127]
ds_read_b64_tr_b16 a[240:241], v29 offset:8192
ds_read_b64_tr_b16 a[242:243], v29 offset:8704
v_mfma_f32_16x16x32_bf16 v[124:127], a[228:231], a[188:191], v[124:127]
ds_read_b64_tr_b16 a[244:245], v29 offset:12288
ds_read_b64_tr_b16 a[246:247], v29 offset:12800
v_mfma_f32_16x16x32_bf16 v[108:111], a[228:231], a[180:183], v[108:111]
v_mfma_f32_16x16x32_bf16 v[108:111], a[224:227], a[176:179], v[108:111]
v_mfma_f32_16x16x32_bf16 v[92:95], a[224:227], a[168:171], v[92:95]
v_mfma_f32_16x16x32_bf16 v[92:95], a[228:231], a[172:175], v[92:95]
buffer_load_dwordx4 a[140:143], v41, s[28:31], s44 offen offset:1024 sc1
v_mfma_f32_16x16x32_bf16 v[76:79], a[228:231], a[164:167], v[76:79]
v_mfma_f32_16x16x32_bf16 v[76:79], a[224:227], a[160:163], v[76:79]
s_waitcnt lgkmcnt(4)
v_mfma_f32_16x16x32_bf16 a[0:3], a[232:235], a[160:163], a[0:3]
ds_read_b64_tr_b16 a[224:225], v30 offset:8192
ds_read_b64_tr_b16 a[226:227], v30 offset:8704
v_mfma_f32_16x16x32_bf16 a[0:3], a[236:239], a[164:167], a[0:3]
ds_read_b64_tr_b16 a[228:229], v30 offset:12288
ds_read_b64_tr_b16 a[230:231], v30 offset:12800
v_mfma_f32_16x16x32_bf16 a[16:19], a[236:239], a[172:175], a[16:19]
v_mfma_f32_16x16x32_bf16 a[16:19], a[232:235], a[168:171], a[16:19]
v_mfma_f32_16x16x32_bf16 a[32:35], a[232:235], a[176:179], a[32:35]
v_mfma_f32_16x16x32_bf16 a[32:35], a[236:239], a[180:183], a[32:35]
buffer_load_dwordx4 a[144:147], v42, s[28:31], s44 offen sc1
v_mfma_f32_16x16x32_bf16 a[48:51], a[236:239], a[188:191], a[48:51]
v_mfma_f32_16x16x32_bf16 a[48:51], a[232:235], a[184:187], a[48:51]
s_waitcnt lgkmcnt(4)
v_mfma_f32_16x16x32_bf16 a[52:55], a[240:243], a[184:187], a[52:55]
ds_read_b64_tr_b16 a[232:233], v31 offset:8192
ds_read_b64_tr_b16 a[234:235], v31 offset:8704
v_mfma_f32_16x16x32_bf16 a[52:55], a[244:247], a[188:191], a[52:55]
ds_read_b64_tr_b16 a[236:237], v31 offset:12288
ds_read_b64_tr_b16 a[238:239], v31 offset:12800
v_mfma_f32_16x16x32_bf16 a[36:39], a[244:247], a[180:183], a[36:39]
v_mfma_f32_16x16x32_bf16 a[36:39], a[240:243], a[176:179], a[36:39]
v_mfma_f32_16x16x32_bf16 a[20:23], a[240:243], a[168:171], a[20:23]
v_mfma_f32_16x16x32_bf16 a[20:23], a[244:247], a[172:175], a[20:23]
buffer_load_dwordx4 a[148:151], v42, s[28:31], s44 offen offset:1024 sc1
v_mfma_f32_16x16x32_bf16 a[4:7], a[244:247], a[164:167], a[4:7]
v_mfma_f32_16x16x32_bf16 a[4:7], a[240:243], a[160:163], a[4:7]
s_waitcnt vmcnt(14) lgkmcnt(4)
s_barrier
v_mfma_f32_16x16x32_bf16 a[8:11], a[224:227], a[160:163], a[8:11]
ds_read_b64_tr_b16 a[240:241], v24 offset:16384
ds_read_b64_tr_b16 a[242:243], v24 offset:17408
v_mfma_f32_16x16x32_bf16 a[8:11], a[228:231], a[164:167], a[8:11]
ds_read_b64_tr_b16 a[244:245], v24 offset:24576
ds_read_b64_tr_b16 a[246:247], v24 offset:25600
v_mfma_f32_16x16x32_bf16 a[24:27], a[228:231], a[172:175], a[24:27]
v_mfma_f32_16x16x32_bf16 a[24:27], a[224:227], a[168:171], a[24:27]
v_mfma_f32_16x16x32_bf16 a[40:43], a[224:227], a[176:179], a[40:43]
v_mfma_f32_16x16x32_bf16 a[40:43], a[228:231], a[180:183], a[40:43]
buffer_load_dwordx4 a[152:155], v43, s[28:31], s44 offen sc1
v_mfma_f32_16x16x32_bf16 a[56:59], a[228:231], a[188:191], a[56:59]
v_mfma_f32_16x16x32_bf16 a[56:59], a[224:227], a[184:187], a[56:59]
s_waitcnt lgkmcnt(4)
v_mfma_f32_16x16x32_bf16 a[60:63], a[232:235], a[184:187], a[60:63]
ds_read_b64_tr_b16 a[224:225], v24 offset:16392
ds_read_b64_tr_b16 a[226:227], v24 offset:17416
v_mfma_f32_16x16x32_bf16 a[60:63], a[236:239], a[188:191], a[60:63]
ds_read_b64_tr_b16 a[228:229], v24 offset:24584
ds_read_b64_tr_b16 a[230:231], v24 offset:25608
v_mfma_f32_16x16x32_bf16 a[44:47], a[236:239], a[180:183], a[44:47]
v_mfma_f32_16x16x32_bf16 a[44:47], a[232:235], a[176:179], a[44:47]
v_mfma_f32_16x16x32_bf16 a[28:31], a[232:235], a[168:171], a[28:31]
v_mfma_f32_16x16x32_bf16 a[28:31], a[236:239], a[172:175], a[28:31]
buffer_load_dwordx4 a[156:159], v43, s[28:31], s44 offen offset:1024 sc1
v_mfma_f32_16x16x32_bf16 a[12:15], a[236:239], a[164:167], a[12:15]
v_mfma_f32_16x16x32_bf16 a[12:15], a[232:235], a[160:163], a[12:15]
s_waitcnt lgkmcnt(4)
v_mfma_f32_16x16x32_bf16 v[128:131], a[240:243], a[192:195], v[128:131]
ds_read_b64_tr_b16 a[232:233], v25 offset:16384
ds_read_b64_tr_b16 a[234:235], v25 offset:17408
v_mfma_f32_16x16x32_bf16 v[128:131], a[244:247], a[196:199], v[128:131]
ds_read_b64_tr_b16 a[236:237], v25 offset:24576
ds_read_b64_tr_b16 a[238:239], v25 offset:25600
v_mfma_f32_16x16x32_bf16 v[144:147], a[244:247], a[204:207], v[144:147]
v_mfma_f32_16x16x32_bf16 v[144:147], a[240:243], a[200:203], v[144:147]
v_mfma_f32_16x16x32_bf16 v[160:163], a[240:243], a[208:211], v[160:163]
s_add_u32 m0, s40, 49152
s_xor_b32 s43, s101, 3670016
v_mfma_f32_16x16x32_bf16 v[160:163], a[244:247], a[212:215], v[160:163]
buffer_load_dwordx4 v32, s[16:19], s43 offen lds
v_mfma_f32_16x16x32_bf16 v[176:179], a[244:247], a[220:223], v[176:179]
v_mfma_f32_16x16x32_bf16 v[176:179], a[240:243], a[216:219], v[176:179]
s_waitcnt lgkmcnt(4)
v_mfma_f32_16x16x32_bf16 v[240:243], a[224:227], a[216:219], v[240:243]
ds_read_b64_tr_b16 a[240:241], v25 offset:16392
ds_read_b64_tr_b16 a[242:243], v25 offset:17416
v_mfma_f32_16x16x32_bf16 v[240:243], a[228:231], a[220:223], v[240:243]
ds_read_b64_tr_b16 a[244:245], v25 offset:24584
ds_read_b64_tr_b16 a[246:247], v25 offset:25608
v_mfma_f32_16x16x32_bf16 v[224:227], a[228:231], a[212:215], v[224:227]
v_mfma_f32_16x16x32_bf16 v[224:227], a[224:227], a[208:211], v[224:227]
v_mfma_f32_16x16x32_bf16 v[208:211], a[224:227], a[200:203], v[208:211]
v_mfma_f32_16x16x32_bf16 v[208:211], a[228:231], a[204:207], v[208:211]
buffer_load_dwordx4 v33, s[16:19], s43 offen offset:1024 lds
v_mfma_f32_16x16x32_bf16 v[192:195], a[228:231], a[196:199], v[192:195]
v_mfma_f32_16x16x32_bf16 v[192:195], a[224:227], a[192:195], v[192:195]
s_waitcnt lgkmcnt(4)
v_mfma_f32_16x16x32_bf16 v[132:135], a[232:235], a[192:195], v[132:135]
ds_read_b64_tr_b16 a[224:225], v26 offset:16384
ds_read_b64_tr_b16 a[226:227], v26 offset:17408
v_mfma_f32_16x16x32_bf16 v[132:135], a[236:239], a[196:199], v[132:135]
ds_read_b64_tr_b16 a[228:229], v26 offset:24576
ds_read_b64_tr_b16 a[230:231], v26 offset:25600
v_mfma_f32_16x16x32_bf16 v[148:151], a[236:239], a[204:207], v[148:151]
v_mfma_f32_16x16x32_bf16 v[148:151], a[232:235], a[200:203], v[148:151]
v_mfma_f32_16x16x32_bf16 v[164:167], a[232:235], a[208:211], v[164:167]
v_mfma_f32_16x16x32_bf16 v[164:167], a[236:239], a[212:215], v[164:167]
buffer_load_dwordx4 v34, s[16:19], s43 offen offset:2048 lds
v_mfma_f32_16x16x32_bf16 v[180:183], a[236:239], a[220:223], v[180:183]
v_mfma_f32_16x16x32_bf16 v[180:183], a[232:235], a[216:219], v[180:183]
s_waitcnt lgkmcnt(4)
v_mfma_f32_16x16x32_bf16 v[244:247], a[240:243], a[216:219], v[244:247]
ds_read_b64_tr_b16 a[232:233], v26 offset:16392
ds_read_b64_tr_b16 a[234:235], v26 offset:17416
v_mfma_f32_16x16x32_bf16 v[244:247], a[244:247], a[220:223], v[244:247]
ds_read_b64_tr_b16 a[236:237], v26 offset:24584
ds_read_b64_tr_b16 a[238:239], v26 offset:25608
v_mfma_f32_16x16x32_bf16 v[228:231], a[244:247], a[212:215], v[228:231]
v_mfma_f32_16x16x32_bf16 v[228:231], a[240:243], a[208:211], v[228:231]
v_mfma_f32_16x16x32_bf16 v[212:215], a[240:243], a[200:203], v[212:215]
s_xor_b32 s86, s100, 7
v_mfma_f32_16x16x32_bf16 v[212:215], a[244:247], a[204:207], v[212:215]
buffer_load_dwordx4 v35, s[16:19], s43 offen offset:3072 lds
v_mfma_f32_16x16x32_bf16 v[196:199], a[244:247], a[196:199], v[196:199]
v_mfma_f32_16x16x32_bf16 v[196:199], a[240:243], a[192:195], v[196:199]
s_waitcnt lgkmcnt(4)
v_mfma_f32_16x16x32_bf16 v[136:139], a[224:227], a[192:195], v[136:139]
ds_read_b64_tr_b16 a[240:241], v27 offset:16384
ds_read_b64_tr_b16 a[242:243], v27 offset:17408
v_mfma_f32_16x16x32_bf16 v[136:139], a[228:231], a[196:199], v[136:139]
ds_read_b64_tr_b16 a[244:245], v27 offset:24576
ds_read_b64_tr_b16 a[246:247], v27 offset:25600
v_mfma_f32_16x16x32_bf16 v[152:155], a[228:231], a[204:207], v[152:155]
v_mfma_f32_16x16x32_bf16 v[152:155], a[224:227], a[200:203], v[152:155]
v_mfma_f32_16x16x32_bf16 v[168:171], a[224:227], a[208:211], v[168:171]
s_add_u32 m0, s41, 49152
s_mul_i32 s43, s86, 229376
v_mfma_f32_16x16x32_bf16 v[168:171], a[228:231], a[212:215], v[168:171]
buffer_load_dwordx4 v36, s[20:23], s43 offen lds
v_mfma_f32_16x16x32_bf16 v[184:187], a[228:231], a[220:223], v[184:187]
v_mfma_f32_16x16x32_bf16 v[184:187], a[224:227], a[216:219], v[184:187]
s_waitcnt lgkmcnt(4)
v_mfma_f32_16x16x32_bf16 v[248:251], a[232:235], a[216:219], v[248:251]
ds_read_b64_tr_b16 a[224:225], v27 offset:16392
ds_read_b64_tr_b16 a[226:227], v27 offset:17416
v_mfma_f32_16x16x32_bf16 v[248:251], a[236:239], a[220:223], v[248:251]
ds_read_b64_tr_b16 a[228:229], v27 offset:24584
ds_read_b64_tr_b16 a[230:231], v27 offset:25608
v_mfma_f32_16x16x32_bf16 v[232:235], a[236:239], a[212:215], v[232:235]
v_mfma_f32_16x16x32_bf16 v[232:235], a[232:235], a[208:211], v[232:235]
v_mfma_f32_16x16x32_bf16 v[216:219], a[232:235], a[200:203], v[216:219]
v_mfma_f32_16x16x32_bf16 v[216:219], a[236:239], a[204:207], v[216:219]
buffer_load_dwordx4 v37, s[20:23], s43 offen offset:1024 lds
v_mfma_f32_16x16x32_bf16 v[200:203], a[236:239], a[196:199], v[200:203]
v_mfma_f32_16x16x32_bf16 v[200:203], a[232:235], a[192:195], v[200:203]
s_waitcnt lgkmcnt(4)
v_mfma_f32_16x16x32_bf16 v[140:143], a[240:243], a[192:195], v[140:143]
ds_read_b64_tr_b16 a[232:233], v28 offset:16384
ds_read_b64_tr_b16 a[234:235], v28 offset:16896
v_mfma_f32_16x16x32_bf16 v[140:143], a[244:247], a[196:199], v[140:143]
ds_read_b64_tr_b16 a[236:237], v28 offset:20480
ds_read_b64_tr_b16 a[238:239], v28 offset:20992
v_mfma_f32_16x16x32_bf16 v[156:159], a[244:247], a[204:207], v[156:159]
v_mfma_f32_16x16x32_bf16 v[156:159], a[240:243], a[200:203], v[156:159]
v_mfma_f32_16x16x32_bf16 v[172:175], a[240:243], a[208:211], v[172:175]
s_add_u32 m0, s41, 57344
v_mfma_f32_16x16x32_bf16 v[172:175], a[244:247], a[212:215], v[172:175]
buffer_load_dwordx4 v36, s[24:27], s43 offen lds
v_mfma_f32_16x16x32_bf16 v[188:191], a[244:247], a[220:223], v[188:191]
v_mfma_f32_16x16x32_bf16 v[188:191], a[240:243], a[216:219], v[188:191]
s_waitcnt lgkmcnt(4)
v_mfma_f32_16x16x32_bf16 v[252:255], a[224:227], a[216:219], v[252:255]
ds_read_b64_tr_b16 a[240:241], v29 offset:16384
ds_read_b64_tr_b16 a[242:243], v29 offset:16896
v_mfma_f32_16x16x32_bf16 v[252:255], a[228:231], a[220:223], v[252:255]
ds_read_b64_tr_b16 a[244:245], v29 offset:20480
ds_read_b64_tr_b16 a[246:247], v29 offset:20992
v_mfma_f32_16x16x32_bf16 v[236:239], a[228:231], a[212:215], v[236:239]
v_mfma_f32_16x16x32_bf16 v[236:239], a[224:227], a[208:211], v[236:239]
v_mfma_f32_16x16x32_bf16 v[220:223], a[224:227], a[200:203], v[220:223]
v_mfma_f32_16x16x32_bf16 v[220:223], a[228:231], a[204:207], v[220:223]
buffer_load_dwordx4 v37, s[24:27], s43 offen offset:1024 lds
v_mfma_f32_16x16x32_bf16 v[204:207], a[228:231], a[196:199], v[204:207]
v_mfma_f32_16x16x32_bf16 v[204:207], a[224:227], a[192:195], v[204:207]
s_waitcnt lgkmcnt(4)
v_mfma_f32_16x16x32_bf16 v[64:67], a[232:235], a[192:195], v[64:67]
ds_read_b64_tr_b16 a[224:225], v30 offset:16384
ds_read_b64_tr_b16 a[226:227], v30 offset:16896
v_mfma_f32_16x16x32_bf16 v[64:67], a[236:239], a[196:199], v[64:67]
ds_read_b64_tr_b16 a[228:229], v30 offset:20480
ds_read_b64_tr_b16 a[230:231], v30 offset:20992
v_mfma_f32_16x16x32_bf16 v[80:83], a[236:239], a[204:207], v[80:83]
v_mfma_f32_16x16x32_bf16 v[80:83], a[232:235], a[200:203], v[80:83]
v_mfma_f32_16x16x32_bf16 v[96:99], a[232:235], a[208:211], v[96:99]
s_xor_b32 s44, s79, 14336
v_mfma_f32_16x16x32_bf16 v[96:99], a[236:239], a[212:215], v[96:99]
buffer_load_dwordx4 a[160:163], v40, s[28:31], s44 offen sc1
v_mfma_f32_16x16x32_bf16 v[112:115], a[236:239], a[220:223], v[112:115]
v_mfma_f32_16x16x32_bf16 v[112:115], a[232:235], a[216:219], v[112:115]
s_waitcnt lgkmcnt(4)
v_mfma_f32_16x16x32_bf16 v[116:119], a[240:243], a[216:219], v[116:119]
ds_read_b64_tr_b16 a[232:233], v31 offset:16384
ds_read_b64_tr_b16 a[234:235], v31 offset:16896
v_mfma_f32_16x16x32_bf16 v[116:119], a[244:247], a[220:223], v[116:119]
ds_read_b64_tr_b16 a[236:237], v31 offset:20480
ds_read_b64_tr_b16 a[238:239], v31 offset:20992
v_mfma_f32_16x16x32_bf16 v[100:103], a[244:247], a[212:215], v[100:103]
v_mfma_f32_16x16x32_bf16 v[100:103], a[240:243], a[208:211], v[100:103]
v_mfma_f32_16x16x32_bf16 v[84:87], a[240:243], a[200:203], v[84:87]
v_mfma_f32_16x16x32_bf16 v[84:87], a[244:247], a[204:207], v[84:87]
buffer_load_dwordx4 a[164:167], v40, s[28:31], s44 offen offset:1024 sc1
v_mfma_f32_16x16x32_bf16 v[68:71], a[244:247], a[196:199], v[68:71]
v_mfma_f32_16x16x32_bf16 v[68:71], a[240:243], a[192:195], v[68:71]
s_waitcnt lgkmcnt(4)
v_mfma_f32_16x16x32_bf16 v[72:75], a[224:227], a[192:195], v[72:75]
ds_read_b64_tr_b16 a[240:241], v28 offset:24576
ds_read_b64_tr_b16 a[242:243], v28 offset:25088
v_mfma_f32_16x16x32_bf16 v[72:75], a[228:231], a[196:199], v[72:75]
ds_read_b64_tr_b16 a[244:245], v28 offset:28672
ds_read_b64_tr_b16 a[246:247], v28 offset:29184
v_mfma_f32_16x16x32_bf16 v[88:91], a[228:231], a[204:207], v[88:91]
v_mfma_f32_16x16x32_bf16 v[88:91], a[224:227], a[200:203], v[88:91]
v_mfma_f32_16x16x32_bf16 v[104:107], a[224:227], a[208:211], v[104:107]
v_mfma_f32_16x16x32_bf16 v[104:107], a[228:231], a[212:215], v[104:107]
buffer_load_dwordx4 a[168:171], v41, s[28:31], s44 offen sc1
v_mfma_f32_16x16x32_bf16 v[120:123], a[228:231], a[220:223], v[120:123]
v_mfma_f32_16x16x32_bf16 v[120:123], a[224:227], a[216:219], v[120:123]
s_waitcnt lgkmcnt(4)
v_mfma_f32_16x16x32_bf16 v[124:127], a[232:235], a[216:219], v[124:127]
ds_read_b64_tr_b16 a[224:225], v29 offset:24576
ds_read_b64_tr_b16 a[226:227], v29 offset:25088
v_mfma_f32_16x16x32_bf16 v[124:127], a[236:239], a[220:223], v[124:127]
ds_read_b64_tr_b16 a[228:229], v29 offset:28672
ds_read_b64_tr_b16 a[230:231], v29 offset:29184
v_mfma_f32_16x16x32_bf16 v[108:111], a[236:239], a[212:215], v[108:111]
v_mfma_f32_16x16x32_bf16 v[108:111], a[232:235], a[208:211], v[108:111]
v_mfma_f32_16x16x32_bf16 v[92:95], a[232:235], a[200:203], v[92:95]
v_mfma_f32_16x16x32_bf16 v[92:95], a[236:239], a[204:207], v[92:95]
buffer_load_dwordx4 a[172:175], v41, s[28:31], s44 offen offset:1024 sc1
v_mfma_f32_16x16x32_bf16 v[76:79], a[236:239], a[196:199], v[76:79]
v_mfma_f32_16x16x32_bf16 v[76:79], a[232:235], a[192:195], v[76:79]
s_waitcnt lgkmcnt(4)
v_mfma_f32_16x16x32_bf16 a[0:3], a[240:243], a[192:195], a[0:3]
ds_read_b64_tr_b16 a[232:233], v30 offset:24576
ds_read_b64_tr_b16 a[234:235], v30 offset:25088
v_mfma_f32_16x16x32_bf16 a[0:3], a[244:247], a[196:199], a[0:3]
ds_read_b64_tr_b16 a[236:237], v30 offset:28672
ds_read_b64_tr_b16 a[238:239], v30 offset:29184
v_mfma_f32_16x16x32_bf16 a[16:19], a[244:247], a[204:207], a[16:19]
v_mfma_f32_16x16x32_bf16 a[16:19], a[240:243], a[200:203], a[16:19]
v_mfma_f32_16x16x32_bf16 a[32:35], a[240:243], a[208:211], a[32:35]
v_mfma_f32_16x16x32_bf16 a[32:35], a[244:247], a[212:215], a[32:35]
buffer_load_dwordx4 a[176:179], v42, s[28:31], s44 offen sc1
v_mfma_f32_16x16x32_bf16 a[48:51], a[244:247], a[220:223], a[48:51]
v_mfma_f32_16x16x32_bf16 a[48:51], a[240:243], a[216:219], a[48:51]
s_waitcnt lgkmcnt(4)
v_mfma_f32_16x16x32_bf16 a[52:55], a[224:227], a[216:219], a[52:55]
ds_read_b64_tr_b16 a[240:241], v31 offset:24576
ds_read_b64_tr_b16 a[242:243], v31 offset:25088
v_mfma_f32_16x16x32_bf16 a[52:55], a[228:231], a[220:223], a[52:55]
ds_read_b64_tr_b16 a[244:245], v31 offset:28672
ds_read_b64_tr_b16 a[246:247], v31 offset:29184
v_mfma_f32_16x16x32_bf16 a[36:39], a[228:231], a[212:215], a[36:39]
v_mfma_f32_16x16x32_bf16 a[36:39], a[224:227], a[208:211], a[36:39]
v_mfma_f32_16x16x32_bf16 a[20:23], a[224:227], a[200:203], a[20:23]
v_mfma_f32_16x16x32_bf16 a[20:23], a[228:231], a[204:207], a[20:23]
buffer_load_dwordx4 a[180:183], v42, s[28:31], s44 offen offset:1024 sc1
v_mfma_f32_16x16x32_bf16 a[4:7], a[228:231], a[196:199], a[4:7]
v_mfma_f32_16x16x32_bf16 a[4:7], a[224:227], a[192:195], a[4:7]
s_waitcnt vmcnt(14) lgkmcnt(4)
s_barrier
v_mfma_f32_16x16x32_bf16 a[8:11], a[232:235], a[192:195], a[8:11]
ds_read_b64_tr_b16 a[224:225], v24 offset:32768
ds_read_b64_tr_b16 a[226:227], v24 offset:33792
v_mfma_f32_16x16x32_bf16 a[8:11], a[236:239], a[196:199], a[8:11]
ds_read_b64_tr_b16 a[228:229], v24 offset:40960
ds_read_b64_tr_b16 a[230:231], v24 offset:41984
v_mfma_f32_16x16x32_bf16 a[24:27], a[236:239], a[204:207], a[24:27]
v_mfma_f32_16x16x32_bf16 a[24:27], a[232:235], a[200:203], a[24:27]
v_mfma_f32_16x16x32_bf16 a[40:43], a[232:235], a[208:211], a[40:43]
v_mfma_f32_16x16x32_bf16 a[40:43], a[236:239], a[212:215], a[40:43]
buffer_load_dwordx4 a[184:187], v43, s[28:31], s44 offen sc1
v_mfma_f32_16x16x32_bf16 a[56:59], a[236:239], a[220:223], a[56:59]
v_mfma_f32_16x16x32_bf16 a[56:59], a[232:235], a[216:219], a[56:59]
s_waitcnt lgkmcnt(4)
v_mfma_f32_16x16x32_bf16 a[60:63], a[240:243], a[216:219], a[60:63]
ds_read_b64_tr_b16 a[232:233], v24 offset:32776
ds_read_b64_tr_b16 a[234:235], v24 offset:33800
v_mfma_f32_16x16x32_bf16 a[60:63], a[244:247], a[220:223], a[60:63]
ds_read_b64_tr_b16 a[236:237], v24 offset:40968
ds_read_b64_tr_b16 a[238:239], v24 offset:41992
v_mfma_f32_16x16x32_bf16 a[44:47], a[244:247], a[212:215], a[44:47]
v_mfma_f32_16x16x32_bf16 a[44:47], a[240:243], a[208:211], a[44:47]
v_mfma_f32_16x16x32_bf16 a[28:31], a[240:243], a[200:203], a[28:31]
v_mfma_f32_16x16x32_bf16 a[28:31], a[244:247], a[204:207], a[28:31]
buffer_load_dwordx4 a[188:191], v43, s[28:31], s44 offen offset:1024 sc1
v_mfma_f32_16x16x32_bf16 a[12:15], a[244:247], a[196:199], a[12:15]
v_mfma_f32_16x16x32_bf16 a[12:15], a[240:243], a[192:195], a[12:15]
s_waitcnt lgkmcnt(4)
v_mfma_f32_16x16x32_bf16 v[128:131], a[224:227], a[128:131], v[128:131]
ds_read_b64_tr_b16 a[240:241], v25 offset:32768
ds_read_b64_tr_b16 a[242:243], v25 offset:33792
v_mfma_f32_16x16x32_bf16 v[128:131], a[228:231], a[132:135], v[128:131]
ds_read_b64_tr_b16 a[244:245], v25 offset:40960
ds_read_b64_tr_b16 a[246:247], v25 offset:41984
v_mfma_f32_16x16x32_bf16 v[144:147], a[228:231], a[140:143], v[144:147]
s_lshl_b32 s80, s85, 8
s_mul_i32 s81, s83, 458752
v_mfma_f32_16x16x32_bf16 v[144:147], a[224:227], a[136:139], v[144:147]
s_add_u32 s81, s81, s80
v_mfma_f32_16x16x32_bf16 v[160:163], a[224:227], a[144:147], v[160:163]
s_add_u32 m0, s40, 0
v_mfma_f32_16x16x32_bf16 v[160:163], a[228:231], a[148:151], v[160:163]
L_pad18:
s_cbranch_execz L_pad19
buffer_load_dwordx4 v16, s[8:11], 0 offen lds
v_mfma_f32_16x16x32_bf16 v[176:179], a[228:231], a[156:159], v[176:179]
s_add_u32 s16, s64, s81
s_addc_u32 s17, s65, 0
v_mfma_f32_16x16x32_bf16 v[176:179], a[224:227], a[152:155], v[176:179]
s_waitcnt lgkmcnt(4)
v_mfma_f32_16x16x32_bf16 v[240:243], a[232:235], a[152:155], v[240:243]
ds_read_b64_tr_b16 a[224:225], v25 offset:32776
ds_read_b64_tr_b16 a[226:227], v25 offset:33800
v_mfma_f32_16x16x32_bf16 v[240:243], a[236:239], a[156:159], v[240:243]
ds_read_b64_tr_b16 a[228:229], v25 offset:40968
ds_read_b64_tr_b16 a[230:231], v25 offset:41992
v_mfma_f32_16x16x32_bf16 v[224:227], a[236:239], a[148:151], v[224:227]
s_mov_b32 s18, 458752
s_mov_b32 s19, 0x20000
v_mfma_f32_16x16x32_bf16 v[224:227], a[232:235], a[144:147], v[224:227]
s_sub_u32 s18, s18, s80
v_mfma_f32_16x16x32_bf16 v[208:211], a[232:235], a[136:139], v[208:211]
v_lshl_add_u32 v52, v1, 4, v3
v_lshlrev_b32 v52, 10, v52
v_mfma_f32_16x16x32_bf16 v[208:211], a[236:239], a[140:143], v[208:211]
buffer_load_dwordx4 v17, s[8:11], 0 offen offset:1024 lds
v_mfma_f32_16x16x32_bf16 v[192:195], a[236:239], a[132:135], v[192:195]
v_lshlrev_b32 v53, 1, v3
v_xor_b32 v53, v2, v53
v_mfma_f32_16x16x32_bf16 v[192:195], a[232:235], a[128:131], v[192:195]
s_waitcnt lgkmcnt(4)
v_mfma_f32_16x16x32_bf16 v[132:135], a[240:243], a[128:131], v[132:135]
ds_read_b64_tr_b16 a[232:233], v26 offset:32768
ds_read_b64_tr_b16 a[234:235], v26 offset:33792
v_mfma_f32_16x16x32_bf16 v[132:135], a[244:247], a[132:135], v[132:135]
ds_read_b64_tr_b16 a[236:237], v26 offset:40960
ds_read_b64_tr_b16 a[238:239], v26 offset:41984
v_mfma_f32_16x16x32_bf16 v[148:151], a[244:247], a[140:143], v[148:151]
v_xor_b32 v54, 0, v53
v_lshl_add_u32 v32, v54, 4, v52
v_mfma_f32_16x16x32_bf16 v[148:151], a[240:243], a[136:139], v[148:151]
v_xor_b32 v54, 8, v53
v_lshl_add_u32 v33, v54, 4, v52
v_mfma_f32_16x16x32_bf16 v[164:167], a[240:243], a[144:147], v[164:167]
v_add_u32 v33, 3072, v33
v_xor_b32 v54, 0, v53
v_mfma_f32_16x16x32_bf16 v[164:167], a[244:247], a[148:151], v[164:167]
buffer_load_dwordx4 v18, s[8:11], 0 offen offset:2048 lds
v_mfma_f32_16x16x32_bf16 v[180:183], a[244:247], a[156:159], v[180:183]
v_lshl_add_u32 v34, v54, 4, v52
v_add_u32 v34, 6144, v34
v_mfma_f32_16x16x32_bf16 v[180:183], a[240:243], a[152:155], v[180:183]
s_waitcnt lgkmcnt(4)
v_mfma_f32_16x16x32_bf16 v[244:247], a[224:227], a[152:155], v[244:247]
ds_read_b64_tr_b16 a[240:241], v26 offset:32776
ds_read_b64_tr_b16 a[242:243], v26 offset:33800
v_mfma_f32_16x16x32_bf16 v[244:247], a[228:231], a[156:159], v[244:247]
ds_read_b64_tr_b16 a[244:245], v26 offset:40968
ds_read_b64_tr_b16 a[246:247], v26 offset:41992
v_mfma_f32_16x16x32_bf16 v[228:231], a[228:231], a[148:151], v[228:231]
v_xor_b32 v54, 8, v53
v_lshl_add_u32 v35, v54, 4, v52
v_mfma_f32_16x16x32_bf16 v[228:231], a[224:227], a[144:147], v[228:231]
v_add_u32 v35, 9216, v35
v_mfma_f32_16x16x32_bf16 v[212:215], a[224:227], a[136:139], v[212:215]
s_lshl_b32 s81, s83, 20
s_add_u32 s81, s81, s80
v_mfma_f32_16x16x32_bf16 v[212:215], a[228:231], a[140:143], v[212:215]
buffer_load_dwordx4 v19, s[8:11], 0 offen offset:3072 lds
v_mfma_f32_16x16x32_bf16 v[196:199], a[228:231], a[132:135], v[196:199]
s_add_u32 s20, s58, s81
s_addc_u32 s21, s59, 0
v_mfma_f32_16x16x32_bf16 v[196:199], a[224:227], a[128:131], v[196:199]
s_waitcnt lgkmcnt(4)
v_mfma_f32_16x16x32_bf16 v[136:139], a[232:235], a[128:131], v[136:139]
ds_read_b64_tr_b16 a[224:225], v27 offset:32768
ds_read_b64_tr_b16 a[226:227], v27 offset:33792
v_mfma_f32_16x16x32_bf16 v[136:139], a[236:239], a[132:135], v[136:139]
ds_read_b64_tr_b16 a[228:229], v27 offset:40960
ds_read_b64_tr_b16 a[230:231], v27 offset:41984
v_mfma_f32_16x16x32_bf16 v[152:155], a[236:239], a[140:143], v[152:155]
s_mov_b32 s22, 1048576
s_mov_b32 s23, 0x20000
v_mfma_f32_16x16x32_bf16 v[152:155], a[232:235], a[136:139], v[152:155]
s_sub_u32 s22, s22, s80
v_mfma_f32_16x16x32_bf16 v[168:171], a[232:235], a[144:147], v[168:171]
s_lshl_b32 s82, s76, 1
s_add_u32 s82, s82, s84
v_mfma_f32_16x16x32_bf16 v[168:171], a[236:239], a[148:151], v[168:171]
v_mfma_f32_16x16x32_bf16 v[184:187], a[236:239], a[156:159], v[184:187]
s_mul_i32 s80, s84, 466944
s_mul_i32 s81, s76, 2113536
v_mfma_f32_16x16x32_bf16 v[184:187], a[232:235], a[152:155], v[184:187]
s_waitcnt lgkmcnt(4)
v_mfma_f32_16x16x32_bf16 v[248:251], a[240:243], a[152:155], v[248:251]
ds_read_b64_tr_b16 a[232:233], v27 offset:32776
ds_read_b64_tr_b16 a[234:235], v27 offset:33800
v_mfma_f32_16x16x32_bf16 v[248:251], a[244:247], a[156:159], v[248:251]
ds_read_b64_tr_b16 a[236:237], v27 offset:40968
ds_read_b64_tr_b16 a[238:239], v27 offset:41992
v_mfma_f32_16x16x32_bf16 v[232:235], a[244:247], a[148:151], v[232:235]
s_add_u32 s80, s80, s81
s_mul_i32 s81, s83, 14336
v_mfma_f32_16x16x32_bf16 v[232:235], a[240:243], a[144:147], v[232:235]
s_add_u32 s80, s80, s81
s_add_u32 s80, s80, 524288
v_mfma_f32_16x16x32_bf16 v[216:219], a[240:243], a[136:139], v[216:219]
s_add_u32 s24, s70, s80
s_addc_u32 s25, s71, 0
v_mfma_f32_16x16x32_bf16 v[216:219], a[244:247], a[140:143], v[216:219]
v_mfma_f32_16x16x32_bf16 v[200:203], a[244:247], a[132:135], v[200:203]
s_mov_b32 s26, 466944
s_mov_b32 s27, 0x20000
v_mfma_f32_16x16x32_bf16 v[200:203], a[240:243], a[128:131], v[200:203]
s_waitcnt lgkmcnt(4)
v_mfma_f32_16x16x32_bf16 v[140:143], a[224:227], a[128:131], v[140:143]
ds_read_b64_tr_b16 a[240:241], v28 offset:32768
ds_read_b64_tr_b16 a[242:243], v28 offset:33280
v_mfma_f32_16x16x32_bf16 v[140:143], a[228:231], a[132:135], v[140:143]
ds_read_b64_tr_b16 a[244:245], v28 offset:36864
ds_read_b64_tr_b16 a[246:247], v28 offset:37376
v_mfma_f32_16x16x32_bf16 v[156:159], a[228:231], a[140:143], v[156:159]
s_mul_i32 s80, s82, 1048576
s_lshl_b32 s81, s83, 15
v_mfma_f32_16x16x32_bf16 v[156:159], a[224:227], a[136:139], v[156:159]
s_add_u32 s80, s80, s81
s_add_u32 s80, s80, 17825792
v_mfma_f32_16x16x32_bf16 v[172:175], a[224:227], a[144:147], v[172:175]
s_add_u32 s28, s70, s80
s_addc_u32 s29, s71, 0
v_mfma_f32_16x16x32_bf16 v[172:175], a[228:231], a[148:151], v[172:175]
v_mfma_f32_16x16x32_bf16 v[188:191], a[228:231], a[156:159], v[188:191]
s_mov_b32 s30, 1048576
s_mov_b32 s31, 0x20000
v_mfma_f32_16x16x32_bf16 v[188:191], a[224:227], a[152:155], v[188:191]
s_waitcnt lgkmcnt(4)
v_mfma_f32_16x16x32_bf16 v[252:255], a[232:235], a[152:155], v[252:255]
ds_read_b64_tr_b16 a[224:225], v29 offset:32768
ds_read_b64_tr_b16 a[226:227], v29 offset:33280
v_mfma_f32_16x16x32_bf16 v[252:255], a[236:239], a[156:159], v[252:255]
ds_read_b64_tr_b16 a[228:229], v29 offset:36864
ds_read_b64_tr_b16 a[230:231], v29 offset:37376
v_mfma_f32_16x16x32_bf16 v[236:239], a[236:239], a[148:151], v[236:239]
s_lshl_b32 s81, s82, 2
s_add_u32 s81, s81, s85
v_mfma_f32_16x16x32_bf16 v[236:239], a[232:235], a[144:147], v[236:239]
s_mul_i32 s80, s81, 196608
s_add_u32 s80, s80, 41943040
v_mfma_f32_16x16x32_bf16 v[220:223], a[232:235], a[136:139], v[220:223]
s_add_u32 s52, s70, s80
s_addc_u32 s53, s71, 0
v_mfma_f32_16x16x32_bf16 v[220:223], a[236:239], a[140:143], v[220:223]
v_mfma_f32_16x16x32_bf16 v[204:207], a[236:239], a[132:135], v[204:207]
s_mov_b32 s54, 196608
s_mov_b32 s55, 0x20000
v_mfma_f32_16x16x32_bf16 v[204:207], a[232:235], a[128:131], v[204:207]
s_waitcnt lgkmcnt(4)
v_mfma_f32_16x16x32_bf16 v[64:67], a[240:243], a[128:131], v[64:67]
ds_read_b64_tr_b16 a[232:233], v30 offset:32768
ds_read_b64_tr_b16 a[234:235], v30 offset:33280
v_mfma_f32_16x16x32_bf16 v[64:67], a[244:247], a[132:135], v[64:67]
ds_read_b64_tr_b16 a[236:237], v30 offset:36864
ds_read_b64_tr_b16 a[238:239], v30 offset:37376
v_mfma_f32_16x16x32_bf16 v[80:83], a[244:247], a[140:143], v[80:83]
s_and_b32 s81, s81, 7
s_lshl_b32 s79, s81, 14
v_mfma_f32_16x16x32_bf16 v[80:83], a[240:243], a[136:139], v[80:83]
s_lshl_b32 s80, s50, 10
s_add_u32 s79, s79, s80
v_mfma_f32_16x16x32_bf16 v[96:99], a[240:243], a[144:147], v[96:99]
s_add_u32 m0, s40, 131072
s_mov_b32 s43, 65536
v_mfma_f32_16x16x32_bf16 v[96:99], a[244:247], a[148:151], v[96:99]
buffer_load_dwordx4 v32, s[16:19], s43 offen lds
v_mfma_f32_16x16x32_bf16 v[112:115], a[244:247], a[156:159], v[112:115]
s_add_u32 s79, s79, 32768
s_lshl_b32 s80, s82, 17
v_mfma_f32_16x16x32_bf16 v[112:115], a[240:243], a[152:155], v[112:115]
s_waitcnt lgkmcnt(4)
v_mfma_f32_16x16x32_bf16 v[116:119], a[224:227], a[152:155], v[116:119]
ds_read_b64_tr_b16 a[240:241], v31 offset:32768
ds_read_b64_tr_b16 a[242:243], v31 offset:33280
v_mfma_f32_16x16x32_bf16 v[116:119], a[228:231], a[156:159], v[116:119]
ds_read_b64_tr_b16 a[244:245], v31 offset:36864
ds_read_b64_tr_b16 a[246:247], v31 offset:37376
v_mfma_f32_16x16x32_bf16 v[100:103], a[228:231], a[148:151], v[100:103]
s_lshl_b32 s81, s85, 2
s_add_u32 s81, s81, s83
v_mfma_f32_16x16x32_bf16 v[100:103], a[224:227], a[144:147], v[100:103]
s_lshl_b32 s81, s81, 6
s_add_u32 s80, s80, s81
v_mfma_f32_16x16x32_bf16 v[84:87], a[224:227], a[136:139], v[84:87]
s_add_u32 s60, s72, s80
s_addc_u32 s61, s73, 0
v_mfma_f32_16x16x32_bf16 v[84:87], a[228:231], a[140:143], v[84:87]
buffer_load_dwordx4 v33, s[16:19], s43 offen offset:1024 lds
v_mfma_f32_16x16x32_bf16 v[68:71], a[228:231], a[132:135], v[68:71]
s_mov_b32 s62, 2097152
s_mov_b32 s63, 0x20000
v_mfma_f32_16x16x32_bf16 v[68:71], a[224:227], a[128:131], v[68:71]
s_waitcnt lgkmcnt(4)
v_mfma_f32_16x16x32_bf16 v[72:75], a[232:235], a[128:131], v[72:75]
ds_read_b64_tr_b16 a[224:225], v28 offset:40960
ds_read_b64_tr_b16 a[226:227], v28 offset:41472
v_mfma_f32_16x16x32_bf16 v[72:75], a[236:239], a[132:135], v[72:75]
ds_read_b64_tr_b16 a[228:229], v28 offset:45056
ds_read_b64_tr_b16 a[230:231], v28 offset:45568
v_mfma_f32_16x16x32_bf16 v[88:91], a[236:239], a[140:143], v[88:91]
s_add_u32 s56, s66, s80
s_addc_u32 s57, s67, 0
v_mfma_f32_16x16x32_bf16 v[88:91], a[232:235], a[136:139], v[88:91]
s_mov_b32 s58, 2097152
s_mov_b32 s59, 0x20000
v_mfma_f32_16x16x32_bf16 v[104:107], a[232:235], a[144:147], v[104:107]
s_sub_u32 s62, s62, s80
s_mov_b32 s58, s62
v_mfma_f32_16x16x32_bf16 v[104:107], a[236:239], a[148:151], v[104:107]
buffer_load_dwordx4 v34, s[16:19], s43 offen offset:2048 lds
v_mfma_f32_16x16x32_bf16 v[120:123], a[236:239], a[156:159], v[120:123]
s_lshr_b32 s101, s83, 1
s_lshl_b32 s101, s101, 7
v_mfma_f32_16x16x32_bf16 v[120:123], a[232:235], a[152:155], v[120:123]
s_waitcnt lgkmcnt(4)
v_mfma_f32_16x16x32_bf16 v[124:127], a[240:243], a[152:155], v[124:127]
ds_read_b64_tr_b16 a[232:233], v29 offset:40960
ds_read_b64_tr_b16 a[234:235], v29 offset:41472
v_mfma_f32_16x16x32_bf16 v[124:127], a[244:247], a[156:159], v[124:127]
ds_read_b64_tr_b16 a[236:237], v29 offset:45056
ds_read_b64_tr_b16 a[238:239], v29 offset:45568
v_mfma_f32_16x16x32_bf16 v[108:111], a[244:247], a[148:151], v[108:111]
s_and_b32 s80, s76, 0
s_lshl_b32 s80, s80, 17
v_mfma_f32_16x16x32_bf16 v[108:111], a[240:243], a[144:147], v[108:111]
s_add_u32 s101, s101, s80
s_xor_b32 s100, s101, 128
v_mfma_f32_16x16x32_bf16 v[92:95], a[240:243], a[136:139], v[92:95]
v_and_b32 v52, 32, v0
v_lshlrev_b32 v52, 19, v52
v_mfma_f32_16x16x32_bf16 v[92:95], a[244:247], a[140:143], v[92:95]
buffer_load_dwordx4 v35, s[16:19], s43 offen offset:3072 lds
v_mfma_f32_16x16x32_bf16 v[76:79], a[244:247], a[132:135], v[76:79]
v_lshl_add_u32 v40, v0, 2, v52
v_lshlrev_b32 v41, 7, v0
v_mfma_f32_16x16x32_bf16 v[76:79], a[240:243], a[128:131], v[76:79]
s_waitcnt lgkmcnt(4)
v_mfma_f32_16x16x32_bf16 a[0:3], a[224:227], a[128:131], a[0:3]
ds_read_b64_tr_b16 a[240:241], v30 offset:40960
ds_read_b64_tr_b16 a[242:243], v30 offset:41472
v_mfma_f32_16x16x32_bf16 a[0:3], a[228:231], a[132:135], a[0:3]
ds_read_b64_tr_b16 a[244:245], v30 offset:45056
ds_read_b64_tr_b16 a[246:247], v30 offset:45568
v_mfma_f32_16x16x32_bf16 a[16:19], a[228:231], a[140:143], a[16:19]
v_lshl_add_u32 v42, v1, 25, v40
v_mul_u32_u24 v52, 262144, v1
v_mfma_f32_16x16x32_bf16 a[16:19], a[224:227], a[136:139], a[16:19]
v_lshl_add_u32 v36, v0, 4, v52
v_add_u32 v37, 131072, v36
v_mfma_f32_16x16x32_bf16 a[32:35], a[224:227], a[144:147], a[32:35]
s_add_u32 m0, s40, 147456
s_mov_b32 s43, 131072
v_mfma_f32_16x16x32_bf16 a[32:35], a[228:231], a[148:151], a[32:35]
buffer_load_dwordx4 v32, s[16:19], s43 offen lds
v_mfma_f32_16x16x32_bf16 a[48:51], a[228:231], a[156:159], a[48:51]
s_lshl_b32 s80, s76, 15
s_sub_u32 s80, s80, 1048576
v_mfma_f32_16x16x32_bf16 a[48:51], a[224:227], a[152:155], a[48:51]
s_waitcnt lgkmcnt(4)
v_mfma_f32_16x16x32_bf16 a[52:55], a[232:235], a[152:155], a[52:55]
ds_read_b64_tr_b16 a[224:225], v31 offset:40960
ds_read_b64_tr_b16 a[226:227], v31 offset:41472
v_mfma_f32_16x16x32_bf16 a[52:55], a[236:239], a[156:159], a[52:55]
ds_read_b64_tr_b16 a[228:229], v31 offset:45056
ds_read_b64_tr_b16 a[230:231], v31 offset:45568
v_mfma_f32_16x16x32_bf16 a[36:39], a[236:239], a[148:151], a[36:39]
v_lshrrev_b32 v52, 1, v2
v_lshl_add_u32 v52, v1, 3, v52
v_mfma_f32_16x16x32_bf16 a[36:39], a[232:235], a[144:147], a[36:39]
v_lshlrev_b32 v52, 10, v52
v_and_b32 v53, 1, v0
v_mfma_f32_16x16x32_bf16 a[20:23], a[232:235], a[136:139], a[20:23]
v_lshl_add_u32 v52, v53, 7, v52
v_lshl_add_u32 v52, v3, 28, v52
v_mfma_f32_16x16x32_bf16 a[20:23], a[236:239], a[140:143], a[20:23]
buffer_load_dwordx4 v33, s[16:19], s43 offen offset:1024 lds
v_mfma_f32_16x16x32_bf16 a[4:7], a[236:239], a[132:135], a[4:7]
v_add_u32 v38, s80, v52
s_mul_i32 s80, s76, 14336
v_mfma_f32_16x16x32_bf16 a[4:7], a[232:235], a[128:131], a[4:7]
s_waitcnt vmcnt(10) lgkmcnt(4)
s_barrier
v_mfma_f32_16x16x32_bf16 a[8:11], a[240:243], a[128:131], a[8:11]
ds_read_b64_tr_b16 a[232:233], v24 offset:49152
ds_read_b64_tr_b16 a[234:235], v24 offset:50176
v_mfma_f32_16x16x32_bf16 a[8:11], a[244:247], a[132:135], a[8:11]
ds_read_b64_tr_b16 a[236:237], v24 offset:57344
ds_read_b64_tr_b16 a[238:239], v24 offset:58368
v_mfma_f32_16x16x32_bf16 a[24:27], a[244:247], a[140:143], a[24:27]
s_sub_u32 s80, s80, 458752
v_mul_u32_u24 v52, 7, v1
v_mfma_f32_16x16x32_bf16 a[24:27], a[240:243], a[136:139], a[24:27]
v_add_u32 v52, v52, v0
v_and_b32 v53, 1, v52
v_mfma_f32_16x16x32_bf16 a[40:43], a[240:243], a[144:147], a[40:43]
v_lshrrev_b32 v52, 1, v52
v_lshlrev_b32 v52, 10, v52
v_mfma_f32_16x16x32_bf16 a[40:43], a[244:247], a[148:151], a[40:43]
buffer_load_dwordx4 v34, s[16:19], s43 offen offset:2048 lds
v_mfma_f32_16x16x32_bf16 a[56:59], a[244:247], a[156:159], a[56:59]
v_lshl_add_u32 v52, v53, 7, v52
v_add_u32 v53, 1, v0
v_mfma_f32_16x16x32_bf16 a[56:59], a[240:243], a[152:155], a[56:59]
s_waitcnt lgkmcnt(4)
v_mfma_f32_16x16x32_bf16 a[60:63], a[224:227], a[152:155], a[60:63]
ds_read_b64_tr_b16 a[240:241], v24 offset:49160
ds_read_b64_tr_b16 a[242:243], v24 offset:50184
v_mfma_f32_16x16x32_bf16 a[60:63], a[228:231], a[156:159], a[60:63]
ds_read_b64_tr_b16 a[244:245], v24 offset:57352
ds_read_b64_tr_b16 a[246:247], v24 offset:58376
v_mfma_f32_16x16x32_bf16 a[44:47], a[228:231], a[148:151], a[44:47]
v_lshrrev_b32 v53, 3, v53
v_lshl_add_u32 v52, v53, 26, v52
v_mfma_f32_16x16x32_bf16 a[44:47], a[224:227], a[144:147], a[44:47]
v_add_u32 v39, s80, v52
s_lshr_b32 s80, s85, 1
v_mfma_f32_16x16x32_bf16 a[28:31], a[224:227], a[136:139], a[28:31]
s_mul_i32 s80, s80, 58368
s_and_b32 s81, s85, 1
v_mfma_f32_16x16x32_bf16 a[28:31], a[228:231], a[140:143], a[28:31]
buffer_load_dwordx4 v35, s[16:19], s43 offen offset:3072 lds
v_mfma_f32_16x16x32_bf16 a[12:15], a[228:231], a[132:135], a[12:15]
s_mul_i32 s81, s81, 7168
s_add_u32 s80, s80, s81
v_mfma_f32_16x16x32_bf16 a[12:15], a[224:227], a[128:131], a[12:15]
s_waitcnt lgkmcnt(4)
v_mfma_f32_16x16x32_bf16 v[128:131], a[232:235], a[160:163], v[128:131]
ds_read_b64_tr_b16 a[224:225], v25 offset:49152
ds_read_b64_tr_b16 a[226:227], v25 offset:50176
v_mfma_f32_16x16x32_bf16 v[128:131], a[236:239], a[164:167], v[128:131]
ds_read_b64_tr_b16 a[228:229], v25 offset:57344
ds_read_b64_tr_b16 a[230:231], v25 offset:58368
v_mfma_f32_16x16x32_bf16 v[144:147], a[236:239], a[172:175], v[144:147]
s_sub_u32 s80, s80, 466944
v_mul_u32_u24 v52, 14, v1
v_mfma_f32_16x16x32_bf16 v[144:147], a[232:235], a[168:171], v[144:147]
v_add_lshl_u32 v52, v52, v0, 7
v_add_u32 v53, 2, v0
v_mfma_f32_16x16x32_bf16 v[160:163], a[232:235], a[176:179], v[160:163]
s_movk_i32 s48, 16384
s_add_u32 m0, s40, 16384
s_movk_i32 s49, 0
v_mfma_f32_16x16x32_bf16 v[160:163], a[236:239], a[180:183], v[160:163]
buffer_load_dwordx4 v16, s[8:11], s48 offen lds
v_mfma_f32_16x16x32_bf16 v[176:179], a[236:239], a[188:191], v[176:179]
v_lshrrev_b32 v53, 4, v53
v_lshl_add_u32 v52, v53, 26, v52
v_mfma_f32_16x16x32_bf16 v[176:179], a[232:235], a[184:187], v[176:179]
s_waitcnt lgkmcnt(4)
v_mfma_f32_16x16x32_bf16 v[240:243], a[240:243], a[184:187], v[240:243]
ds_read_b64_tr_b16 a[232:233], v25 offset:49160
ds_read_b64_tr_b16 a[234:235], v25 offset:50184
v_mfma_f32_16x16x32_bf16 v[240:243], a[244:247], a[188:191], v[240:243]
ds_read_b64_tr_b16 a[236:237], v25 offset:57352
ds_read_b64_tr_b16 a[238:239], v25 offset:58376
v_mfma_f32_16x16x32_bf16 v[224:227], a[244:247], a[180:183], v[224:227]
v_add_u32 v43, s80, v52
s_lshl_b32 s80, s77, 18
v_mfma_f32_16x16x32_bf16 v[224:227], a[240:243], a[176:179], v[224:227]
v_add_u32 v52, s80, v42
s_and_b32 s64, s76, 0
v_mfma_f32_16x16x32_bf16 v[208:211], a[240:243], a[168:171], v[208:211]
s_xor_b32 s64, s64, s75
s_lshl_b32 s64, s64, 10
v_mfma_f32_16x16x32_bf16 v[208:211], a[244:247], a[172:175], v[208:211]
buffer_load_dwordx4 v17, s[8:11], s48 offen offset:1024 lds
v_mfma_f32_16x16x32_bf16 v[192:195], a[244:247], a[164:167], v[192:195]
s_xor_b32 s65, s64, 1024
s_xor_b32 s66, s64, 2048
v_mfma_f32_16x16x32_bf16 v[192:195], a[240:243], a[160:163], v[192:195]
s_waitcnt lgkmcnt(4)
v_mfma_f32_16x16x32_bf16 v[132:135], a[224:227], a[160:163], v[132:135]
ds_read_b64_tr_b16 a[240:241], v26 offset:49152
ds_read_b64_tr_b16 a[242:243], v26 offset:50176
v_mfma_f32_16x16x32_bf16 v[132:135], a[228:231], a[164:167], v[132:135]
ds_read_b64_tr_b16 a[244:245], v26 offset:57344
ds_read_b64_tr_b16 a[246:247], v26 offset:58368
v_mfma_f32_16x16x32_bf16 v[148:151], a[228:231], a[172:175], v[148:151]
s_xor_b32 s67, s64, 3072
v_mfma_f32_16x16x32_bf16 v[148:151], a[224:227], a[168:171], v[148:151]
v_mov_b32 v60, s87
buffer_store_dword v60, v52, s[88:91], 0 offen sc1
v_mfma_f32_16x16x32_bf16 v[164:167], a[224:227], a[176:179], v[164:167]
v_accvgpr_write_b32 a128, 0
v_accvgpr_write_b32 a129, 0
v_mfma_f32_16x16x32_bf16 v[164:167], a[228:231], a[180:183], v[164:167]
buffer_load_dwordx4 v18, s[8:11], s48 offen offset:2048 lds
v_mfma_f32_16x16x32_bf16 v[180:183], a[228:231], a[188:191], v[180:183]
v_accvgpr_write_b32 a130, 0
v_accvgpr_write_b32 a131, 0
v_mfma_f32_16x16x32_bf16 v[180:183], a[224:227], a[184:187], v[180:183]
s_waitcnt lgkmcnt(4)
v_mfma_f32_16x16x32_bf16 v[244:247], a[232:235], a[184:187], v[244:247]
ds_read_b64_tr_b16 a[224:225], v26 offset:49160
ds_read_b64_tr_b16 a[226:227], v26 offset:50184
v_mfma_f32_16x16x32_bf16 v[244:247], a[236:239], a[188:191], v[244:247]
ds_read_b64_tr_b16 a[228:229], v26 offset:57352
ds_read_b64_tr_b16 a[230:231], v26 offset:58376
v_mfma_f32_16x16x32_bf16 v[228:231], a[236:239], a[180:183], v[228:231]
v_accvgpr_write_b32 a132, 0
v_accvgpr_write_b32 a133, 0
v_mfma_f32_16x16x32_bf16 v[228:231], a[232:235], a[176:179], v[228:231]
v_accvgpr_write_b32 a134, 0
v_accvgpr_write_b32 a135, 0
v_mfma_f32_16x16x32_bf16 v[212:215], a[232:235], a[168:171], v[212:215]
v_accvgpr_write_b32 a136, 0
v_accvgpr_write_b32 a137, 0
v_mfma_f32_16x16x32_bf16 v[212:215], a[236:239], a[172:175], v[212:215]
buffer_load_dwordx4 v19, s[8:11], s48 offen offset:3072 lds
v_mfma_f32_16x16x32_bf16 v[196:199], a[236:239], a[164:167], v[196:199]
v_accvgpr_write_b32 a138, 0
v_accvgpr_write_b32 a139, 0
v_mfma_f32_16x16x32_bf16 v[196:199], a[232:235], a[160:163], v[196:199]
s_waitcnt lgkmcnt(4)
v_mfma_f32_16x16x32_bf16 v[136:139], a[240:243], a[160:163], v[136:139]
ds_read_b64_tr_b16 a[232:233], v27 offset:49152
ds_read_b64_tr_b16 a[234:235], v27 offset:50176
v_mfma_f32_16x16x32_bf16 v[136:139], a[244:247], a[164:167], v[136:139]
ds_read_b64_tr_b16 a[236:237], v27 offset:57344
ds_read_b64_tr_b16 a[238:239], v27 offset:58368
v_mfma_f32_16x16x32_bf16 v[152:155], a[244:247], a[172:175], v[152:155]
v_accvgpr_write_b32 a140, 0
v_accvgpr_write_b32 a141, 0
v_mfma_f32_16x16x32_bf16 v[152:155], a[240:243], a[168:171], v[152:155]
v_accvgpr_write_b32 a142, 0
v_accvgpr_write_b32 a143, 0
v_mfma_f32_16x16x32_bf16 v[168:171], a[240:243], a[176:179], v[168:171]
s_add_u32 m0, s42, 16384
v_mfma_f32_16x16x32_bf16 v[168:171], a[244:247], a[180:183], v[168:171]
buffer_load_dwordx4 v20, s[12:15], 0 offen lds
v_mfma_f32_16x16x32_bf16 v[184:187], a[244:247], a[188:191], v[184:187]
v_mul_f32 v128, s46, v128
v_mul_f32 v129, s46, v129
v_mfma_f32_16x16x32_bf16 v[184:187], a[240:243], a[184:187], v[184:187]
s_waitcnt lgkmcnt(4)
v_mfma_f32_16x16x32_bf16 v[248:251], a[224:227], a[184:187], v[248:251]
ds_read_b64_tr_b16 a[240:241], v27 offset:49160
ds_read_b64_tr_b16 a[242:243], v27 offset:50184
v_mfma_f32_16x16x32_bf16 v[248:251], a[228:231], a[188:191], v[248:251]
ds_read_b64_tr_b16 a[244:245], v27 offset:57352
ds_read_b64_tr_b16 a[246:247], v27 offset:58376
v_mfma_f32_16x16x32_bf16 v[232:235], a[228:231], a[180:183], v[232:235]
v_mul_f32 v130, s46, v130
v_mul_f32 v131, s46, v131
v_mfma_f32_16x16x32_bf16 v[232:235], a[224:227], a[176:179], v[232:235]
v_cvt_pk_bf16_f32 v128, v128, v129
v_cvt_pk_bf16_f32 v129, v130, v131
v_mfma_f32_16x16x32_bf16 v[216:219], a[224:227], a[168:171], v[216:219]
v_mul_f32 v144, s46, v144
v_mul_f32 v145, s46, v145
v_mfma_f32_16x16x32_bf16 v[216:219], a[228:231], a[172:175], v[216:219]
buffer_load_dwordx4 v21, s[12:15], 0 offen offset:1024 lds
v_mfma_f32_16x16x32_bf16 v[200:203], a[228:231], a[164:167], v[200:203]
v_mul_f32 v146, s46, v146
v_mul_f32 v147, s46, v147
v_mfma_f32_16x16x32_bf16 v[200:203], a[224:227], a[160:163], v[200:203]
s_waitcnt lgkmcnt(4)
v_mfma_f32_16x16x32_bf16 v[140:143], a[232:235], a[160:163], v[140:143]
ds_read_b64_tr_b16 a[224:225], v28 offset:49152
ds_read_b64_tr_b16 a[226:227], v28 offset:49664
v_mfma_f32_16x16x32_bf16 v[140:143], a[236:239], a[164:167], v[140:143]
ds_read_b64_tr_b16 a[228:229], v28 offset:53248
ds_read_b64_tr_b16 a[230:231], v28 offset:53760
v_mfma_f32_16x16x32_bf16 v[156:159], a[236:239], a[172:175], v[156:159]
v_cvt_pk_bf16_f32 v144, v144, v145
v_cvt_pk_bf16_f32 v145, v146, v147
v_mfma_f32_16x16x32_bf16 v[156:159], a[232:235], a[168:171], v[156:159]
v_mul_f32 v160, s46, v160
v_mul_f32 v161, s46, v161
v_mfma_f32_16x16x32_bf16 v[172:175], a[232:235], a[176:179], v[172:175]
v_mul_f32 v162, s46, v162
v_mul_f32 v163, s46, v163
v_mfma_f32_16x16x32_bf16 v[172:175], a[236:239], a[180:183], v[172:175]
buffer_load_dwordx4 v20, s[12:15], 0 offen offset:2048 lds
v_mfma_f32_16x16x32_bf16 v[188:191], a[236:239], a[188:191], v[188:191]
v_cvt_pk_bf16_f32 v160, v160, v161
v_cvt_pk_bf16_f32 v161, v162, v163
v_mfma_f32_16x16x32_bf16 v[188:191], a[232:235], a[184:187], v[188:191]
s_waitcnt lgkmcnt(4)
v_mfma_f32_16x16x32_bf16 v[252:255], a[240:243], a[184:187], v[252:255]
ds_read_b64_tr_b16 a[232:233], v29 offset:49152
ds_read_b64_tr_b16 a[234:235], v29 offset:49664
v_mfma_f32_16x16x32_bf16 v[252:255], a[244:247], a[188:191], v[252:255]
ds_read_b64_tr_b16 a[236:237], v29 offset:53248
ds_read_b64_tr_b16 a[238:239], v29 offset:53760
v_mfma_f32_16x16x32_bf16 v[236:239], a[244:247], a[180:183], v[236:239]
v_mul_f32 v176, s46, v176
v_mul_f32 v177, s46, v177
v_mfma_f32_16x16x32_bf16 v[236:239], a[240:243], a[176:179], v[236:239]
v_mul_f32 v178, s46, v178
v_mul_f32 v179, s46, v179
v_mfma_f32_16x16x32_bf16 v[220:223], a[240:243], a[168:171], v[220:223]
v_cvt_pk_bf16_f32 v176, v176, v177
v_cvt_pk_bf16_f32 v177, v178, v179
v_mfma_f32_16x16x32_bf16 v[220:223], a[244:247], a[172:175], v[220:223]
buffer_load_dwordx4 v21, s[12:15], 0 offen offset:3072 lds
v_mfma_f32_16x16x32_bf16 v[204:207], a[244:247], a[164:167], v[204:207]
v_mul_f32 v192, s46, v192
v_mul_f32 v193, s46, v193
v_mfma_f32_16x16x32_bf16 v[204:207], a[240:243], a[160:163], v[204:207]
s_waitcnt lgkmcnt(4)
v_mfma_f32_16x16x32_bf16 v[64:67], a[224:227], a[160:163], v[64:67]
ds_read_b64_tr_b16 a[240:241], v30 offset:49152
ds_read_b64_tr_b16 a[242:243], v30 offset:49664
v_mfma_f32_16x16x32_bf16 v[64:67], a[228:231], a[164:167], v[64:67]
ds_read_b64_tr_b16 a[244:245], v30 offset:53248
ds_read_b64_tr_b16 a[246:247], v30 offset:53760
v_mfma_f32_16x16x32_bf16 v[80:83], a[228:231], a[172:175], v[80:83]
v_mul_f32 v194, s46, v194
v_mul_f32 v195, s46, v195
v_mfma_f32_16x16x32_bf16 v[80:83], a[224:227], a[168:171], v[80:83]
v_cvt_pk_bf16_f32 v130, v192, v193
v_cvt_pk_bf16_f32 v131, v194, v195
v_mfma_f32_16x16x32_bf16 v[96:99], a[224:227], a[176:179], v[96:99]
v_mul_f32 v208, s46, v208
v_mul_f32 v209, s46, v209
v_mfma_f32_16x16x32_bf16 v[96:99], a[228:231], a[180:183], v[96:99]
v_mul_f32 v210, s46, v210
v_mul_f32 v211, s46, v211
v_mfma_f32_16x16x32_bf16 v[112:115], a[228:231], a[188:191], v[112:115]
v_cvt_pk_bf16_f32 v146, v208, v209
v_cvt_pk_bf16_f32 v147, v210, v211
v_mfma_f32_16x16x32_bf16 v[112:115], a[224:227], a[184:187], v[112:115]
s_waitcnt lgkmcnt(4)
v_mfma_f32_16x16x32_bf16 v[116:119], a[232:235], a[184:187], v[116:119]
ds_read_b64_tr_b16 a[224:225], v31 offset:49152
ds_read_b64_tr_b16 a[226:227], v31 offset:49664
v_mfma_f32_16x16x32_bf16 v[116:119], a[236:239], a[188:191], v[116:119]
ds_read_b64_tr_b16 a[228:229], v31 offset:53248
ds_read_b64_tr_b16 a[230:231], v31 offset:53760
v_mfma_f32_16x16x32_bf16 v[100:103], a[236:239], a[180:183], v[100:103]
v_mul_f32 v224, s46, v224
v_mul_f32 v225, s46, v225
v_mfma_f32_16x16x32_bf16 v[100:103], a[232:235], a[176:179], v[100:103]
v_mul_f32 v226, s46, v226
v_mul_f32 v227, s46, v227
v_mfma_f32_16x16x32_bf16 v[84:87], a[232:235], a[168:171], v[84:87]
v_cvt_pk_bf16_f32 v162, v224, v225
v_cvt_pk_bf16_f32 v163, v226, v227
v_mfma_f32_16x16x32_bf16 v[84:87], a[236:239], a[172:175], v[84:87]
v_mul_f32 v240, s46, v240
v_mul_f32 v241, s46, v241
v_mfma_f32_16x16x32_bf16 v[68:71], a[236:239], a[164:167], v[68:71]
v_mul_f32 v242, s46, v242
v_mul_f32 v243, s46, v243
v_mfma_f32_16x16x32_bf16 v[68:71], a[232:235], a[160:163], v[68:71]
s_waitcnt lgkmcnt(4)
v_mfma_f32_16x16x32_bf16 v[72:75], a[240:243], a[160:163], v[72:75]
ds_read_b64_tr_b16 a[232:233], v28 offset:57344
ds_read_b64_tr_b16 a[234:235], v28 offset:57856
v_mfma_f32_16x16x32_bf16 v[72:75], a[244:247], a[164:167], v[72:75]
ds_read_b64_tr_b16 a[236:237], v28 offset:61440
ds_read_b64_tr_b16 a[238:239], v28 offset:61952
v_mfma_f32_16x16x32_bf16 v[88:91], a[244:247], a[172:175], v[88:91]
v_cvt_pk_bf16_f32 v178, v240, v241
v_cvt_pk_bf16_f32 v179, v242, v243
v_mfma_f32_16x16x32_bf16 v[88:91], a[240:243], a[168:171], v[88:91]
v_mul_f32 v132, s46, v132
v_mul_f32 v133, s46, v133
v_mfma_f32_16x16x32_bf16 v[104:107], a[240:243], a[176:179], v[104:107]
v_mul_f32 v134, s46, v134
v_mul_f32 v135, s46, v135
v_mfma_f32_16x16x32_bf16 v[104:107], a[244:247], a[180:183], v[104:107]
v_cvt_pk_bf16_f32 v132, v132, v133
v_cvt_pk_bf16_f32 v133, v134, v135
v_mfma_f32_16x16x32_bf16 v[120:123], a[244:247], a[188:191], v[120:123]
v_mul_f32 v148, s46, v148
v_mul_f32 v149, s46, v149
v_mfma_f32_16x16x32_bf16 v[120:123], a[240:243], a[184:187], v[120:123]
s_waitcnt lgkmcnt(4)
v_mfma_f32_16x16x32_bf16 v[124:127], a[224:227], a[184:187], v[124:127]
ds_read_b64_tr_b16 a[240:241], v29 offset:57344
ds_read_b64_tr_b16 a[242:243], v29 offset:57856
v_mfma_f32_16x16x32_bf16 v[124:127], a[228:231], a[188:191], v[124:127]
ds_read_b64_tr_b16 a[244:245], v29 offset:61440
ds_read_b64_tr_b16 a[246:247], v29 offset:61952
v_mfma_f32_16x16x32_bf16 v[108:111], a[228:231], a[180:183], v[108:111]
v_mul_f32 v150, s46, v150
v_mul_f32 v151, s46, v151
v_mfma_f32_16x16x32_bf16 v[108:111], a[224:227], a[176:179], v[108:111]
v_cvt_pk_bf16_f32 v148, v148, v149
L_pad19:
s_cbranch_execz L_walked0
v_cvt_pk_bf16_f32 v149, v150, v151
v_mfma_f32_16x16x32_bf16 v[92:95], a[224:227], a[168:171], v[92:95]
v_mul_f32 v164, s46, v164
v_mul_f32 v165, s46, v165
v_mfma_f32_16x16x32_bf16 v[92:95], a[228:231], a[172:175], v[92:95]
v_mul_f32 v166, s46, v166
v_mul_f32 v167, s46, v167
v_mfma_f32_16x16x32_bf16 v[76:79], a[228:231], a[164:167], v[76:79]
v_cvt_pk_bf16_f32 v164, v164, v165
v_cvt_pk_bf16_f32 v165, v166, v167
v_mfma_f32_16x16x32_bf16 v[76:79], a[224:227], a[160:163], v[76:79]
s_waitcnt lgkmcnt(4)
v_mfma_f32_16x16x32_bf16 a[0:3], a[232:235], a[160:163], a[0:3]
ds_read_b64_tr_b16 a[224:225], v30 offset:57344
ds_read_b64_tr_b16 a[226:227], v30 offset:57856
v_mfma_f32_16x16x32_bf16 a[0:3], a[236:239], a[164:167], a[0:3]
ds_read_b64_tr_b16 a[228:229], v30 offset:61440
ds_read_b64_tr_b16 a[230:231], v30 offset:61952
v_mfma_f32_16x16x32_bf16 a[16:19], a[236:239], a[172:175], a[16:19]
v_mul_f32 v180, s46, v180
v_mul_f32 v181, s46, v181
v_mfma_f32_16x16x32_bf16 a[16:19], a[232:235], a[168:171], a[16:19]
v_mul_f32 v182, s46, v182
v_mul_f32 v183, s46, v183
v_mfma_f32_16x16x32_bf16 a[32:35], a[232:235], a[176:179], a[32:35]
v_cvt_pk_bf16_f32 v180, v180, v181
v_cvt_pk_bf16_f32 v181, v182, v183
v_mfma_f32_16x16x32_bf16 a[32:35], a[236:239], a[180:183], a[32:35]
v_mul_f32 v196, s46, v196
v_mul_f32 v197, s46, v197
v_mfma_f32_16x16x32_bf16 a[48:51], a[236:239], a[188:191], a[48:51]
v_mul_f32 v198, s46, v198
v_mul_f32 v199, s46, v199
v_mfma_f32_16x16x32_bf16 a[48:51], a[232:235], a[184:187], a[48:51]
s_waitcnt lgkmcnt(4)
v_mfma_f32_16x16x32_bf16 a[52:55], a[240:243], a[184:187], a[52:55]
ds_read_b64_tr_b16 a[232:233], v31 offset:57344
ds_read_b64_tr_b16 a[234:235], v31 offset:57856
v_mfma_f32_16x16x32_bf16 a[52:55], a[244:247], a[188:191], a[52:55]
ds_read_b64_tr_b16 a[236:237], v31 offset:61440
ds_read_b64_tr_b16 a[238:239], v31 offset:61952
v_mfma_f32_16x16x32_bf16 a[36:39], a[244:247], a[180:183], a[36:39]
v_cvt_pk_bf16_f32 v134, v196, v197
v_cvt_pk_bf16_f32 v135, v198, v199
v_mfma_f32_16x16x32_bf16 a[36:39], a[240:243], a[176:179], a[36:39]
v_mul_f32 v212, s46, v212
v_mul_f32 v213, s46, v213
v_mfma_f32_16x16x32_bf16 a[20:23], a[240:243], a[168:171], a[20:23]
v_mul_f32 v214, s46, v214
v_mul_f32 v215, s46, v215
v_mfma_f32_16x16x32_bf16 a[20:23], a[244:247], a[172:175], a[20:23]
v_cvt_pk_bf16_f32 v150, v212, v213
v_cvt_pk_bf16_f32 v151, v214, v215
v_mfma_f32_16x16x32_bf16 a[4:7], a[244:247], a[164:167], a[4:7]
v_mul_f32 v228, s46, v228
v_mul_f32 v229, s46, v229
v_mfma_f32_16x16x32_bf16 a[4:7], a[240:243], a[160:163], a[4:7]
s_waitcnt lgkmcnt(4)
v_mfma_f32_16x16x32_bf16 a[8:11], a[224:227], a[160:163], a[8:11]
v_mul_f32 v230, s46, v230
v_mul_f32 v231, s46, v231
v_mfma_f32_16x16x32_bf16 a[8:11], a[228:231], a[164:167], a[8:11]
v_cvt_pk_bf16_f32 v166, v228, v229
v_cvt_pk_bf16_f32 v167, v230, v231
v_mfma_f32_16x16x32_bf16 a[24:27], a[228:231], a[172:175], a[24:27]
v_mul_f32 v244, s46, v244
v_mul_f32 v245, s46, v245
v_mfma_f32_16x16x32_bf16 a[24:27], a[224:227], a[168:171], a[24:27]
v_mul_f32 v246, s46, v246
v_mul_f32 v247, s46, v247
v_mfma_f32_16x16x32_bf16 a[40:43], a[224:227], a[176:179], a[40:43]
v_cvt_pk_bf16_f32 v182, v244, v245
v_cvt_pk_bf16_f32 v183, v246, v247
v_mfma_f32_16x16x32_bf16 a[40:43], a[228:231], a[180:183], a[40:43]
v_mul_f32 v136, s46, v136
v_mul_f32 v137, s46, v137
v_mfma_f32_16x16x32_bf16 a[56:59], a[228:231], a[188:191], a[56:59]
v_mul_f32 v138, s46, v138
v_mul_f32 v139, s46, v139
v_mfma_f32_16x16x32_bf16 a[56:59], a[224:227], a[184:187], a[56:59]
s_waitcnt lgkmcnt(0)
v_mfma_f32_16x16x32_bf16 a[60:63], a[232:235], a[184:187], a[60:63]
v_cvt_pk_bf16_f32 v136, v136, v137
v_cvt_pk_bf16_f32 v137, v138, v139
v_mfma_f32_16x16x32_bf16 a[60:63], a[236:239], a[188:191], a[60:63]
v_mul_f32 v152, s46, v152
v_mul_f32 v153, s46, v153
v_mfma_f32_16x16x32_bf16 a[44:47], a[236:239], a[180:183], a[44:47]
v_mul_f32 v154, s46, v154
v_mul_f32 v155, s46, v155
v_mfma_f32_16x16x32_bf16 a[44:47], a[232:235], a[176:179], a[44:47]
v_cvt_pk_bf16_f32 v152, v152, v153
v_cvt_pk_bf16_f32 v153, v154, v155
v_mfma_f32_16x16x32_bf16 a[28:31], a[232:235], a[168:171], a[28:31]
v_mul_f32 v168, s46, v168
v_mul_f32 v169, s46, v169
v_mfma_f32_16x16x32_bf16 a[28:31], a[236:239], a[172:175], a[28:31]
v_mul_f32 v170, s46, v170
v_mul_f32 v171, s46, v171
v_mfma_f32_16x16x32_bf16 a[12:15], a[236:239], a[164:167], a[12:15]
v_cvt_pk_bf16_f32 v168, v168, v169
v_cvt_pk_bf16_f32 v169, v170, v171
v_mfma_f32_16x16x32_bf16 a[12:15], a[232:235], a[160:163], a[12:15]
s_waitcnt vmcnt(16)
s_barrier
ds_read_b128 a[144:147], v4
ds_read_b128 a[148:151], v5
ds_read_b128 a[152:155], v6
ds_read_b128 a[156:159], v7
s_add_u32 m0, s40, 32768
s_add_u32 s48, s48, 16384
buffer_load_dwordx4 v16, s[8:11], s48 offen lds
buffer_load_dwordx4 v17, s[8:11], s48 offen offset:1024 lds
buffer_load_dwordx4 v18, s[8:11], s48 offen offset:2048 lds
buffer_load_dwordx4 v19, s[8:11], s48 offen offset:3072 lds
s_add_u32 m0, s42, 32768
s_add_u32 s49, s49, 16384
buffer_load_dwordx4 v20, s[12:15], s49 offen lds
buffer_load_dwordx4 v21, s[12:15], s49 offen offset:1024 lds
buffer_load_dwordx4 v20, s[12:15], s49 offen offset:2048 lds
buffer_load_dwordx4 v21, s[12:15], s49 offen offset:3072 lds
v_mul_f32 v184, s46, v184
v_mul_f32 v185, s46, v185
v_mul_f32 v186, s46, v186
v_mul_f32 v187, s46, v187
v_cvt_pk_bf16_f32 v184, v184, v185
v_cvt_pk_bf16_f32 v185, v186, v187
v_pk_mul_f32 v[200:201], v[200:201], s[46:47]
v_pk_mul_f32 v[202:203], v[202:203], s[46:47]
v_pk_mul_f32 v[216:217], v[216:217], s[46:47]
v_pk_mul_f32 v[218:219], v[218:219], s[46:47]
v_pk_mul_f32 v[232:233], v[232:233], s[46:47]
v_pk_mul_f32 v[234:235], v[234:235], s[46:47]
v_pk_mul_f32 v[248:249], v[248:249], s[46:47]
v_pk_mul_f32 v[250:251], v[250:251], s[46:47]
v_cvt_pk_bf16_f32 v138, v200, v201
v_cvt_pk_bf16_f32 v139, v202, v203
v_cvt_pk_bf16_f32 v154, v216, v217
v_cvt_pk_bf16_f32 v155, v218, v219
v_cvt_pk_bf16_f32 v170, v232, v233
v_cvt_pk_bf16_f32 v171, v234, v235
v_cvt_pk_bf16_f32 v186, v248, v249
v_cvt_pk_bf16_f32 v187, v250, v251
v_pk_mul_f32 v[140:141], v[140:141], s[46:47]
v_pk_mul_f32 v[142:143], v[142:143], s[46:47]
v_pk_mul_f32 v[156:157], v[156:157], s[46:47]
v_pk_mul_f32 v[158:159], v[158:159], s[46:47]
v_pk_mul_f32 v[172:173], v[172:173], s[46:47]
v_pk_mul_f32 v[174:175], v[174:175], s[46:47]
v_pk_mul_f32 v[188:189], v[188:189], s[46:47]
v_pk_mul_f32 v[190:191], v[190:191], s[46:47]
v_cvt_pk_bf16_f32 v140, v140, v141
v_cvt_pk_bf16_f32 v141, v142, v143
v_cvt_pk_bf16_f32 v156, v156, v157
v_cvt_pk_bf16_f32 v157, v158, v159
v_cvt_pk_bf16_f32 v172, v172, v173
v_cvt_pk_bf16_f32 v173, v174, v175
v_cvt_pk_bf16_f32 v188, v188, v189
v_cvt_pk_bf16_f32 v189, v190, v191
v_pk_mul_f32 v[204:205], v[204:205], s[46:47]
v_pk_mul_f32 v[206:207], v[206:207], s[46:47]
v_pk_mul_f32 v[220:221], v[220:221], s[46:47]
v_pk_mul_f32 v[222:223], v[222:223], s[46:47]
v_pk_mul_f32 v[236:237], v[236:237], s[46:47]
v_pk_mul_f32 v[238:239], v[238:239], s[46:47]
v_pk_mul_f32 v[252:253], v[252:253], s[46:47]
v_pk_mul_f32 v[254:255], v[254:255], s[46:47]
v_cvt_pk_bf16_f32 v142, v204, v205
v_cvt_pk_bf16_f32 v143, v206, v207
v_cvt_pk_bf16_f32 v158, v220, v221
v_cvt_pk_bf16_f32 v159, v222, v223
v_cvt_pk_bf16_f32 v174, v236, v237
v_cvt_pk_bf16_f32 v175, v238, v239
v_cvt_pk_bf16_f32 v190, v252, v253
v_cvt_pk_bf16_f32 v191, v254, v255
s_mov_b32 s46, 0xbfb8aa3b
s_mov_b32 s47, 0xbfb8aa3b
s_waitcnt lgkmcnt(0)
v_mfma_f32_16x16x32_bf16 v[192:195], a[144:147], v[128:131], 0
v_accvgpr_read_b32 v208, a0
v_accvgpr_read_b32 v209, a1
v_mfma_f32_16x16x32_bf16 v[192:195], a[148:151], v[132:135], v[192:195]
v_accvgpr_read_b32 v210, a2
v_accvgpr_read_b32 v211, a3
v_mfma_f32_16x16x32_bf16 v[192:195], a[152:155], v[136:139], v[192:195]
v_accvgpr_read_b32 v212, a4
v_accvgpr_read_b32 v213, a5
v_mfma_f32_16x16x32_bf16 v[192:195], a[156:159], v[140:143], v[192:195]
v_accvgpr_read_b32 v214, a6
v_accvgpr_read_b32 v215, a7
v_mfma_f32_16x16x32_bf16 v[196:199], a[144:147], v[144:147], 0
v_accvgpr_read_b32 v216, a8
v_accvgpr_read_b32 v217, a9
v_mfma_f32_16x16x32_bf16 v[196:199], a[148:151], v[148:151], v[196:199]
v_accvgpr_read_b32 v218, a10
v_accvgpr_read_b32 v219, a11
v_mfma_f32_16x16x32_bf16 v[196:199], a[152:155], v[152:155], v[196:199]
v_accvgpr_read_b32 v220, a12
v_accvgpr_read_b32 v221, a13
v_mfma_f32_16x16x32_bf16 v[196:199], a[156:159], v[156:159], v[196:199]
v_accvgpr_read_b32 v222, a14
v_accvgpr_read_b32 v223, a15
v_mfma_f32_16x16x32_bf16 v[200:203], a[144:147], v[160:163], 0
v_accvgpr_read_b32 v224, a16
v_accvgpr_read_b32 v225, a17
v_mfma_f32_16x16x32_bf16 v[200:203], a[148:151], v[164:167], v[200:203]
v_accvgpr_read_b32 v226, a18
v_accvgpr_read_b32 v227, a19
v_mfma_f32_16x16x32_bf16 v[200:203], a[152:155], v[168:171], v[200:203]
v_accvgpr_read_b32 v228, a20
v_accvgpr_read_b32 v229, a21
v_mfma_f32_16x16x32_bf16 v[200:203], a[156:159], v[172:175], v[200:203]
v_accvgpr_read_b32 v230, a22
v_accvgpr_read_b32 v231, a23
v_mfma_f32_16x16x32_bf16 v[204:207], a[144:147], v[176:179], 0
v_accvgpr_read_b32 v232, a24
v_accvgpr_read_b32 v233, a25
v_mfma_f32_16x16x32_bf16 v[204:207], a[148:151], v[180:183], v[204:207]
v_accvgpr_read_b32 v234, a26
v_accvgpr_read_b32 v235, a27
v_mfma_f32_16x16x32_bf16 v[204:207], a[152:155], v[184:187], v[204:207]
v_accvgpr_read_b32 v236, a28
v_accvgpr_read_b32 v237, a29
v_mfma_f32_16x16x32_bf16 v[204:207], a[156:159], v[188:191], v[204:207]
v_accvgpr_read_b32 v238, a30
v_accvgpr_read_b32 v239, a31
s_lshl_b32 s80, s75, 11
v_pk_mul_f32 v[240:241], v[64:65], s[46:47]
v_pk_mul_f32 v[242:243], v[66:67], s[46:47]
v_pk_mul_f32 v[244:245], v[68:69], s[46:47]
v_pk_mul_f32 v[246:247], v[70:71], s[46:47]
v_pk_mul_f32 v[248:249], v[72:73], s[46:47]
v_pk_mul_f32 v[250:251], v[74:75], s[46:47]
v_pk_mul_f32 v[252:253], v[76:77], s[46:47]
v_pk_mul_f32 v[254:255], v[78:79], s[46:47]
v_exp_f32 v240, v240
v_exp_f32 v241, v241
v_exp_f32 v242, v242
v_exp_f32 v243, v243
v_exp_f32 v244, v244
v_exp_f32 v245, v245
v_exp_f32 v246, v246
v_exp_f32 v247, v247
v_exp_f32 v248, v248
v_exp_f32 v249, v249
v_exp_f32 v250, v250
v_exp_f32 v251, v251
v_exp_f32 v252, v252
v_exp_f32 v253, v253
v_exp_f32 v254, v254
v_exp_f32 v255, v255
v_pk_mul_f32 v[64:65], v[64:65], v[208:209]
v_pk_mul_f32 v[66:67], v[66:67], v[210:211]
v_pk_mul_f32 v[68:69], v[68:69], v[212:213]
v_pk_mul_f32 v[70:71], v[70:71], v[214:215]
v_pk_mul_f32 v[72:73], v[72:73], v[216:217]
v_pk_mul_f32 v[74:75], v[74:75], v[218:219]
v_pk_mul_f32 v[76:77], v[76:77], v[220:221]
v_pk_mul_f32 v[78:79], v[78:79], v[222:223]
v_pk_add_f32 v[240:241], v[240:241], 1.0 op_sel_hi:[1,0]
v_pk_add_f32 v[242:243], v[242:243], 1.0 op_sel_hi:[1,0]
v_pk_add_f32 v[244:245], v[244:245], 1.0 op_sel_hi:[1,0]
v_pk_add_f32 v[246:247], v[246:247], 1.0 op_sel_hi:[1,0]
v_pk_add_f32 v[248:249], v[248:249], 1.0 op_sel_hi:[1,0]
v_pk_add_f32 v[250:251], v[250:251], 1.0 op_sel_hi:[1,0]
v_pk_add_f32 v[252:253], v[252:253], 1.0 op_sel_hi:[1,0]
v_pk_add_f32 v[254:255], v[254:255], 1.0 op_sel_hi:[1,0]
v_rcp_f32 v240, v240
v_rcp_f32 v241, v241
v_rcp_f32 v242, v242
v_rcp_f32 v243, v243
v_rcp_f32 v244, v244
v_rcp_f32 v245, v245
v_rcp_f32 v246, v246
v_rcp_f32 v247, v247
v_rcp_f32 v248, v248
v_rcp_f32 v249, v249
v_rcp_f32 v250, v250
v_rcp_f32 v251, v251
v_rcp_f32 v252, v252
v_rcp_f32 v253, v253
v_rcp_f32 v254, v254
v_rcp_f32 v255, v255
v_pk_mul_f32 v[64:65], v[64:65], v[240:241]
v_pk_mul_f32 v[66:67], v[66:67], v[242:243]
v_pk_mul_f32 v[68:69], v[68:69], v[244:245]
v_pk_mul_f32 v[70:71], v[70:71], v[246:247]
v_pk_mul_f32 v[72:73], v[72:73], v[248:249]
v_pk_mul_f32 v[74:75], v[74:75], v[250:251]
v_pk_mul_f32 v[76:77], v[76:77], v[252:253]
v_pk_mul_f32 v[78:79], v[78:79], v[254:255]
v_cvt_pk_bf16_f32 v24, v64, v65
v_cvt_pk_bf16_f32 v25, v66, v67
v_cvt_pk_bf16_f32 v26, v68, v69
v_cvt_pk_bf16_f32 v27, v70, v71
v_cvt_pk_bf16_f32 v68, v72, v73
v_cvt_pk_bf16_f32 v69, v74, v75
v_cvt_pk_bf16_f32 v70, v76, v77
v_cvt_pk_bf16_f32 v71, v78, v79
buffer_store_dwordx4 v[24:27], v44, s[32:35], s80 offen sc1
buffer_store_dwordx4 v[68:71], v44, s[32:35], s80 offen offset:1024 sc1
v_pk_mul_f32 v[240:241], v[80:81], s[46:47]
v_pk_mul_f32 v[242:243], v[82:83], s[46:47]
v_pk_mul_f32 v[244:245], v[84:85], s[46:47]
v_pk_mul_f32 v[246:247], v[86:87], s[46:47]
v_pk_mul_f32 v[248:249], v[88:89], s[46:47]
v_pk_mul_f32 v[250:251], v[90:91], s[46:47]
v_pk_mul_f32 v[252:253], v[92:93], s[46:47]
v_pk_mul_f32 v[254:255], v[94:95], s[46:47]
v_exp_f32 v240, v240
v_exp_f32 v241, v241
v_exp_f32 v242, v242
v_exp_f32 v243, v243
v_exp_f32 v244, v244
v_exp_f32 v245, v245
v_exp_f32 v246, v246
v_exp_f32 v247, v247
v_exp_f32 v248, v248
v_exp_f32 v249, v249
v_exp_f32 v250, v250
v_exp_f32 v251, v251
v_exp_f32 v252, v252
v_exp_f32 v253, v253
v_exp_f32 v254, v254
v_exp_f32 v255, v255
v_pk_mul_f32 v[80:81], v[80:81], v[224:225]
v_pk_mul_f32 v[82:83], v[82:83], v[226:227]
v_pk_mul_f32 v[84:85], v[84:85], v[228:229]
v_pk_mul_f32 v[86:87], v[86:87], v[230:231]
v_pk_mul_f32 v[88:89], v[88:89], v[232:233]
v_pk_mul_f32 v[90:91], v[90:91], v[234:235]
v_pk_mul_f32 v[92:93], v[92:93], v[236:237]
v_pk_mul_f32 v[94:95], v[94:95], v[238:239]
v_pk_add_f32 v[240:241], v[240:241], 1.0 op_sel_hi:[1,0]
v_pk_add_f32 v[242:243], v[242:243], 1.0 op_sel_hi:[1,0]
v_pk_add_f32 v[244:245], v[244:245], 1.0 op_sel_hi:[1,0]
v_pk_add_f32 v[246:247], v[246:247], 1.0 op_sel_hi:[1,0]
v_pk_add_f32 v[248:249], v[248:249], 1.0 op_sel_hi:[1,0]
v_pk_add_f32 v[250:251], v[250:251], 1.0 op_sel_hi:[1,0]
v_pk_add_f32 v[252:253], v[252:253], 1.0 op_sel_hi:[1,0]
v_pk_add_f32 v[254:255], v[254:255], 1.0 op_sel_hi:[1,0]
v_rcp_f32 v240, v240
v_rcp_f32 v241, v241
v_rcp_f32 v242, v242
v_rcp_f32 v243, v243
v_rcp_f32 v244, v244
v_rcp_f32 v245, v245
v_rcp_f32 v246, v246
v_rcp_f32 v247, v247
v_rcp_f32 v248, v248
v_rcp_f32 v249, v249
v_rcp_f32 v250, v250
v_rcp_f32 v251, v251
v_rcp_f32 v252, v252
v_rcp_f32 v253, v253
v_rcp_f32 v254, v254
v_rcp_f32 v255, v255
v_pk_mul_f32 v[80:81], v[80:81], v[240:241]
v_pk_mul_f32 v[82:83], v[82:83], v[242:243]
v_pk_mul_f32 v[84:85], v[84:85], v[244:245]
v_pk_mul_f32 v[86:87], v[86:87], v[246:247]
v_pk_mul_f32 v[88:89], v[88:89], v[248:249]
v_pk_mul_f32 v[90:91], v[90:91], v[250:251]
v_pk_mul_f32 v[92:93], v[92:93], v[252:253]
v_pk_mul_f32 v[94:95], v[94:95], v[254:255]
v_cvt_pk_bf16_f32 v28, v80, v81
v_cvt_pk_bf16_f32 v29, v82, v83
v_cvt_pk_bf16_f32 v30, v84, v85
v_cvt_pk_bf16_f32 v31, v86, v87
v_cvt_pk_bf16_f32 v84, v88, v89
v_cvt_pk_bf16_f32 v85, v90, v91
v_cvt_pk_bf16_f32 v86, v92, v93
v_cvt_pk_bf16_f32 v87, v94, v95
buffer_store_dwordx4 v[28:31], v45, s[32:35], s80 offen sc1
buffer_store_dwordx4 v[84:87], v45, s[32:35], s80 offen offset:1024 sc1
v_accvgpr_read_b32 v208, a32
v_accvgpr_read_b32 v209, a33
v_accvgpr_read_b32 v210, a34
v_accvgpr_read_b32 v211, a35
v_accvgpr_read_b32 v212, a36
v_accvgpr_read_b32 v213, a37
v_accvgpr_read_b32 v214, a38
v_accvgpr_read_b32 v215, a39
v_accvgpr_read_b32 v216, a40
v_accvgpr_read_b32 v217, a41
v_accvgpr_read_b32 v218, a42
v_accvgpr_read_b32 v219, a43
v_accvgpr_read_b32 v220, a44
v_accvgpr_read_b32 v221, a45
v_accvgpr_read_b32 v222, a46
v_accvgpr_read_b32 v223, a47
v_pk_mul_f32 v[240:241], v[96:97], s[46:47]
v_pk_mul_f32 v[242:243], v[98:99], s[46:47]
v_pk_mul_f32 v[244:245], v[100:101], s[46:47]
v_pk_mul_f32 v[246:247], v[102:103], s[46:47]
v_pk_mul_f32 v[248:249], v[104:105], s[46:47]
v_pk_mul_f32 v[250:251], v[106:107], s[46:47]
v_pk_mul_f32 v[252:253], v[108:109], s[46:47]
v_pk_mul_f32 v[254:255], v[110:111], s[46:47]
v_exp_f32 v240, v240
v_exp_f32 v241, v241
v_exp_f32 v242, v242
v_exp_f32 v243, v243
v_exp_f32 v244, v244
v_exp_f32 v245, v245
v_exp_f32 v246, v246
v_exp_f32 v247, v247
v_exp_f32 v248, v248
v_exp_f32 v249, v249
v_exp_f32 v250, v250
v_exp_f32 v251, v251
v_exp_f32 v252, v252
v_exp_f32 v253, v253
v_exp_f32 v254, v254
v_exp_f32 v255, v255
v_pk_mul_f32 v[96:97], v[96:97], v[208:209]
v_pk_mul_f32 v[98:99], v[98:99], v[210:211]
v_pk_mul_f32 v[100:101], v[100:101], v[212:213]
v_pk_mul_f32 v[102:103], v[102:103], v[214:215]
v_pk_mul_f32 v[104:105], v[104:105], v[216:217]
v_pk_mul_f32 v[106:107], v[106:107], v[218:219]
v_pk_mul_f32 v[108:109], v[108:109], v[220:221]
v_pk_mul_f32 v[110:111], v[110:111], v[222:223]
v_pk_add_f32 v[240:241], v[240:241], 1.0 op_sel_hi:[1,0]
v_pk_add_f32 v[242:243], v[242:243], 1.0 op_sel_hi:[1,0]
v_pk_add_f32 v[244:245], v[244:245], 1.0 op_sel_hi:[1,0]
v_pk_add_f32 v[246:247], v[246:247], 1.0 op_sel_hi:[1,0]
v_pk_add_f32 v[248:249], v[248:249], 1.0 op_sel_hi:[1,0]
v_pk_add_f32 v[250:251], v[250:251], 1.0 op_sel_hi:[1,0]
v_pk_add_f32 v[252:253], v[252:253], 1.0 op_sel_hi:[1,0]
v_pk_add_f32 v[254:255], v[254:255], 1.0 op_sel_hi:[1,0]
v_rcp_f32 v240, v240
v_rcp_f32 v241, v241
v_rcp_f32 v242, v242
v_rcp_f32 v243, v243
v_rcp_f32 v244, v244
v_rcp_f32 v245, v245
v_rcp_f32 v246, v246
v_rcp_f32 v247, v247
v_rcp_f32 v248, v248
v_rcp_f32 v249, v249
v_rcp_f32 v250, v250
v_rcp_f32 v251, v251
v_rcp_f32 v252, v252
v_rcp_f32 v253, v253
v_rcp_f32 v254, v254
v_rcp_f32 v255, v255
v_pk_mul_f32 v[96:97], v[96:97], v[240:241]
v_pk_mul_f32 v[98:99], v[98:99], v[242:243]
v_pk_mul_f32 v[100:101], v[100:101], v[244:245]
v_pk_mul_f32 v[102:103], v[102:103], v[246:247]
v_pk_mul_f32 v[104:105], v[104:105], v[248:249]
v_pk_mul_f32 v[106:107], v[106:107], v[250:251]
v_pk_mul_f32 v[108:109], v[108:109], v[252:253]
v_pk_mul_f32 v[110:111], v[110:111], v[254:255]
v_cvt_pk_bf16_f32 v96, v96, v97
v_cvt_pk_bf16_f32 v97, v98, v99
v_cvt_pk_bf16_f32 v98, v100, v101
v_cvt_pk_bf16_f32 v99, v102, v103
v_cvt_pk_bf16_f32 v100, v104, v105
v_cvt_pk_bf16_f32 v101, v106, v107
v_cvt_pk_bf16_f32 v102, v108, v109
v_cvt_pk_bf16_f32 v103, v110, v111
buffer_store_dwordx4 v[96:99], v46, s[32:35], s80 offen sc1
buffer_store_dwordx4 v[100:103], v46, s[32:35], s80 offen offset:1024 sc1
v_accvgpr_read_b32 v224, a48
v_accvgpr_read_b32 v225, a49
v_accvgpr_read_b32 v226, a50
v_accvgpr_read_b32 v227, a51
v_accvgpr_read_b32 v228, a52
v_accvgpr_read_b32 v229, a53
v_accvgpr_read_b32 v230, a54
v_accvgpr_read_b32 v231, a55
v_accvgpr_read_b32 v232, a56
v_accvgpr_read_b32 v233, a57
v_accvgpr_read_b32 v234, a58
v_accvgpr_read_b32 v235, a59
v_accvgpr_read_b32 v236, a60
v_accvgpr_read_b32 v237, a61
v_accvgpr_read_b32 v238, a62
v_accvgpr_read_b32 v239, a63
v_pk_mul_f32 v[240:241], v[112:113], s[46:47]
v_pk_mul_f32 v[242:243], v[114:115], s[46:47]
v_pk_mul_f32 v[244:245], v[116:117], s[46:47]
v_pk_mul_f32 v[246:247], v[118:119], s[46:47]
v_pk_mul_f32 v[248:249], v[120:121], s[46:47]
v_pk_mul_f32 v[250:251], v[122:123], s[46:47]
v_pk_mul_f32 v[252:253], v[124:125], s[46:47]
v_pk_mul_f32 v[254:255], v[126:127], s[46:47]
v_exp_f32 v240, v240
v_exp_f32 v241, v241
v_exp_f32 v242, v242
v_exp_f32 v243, v243
v_exp_f32 v244, v244
v_exp_f32 v245, v245
v_exp_f32 v246, v246
v_exp_f32 v247, v247
v_exp_f32 v248, v248
v_exp_f32 v249, v249
v_exp_f32 v250, v250
v_exp_f32 v251, v251
v_exp_f32 v252, v252
v_exp_f32 v253, v253
v_exp_f32 v254, v254
v_exp_f32 v255, v255
v_pk_mul_f32 v[112:113], v[112:113], v[224:225]
v_pk_mul_f32 v[114:115], v[114:115], v[226:227]
v_pk_mul_f32 v[116:117], v[116:117], v[228:229]
v_pk_mul_f32 v[118:119], v[118:119], v[230:231]
v_pk_mul_f32 v[120:121], v[120:121], v[232:233]
v_pk_mul_f32 v[122:123], v[122:123], v[234:235]
v_pk_mul_f32 v[124:125], v[124:125], v[236:237]
v_pk_mul_f32 v[126:127], v[126:127], v[238:239]
v_pk_add_f32 v[240:241], v[240:241], 1.0 op_sel_hi:[1,0]
v_pk_add_f32 v[242:243], v[242:243], 1.0 op_sel_hi:[1,0]
v_pk_add_f32 v[244:245], v[244:245], 1.0 op_sel_hi:[1,0]
v_pk_add_f32 v[246:247], v[246:247], 1.0 op_sel_hi:[1,0]
v_pk_add_f32 v[248:249], v[248:249], 1.0 op_sel_hi:[1,0]
v_pk_add_f32 v[250:251], v[250:251], 1.0 op_sel_hi:[1,0]
v_pk_add_f32 v[252:253], v[252:253], 1.0 op_sel_hi:[1,0]
v_pk_add_f32 v[254:255], v[254:255], 1.0 op_sel_hi:[1,0]
v_rcp_f32 v240, v240
v_rcp_f32 v241, v241
v_rcp_f32 v242, v242
v_rcp_f32 v243, v243
v_rcp_f32 v244, v244
v_rcp_f32 v245, v245
v_rcp_f32 v246, v246
v_rcp_f32 v247, v247
v_rcp_f32 v248, v248
v_rcp_f32 v249, v249
v_rcp_f32 v250, v250
v_rcp_f32 v251, v251
v_rcp_f32 v252, v252
v_rcp_f32 v253, v253
v_rcp_f32 v254, v254
v_rcp_f32 v255, v255
v_pk_mul_f32 v[112:113], v[112:113], v[240:241]
v_pk_mul_f32 v[114:115], v[114:115], v[242:243]
v_pk_mul_f32 v[116:117], v[116:117], v[244:245]
v_pk_mul_f32 v[118:119], v[118:119], v[246:247]
v_pk_mul_f32 v[120:121], v[120:121], v[248:249]
v_pk_mul_f32 v[122:123], v[122:123], v[250:251]
v_pk_mul_f32 v[124:125], v[124:125], v[252:253]
v_pk_mul_f32 v[126:127], v[126:127], v[254:255]
v_cvt_pk_bf16_f32 v112, v112, v113
v_cvt_pk_bf16_f32 v113, v114, v115
v_cvt_pk_bf16_f32 v114, v116, v117
v_cvt_pk_bf16_f32 v115, v118, v119
v_cvt_pk_bf16_f32 v116, v120, v121
v_cvt_pk_bf16_f32 v117, v122, v123
v_cvt_pk_bf16_f32 v118, v124, v125
v_cvt_pk_bf16_f32 v119, v126, v127
buffer_store_dwordx4 v[112:115], v47, s[32:35], s80 offen sc1
buffer_store_dwordx4 v[116:119], v47, s[32:35], s80 offen offset:1024 sc1
s_branch L_join
L_end:
s_endpgm
L_fallback:
s_cmp_lg_u32 s51, 0
s_cbranch_scc1 L_nofb
s_mov_b32 s51, 1
s_mov_b32 s48, 0
s_mov_b32 s34, 0
v_accvgpr_write_b32 a128, 0
v_accvgpr_write_b32 a129, 0
v_accvgpr_write_b32 a130, 0
v_accvgpr_write_b32 a131, 0
v_accvgpr_write_b32 a132, 0
v_accvgpr_write_b32 a133, 0
v_accvgpr_write_b32 a134, 0
v_accvgpr_write_b32 a135, 0
v_accvgpr_write_b32 a136, 0
v_accvgpr_write_b32 a137, 0
v_accvgpr_write_b32 a138, 0
v_accvgpr_write_b32 a139, 0
v_accvgpr_write_b32 a140, 0
v_accvgpr_write_b32 a141, 0
v_accvgpr_write_b32 a142, 0
v_accvgpr_write_b32 a143, 0
v_mov_b32 v52, 0xff800000
v_mov_b32 v53, 0xff800000
v_mov_b32 v54, 0xff800000
v_mov_b32 v55, 0xff800000
L_fb_loop:
s_waitcnt vmcnt(0) lgkmcnt(0)
s_barrier
s_add_u32 m0, s40, 0
s_nop 0
buffer_load_dwordx4 v16, s[8:11], s48 offen lds
buffer_load_dwordx4 v17, s[8:11], s48 offen offset:1024 lds
buffer_load_dwordx4 v18, s[8:11], s48 offen offset:2048 lds
buffer_load_dwordx4 v19, s[8:11], s48 offen offset:3072 lds
s_waitcnt vmcnt(0)
s_barrier
ds_read_b128 a[144:147], v4 offset:0
ds_read_b128 a[148:151], v5 offset:0
ds_read_b128 a[152:155], v6 offset:0
ds_read_b128 a[156:159], v7 offset:0
s_waitcnt lgkmcnt(0)
v_mfma_f32_16x16x32_bf16 v[192:195], a[144:147], v[128:131], 0
v_mfma_f32_16x16x32_bf16 v[192:195], a[148:151], v[132:135], v[192:195]
v_mfma_f32_16x16x32_bf16 v[192:195], a[152:155], v[136:139], v[192:195]
v_mfma_f32_16x16x32_bf16 v[192:195], a[156:159], v[140:143], v[192:195]
v_mfma_f32_16x16x32_bf16 v[196:199], a[144:147], v[144:147], 0
v_mfma_f32_16x16x32_bf16 v[196:199], a[148:151], v[148:151], v[196:199]
v_mfma_f32_16x16x32_bf16 v[196:199], a[152:155], v[152:155], v[196:199]
v_mfma_f32_16x16x32_bf16 v[196:199], a[156:159], v[156:159], v[196:199]
v_mfma_f32_16x16x32_bf16 v[200:203], a[144:147], v[160:163], 0
v_mfma_f32_16x16x32_bf16 v[200:203], a[148:151], v[164:167], v[200:203]
v_mfma_f32_16x16x32_bf16 v[200:203], a[152:155], v[168:171], v[200:203]
v_mfma_f32_16x16x32_bf16 v[200:203], a[156:159], v[172:175], v[200:203]
v_mfma_f32_16x16x32_bf16 v[204:207], a[144:147], v[176:179], 0
v_mfma_f32_16x16x32_bf16 v[204:207], a[148:151], v[180:183], v[204:207]
v_mfma_f32_16x16x32_bf16 v[204:207], a[152:155], v[184:187], v[204:207]
v_mfma_f32_16x16x32_bf16 v[204:207], a[156:159], v[188:191], v[204:207]
s_nop 7
v_max3_f32 v52, v52, v192, v193
v_max3_f32 v52, v52, v194, v195
v_max3_f32 v53, v53, v196, v197
v_max3_f32 v53, v53, v198, v199
v_max3_f32 v54, v54, v200, v201
v_max3_f32 v54, v54, v202, v203
v_max3_f32 v55, v55, v204, v205
v_max3_f32 v55, v55, v206, v207
ds_read_b128 a[144:147], v4 offset:4096
ds_read_b128 a[148:151], v5 offset:4096
ds_read_b128 a[152:155], v6 offset:4096
ds_read_b128 a[156:159], v7 offset:4096
s_waitcnt lgkmcnt(0)
v_mfma_f32_16x16x32_bf16 v[192:195], a[144:147], v[128:131], 0
v_mfma_f32_16x16x32_bf16 v[192:195], a[148:151], v[132:135], v[192:195]
v_mfma_f32_16x16x32_bf16 v[192:195], a[152:155], v[136:139], v[192:195]
v_mfma_f32_16x16x32_bf16 v[192:195], a[156:159], v[140:143], v[192:195]
v_mfma_f32_16x16x32_bf16 v[196:199], a[144:147], v[144:147], 0
v_mfma_f32_16x16x32_bf16 v[196:199], a[148:151], v[148:151], v[196:199]
v_mfma_f32_16x16x32_bf16 v[196:199], a[152:155], v[152:155], v[196:199]
v_mfma_f32_16x16x32_bf16 v[196:199], a[156:159], v[156:159], v[196:199]
v_mfma_f32_16x16x32_bf16 v[200:203], a[144:147], v[160:163], 0
v_mfma_f32_16x16x32_bf16 v[200:203], a[148:151], v[164:167], v[200:203]
v_mfma_f32_16x16x32_bf16 v[200:203], a[152:155], v[168:171], v[200:203]
v_mfma_f32_16x16x32_bf16 v[200:203], a[156:159], v[172:175], v[200:203]
v_mfma_f32_16x16x32_bf16 v[204:207], a[144:147], v[176:179], 0
v_mfma_f32_16x16x32_bf16 v[204:207], a[148:151], v[180:183], v[204:207]
v_mfma_f32_16x16x32_bf16 v[204:207], a[152:155], v[184:187], v[204:207]
v_mfma_f32_16x16x32_bf16 v[204:207], a[156:159], v[188:191], v[204:207]
s_nop 7
v_max3_f32 v52, v52, v192, v193
v_max3_f32 v52, v52, v194, v195
v_max3_f32 v53, v53, v196, v197
v_max3_f32 v53, v53, v198, v199
v_max3_f32 v54, v54, v200, v201
v_max3_f32 v54, v54, v202, v203
v_max3_f32 v55, v55, v204, v205
v_max3_f32 v55, v55, v206, v207
ds_read_b128 a[144:147], v4 offset:8192
ds_read_b128 a[148:151], v5 offset:8192
ds_read_b128 a[152:155], v6 offset:8192
ds_read_b128 a[156:159], v7 offset:8192
s_waitcnt lgkmcnt(0)
v_mfma_f32_16x16x32_bf16 v[192:195], a[144:147], v[128:131], 0
v_mfma_f32_16x16x32_bf16 v[192:195], a[148:151], v[132:135], v[192:195]
v_mfma_f32_16x16x32_bf16 v[192:195], a[152:155], v[136:139], v[192:195]
v_mfma_f32_16x16x32_bf16 v[192:195], a[156:159], v[140:143], v[192:195]
v_mfma_f32_16x16x32_bf16 v[196:199], a[144:147], v[144:147], 0
v_mfma_f32_16x16x32_bf16 v[196:199], a[148:151], v[148:151], v[196:199]
v_mfma_f32_16x16x32_bf16 v[196:199], a[152:155], v[152:155], v[196:199]
v_mfma_f32_16x16x32_bf16 v[196:199], a[156:159], v[156:159], v[196:199]
v_mfma_f32_16x16x32_bf16 v[200:203], a[144:147], v[160:163], 0
v_mfma_f32_16x16x32_bf16 v[200:203], a[148:151], v[164:167], v[200:203]
v_mfma_f32_16x16x32_bf16 v[200:203], a[152:155], v[168:171], v[200:203]
v_mfma_f32_16x16x32_bf16 v[200:203], a[156:159], v[172:175], v[200:203]
v_mfma_f32_16x16x32_bf16 v[204:207], a[144:147], v[176:179], 0
v_mfma_f32_16x16x32_bf16 v[204:207], a[148:151], v[180:183], v[204:207]
v_mfma_f32_16x16x32_bf16 v[204:207], a[152:155], v[184:187], v[204:207]
v_mfma_f32_16x16x32_bf16 v[204:207], a[156:159], v[188:191], v[204:207]
s_nop 7
v_max3_f32 v52, v52, v192, v193
v_max3_f32 v52, v52, v194, v195
v_max3_f32 v53, v53, v196, v197
v_max3_f32 v53, v53, v198, v199
v_max3_f32 v54, v54, v200, v201
v_max3_f32 v54, v54, v202, v203
v_max3_f32 v55, v55, v204, v205
v_max3_f32 v55, v55, v206, v207
ds_read_b128 a[144:147], v4 offset:12288
ds_read_b128 a[148:151], v5 offset:12288
ds_read_b128 a[152:155], v6 offset:12288
ds_read_b128 a[156:159], v7 offset:12288
s_waitcnt lgkmcnt(0)
v_mfma_f32_16x16x32_bf16 v[192:195], a[144:147], v[128:131], 0
v_mfma_f32_16x16x32_bf16 v[192:195], a[148:151], v[132:135], v[192:195]
v_mfma_f32_16x16x32_bf16 v[192:195], a[152:155], v[136:139], v[192:195]
v_mfma_f32_16x16x32_bf16 v[192:195], a[156:159], v[140:143], v[192:195]
v_mfma_f32_16x16x32_bf16 v[196:199], a[144:147], v[144:147], 0
v_mfma_f32_16x16x32_bf16 v[196:199], a[148:151], v[148:151], v[196:199]
v_mfma_f32_16x16x32_bf16 v[196:199], a[152:155], v[152:155], v[196:199]
v_mfma_f32_16x16x32_bf16 v[196:199], a[156:159], v[156:159], v[196:199]
v_mfma_f32_16x16x32_bf16 v[200:203], a[144:147], v[160:163], 0
v_mfma_f32_16x16x32_bf16 v[200:203], a[148:151], v[164:167], v[200:203]
v_mfma_f32_16x16x32_bf16 v[200:203], a[152:155], v[168:171], v[200:203]
v_mfma_f32_16x16x32_bf16 v[200:203], a[156:159], v[172:175], v[200:203]
v_mfma_f32_16x16x32_bf16 v[204:207], a[144:147], v[176:179], 0
v_mfma_f32_16x16x32_bf16 v[204:207], a[148:151], v[180:183], v[204:207]
v_mfma_f32_16x16x32_bf16 v[204:207], a[152:155], v[184:187], v[204:207]
v_mfma_f32_16x16x32_bf16 v[204:207], a[156:159], v[188:191], v[204:207]
s_nop 7
v_max3_f32 v52, v52, v192, v193
v_max3_f32 v52, v52, v194, v195
v_max3_f32 v53, v53, v196, v197
v_max3_f32 v53, v53, v198, v199
v_max3_f32 v54, v54, v200, v201
v_max3_f32 v54, v54, v202, v203
v_max3_f32 v55, v55, v204, v205
v_max3_f32 v55, v55, v206, v207
s_add_u32 s48, s48, 16384
s_cmp_lt_u32 s48, 524288
s_cbranch_scc1 L_fb_loop
s_barrier
s_add_u32 m0, s40, 0
s_movk_i32 s48, 16384
buffer_load_dwordx4 v16, s[8:11], 0 offen lds
buffer_load_dwordx4 v17, s[8:11], 0 offen offset:1024 lds
buffer_load_dwordx4 v18, s[8:11], 0 offen offset:2048 lds
buffer_load_dwordx4 v19, s[8:11], 0 offen offset:3072 lds
s_add_u32 m0, s40, 16384
s_movk_i32 s49, 0
buffer_load_dwordx4 v16, s[8:11], s48 offen lds
buffer_load_dwordx4 v17, s[8:11], s48 offen offset:1024 lds
buffer_load_dwordx4 v18, s[8:11], s48 offen offset:2048 lds
buffer_load_dwordx4 v19, s[8:11], s48 offen offset:3072 lds
s_add_u32 m0, s42, 16384
s_nop 0
buffer_load_dwordx4 v20, s[12:15], 0 offen lds
buffer_load_dwordx4 v21, s[12:15], 0 offen offset:1024 lds
buffer_load_dwordx4 v20, s[12:15], 0 offen offset:2048 lds
buffer_load_dwordx4 v21, s[12:15], 0 offen offset:3072 lds
s_add_u32 m0, s40, 32768
s_add_u32 s48, s48, 16384
buffer_load_dwordx4 v16, s[8:11], s48 offen lds
buffer_load_dwordx4 v17, s[8:11], s48 offen offset:1024 lds
buffer_load_dwordx4 v18, s[8:11], s48 offen offset:2048 lds
buffer_load_dwordx4 v19, s[8:11], s48 offen offset:3072 lds
s_add_u32 m0, s42, 32768
s_add_u32 s49, s49, 16384
buffer_load_dwordx4 v20, s[12:15], s49 offen lds
buffer_load_dwordx4 v21, s[12:15], s49 offen offset:1024 lds
buffer_load_dwordx4 v20, s[12:15], s49 offen offset:2048 lds
buffer_load_dwordx4 v21, s[12:15], s49 offen offset:3072 lds
s_waitcnt vmcnt(0)
s_barrier
ds_read_b128 a[144:147], v4
ds_read_b128 a[148:151], v5
ds_read_b128 a[152:155], v6
ds_read_b128 a[156:159], v7
s_waitcnt lgkmcnt(0)
s_branch L_attn
.section .rodata,"a"
.p2align 6
.amdhsa_kernel recurrent_scan__mha_block_cached__glu_gated_swiglu__prompt_kernel
  .amdhsa_next_free_vgpr 512
  .amdhsa_next_free_sgpr 102
  .amdhsa_accum_offset 256
  .amdhsa_group_segment_fixed_size 0
  .amdhsa_kernarg_size 96
  .amdhsa_user_sgpr_count 2
  .amdhsa_user_sgpr_kernarg_segment_ptr 1
  .amdhsa_system_sgpr_workgroup_id_x 1
.end_amdhsa_kernel
```
